```python
import torch

def _softmax(x, axis=-1):
    return torch.softmax(x, dim=axis)
def _gelu(x):
    return torch.nn.functional.gelu(x, approximate="tanh")
def _silu(x):
    return torch.nn.functional.silu(x)
def _sigmoid(x):
    return torch.sigmoid(x)
def _layernorm(x, axis=-1, eps=1e-5):
    m = x.mean(dim=axis, keepdim=True)
    v = x.var(dim=axis, keepdim=True, unbiased=False)
    return (x - m) / torch.sqrt(v + eps)
def _scatter_add(tgt, idx, src, axis=0):
    return tgt.clone().index_add_(axis, idx, src)
def _segment_sum(src, seg, n):
    out = torch.zeros((n,) + src.shape[1:], dtype=src.dtype)
    return out.index_add_(0, seg, src)
def _pad(x, pw):
    flat = tuple(v for pair in reversed(pw) for v in pair)
    return torch.nn.functional.pad(x, flat)

kernel_name = 'interleave_layers__gqa_block_cached__glu_gated_bilinear__decode'

def setup_inputs():

    _w = (lambda a: (lambda t: t.to(torch.bfloat16) if t.is_floating_point() else t)(torch.as_tensor(a)))
    def _A_setup():
        B, Sq, D = 1, 1, 512
        Hq, Hkv, Sk, Dh = 32, 32, 32768, 128
        assert Hq % Hkv == 0, (Hq, Hkv)
        return {
            "x": _w((lambda *s: torch.randn(*s, dtype=torch.bfloat16) * 0.1)(B, Sq, D)),
            "k_cache": _w((lambda *s: torch.randn(*s, dtype=torch.bfloat16) * 0.8)(B, Hkv, Sk, Dh)),
            "v_cache": _w((lambda *s: torch.randn(*s, dtype=torch.bfloat16) * 3.2)(B, Hkv, Sk, Dh)),
            "wq": _w((lambda *s: torch.randn(*s, dtype=torch.bfloat16) * 0.8)(D, Hq * Dh) * (D ** -0.5)),
            "wo": _w((lambda *s: torch.randn(*s, dtype=torch.bfloat16) * 3.2)(Hq * Dh, D) * ((Hq * Dh) ** -0.5)),
        }
    _A_in = _A_setup()

    def _B_setup():
        B, S, D, F = 1, 1, 512, 1376
        return {
            "x": _w((lambda *s: torch.randn(*s, dtype=torch.bfloat16) * 0.1)(B, S, D)),
            "w_gate": _w((lambda *s: torch.randn(*s, dtype=torch.bfloat16) * 0.8)(D, F) * (D ** -0.5)),
            "w_up": _w((lambda *s: torch.randn(*s, dtype=torch.bfloat16) * 0.8)(D, F) * (D ** -0.5)),
            "w_down": _w((lambda *s: torch.randn(*s, dtype=torch.bfloat16) * 0.8)(F, D) * (F ** -0.5)),
        }
    _B_in = _B_setup()

    return {
        "A_x": _A_in["x"],
        "A_k_cache": _A_in["k_cache"],
        "A_v_cache": _A_in["v_cache"],
        "A_wq": _A_in["wq"],
        "A_wo": _A_in["wo"],
        "B_x": _B_in["x"],
        "B_w_gate": _B_in["w_gate"],
        "B_w_up": _B_in["w_up"],
        "B_w_down": _B_in["w_down"],
    }

def reference(A_x, A_k_cache, A_v_cache, A_wq, A_wo, B_x, B_w_gate, B_w_up, B_w_down):
    def _A_ref(x, k_cache, v_cache, wq, wo):
        B, Sq, D = x.shape
        Hq, Dh = 32, 128
        Hkv = k_cache.shape[1]
        rep = Hq // Hkv
        q = (lambda x, *d: x.permute(*d))((x @ wq).reshape(B, Sq, Hq, Dh), 0, 2, 1, 3)
        k = (lambda x, n, axis: torch.repeat_interleave(x, n, dim=axis))(k_cache, rep, axis=1)
        v = (lambda x, n, axis: torch.repeat_interleave(x, n, dim=axis))(v_cache, rep, axis=1)
        scores = torch.einsum("bhqd,bhkd->bhqk", q, k) * (Dh ** -0.5)
        p = _softmax(scores, axis=-1)
        o = torch.einsum("bhqk,bhkd->bhqd", p, v)
        return (lambda x, *d: x.permute(*d))(o, 0, 2, 1, 3).reshape(B, Sq, Hq * Dh) @ wo

    def _B_ref(x, w_gate, w_up, w_down):
        g = torch.einsum("bsd,df->bsf", x, w_gate)
        u = torch.einsum("bsd,df->bsf", x, w_up)
        h = g * u
        return torch.einsum("bsf,fd->bsd", h, w_down)

    x = A_x
    x = x + _A_ref(_layernorm(x, axis=-1), A_k_cache, A_v_cache, A_wq, A_wo)
    x = x + _B_ref(_layernorm(x, axis=-1), B_w_gate, B_w_up, B_w_down)
    x = x + _A_ref(_layernorm(x, axis=-1), A_k_cache, A_v_cache, A_wq, A_wo)
    x = x + _B_ref(_layernorm(x, axis=-1), B_w_gate, B_w_up, B_w_down)
    return x
```

```asm
; @launch grid=(256,1,1) block=(256,1,1) lds=163840
.amdgcn_target "amdgcn-amd-amdhsa--gfx950"
.text
.globl interleave_layers__gqa_block_cached__glu_gated_bilinear__decode_kernel
.p2align 8
.type interleave_layers__gqa_block_cached__glu_gated_bilinear__decode_kernel,@function
interleave_layers__gqa_block_cached__glu_gated_bilinear__decode_kernel:
    s_cmp_ge_u32 s2, 256
    s_cbranch_scc1 L_end
    s_load_dwordx16 s[4:19], s[0:1], 0
    s_load_dwordx8 s[20:27], s[0:1], 64
    v_lshrrev_b32 v1, 6, v0
    v_and_b32 v32, 63, v0
    v_readfirstlane_b32 s3, v1
    v_lshrrev_b32 v33, 4, v32
    v_and_b32 v34, 15, v32
    v_lshrrev_b32 v35, 1, v34
    v_lshlrev_b32 v1, 8, v35
    v_and_b32 v35, 1, v34
    v_lshl_add_u32 v1, v35, 6, v1
    v_lshl_add_u32 v1, v33, 4, v1
    v_lshlrev_b32 v2, 9, v33
    v_lshl_add_u32 v2, v34, 4, v2
    s_and_b32 s65, s2, 7
    s_lshr_b32 s66, s2, 3
    s_lshl_b32 s64, s65, 5
    s_add_u32 s64, s64, s66
    s_lshr_b32 s67, s64, 3
    s_lshl_b32 s67, s67, 23
    s_and_b32 s92, s64, 7
    s_lshl_b32 s92, s92, 14
    s_add_u32 s67, s67, s92
    s_lshl_b32 s92, s3, 12
    s_add_u32 s67, s67, s92
    s_lshr_b32 s92, s64, 3
    s_and_b32 s92, s92, 31
    s_mul_i32 s92, s92, 2
    s_and_b32 s92, s92, 63
    s_lshl_b32 s92, s92, 17
    s_add_u32 s67, s67, s92
    s_mov_b32 s30, 0x10000000
    s_mov_b32 s31, 0x20000
    s_mov_b32 s34, 0x10000000
    s_mov_b32 s35, 0x20000
    s_waitcnt lgkmcnt(0)
    s_mov_b32 s28, s6
    s_and_b32 s29, s7, 0xffff
    s_mov_b32 s32, s8
    s_and_b32 s33, s9, 0xffff
    s_add_u32 s68, s67, 0
    s_xor_b32 s78, s68, s67
    s_and_b32 s78, s78, 0xff800000
    s_xor_b32 s68, s68, s78
    s_add_u32 s79, s67, 131072
    s_xor_b32 s78, s79, s67
    s_and_b32 s78, s78, 0xff800000
    s_xor_b32 s79, s79, s78
    buffer_load_dwordx4 v[48:51], v1, s[28:31], s68 offen offset:0 nt
    buffer_load_dwordx4 v[52:55], v1, s[28:31], s68 offen offset:128 nt
    buffer_load_dwordx4 v[56:59], v1, s[28:31], s68 offen offset:2048 nt
    buffer_load_dwordx4 v[60:63], v1, s[28:31], s68 offen offset:2176 nt
    buffer_load_dwordx4 v[80:83], v1, s[28:31], s79 offen offset:0
    buffer_load_dwordx4 v[84:87], v1, s[28:31], s79 offen offset:128
    s_waitcnt vmcnt(5)
    buffer_load_dwordx4 v[88:91], v1, s[28:31], s79 offen offset:2048
    s_waitcnt vmcnt(5)
    buffer_load_dwordx4 v[92:95], v1, s[28:31], s79 offen offset:2176
    v_lshlrev_b32 v35, 2, v0
    v_lshlrev_b32 v36, 4, v32
    global_load_dword v15, v35, s[4:5]
    global_load_dwordx4 v[40:43], v36, s[4:5]
    s_mov_b32 s36, s26
    s_and_b32 s37, s27, 0xffff
    s_mov_b32 s38, 0x40000000
    s_mov_b32 s39, 0x20000
    s_mov_b32 s40, s10
    s_and_b32 s41, s11, 0xffff
    s_mov_b32 s42, 0x400000
    s_mov_b32 s43, 0x20000
    s_mov_b32 s44, s12
    s_and_b32 s45, s13, 0xffff
    s_mov_b32 s46, 0x400000
    s_mov_b32 s47, 0x20000
    s_mov_b32 s48, s16
    s_and_b32 s49, s17, 0xffff
    s_mov_b32 s50, 0x158000
    s_mov_b32 s51, 0x20000
    s_mov_b32 s52, s18
    s_and_b32 s53, s19, 0xffff
    s_mov_b32 s54, 0x158000
    s_mov_b32 s55, 0x20000
    s_mov_b32 s56, s20
    s_and_b32 s57, s21, 0xffff
    s_mov_b32 s58, 0x158000
    s_mov_b32 s59, 0x20000
    s_mov_b64 s[60:61], s[22:23]
    s_mov_b64 s[62:63], s[24:25]
    s_lshr_b32 s82, s64, 3
    v_lshlrev_b32 v14, 15, v33
    v_lshl_add_u32 v14, v34, 4, v14
    s_mul_i32 s92, s3, 39936
    s_add_u32 s92, s92, 4096
    v_add_u32 v3, s92, v36
    s_lshl_b32 s94, s3, 20
    s_lshl_b32 s93, s82, 8
    s_add_u32 s94, s94, s93
    s_or_b32 s92, s64, s3
    s_cmp_lg_u32 s92, 0
    s_cbranch_scc1 L_ntl_1
    v_lshlrev_b32 v44, 7, v0
    s_mov_b32 s92, 524288
    buffer_load_dword v28, v44, s[36:39], s92 offen sc1
    s_mov_b32 s92, 532480
    buffer_load_dword v29, v44, s[36:39], s92 offen sc1
    s_mov_b32 s92, 540672
    buffer_load_dword v30, v44, s[36:39], s92 offen sc1
    s_mov_b32 s92, 548864
    buffer_load_dword v31, v44, s[36:39], s92 offen sc1
L_ntl_1:
    s_add_u32 s93, s66, 0
    s_and_b32 s93, s93, 7
    s_lshl_b32 s93, s93, 17
    s_add_u32 s93, s93, s94
    s_add_u32 s93, s93, 0
    buffer_load_dwordx4 a[192:195], v14, s[40:43], s93 offen
    s_add_u32 s93, s66, 0
    s_and_b32 s93, s93, 7
    s_lshl_b32 s93, s93, 17
    s_add_u32 s93, s93, s94
    s_add_u32 s93, s93, 8192
    buffer_load_dwordx4 a[196:199], v14, s[40:43], s93 offen
    s_add_u32 s93, s66, 0
    s_and_b32 s93, s93, 7
    s_lshl_b32 s93, s93, 17
    s_add_u32 s93, s93, s94
    s_add_u32 s93, s93, 16384
    buffer_load_dwordx4 a[200:203], v14, s[40:43], s93 offen
    s_add_u32 s93, s66, 0
    s_and_b32 s93, s93, 7
    s_lshl_b32 s93, s93, 17
    s_add_u32 s93, s93, s94
    s_add_u32 s93, s93, 24576
    buffer_load_dwordx4 a[204:207], v14, s[40:43], s93 offen
    s_add_u32 s68, s67, 262144
    s_xor_b32 s78, s68, s67
    s_and_b32 s78, s78, 0xff800000
    s_xor_b32 s68, s68, s78
    s_waitcnt vmcnt(10)
    buffer_load_dwordx4 v[112:115], v1, s[28:31], s68 offen offset:0 nt
    s_waitcnt vmcnt(10)
    buffer_load_dwordx4 v[116:119], v1, s[28:31], s68 offen offset:128 nt
    s_add_u32 s93, s66, 1
    s_and_b32 s93, s93, 7
    s_lshl_b32 s93, s93, 17
    s_add_u32 s93, s93, s94
    s_add_u32 s93, s93, 0
    buffer_load_dwordx4 a[208:211], v14, s[40:43], s93 offen
    s_waitcnt vmcnt(11)
    buffer_load_dwordx4 v[120:123], v1, s[28:31], s68 offen offset:2048 nt
    s_waitcnt vmcnt(11)
    buffer_load_dwordx4 v[124:127], v1, s[28:31], s68 offen offset:2176 nt
    s_add_u32 s93, s66, 1
    s_and_b32 s93, s93, 7
    s_lshl_b32 s93, s93, 17
    s_add_u32 s93, s93, s94
    s_add_u32 s93, s93, 8192
    buffer_load_dwordx4 a[212:215], v14, s[40:43], s93 offen
    s_add_u32 s79, s67, 393216
    s_xor_b32 s78, s79, s67
    s_and_b32 s78, s78, 0xff800000
    s_xor_b32 s79, s79, s78
    s_waitcnt vmcnt(13)
    buffer_load_dwordx4 v[64:67], v1, s[28:31], s79 offen offset:0
    s_waitcnt vmcnt(13)
    buffer_load_dwordx4 v[68:71], v1, s[28:31], s79 offen offset:128
    s_add_u32 s93, s66, 1
    s_and_b32 s93, s93, 7
    s_lshl_b32 s93, s93, 17
    s_add_u32 s93, s93, s94
    s_add_u32 s93, s93, 16384
    buffer_load_dwordx4 a[216:219], v14, s[40:43], s93 offen
    s_waitcnt vmcnt(8)
    buffer_load_dwordx4 v[72:75], v1, s[28:31], s79 offen offset:2048
    s_waitcnt vmcnt(8)
    buffer_load_dwordx4 v[76:79], v1, s[28:31], s79 offen offset:2176
    s_add_u32 s93, s66, 1
    s_and_b32 s93, s93, 7
    s_lshl_b32 s93, s93, 17
    s_add_u32 s93, s93, s94
    s_add_u32 s93, s93, 24576
    buffer_load_dwordx4 a[220:223], v14, s[40:43], s93 offen
    s_mov_b32 s69, 0x3e0293ee
    s_mov_b32 s70, 0x05040100
    s_mov_b32 s71, 0x07060302
    s_mov_b32 s83, 0x3f803f80
    s_mov_b32 s72, 0
    s_mul_i32 s74, s65, 43
    s_add_u32 s75, s74, 43
    s_lshr_b32 s74, s74, 2
    s_lshr_b32 s75, s75, 2
    s_sub_u32 s75, s75, s74
    s_lshl_b32 s75, s75, 1
    s_lshl_b32 s92, s75, 2
    s_sub_u32 s92, s92, 64
    s_lshl_b32 s92, 1, s92
    s_sub_u32 s92, s92, 1
    s_bitcmp0_b32 s3, 0
    s_cselect_b32 s80, -1, s92
    s_cselect_b32 s81, -1, 0
    s_getreg_b32 s96, hwreg(HW_REG_XCC_ID)
    s_and_b32 s96, s96, 15
    s_mov_b32 s98, 0x55555555
    s_mov_b32 s99, 0x55555555
    v_and_b32 v35, 2, v34
    v_cmp_eq_u32 vcc, 2, v35
    v_mov_b32 v36, 0xffff
    v_mov_b32 v37, 0xffff0000
    v_cndmask_b32 v36, v36, v37, vcc
    v_and_b32 v35, 13, v34
    v_cmp_eq_u32 vcc, 0, v35
    s_nop 1
    v_cndmask_b32 v4, 0, v36, vcc
    v_cmp_eq_u32 vcc, 4, v35
    s_nop 1
    v_cndmask_b32 v5, 0, v36, vcc
    v_cmp_eq_u32 vcc, 8, v35
    s_nop 1
    v_cndmask_b32 v6, 0, v36, vcc
    v_cmp_eq_u32 vcc, 12, v35
    s_nop 1
    v_cndmask_b32 v7, 0, v36, vcc
    v_mov_b32 v8, 0
    v_mov_b32 v9, 0
    v_mov_b32 v10, 0
    v_mov_b32 v11, 0
    v_mov_b32 v36, -1
    v_mov_b32 v37, -1
    v_lshlrev_b32 v38, 3, v32
    v_lshlrev_b32 v39, 2, v32
    s_and_b32 s95, s3, 1
    s_mul_i32 s95, s95, 262144
    s_cmp_ge_u32 s3, 2
    s_cbranch_scc1 L_clhi_2
    s_lshl_b32 s92, s64, 9
    s_add_u32 s92, s92, s95
    buffer_store_dwordx2 v[36:37], v38, s[36:39], s92 offen sc1
    s_mov_b64 exec, 1
    s_lshl_b32 s92, s64, 3
    s_add_u32 s92, s92, s95
    s_add_u32 s92, s92, 131072
    buffer_store_dwordx2 v[36:37], v38, s[36:39], s92 offen sc1
    s_mov_b32 exec_lo, 0xff
    s_mov_b32 exec_hi, 0x0
    s_lshl_b32 s92, s64, 5
    s_add_u32 s92, s92, s95
    s_add_u32 s92, s92, 188416
    buffer_store_dword v36, v39, s[36:39], s92 offen sc1
    s_branch L_cle_3
L_clhi_2:
    s_mov_b32 exec_lo, 0xffff
    s_mov_b32 exec_hi, 0x0
    s_lshl_b32 s92, s64, 6
    s_add_u32 s92, s92, s95
    s_add_u32 s92, s92, 135168
    buffer_store_dword v36, v39, s[36:39], s92 offen sc1
    s_lshl_b32 s92, s64, 6
    s_add_u32 s92, s92, s95
    s_add_u32 s92, s92, 155648
    buffer_store_dword v36, v39, s[36:39], s92 offen sc1
    s_cmp_ge_u32 s66, s75
    s_cbranch_scc1 L_cle_3
    s_lshr_b32 s92, s66, 1
    s_add_u32 s92, s92, s74
    s_lshl_b32 s92, s92, 6
    s_bitcmp1_b32 s66, 0
    s_cselect_b32 s93, 5632, 0
    s_add_u32 s92, s92, s93
    s_add_u32 s92, s92, 176128
    s_add_u32 s92, s92, s95
    buffer_store_dword v36, v39, s[36:39], s92 offen sc1
L_cle_3:
    s_mov_b64 exec, -1
    s_or_b32 s92, s66, s3
    s_cmp_lg_u32 s92, 0
    s_cbranch_scc1 L_clp_4
    s_lshl_b32 s92, s65, 8
    s_add_u32 s92, s92, 589824
    buffer_store_dword v36, v39, s[36:39], s92 offen sc1
L_clp_4:
    s_waitcnt vmcnt(16)
    v_dot2_f32_bf16 v32, v40, s83, 0
    v_dot2_f32_bf16 v33, v40, v40, 0
    v_dot2_f32_bf16 v32, v41, s83, v32
    v_dot2_f32_bf16 v33, v41, v41, v33
    v_dot2_f32_bf16 v32, v42, s83, v32
    v_dot2_f32_bf16 v33, v42, v42, v33
    v_dot2_f32_bf16 v32, v43, s83, v32
    v_dot2_f32_bf16 v33, v43, v43, v33
    s_nop 1
    v_add_f32_dpp v32, v32, v32 row_ror:8 row_mask:0xf bank_mask:0xf
    v_add_f32_dpp v33, v33, v33 row_ror:8 row_mask:0xf bank_mask:0xf
    s_nop 0
    v_add_f32_dpp v32, v32, v32 row_ror:4 row_mask:0xf bank_mask:0xf
    v_add_f32_dpp v33, v33, v33 row_ror:4 row_mask:0xf bank_mask:0xf
    s_nop 0
    v_add_f32_dpp v32, v32, v32 row_ror:2 row_mask:0xf bank_mask:0xf
    v_add_f32_dpp v33, v33, v33 row_ror:2 row_mask:0xf bank_mask:0xf
    s_nop 0
    v_add_f32_dpp v32, v32, v32 row_ror:1 row_mask:0xf bank_mask:0xf
    v_add_f32_dpp v33, v33, v33 row_ror:1 row_mask:0xf bank_mask:0xf
    v_mov_b32 v34, v32
    s_nop 1
    v_permlane32_swap_b32 v32, v34
    v_add_f32 v32, v32, v34
    v_mov_b32 v34, v32
    s_nop 1
    v_permlane16_swap_b32 v32, v34
    v_add_f32 v32, v32, v34
    v_mov_b32 v34, v33
    s_nop 1
    v_permlane32_swap_b32 v33, v34
    v_add_f32 v33, v33, v34
    v_mov_b32 v34, v33
    s_nop 1
    v_permlane16_swap_b32 v33, v34
    v_add_f32 v33, v33, v34
    v_mul_f32 v32, 0x3b000000, v32
    v_mul_f32 v33, 0x3b000000, v33
    v_fma_f32 v33, -v32, v32, v33
    v_max_f32 v33, 0, v33
    v_cvt_pk_bf16_f32 v34, v32, v33
    v_and_b32 v33, 0xffff0000, v34
    v_lshlrev_b32 v32, 16, v34
    v_add_f32 v33, 0x3727c5ac, v33
    v_cvt_pk_bf16_f32 v33, v33, v33
    v_and_b32 v33, 0xffff0000, v33
    v_sqrt_f32 v33, v33
    s_nop 0
    v_cvt_pk_bf16_f32 v33, v33, v33
    v_and_b32 v33, 0xffff0000, v33
    v_rcp_f32 v33, v33
    v_lshlrev_b32 v36, 16, v40
    v_and_b32 v37, 0xffff0000, v40
    v_sub_f32 v36, v36, v32
    v_sub_f32 v37, v37, v32
    v_cvt_pk_bf16_f32 v38, v36, v37
    v_lshlrev_b32 v36, 16, v38
    v_and_b32 v37, 0xffff0000, v38
    v_mul_f32 v36, v36, v33
    v_mul_f32 v37, v37, v33
    v_cvt_pk_bf16_f32 v44, v36, v37
    v_lshlrev_b32 v36, 16, v41
    v_and_b32 v37, 0xffff0000, v41
    v_sub_f32 v36, v36, v32
    v_sub_f32 v37, v37, v32
    v_cvt_pk_bf16_f32 v38, v36, v37
    v_lshlrev_b32 v36, 16, v38
    v_and_b32 v37, 0xffff0000, v38
    v_mul_f32 v36, v36, v33
    v_mul_f32 v37, v37, v33
    v_cvt_pk_bf16_f32 v45, v36, v37
    v_lshlrev_b32 v36, 16, v42
    v_and_b32 v37, 0xffff0000, v42
    v_sub_f32 v36, v36, v32
    v_sub_f32 v37, v37, v32
    v_cvt_pk_bf16_f32 v38, v36, v37
    v_lshlrev_b32 v36, 16, v38
    v_and_b32 v37, 0xffff0000, v38
    v_mul_f32 v36, v36, v33
    v_mul_f32 v37, v37, v33
    v_cvt_pk_bf16_f32 v46, v36, v37
    v_lshlrev_b32 v36, 16, v43
    v_and_b32 v37, 0xffff0000, v43
    v_sub_f32 v36, v36, v32
    v_sub_f32 v37, v37, v32
    v_cvt_pk_bf16_f32 v38, v36, v37
    v_lshlrev_b32 v36, 16, v38
    v_and_b32 v37, 0xffff0000, v38
    v_mul_f32 v36, v36, v33
    v_mul_f32 v37, v37, v33
    v_cvt_pk_bf16_f32 v47, v36, v37
    ds_write_b128 v3, v[44:47]
    v_lshrrev_b32 v34, 4, v0
    v_and_b32 v34, 3, v34
    s_mul_i32 s92, s3, 40192
    s_add_u32 s92, s92, 4096
    v_lshl_add_u32 v13, v34, 3, s92
    v_mov_b32 v16, 0
    v_and_b32 v20, s83, v4
    s_nop 1
    v_mov_b32_dpp v16, v20 quad_perm:[1,0,3,2] row_mask:0xf bank_mask:0xf
    v_mov_b32 v17, 0
    v_and_b32 v21, s83, v5
    s_nop 1
    v_mov_b32_dpp v17, v21 quad_perm:[1,0,3,2] row_mask:0xf bank_mask:0xf
    v_mov_b32 v18, 0
    v_and_b32 v22, s83, v6
    s_nop 1
    v_mov_b32_dpp v18, v22 quad_perm:[1,0,3,2] row_mask:0xf bank_mask:0xf
    v_mov_b32 v19, 0
    v_and_b32 v23, s83, v7
    s_nop 1
    v_mov_b32_dpp v19, v23 quad_perm:[1,0,3,2] row_mask:0xf bank_mask:0xf
    s_mov_b32 s84, 0x01000100
    s_mov_b32 s85, 0x03020302
    s_waitcnt lgkmcnt(0)
    s_add_u32 s95, s66, 0
    s_and_b32 s95, s95, 7
    s_lshl_b32 s95, s95, 5
    v_add_u32 v26, s95, v13
    ds_read_b64 v[24:25], v26
    s_waitcnt lgkmcnt(0)
    v_perm_b32 v32, v24, v24, s84
    v_perm_b32 v33, v24, v24, s85
    v_perm_b32 v34, v25, v25, s84
    v_perm_b32 v35, v25, v25, s85
    v_and_or_b32 v36, v32, v4, v16
    v_and_or_b32 v37, v32, v5, v17
    v_and_or_b32 v38, v32, v6, v18
    v_and_or_b32 v39, v32, v7, v19
    v_and_or_b32 v40, v33, v4, v16
    v_and_or_b32 v41, v33, v5, v17
    v_and_or_b32 v42, v33, v6, v18
    v_and_or_b32 v43, v33, v7, v19
    s_waitcnt vmcnt(12)
    v_mfma_f32_16x16x32_bf16 v[8:11], v[36:39], a[192:195], v[8:11]
    v_and_or_b32 v36, v34, v4, v16
    v_and_or_b32 v37, v34, v5, v17
    v_and_or_b32 v38, v34, v6, v18
    v_and_or_b32 v39, v34, v7, v19
    v_mfma_f32_16x16x32_bf16 v[8:11], v[40:43], a[196:199], v[8:11]
    v_and_or_b32 v40, v35, v4, v16
    v_and_or_b32 v41, v35, v5, v17
    v_and_or_b32 v42, v35, v6, v18
    v_and_or_b32 v43, v35, v7, v19
    v_mfma_f32_16x16x32_bf16 v[8:11], v[36:39], a[200:203], v[8:11]
    s_nop 0
    v_mfma_f32_16x16x32_bf16 v[8:11], v[40:43], a[204:207], v[8:11]
    s_or_b32 s92, s64, s3
    s_cmp_lg_u32 s92, 0
    s_cbranch_scc1 L_notag_5
    v_mov_b32 v40, 0
    v_mov_b32 v41, 0
    v_mov_b32 v42, 0
    v_mov_b32 v43, 0
    v_lshlrev_b32 v33, 5, v0
    ds_write_b128 v33, v[40:43] offset:8192
    ds_write_b128 v33, v[40:43] offset:8208
    v_mov_b32 v34, 1
    s_waitcnt lgkmcnt(0)
    v_and_b32 v36, 0x1ff, v28
    v_lshlrev_b32 v36, 2, v36
    ds_write_b32 v36, v34 offset:8192
    v_and_b32 v37, 0x1ff, v29
    v_lshlrev_b32 v37, 2, v37
    ds_write_b32 v37, v34 offset:8192
    v_and_b32 v38, 0x1ff, v30
    v_lshlrev_b32 v38, 2, v38
    ds_write_b32 v38, v34 offset:8192
    v_and_b32 v39, 0x1ff, v31
    v_lshlrev_b32 v39, 2, v39
    ds_write_b32 v39, v34 offset:8192
    s_waitcnt lgkmcnt(0)
    ds_read_b128 v[40:43], v33 offset:8192
    ds_read_b128 v[44:47], v33 offset:8208
    v_mov_b32 v34, -1
    v_lshlrev_b32 v35, 3, v0
    s_waitcnt lgkmcnt(0)
    v_add_u32 v36, 0, v35
    v_cmp_eq_u32 vcc, 0, v40
    s_nop 1
    v_cndmask_b32 v34, v34, v36, vcc
    v_add_u32 v36, 1, v35
    v_cmp_eq_u32 vcc, 0, v41
    s_nop 1
    v_cndmask_b32 v34, v34, v36, vcc
    v_add_u32 v36, 2, v35
    v_cmp_eq_u32 vcc, 0, v42
    s_nop 1
    v_cndmask_b32 v34, v34, v36, vcc
    v_add_u32 v36, 3, v35
    v_cmp_eq_u32 vcc, 0, v43
    s_nop 1
    v_cndmask_b32 v34, v34, v36, vcc
    v_add_u32 v36, 4, v35
    v_cmp_eq_u32 vcc, 0, v44
    s_nop 1
    v_cndmask_b32 v34, v34, v36, vcc
    v_add_u32 v36, 5, v35
    v_cmp_eq_u32 vcc, 0, v45
    s_nop 1
    v_cndmask_b32 v34, v34, v36, vcc
    v_add_u32 v36, 6, v35
    v_cmp_eq_u32 vcc, 0, v46
    s_nop 1
    v_cndmask_b32 v34, v34, v36, vcc
    v_add_u32 v36, 7, v35
    v_cmp_eq_u32 vcc, 0, v47
    s_nop 1
    v_cndmask_b32 v34, v34, v36, vcc
    v_cmp_ne_u32 vcc, -1, v34
    s_nop 1
    s_ff1_i32_b64 s92, vcc
    s_nop 3
    v_readlane_b32 s93, v34, s92
    s_nop 1
    s_or_b32 s93, s93, 0x200
    v_mov_b32 v34, s93
    v_mov_b32 v35, 0
    s_mov_b64 exec, 1
    global_store_dword v35, v34, s[62:63] sc1
    s_mov_b64 exec, -1
L_notag_5:
    s_add_u32 s68, s67, 524288
    s_xor_b32 s78, s68, s67
    s_and_b32 s78, s78, 0xff800000
    s_xor_b32 s68, s68, s78
    s_waitcnt vmcnt(7)
    buffer_load_dwordx4 v[96:99], v1, s[28:31], s68 offen offset:0 nt
    s_waitcnt vmcnt(6)
    buffer_load_dwordx4 v[100:103], v1, s[28:31], s68 offen offset:128 nt
    s_add_u32 s93, s66, 2
    s_and_b32 s93, s93, 7
    s_lshl_b32 s93, s93, 17
    s_add_u32 s93, s93, s94
    s_add_u32 s93, s93, 0
    buffer_load_dwordx4 a[224:227], v14, s[40:43], s93 offen
    s_waitcnt vmcnt(7)
    buffer_load_dwordx4 v[104:107], v1, s[28:31], s68 offen offset:2048 nt
    s_waitcnt vmcnt(6)
    buffer_load_dwordx4 v[108:111], v1, s[28:31], s68 offen offset:2176 nt
    s_add_u32 s93, s66, 2
    s_and_b32 s93, s93, 7
    s_lshl_b32 s93, s93, 17
    s_add_u32 s93, s93, s94
    s_add_u32 s93, s93, 8192
    buffer_load_dwordx4 a[228:231], v14, s[40:43], s93 offen
    s_add_u32 s79, s67, 655360
    s_xor_b32 s78, s79, s67
    s_and_b32 s78, s78, 0xff800000
    s_xor_b32 s79, s79, s78
    s_waitcnt vmcnt(8)
    buffer_load_dwordx4 v[128:131], v1, s[28:31], s79 offen offset:0
    s_waitcnt vmcnt(8)
    buffer_load_dwordx4 v[132:135], v1, s[28:31], s79 offen offset:128
    s_add_u32 s93, s66, 2
    s_and_b32 s93, s93, 7
    s_lshl_b32 s93, s93, 17
    s_add_u32 s93, s93, s94
    s_add_u32 s93, s93, 16384
    buffer_load_dwordx4 a[232:235], v14, s[40:43], s93 offen
    s_waitcnt vmcnt(8)
    buffer_load_dwordx4 v[136:139], v1, s[28:31], s79 offen offset:2048
    s_waitcnt vmcnt(8)
    buffer_load_dwordx4 v[140:143], v1, s[28:31], s79 offen offset:2176
    s_add_u32 s93, s66, 2
    s_and_b32 s93, s93, 7
    s_lshl_b32 s93, s93, 17
    s_add_u32 s93, s93, s94
    s_add_u32 s93, s93, 24576
    buffer_load_dwordx4 a[236:239], v14, s[40:43], s93 offen
    s_add_u32 s95, s66, 1
    s_and_b32 s95, s95, 7
    s_lshl_b32 s95, s95, 5
    v_add_u32 v26, s95, v13
    ds_read_b64 v[24:25], v26
    s_waitcnt lgkmcnt(0)
    v_perm_b32 v32, v24, v24, s84
    v_perm_b32 v33, v24, v24, s85
    v_perm_b32 v34, v25, v25, s84
    v_perm_b32 v35, v25, v25, s85
    v_and_or_b32 v36, v32, v4, v16
    v_and_or_b32 v37, v32, v5, v17
    v_and_or_b32 v38, v32, v6, v18
    v_and_or_b32 v39, v32, v7, v19
    v_and_or_b32 v40, v33, v4, v16
    v_and_or_b32 v41, v33, v5, v17
    v_and_or_b32 v42, v33, v6, v18
    v_and_or_b32 v43, v33, v7, v19
    s_waitcnt vmcnt(12)
    v_mfma_f32_16x16x32_bf16 v[8:11], v[36:39], a[208:211], v[8:11]
    v_and_or_b32 v36, v34, v4, v16
    v_and_or_b32 v37, v34, v5, v17
    v_and_or_b32 v38, v34, v6, v18
    v_and_or_b32 v39, v34, v7, v19
    v_mfma_f32_16x16x32_bf16 v[8:11], v[40:43], a[212:215], v[8:11]
    v_and_or_b32 v40, v35, v4, v16
    v_and_or_b32 v41, v35, v5, v17
    v_and_or_b32 v42, v35, v6, v18
    v_and_or_b32 v43, v35, v7, v19
    v_mfma_f32_16x16x32_bf16 v[8:11], v[36:39], a[216:219], v[8:11]
    s_nop 0
    v_mfma_f32_16x16x32_bf16 v[8:11], v[40:43], a[220:223], v[8:11]
    s_add_u32 s68, s67, 786432
    s_xor_b32 s78, s68, s67
    s_and_b32 s78, s78, 0xff800000
    s_xor_b32 s68, s68, s78
    s_waitcnt vmcnt(7)
    buffer_load_dwordx4 v[144:147], v1, s[28:31], s68 offen offset:0 nt
    s_waitcnt vmcnt(6)
    buffer_load_dwordx4 v[148:151], v1, s[28:31], s68 offen offset:128 nt
    s_add_u32 s93, s66, 3
    s_and_b32 s93, s93, 7
    s_lshl_b32 s93, s93, 17
    s_add_u32 s93, s93, s94
    s_add_u32 s93, s93, 0
    buffer_load_dwordx4 a[240:243], v14, s[40:43], s93 offen
    s_waitcnt vmcnt(7)
    buffer_load_dwordx4 v[152:155], v1, s[28:31], s68 offen offset:2048 nt
    s_waitcnt vmcnt(6)
    buffer_load_dwordx4 v[156:159], v1, s[28:31], s68 offen offset:2176 nt
    s_add_u32 s93, s66, 3
    s_and_b32 s93, s93, 7
    s_lshl_b32 s93, s93, 17
    s_add_u32 s93, s93, s94
    s_add_u32 s93, s93, 8192
    buffer_load_dwordx4 a[244:247], v14, s[40:43], s93 offen
    s_add_u32 s79, s67, 917504
    s_xor_b32 s78, s79, s67
    s_and_b32 s78, s78, 0xff800000
    s_xor_b32 s79, s79, s78
    s_waitcnt vmcnt(8)
    buffer_load_dwordx4 v[160:163], v1, s[28:31], s79 offen offset:0
    s_waitcnt vmcnt(8)
    buffer_load_dwordx4 v[164:167], v1, s[28:31], s79 offen offset:128
    s_add_u32 s93, s66, 3
    s_and_b32 s93, s93, 7
    s_lshl_b32 s93, s93, 17
    s_add_u32 s93, s93, s94
    s_add_u32 s93, s93, 16384
    buffer_load_dwordx4 a[248:251], v14, s[40:43], s93 offen
    s_waitcnt vmcnt(8)
    buffer_load_dwordx4 v[168:171], v1, s[28:31], s79 offen offset:2048
    s_waitcnt vmcnt(8)
    buffer_load_dwordx4 v[172:175], v1, s[28:31], s79 offen offset:2176
    s_add_u32 s93, s66, 3
    s_and_b32 s93, s93, 7
    s_lshl_b32 s93, s93, 17
    s_add_u32 s93, s93, s94
    s_add_u32 s93, s93, 24576
    buffer_load_dwordx4 a[252:255], v14, s[40:43], s93 offen
    s_add_u32 s95, s66, 2
    s_and_b32 s95, s95, 7
    s_lshl_b32 s95, s95, 5
    v_add_u32 v26, s95, v13
    ds_read_b64 v[24:25], v26
    s_waitcnt lgkmcnt(0)
    v_perm_b32 v32, v24, v24, s84
    v_perm_b32 v33, v24, v24, s85
    v_perm_b32 v34, v25, v25, s84
    v_perm_b32 v35, v25, v25, s85
    v_and_or_b32 v36, v32, v4, v16
    v_and_or_b32 v37, v32, v5, v17
    v_and_or_b32 v38, v32, v6, v18
    v_and_or_b32 v39, v32, v7, v19
    v_and_or_b32 v40, v33, v4, v16
    v_and_or_b32 v41, v33, v5, v17
    v_and_or_b32 v42, v33, v6, v18
    v_and_or_b32 v43, v33, v7, v19
    s_waitcnt vmcnt(12)
    v_mfma_f32_16x16x32_bf16 v[8:11], v[36:39], a[224:227], v[8:11]
    v_and_or_b32 v36, v34, v4, v16
    v_and_or_b32 v37, v34, v5, v17
    v_and_or_b32 v38, v34, v6, v18
    v_and_or_b32 v39, v34, v7, v19
    v_mfma_f32_16x16x32_bf16 v[8:11], v[40:43], a[228:231], v[8:11]
    v_and_or_b32 v40, v35, v4, v16
    v_and_or_b32 v41, v35, v5, v17
    v_and_or_b32 v42, v35, v6, v18
    v_and_or_b32 v43, v35, v7, v19
    v_mfma_f32_16x16x32_bf16 v[8:11], v[36:39], a[232:235], v[8:11]
    s_nop 0
    v_mfma_f32_16x16x32_bf16 v[8:11], v[40:43], a[236:239], v[8:11]
    s_add_u32 s68, s67, 1048576
    s_xor_b32 s78, s68, s67
    s_and_b32 s78, s78, 0xff800000
    s_xor_b32 s68, s68, s78
    s_waitcnt vmcnt(7)
    buffer_load_dwordx4 v[176:179], v1, s[28:31], s68 offen offset:0 nt
    s_waitcnt vmcnt(6)
    buffer_load_dwordx4 v[180:183], v1, s[28:31], s68 offen offset:128 nt
    s_add_u32 s93, s66, 4
    s_and_b32 s93, s93, 7
    s_lshl_b32 s93, s93, 17
    s_add_u32 s93, s93, s94
    s_add_u32 s93, s93, 0
    buffer_load_dwordx4 a[192:195], v14, s[40:43], s93 offen
    s_waitcnt vmcnt(7)
    buffer_load_dwordx4 v[184:187], v1, s[28:31], s68 offen offset:2048 nt
    s_waitcnt vmcnt(6)
    buffer_load_dwordx4 v[188:191], v1, s[28:31], s68 offen offset:2176 nt
    s_add_u32 s93, s66, 4
    s_and_b32 s93, s93, 7
    s_lshl_b32 s93, s93, 17
    s_add_u32 s93, s93, s94
    s_add_u32 s93, s93, 8192
    buffer_load_dwordx4 a[196:199], v14, s[40:43], s93 offen
    s_add_u32 s79, s67, 1179648
    s_xor_b32 s78, s79, s67
    s_and_b32 s78, s78, 0xff800000
    s_xor_b32 s79, s79, s78
    s_waitcnt vmcnt(8)
    buffer_load_dwordx4 v[192:195], v1, s[28:31], s79 offen offset:0
    s_waitcnt vmcnt(8)
    buffer_load_dwordx4 v[196:199], v1, s[28:31], s79 offen offset:128
    s_add_u32 s93, s66, 4
    s_and_b32 s93, s93, 7
    s_lshl_b32 s93, s93, 17
    s_add_u32 s93, s93, s94
    s_add_u32 s93, s93, 16384
    buffer_load_dwordx4 a[200:203], v14, s[40:43], s93 offen
    s_waitcnt vmcnt(8)
    buffer_load_dwordx4 v[200:203], v1, s[28:31], s79 offen offset:2048
    s_waitcnt vmcnt(8)
    buffer_load_dwordx4 v[204:207], v1, s[28:31], s79 offen offset:2176
    s_add_u32 s93, s66, 4
    s_and_b32 s93, s93, 7
    s_lshl_b32 s93, s93, 17
    s_add_u32 s93, s93, s94
    s_add_u32 s93, s93, 24576
    buffer_load_dwordx4 a[204:207], v14, s[40:43], s93 offen
    s_add_u32 s95, s66, 3
    s_and_b32 s95, s95, 7
    s_lshl_b32 s95, s95, 5
    v_add_u32 v26, s95, v13
    ds_read_b64 v[24:25], v26
    s_waitcnt lgkmcnt(0)
    v_perm_b32 v32, v24, v24, s84
    v_perm_b32 v33, v24, v24, s85
    v_perm_b32 v34, v25, v25, s84
    v_perm_b32 v35, v25, v25, s85
    v_and_or_b32 v36, v32, v4, v16
    v_and_or_b32 v37, v32, v5, v17
    v_and_or_b32 v38, v32, v6, v18
    v_and_or_b32 v39, v32, v7, v19
    v_and_or_b32 v40, v33, v4, v16
    v_and_or_b32 v41, v33, v5, v17
    v_and_or_b32 v42, v33, v6, v18
    v_and_or_b32 v43, v33, v7, v19
    s_waitcnt vmcnt(12)
    v_mfma_f32_16x16x32_bf16 v[8:11], v[36:39], a[240:243], v[8:11]
    v_and_or_b32 v36, v34, v4, v16
    v_and_or_b32 v37, v34, v5, v17
    v_and_or_b32 v38, v34, v6, v18
    v_and_or_b32 v39, v34, v7, v19
    v_mfma_f32_16x16x32_bf16 v[8:11], v[40:43], a[244:247], v[8:11]
    v_and_or_b32 v40, v35, v4, v16
    v_and_or_b32 v41, v35, v5, v17
    v_and_or_b32 v42, v35, v6, v18
    v_and_or_b32 v43, v35, v7, v19
    v_mfma_f32_16x16x32_bf16 v[8:11], v[36:39], a[248:251], v[8:11]
    s_nop 0
    v_mfma_f32_16x16x32_bf16 v[8:11], v[40:43], a[252:255], v[8:11]
    s_add_u32 s68, s67, 1310720
    s_xor_b32 s78, s68, s67
    s_and_b32 s78, s78, 0xff800000
    s_xor_b32 s68, s68, s78
    s_waitcnt vmcnt(7)
    buffer_load_dwordx4 v[208:211], v1, s[28:31], s68 offen offset:0 nt
    s_waitcnt vmcnt(6)
    buffer_load_dwordx4 v[212:215], v1, s[28:31], s68 offen offset:128 nt
    s_add_u32 s93, s66, 5
    s_and_b32 s93, s93, 7
    s_lshl_b32 s93, s93, 17
    s_add_u32 s93, s93, s94
    s_add_u32 s93, s93, 0
    buffer_load_dwordx4 a[208:211], v14, s[40:43], s93 offen
    s_waitcnt vmcnt(7)
    buffer_load_dwordx4 v[216:219], v1, s[28:31], s68 offen offset:2048 nt
    s_waitcnt vmcnt(6)
    buffer_load_dwordx4 v[220:223], v1, s[28:31], s68 offen offset:2176 nt
    s_add_u32 s93, s66, 5
    s_and_b32 s93, s93, 7
    s_lshl_b32 s93, s93, 17
    s_add_u32 s93, s93, s94
    s_add_u32 s93, s93, 8192
    buffer_load_dwordx4 a[212:215], v14, s[40:43], s93 offen
    s_add_u32 s79, s67, 1441792
    s_xor_b32 s78, s79, s67
    s_and_b32 s78, s78, 0xff800000
    s_xor_b32 s79, s79, s78
    s_waitcnt vmcnt(8)
    buffer_load_dwordx4 a[0:3], v1, s[28:31], s79 offen offset:0
    s_waitcnt vmcnt(8)
    buffer_load_dwordx4 a[4:7], v1, s[28:31], s79 offen offset:128
    s_add_u32 s93, s66, 5
    s_and_b32 s93, s93, 7
    s_lshl_b32 s93, s93, 17
    s_add_u32 s93, s93, s94
    s_add_u32 s93, s93, 16384
    buffer_load_dwordx4 a[216:219], v14, s[40:43], s93 offen
    s_waitcnt vmcnt(8)
    buffer_load_dwordx4 a[8:11], v1, s[28:31], s79 offen offset:2048
    s_waitcnt vmcnt(8)
    buffer_load_dwordx4 a[12:15], v1, s[28:31], s79 offen offset:2176
    s_add_u32 s93, s66, 5
    s_and_b32 s93, s93, 7
    s_lshl_b32 s93, s93, 17
    s_add_u32 s93, s93, s94
    s_add_u32 s93, s93, 24576
    buffer_load_dwordx4 a[220:223], v14, s[40:43], s93 offen
    s_add_u32 s95, s66, 4
    s_and_b32 s95, s95, 7
    s_lshl_b32 s95, s95, 5
    v_add_u32 v26, s95, v13
    ds_read_b64 v[24:25], v26
    s_waitcnt lgkmcnt(0)
    v_perm_b32 v32, v24, v24, s84
    v_perm_b32 v33, v24, v24, s85
    v_perm_b32 v34, v25, v25, s84
    v_perm_b32 v35, v25, v25, s85
    v_and_or_b32 v36, v32, v4, v16
    v_and_or_b32 v37, v32, v5, v17
    v_and_or_b32 v38, v32, v6, v18
    v_and_or_b32 v39, v32, v7, v19
    v_and_or_b32 v40, v33, v4, v16
    v_and_or_b32 v41, v33, v5, v17
    v_and_or_b32 v42, v33, v6, v18
    v_and_or_b32 v43, v33, v7, v19
    s_waitcnt vmcnt(12)
    v_mfma_f32_16x16x32_bf16 v[8:11], v[36:39], a[192:195], v[8:11]
    v_and_or_b32 v36, v34, v4, v16
    v_and_or_b32 v37, v34, v5, v17
    v_and_or_b32 v38, v34, v6, v18
    v_and_or_b32 v39, v34, v7, v19
    v_mfma_f32_16x16x32_bf16 v[8:11], v[40:43], a[196:199], v[8:11]
    v_and_or_b32 v40, v35, v4, v16
    v_and_or_b32 v41, v35, v5, v17
    v_and_or_b32 v42, v35, v6, v18
    v_and_or_b32 v43, v35, v7, v19
    v_mfma_f32_16x16x32_bf16 v[8:11], v[36:39], a[200:203], v[8:11]
    s_nop 0
    v_mfma_f32_16x16x32_bf16 v[8:11], v[40:43], a[204:207], v[8:11]
    s_add_u32 s68, s67, 1572864
    s_xor_b32 s78, s68, s67
    s_and_b32 s78, s78, 0xff800000
    s_xor_b32 s68, s68, s78
    s_waitcnt vmcnt(7)
    buffer_load_dwordx4 a[16:19], v1, s[28:31], s68 offen offset:0 nt
    s_waitcnt vmcnt(6)
    buffer_load_dwordx4 a[20:23], v1, s[28:31], s68 offen offset:128 nt
    s_add_u32 s93, s66, 6
    s_and_b32 s93, s93, 7
    s_lshl_b32 s93, s93, 17
    s_add_u32 s93, s93, s94
    s_add_u32 s93, s93, 0
    buffer_load_dwordx4 a[224:227], v14, s[40:43], s93 offen
    s_waitcnt vmcnt(7)
    buffer_load_dwordx4 a[24:27], v1, s[28:31], s68 offen offset:2048 nt
    s_waitcnt vmcnt(6)
    buffer_load_dwordx4 a[28:31], v1, s[28:31], s68 offen offset:2176 nt
    s_add_u32 s93, s66, 6
    s_and_b32 s93, s93, 7
    s_lshl_b32 s93, s93, 17
    s_add_u32 s93, s93, s94
    s_add_u32 s93, s93, 8192
    buffer_load_dwordx4 a[228:231], v14, s[40:43], s93 offen
    s_add_u32 s79, s67, 1703936
    s_xor_b32 s78, s79, s67
    s_and_b32 s78, s78, 0xff800000
    s_xor_b32 s79, s79, s78
    s_waitcnt vmcnt(7)
    buffer_load_dwordx4 a[32:35], v1, s[28:31], s79 offen offset:0 nt
    s_waitcnt vmcnt(6)
    buffer_load_dwordx4 a[36:39], v1, s[28:31], s79 offen offset:128 nt
    s_add_u32 s93, s66, 6
    s_and_b32 s93, s93, 7
    s_lshl_b32 s93, s93, 17
    s_add_u32 s93, s93, s94
    s_add_u32 s93, s93, 16384
    buffer_load_dwordx4 a[232:235], v14, s[40:43], s93 offen
    s_waitcnt vmcnt(7)
    buffer_load_dwordx4 a[40:43], v1, s[28:31], s79 offen offset:2048 nt
    s_waitcnt vmcnt(6)
    buffer_load_dwordx4 a[44:47], v1, s[28:31], s79 offen offset:2176 nt
    s_add_u32 s93, s66, 6
    s_and_b32 s93, s93, 7
    s_lshl_b32 s93, s93, 17
    s_add_u32 s93, s93, s94
    s_add_u32 s93, s93, 24576
    buffer_load_dwordx4 a[236:239], v14, s[40:43], s93 offen
    s_add_u32 s95, s66, 5
    s_and_b32 s95, s95, 7
    s_lshl_b32 s95, s95, 5
    v_add_u32 v26, s95, v13
    ds_read_b64 v[24:25], v26
    s_waitcnt lgkmcnt(0)
    v_perm_b32 v32, v24, v24, s84
    v_perm_b32 v33, v24, v24, s85
    v_perm_b32 v34, v25, v25, s84
    v_perm_b32 v35, v25, v25, s85
    v_and_or_b32 v36, v32, v4, v16
    v_and_or_b32 v37, v32, v5, v17
    v_and_or_b32 v38, v32, v6, v18
    v_and_or_b32 v39, v32, v7, v19
    v_and_or_b32 v40, v33, v4, v16
    v_and_or_b32 v41, v33, v5, v17
    v_and_or_b32 v42, v33, v6, v18
    v_and_or_b32 v43, v33, v7, v19
    s_waitcnt vmcnt(12)
    v_mfma_f32_16x16x32_bf16 v[8:11], v[36:39], a[208:211], v[8:11]
    v_and_or_b32 v36, v34, v4, v16
    v_and_or_b32 v37, v34, v5, v17
    v_and_or_b32 v38, v34, v6, v18
    v_and_or_b32 v39, v34, v7, v19
    v_mfma_f32_16x16x32_bf16 v[8:11], v[40:43], a[212:215], v[8:11]
    v_and_or_b32 v40, v35, v4, v16
    v_and_or_b32 v41, v35, v5, v17
    v_and_or_b32 v42, v35, v6, v18
    v_and_or_b32 v43, v35, v7, v19
    v_mfma_f32_16x16x32_bf16 v[8:11], v[36:39], a[216:219], v[8:11]
    s_nop 0
    v_mfma_f32_16x16x32_bf16 v[8:11], v[40:43], a[220:223], v[8:11]
    s_add_u32 s68, s67, 1835008
    s_xor_b32 s78, s68, s67
    s_and_b32 s78, s78, 0xff800000
    s_xor_b32 s68, s68, s78
    s_waitcnt vmcnt(8)
    buffer_load_dwordx4 a[48:51], v1, s[28:31], s68 offen offset:0
    s_waitcnt vmcnt(8)
    buffer_load_dwordx4 a[52:55], v1, s[28:31], s68 offen offset:128
    s_add_u32 s93, s66, 7
    s_and_b32 s93, s93, 7
    s_lshl_b32 s93, s93, 17
    s_add_u32 s93, s93, s94
    s_add_u32 s93, s93, 0
    buffer_load_dwordx4 a[240:243], v14, s[40:43], s93 offen
    s_waitcnt vmcnt(8)
    buffer_load_dwordx4 a[56:59], v1, s[28:31], s68 offen offset:2048
    s_waitcnt vmcnt(8)
    buffer_load_dwordx4 a[60:63], v1, s[28:31], s68 offen offset:2176
    s_add_u32 s93, s66, 7
    s_and_b32 s93, s93, 7
    s_lshl_b32 s93, s93, 17
    s_add_u32 s93, s93, s94
    s_add_u32 s93, s93, 8192
    buffer_load_dwordx4 a[244:247], v14, s[40:43], s93 offen
    s_add_u32 s79, s67, 1966080
    s_xor_b32 s78, s79, s67
    s_and_b32 s78, s78, 0xff800000
    s_xor_b32 s79, s79, s78
    s_waitcnt vmcnt(7)
    buffer_load_dwordx4 a[64:67], v1, s[28:31], s79 offen offset:0 nt
    s_waitcnt vmcnt(6)
    buffer_load_dwordx4 a[68:71], v1, s[28:31], s79 offen offset:128 nt
    s_add_u32 s93, s66, 7
    s_and_b32 s93, s93, 7
    s_lshl_b32 s93, s93, 17
    s_add_u32 s93, s93, s94
    s_add_u32 s93, s93, 16384
    buffer_load_dwordx4 a[248:251], v14, s[40:43], s93 offen
    s_waitcnt vmcnt(7)
    buffer_load_dwordx4 a[72:75], v1, s[28:31], s79 offen offset:2048 nt
    s_waitcnt vmcnt(6)
    buffer_load_dwordx4 a[76:79], v1, s[28:31], s79 offen offset:2176 nt
    s_add_u32 s93, s66, 7
    s_and_b32 s93, s93, 7
    s_lshl_b32 s93, s93, 17
    s_add_u32 s93, s93, s94
    s_add_u32 s93, s93, 24576
    buffer_load_dwordx4 a[252:255], v14, s[40:43], s93 offen
    s_add_u32 s95, s66, 6
    s_and_b32 s95, s95, 7
    s_lshl_b32 s95, s95, 5
    v_add_u32 v26, s95, v13
    ds_read_b64 v[24:25], v26
    s_waitcnt lgkmcnt(0)
    v_perm_b32 v32, v24, v24, s84
    v_perm_b32 v33, v24, v24, s85
    v_perm_b32 v34, v25, v25, s84
    v_perm_b32 v35, v25, v25, s85
    v_and_or_b32 v36, v32, v4, v16
    v_and_or_b32 v37, v32, v5, v17
    v_and_or_b32 v38, v32, v6, v18
    v_and_or_b32 v39, v32, v7, v19
    v_and_or_b32 v40, v33, v4, v16
    v_and_or_b32 v41, v33, v5, v17
    v_and_or_b32 v42, v33, v6, v18
    v_and_or_b32 v43, v33, v7, v19
    s_waitcnt vmcnt(12)
    v_mfma_f32_16x16x32_bf16 v[8:11], v[36:39], a[224:227], v[8:11]
    v_and_or_b32 v36, v34, v4, v16
    v_and_or_b32 v37, v34, v5, v17
    v_and_or_b32 v38, v34, v6, v18
    v_and_or_b32 v39, v34, v7, v19
    v_mfma_f32_16x16x32_bf16 v[8:11], v[40:43], a[228:231], v[8:11]
    v_and_or_b32 v40, v35, v4, v16
    v_and_or_b32 v41, v35, v5, v17
    v_and_or_b32 v42, v35, v6, v18
    v_and_or_b32 v43, v35, v7, v19
    v_mfma_f32_16x16x32_bf16 v[8:11], v[36:39], a[232:235], v[8:11]
    s_nop 0
    v_mfma_f32_16x16x32_bf16 v[8:11], v[40:43], a[236:239], v[8:11]
    s_add_u32 s68, s67, 2097152
    s_xor_b32 s78, s68, s67
    s_and_b32 s78, s78, 0xff800000
    s_xor_b32 s68, s68, s78
    s_waitcnt vmcnt(8)
    buffer_load_dwordx4 a[80:83], v1, s[28:31], s68 offen offset:0
    s_waitcnt vmcnt(8)
    buffer_load_dwordx4 a[84:87], v1, s[28:31], s68 offen offset:128
    s_waitcnt vmcnt(7)
    buffer_load_dwordx4 a[88:91], v1, s[28:31], s68 offen offset:2048
    s_waitcnt vmcnt(7)
    buffer_load_dwordx4 a[92:95], v1, s[28:31], s68 offen offset:2176
    s_add_u32 s79, s67, 2228224
    s_xor_b32 s78, s79, s67
    s_and_b32 s78, s78, 0xff800000
    s_xor_b32 s79, s79, s78
    s_waitcnt vmcnt(5)
    buffer_load_dwordx4 a[96:99], v1, s[28:31], s79 offen offset:0 nt
    s_waitcnt vmcnt(4)
    buffer_load_dwordx4 a[100:103], v1, s[28:31], s79 offen offset:128 nt
    s_waitcnt vmcnt(4)
    buffer_load_dwordx4 a[104:107], v1, s[28:31], s79 offen offset:2048 nt
    s_waitcnt vmcnt(4)
    buffer_load_dwordx4 a[108:111], v1, s[28:31], s79 offen offset:2176 nt
    s_add_u32 s95, s66, 7
    s_and_b32 s95, s95, 7
    s_lshl_b32 s95, s95, 5
    v_add_u32 v26, s95, v13
    ds_read_b64 v[24:25], v26
    s_waitcnt lgkmcnt(0)
    v_perm_b32 v32, v24, v24, s84
    v_perm_b32 v33, v24, v24, s85
    v_perm_b32 v34, v25, v25, s84
    v_perm_b32 v35, v25, v25, s85
    v_and_or_b32 v36, v32, v4, v16
    v_and_or_b32 v37, v32, v5, v17
    v_and_or_b32 v38, v32, v6, v18
    v_and_or_b32 v39, v32, v7, v19
    v_and_or_b32 v40, v33, v4, v16
    v_and_or_b32 v41, v33, v5, v17
    v_and_or_b32 v42, v33, v6, v18
    v_and_or_b32 v43, v33, v7, v19
    s_waitcnt vmcnt(8)
    v_mfma_f32_16x16x32_bf16 v[8:11], v[36:39], a[240:243], v[8:11]
    v_and_or_b32 v36, v34, v4, v16
    v_and_or_b32 v37, v34, v5, v17
    v_and_or_b32 v38, v34, v6, v18
    v_and_or_b32 v39, v34, v7, v19
    v_mfma_f32_16x16x32_bf16 v[8:11], v[40:43], a[244:247], v[8:11]
    v_and_or_b32 v40, v35, v4, v16
    v_and_or_b32 v41, v35, v5, v17
    v_and_or_b32 v42, v35, v6, v18
    v_and_or_b32 v43, v35, v7, v19
    v_mfma_f32_16x16x32_bf16 v[8:11], v[36:39], a[248:251], v[8:11]
    s_nop 0
    v_mfma_f32_16x16x32_bf16 v[8:11], v[40:43], a[252:255], v[8:11]
    s_nop 7
    v_mov_b32 v46, v9
    v_mov_b32 v47, v11
    v_and_b32 v44, 15, v0
    v_lshlrev_b32 v44, 5, v44
    v_and_b32 v45, 48, v0
    v_lshrrev_b32 v45, 1, v45
    v_lshrrev_b32 v42, 6, v0
    v_lshl_add_u32 v44, v42, 9, v44
    v_add_u32 v44, v44, v45
    v_mov_b32 v9, v10
    ds_write_b64 v44, v[8:9] offset:12288
    ds_write_b64 v44, v[46:47] offset:0
    v_and_b32 v43, 63, v0
    v_lshlrev_b32 v44, 3, v43
    s_waitcnt lgkmcnt(0)
    s_barrier
    ds_read_b64 v[32:33], v44 offset:12288
    ds_read_b64 v[34:35], v44 offset:12800
    ds_read_b64 v[36:37], v44 offset:13312
    ds_read_b64 v[38:39], v44 offset:13824
    s_and_b32 s92, s66, 7
    s_lshl_b32 s92, s92, 6
    v_and_b32 v40, 15, v0
    v_lshlrev_b32 v40, 2, v40
    v_lshl_add_u32 v41, v42, 9, v40
    v_add_u32 v41, s92, v41
    ds_read_b32 v41, v41 offset:0
    v_lshl_add_u32 v40, v42, 7, v40
    s_waitcnt lgkmcnt(0)
    ds_write_b32 v40, v41 offset:3264
    v_lshlrev_b32 v45, 2, v0
    v_and_b32 v46, 48, v43
    v_and_b32 v47, 1, v43
    v_lshl_add_u32 v46, v47, 6, v46
    v_lshl_add_u32 v46, v42, 8, v46
    s_waitcnt lgkmcnt(0)
    v_add_f32 v32, v32, v34
    v_add_f32 v33, v33, v35
    v_add_f32 v36, v36, v38
    v_add_f32 v37, v37, v39
    v_add_f32 v32, v32, v36
    v_add_f32 v33, v33, v37
    v_cvt_pk_bf16_f32 v32, v32, v33
    ds_write_b32 v45, v32 offset:14336
    s_waitcnt lgkmcnt(0)
    ds_read_b128 v[16:19], v46 offset:14336
    ds_read_b128 v[20:23], v46 offset:14464
    v_mov_b32 v8, 0
    v_mov_b32 v9, 0
    v_mov_b32 v10, 0
    v_mov_b32 v11, 0
    v_mov_b32 v12, 0
    v_mov_b32 v13, 0xff800000
    v_mov_b32 v14, 0xff800000
    s_waitcnt lgkmcnt(0)
    s_barrier
    s_mov_b32 s84, 0x6040200
    s_mov_b32 s85, 0x7050301
    s_mov_b32 s86, 0x5010400
    s_mov_b32 s87, 0x7030602
    s_mov_b32 s88, 0x80808080
    s_mov_b32 s89, 0xf0f0f0f
    s_mov_b32 s90, 0x00010001
    s_mov_b32 s86, 0x7fff7fff
    s_add_u32 s68, s67, 2359296
    s_xor_b32 s78, s68, s67
    s_and_b32 s78, s78, 0xff800000
    s_xor_b32 s68, s68, s78
    s_waitcnt vmcnt(5)
    buffer_load_dwordx4 a[112:115], v1, s[28:31], s68 offen offset:0
    s_waitcnt vmcnt(63)
    v_mfma_f32_16x16x32_bf16 v[24:27], v[48:51], v[16:19], 0
    v_mfma_f32_16x16x32_bf16 v[28:31], v[56:59], v[16:19], 0
    v_mfma_f32_16x16x32_bf16 v[24:27], v[52:55], v[20:23], v[24:27]
    v_mfma_f32_16x16x32_bf16 v[28:31], v[60:63], v[20:23], v[28:31]
    s_mov_b32 exec_lo, 0x30003
    s_mov_b32 exec_hi, 0x30003
    s_nop 4
    v_add_f32_dpp v224, v25, v24 quad_perm:[1,0,3,2] row_mask:0xf bank_mask:0xf
    v_add_f32_dpp v225, v27, v26 quad_perm:[1,0,3,2] row_mask:0xf bank_mask:0xf
    v_add_f32_dpp v226, v29, v28 quad_perm:[1,0,3,2] row_mask:0xf bank_mask:0xf
    v_add_f32_dpp v227, v31, v30 quad_perm:[1,0,3,2] row_mask:0xf bank_mask:0xf
    s_mov_b64 exec, -1
    v_mov_b32 v46, 0
    global_load_dword v47, v46, s[62:63] sc1
    s_waitcnt vmcnt(6)
    buffer_load_dwordx4 a[116:119], v1, s[28:31], s68 offen offset:128
    s_waitcnt vmcnt(63)
    v_mfma_f32_16x16x32_bf16 v[24:27], v[80:83], v[16:19], 0
    v_mfma_f32_16x16x32_bf16 v[28:31], v[88:91], v[16:19], 0
    v_mfma_f32_16x16x32_bf16 v[24:27], v[84:87], v[20:23], v[24:27]
    v_mfma_f32_16x16x32_bf16 v[28:31], v[92:95], v[20:23], v[28:31]
    s_mov_b32 exec_lo, 0xc000c
    s_mov_b32 exec_hi, 0xc000c
    s_nop 4
    v_add_f32_dpp v224, v25, v24 quad_perm:[1,0,3,2] row_mask:0xf bank_mask:0xf
    v_add_f32_dpp v225, v27, v26 quad_perm:[1,0,3,2] row_mask:0xf bank_mask:0xf
    v_add_f32_dpp v226, v29, v28 quad_perm:[1,0,3,2] row_mask:0xf bank_mask:0xf
    v_add_f32_dpp v227, v31, v30 quad_perm:[1,0,3,2] row_mask:0xf bank_mask:0xf
    s_mov_b64 exec, -1
    s_waitcnt vmcnt(6)
    buffer_load_dwordx4 a[120:123], v1, s[28:31], s68 offen offset:2048
    s_waitcnt vmcnt(63)
    v_mfma_f32_16x16x32_bf16 v[24:27], v[112:115], v[16:19], 0
    v_mfma_f32_16x16x32_bf16 v[28:31], v[120:123], v[16:19], 0
    v_mfma_f32_16x16x32_bf16 v[24:27], v[116:119], v[20:23], v[24:27]
    v_mfma_f32_16x16x32_bf16 v[28:31], v[124:127], v[20:23], v[28:31]
    s_mov_b32 exec_lo, 0xc000c0
    s_mov_b32 exec_hi, 0xc000c0
    s_nop 4
    v_add_f32_dpp v224, v25, v24 quad_perm:[1,0,3,2] row_mask:0xf bank_mask:0xf
    v_add_f32_dpp v225, v27, v26 quad_perm:[1,0,3,2] row_mask:0xf bank_mask:0xf
    v_add_f32_dpp v226, v29, v28 quad_perm:[1,0,3,2] row_mask:0xf bank_mask:0xf
    v_add_f32_dpp v227, v31, v30 quad_perm:[1,0,3,2] row_mask:0xf bank_mask:0xf
    s_mov_b64 exec, -1
    s_waitcnt vmcnt(6)
    buffer_load_dwordx4 a[124:127], v1, s[28:31], s68 offen offset:2176
    s_waitcnt vmcnt(63)
    v_mfma_f32_16x16x32_bf16 v[24:27], v[64:67], v[16:19], 0
    v_mfma_f32_16x16x32_bf16 v[28:31], v[72:75], v[16:19], 0
    v_mfma_f32_16x16x32_bf16 v[24:27], v[68:71], v[20:23], v[24:27]
    v_mfma_f32_16x16x32_bf16 v[28:31], v[76:79], v[20:23], v[28:31]
    s_mov_b32 exec_lo, 0xc000c00
    s_mov_b32 exec_hi, 0xc000c00
    s_nop 4
    v_add_f32_dpp v224, v25, v24 quad_perm:[1,0,3,2] row_mask:0xf bank_mask:0xf
    v_add_f32_dpp v225, v27, v26 quad_perm:[1,0,3,2] row_mask:0xf bank_mask:0xf
    v_add_f32_dpp v226, v29, v28 quad_perm:[1,0,3,2] row_mask:0xf bank_mask:0xf
    v_add_f32_dpp v227, v31, v30 quad_perm:[1,0,3,2] row_mask:0xf bank_mask:0xf
    s_mov_b64 exec, -1
    s_add_u32 s79, s67, 2490368
    s_xor_b32 s78, s79, s67
    s_and_b32 s78, s78, 0xff800000
    s_xor_b32 s79, s79, s78
    s_waitcnt vmcnt(5)
    buffer_load_dwordx4 a[128:131], v1, s[28:31], s79 offen offset:0 nt
    s_waitcnt vmcnt(63)
    v_mfma_f32_16x16x32_bf16 v[24:27], v[96:99], v[16:19], 0
    v_mfma_f32_16x16x32_bf16 v[28:31], v[104:107], v[16:19], 0
    v_mfma_f32_16x16x32_bf16 v[24:27], v[100:103], v[20:23], v[24:27]
    v_mfma_f32_16x16x32_bf16 v[28:31], v[108:111], v[20:23], v[28:31]
    s_mov_b32 exec_lo, 0x30003000
    s_mov_b32 exec_hi, 0x30003000
    s_nop 4
    v_add_f32_dpp v224, v25, v24 quad_perm:[1,0,3,2] row_mask:0xf bank_mask:0xf
    v_add_f32_dpp v225, v27, v26 quad_perm:[1,0,3,2] row_mask:0xf bank_mask:0xf
    v_add_f32_dpp v226, v29, v28 quad_perm:[1,0,3,2] row_mask:0xf bank_mask:0xf
    v_add_f32_dpp v227, v31, v30 quad_perm:[1,0,3,2] row_mask:0xf bank_mask:0xf
    s_mov_b64 exec, -1
    s_waitcnt vmcnt(5)
    buffer_load_dwordx4 a[132:135], v1, s[28:31], s79 offen offset:128 nt
    s_waitcnt vmcnt(63)
    v_mfma_f32_16x16x32_bf16 v[24:27], v[128:131], v[16:19], 0
    v_mfma_f32_16x16x32_bf16 v[28:31], v[136:139], v[16:19], 0
    v_mfma_f32_16x16x32_bf16 v[24:27], v[132:135], v[20:23], v[24:27]
    v_mfma_f32_16x16x32_bf16 v[28:31], v[140:143], v[20:23], v[28:31]
    s_mov_b32 exec_lo, 0x30003
    s_mov_b32 exec_hi, 0x30003
    s_nop 4
    v_add_f32_dpp v228, v25, v24 quad_perm:[1,0,3,2] row_mask:0xf bank_mask:0xf
    v_add_f32_dpp v229, v27, v26 quad_perm:[1,0,3,2] row_mask:0xf bank_mask:0xf
    v_add_f32_dpp v230, v29, v28 quad_perm:[1,0,3,2] row_mask:0xf bank_mask:0xf
    v_add_f32_dpp v231, v31, v30 quad_perm:[1,0,3,2] row_mask:0xf bank_mask:0xf
    s_mov_b64 exec, -1
    s_waitcnt vmcnt(5)
    v_readfirstlane_b32 s97, v47
    s_nop 1
    s_cmp_lg_u32 s97, 0
    s_cbranch_scc1 L_tgok_6
    s_call_b64 s[76:77], L_tagspin
L_tgok_6:
    s_cmp_lg_u32 s3, 0
    s_cbranch_scc1 L_tge_7
    s_lshl_b32 s92, s96, 12
    s_or_b32 s92, s92, s97
    v_mov_b32 v32, s92
    v_mov_b32 v33, 0
    s_mul_i32 s93, s64, 128
    s_add_u32 s93, s93, 524288
    s_mov_b64 exec, 1
    buffer_store_dword v32, v33, s[36:39], s93 offen sc1
    s_mov_b64 exec, -1
L_tge_7:
    v_and_b32 v24, 0x7fff7fff, v128
    v_and_b32 v26, 0x7fff7fff, v129
    v_pk_max_u16 v24, v24, v26
    v_and_b32 v25, 0x7fff7fff, v130
    v_pk_max_u16 v24, v24, v25
    v_and_b32 v26, 0x7fff7fff, v131
    v_pk_max_u16 v24, v24, v26
    v_and_b32 v25, 0x7fff7fff, v132
    v_pk_max_u16 v24, v24, v25
    v_and_b32 v26, 0x7fff7fff, v133
    v_pk_max_u16 v24, v24, v26
    v_and_b32 v25, 0x7fff7fff, v134
    v_pk_max_u16 v24, v24, v25
    v_and_b32 v26, 0x7fff7fff, v135
    v_pk_max_u16 v24, v24, v26
    v_and_b32 v25, 0x7fff7fff, v136
    v_pk_max_u16 v24, v24, v25
    v_and_b32 v26, 0x7fff7fff, v137
    v_pk_max_u16 v24, v24, v26
    v_and_b32 v25, 0x7fff7fff, v138
    v_pk_max_u16 v24, v24, v25
    v_and_b32 v26, 0x7fff7fff, v139
    v_pk_max_u16 v24, v24, v26
    v_and_b32 v25, 0x7fff7fff, v140
    v_pk_max_u16 v24, v24, v25
    v_and_b32 v26, 0x7fff7fff, v141
    v_pk_max_u16 v24, v24, v26
    v_and_b32 v25, 0x7fff7fff, v142
    v_pk_max_u16 v24, v24, v25
    v_and_b32 v26, 0x7fff7fff, v143
    v_pk_max_u16 v24, v24, v26
    v_lshrrev_b32 v25, 16, v24
    v_and_b32 v24, 0xffff, v24
    v_max_u32 v24, v24, v25
    s_nop 1
    v_max_u32_dpp v24, v24, v24 row_ror:8 row_mask:0xf bank_mask:0xf
    s_nop 1
    v_max_u32_dpp v24, v24, v24 row_ror:4 row_mask:0xf bank_mask:0xf
    s_nop 1
    v_max_u32_dpp v24, v24, v24 row_ror:2 row_mask:0xf bank_mask:0xf
    s_nop 1
    v_max_u32_dpp v24, v24, v24 row_ror:1 row_mask:0xf bank_mask:0xf
    v_mov_b32 v25, v24
    s_nop 1
    v_permlane32_swap_b32 v24, v25
    v_max_u32 v24, v24, v25
    v_mov_b32 v25, v24
    s_nop 1
    v_permlane16_swap_b32 v24, v25
    v_max_u32 v24, v24, v25
    s_nop 0
    v_readfirstlane_b32 s62, v24
    s_nop 1
    s_lshr_b32 s62, s62, 8
    s_max_u32 s62, s62, 14
    s_sub_u32 s62, s62, 14
    s_min_u32 s62, s62, 62
    s_mul_i32 s62, s62, 0x01000100
    s_mov_b32 s82, 0
    s_waitcnt vmcnt(4)
    buffer_load_dwordx4 a[136:139], v1, s[28:31], s79 offen offset:2048 nt
    s_waitcnt vmcnt(63)
    v_mfma_f32_16x16x32_bf16 v[24:27], v[144:147], v[16:19], 0
    v_mfma_f32_16x16x32_bf16 v[28:31], v[152:155], v[16:19], 0
    v_mfma_f32_16x16x32_bf16 v[24:27], v[148:151], v[20:23], v[24:27]
    v_mfma_f32_16x16x32_bf16 v[28:31], v[156:159], v[20:23], v[28:31]
    s_mov_b32 exec_lo, 0xc000c
    s_mov_b32 exec_hi, 0xc000c
    s_nop 4
    v_add_f32_dpp v228, v25, v24 quad_perm:[1,0,3,2] row_mask:0xf bank_mask:0xf
    v_add_f32_dpp v229, v27, v26 quad_perm:[1,0,3,2] row_mask:0xf bank_mask:0xf
    v_add_f32_dpp v230, v29, v28 quad_perm:[1,0,3,2] row_mask:0xf bank_mask:0xf
    v_add_f32_dpp v231, v31, v30 quad_perm:[1,0,3,2] row_mask:0xf bank_mask:0xf
    s_mov_b64 exec, -1
    s_waitcnt vmcnt(4)
    buffer_load_dwordx4 a[140:143], v1, s[28:31], s79 offen offset:2176 nt
    s_waitcnt vmcnt(63)
    v_mfma_f32_16x16x32_bf16 v[24:27], v[160:163], v[16:19], 0
    v_mfma_f32_16x16x32_bf16 v[28:31], v[168:171], v[16:19], 0
    v_mfma_f32_16x16x32_bf16 v[24:27], v[164:167], v[20:23], v[24:27]
    v_mfma_f32_16x16x32_bf16 v[28:31], v[172:175], v[20:23], v[28:31]
    s_mov_b32 exec_lo, 0xc000c0
    s_mov_b32 exec_hi, 0xc000c0
    s_nop 4
    v_add_f32_dpp v228, v25, v24 quad_perm:[1,0,3,2] row_mask:0xf bank_mask:0xf
    v_add_f32_dpp v229, v27, v26 quad_perm:[1,0,3,2] row_mask:0xf bank_mask:0xf
    v_add_f32_dpp v230, v29, v28 quad_perm:[1,0,3,2] row_mask:0xf bank_mask:0xf
    v_add_f32_dpp v231, v31, v30 quad_perm:[1,0,3,2] row_mask:0xf bank_mask:0xf
    s_mov_b64 exec, -1
    s_add_u32 s68, s67, 2621440
    s_xor_b32 s78, s68, s67
    s_and_b32 s78, s78, 0xff800000
    s_xor_b32 s68, s68, s78
    s_waitcnt vmcnt(5)
    buffer_load_dwordx4 a[144:147], v1, s[28:31], s68 offen offset:0
    s_waitcnt vmcnt(61)
    v_mfma_f32_16x16x32_bf16 v[24:27], v[176:179], v[16:19], 0
    v_mfma_f32_16x16x32_bf16 v[28:31], v[184:187], v[16:19], 0
    v_mfma_f32_16x16x32_bf16 v[24:27], v[180:183], v[20:23], v[24:27]
    v_mfma_f32_16x16x32_bf16 v[28:31], v[188:191], v[20:23], v[28:31]
    s_mov_b32 exec_lo, 0x3000300
    s_mov_b32 exec_hi, 0x3000300
    s_nop 4
    v_add_f32_dpp v228, v25, v24 quad_perm:[1,0,3,2] row_mask:0xf bank_mask:0xf
    v_add_f32_dpp v229, v27, v26 quad_perm:[1,0,3,2] row_mask:0xf bank_mask:0xf
    v_add_f32_dpp v230, v29, v28 quad_perm:[1,0,3,2] row_mask:0xf bank_mask:0xf
    v_add_f32_dpp v231, v31, v30 quad_perm:[1,0,3,2] row_mask:0xf bank_mask:0xf
    s_mov_b64 exec, -1
    s_waitcnt vmcnt(5)
    buffer_load_dwordx4 a[148:151], v1, s[28:31], s68 offen offset:128
    s_waitcnt vmcnt(56)
    v_mfma_f32_16x16x32_bf16 v[24:27], v[192:195], v[16:19], 0
    v_mfma_f32_16x16x32_bf16 v[28:31], v[200:203], v[16:19], 0
    v_mfma_f32_16x16x32_bf16 v[24:27], v[196:199], v[20:23], v[24:27]
    v_mfma_f32_16x16x32_bf16 v[28:31], v[204:207], v[20:23], v[28:31]
    s_mov_b32 exec_lo, 0x30003000
    s_mov_b32 exec_hi, 0x30003000
    s_nop 4
    v_add_f32_dpp v228, v25, v24 quad_perm:[1,0,3,2] row_mask:0xf bank_mask:0xf
    v_add_f32_dpp v229, v27, v26 quad_perm:[1,0,3,2] row_mask:0xf bank_mask:0xf
    v_add_f32_dpp v230, v29, v28 quad_perm:[1,0,3,2] row_mask:0xf bank_mask:0xf
    v_add_f32_dpp v231, v31, v30 quad_perm:[1,0,3,2] row_mask:0xf bank_mask:0xf
    s_mov_b64 exec, -1
    s_waitcnt vmcnt(5)
    buffer_load_dwordx4 a[152:155], v1, s[28:31], s68 offen offset:2048
    s_waitcnt vmcnt(51)
    v_mfma_f32_16x16x32_bf16 v[24:27], v[208:211], v[16:19], 0
    v_mfma_f32_16x16x32_bf16 v[28:31], v[216:219], v[16:19], 0
    v_mfma_f32_16x16x32_bf16 v[24:27], v[212:215], v[20:23], v[24:27]
    v_mfma_f32_16x16x32_bf16 v[28:31], v[220:223], v[20:23], v[28:31]
    s_mov_b32 exec_lo, 0xc000c000
    s_mov_b32 exec_hi, 0xc000c000
    s_nop 4
    v_add_f32_dpp v228, v25, v24 quad_perm:[1,0,3,2] row_mask:0xf bank_mask:0xf
    v_add_f32_dpp v229, v27, v26 quad_perm:[1,0,3,2] row_mask:0xf bank_mask:0xf
    v_add_f32_dpp v230, v29, v28 quad_perm:[1,0,3,2] row_mask:0xf bank_mask:0xf
    v_add_f32_dpp v231, v31, v30 quad_perm:[1,0,3,2] row_mask:0xf bank_mask:0xf
    s_mov_b64 exec, -1
    s_waitcnt vmcnt(5)
    buffer_load_dwordx4 a[156:159], v1, s[28:31], s68 offen offset:2176
    s_waitcnt vmcnt(46)
    v_mfma_f32_16x16x32_bf16 v[24:27], a[0:3], v[16:19], 0
    v_mfma_f32_16x16x32_bf16 v[28:31], a[8:11], v[16:19], 0
    v_mfma_f32_16x16x32_bf16 v[24:27], a[4:7], v[20:23], v[24:27]
    v_mfma_f32_16x16x32_bf16 v[28:31], a[12:15], v[20:23], v[28:31]
    s_mov_b32 exec_lo, 0xc000c
    s_mov_b32 exec_hi, 0xc000c
    s_nop 4
    v_add_f32_dpp v232, v25, v24 quad_perm:[1,0,3,2] row_mask:0xf bank_mask:0xf
    v_add_f32_dpp v233, v27, v26 quad_perm:[1,0,3,2] row_mask:0xf bank_mask:0xf
    v_add_f32_dpp v234, v29, v28 quad_perm:[1,0,3,2] row_mask:0xf bank_mask:0xf
    v_add_f32_dpp v235, v31, v30 quad_perm:[1,0,3,2] row_mask:0xf bank_mask:0xf
    s_mov_b64 exec, -1
    s_add_u32 s79, s67, 2752512
    s_xor_b32 s78, s79, s67
    s_and_b32 s78, s78, 0xff800000
    s_xor_b32 s79, s79, s78
    s_waitcnt vmcnt(4)
    buffer_load_dwordx4 a[160:163], v1, s[28:31], s79 offen offset:0 nt
    s_waitcnt vmcnt(41)
    v_mfma_f32_16x16x32_bf16 v[24:27], a[16:19], v[16:19], 0
    v_mfma_f32_16x16x32_bf16 v[28:31], a[24:27], v[16:19], 0
    v_mfma_f32_16x16x32_bf16 v[24:27], a[20:23], v[20:23], v[24:27]
    v_mfma_f32_16x16x32_bf16 v[28:31], a[28:31], v[20:23], v[28:31]
    s_mov_b32 exec_lo, 0x300030
    s_mov_b32 exec_hi, 0x300030
    s_nop 4
    v_add_f32_dpp v232, v25, v24 quad_perm:[1,0,3,2] row_mask:0xf bank_mask:0xf
    v_add_f32_dpp v233, v27, v26 quad_perm:[1,0,3,2] row_mask:0xf bank_mask:0xf
    v_add_f32_dpp v234, v29, v28 quad_perm:[1,0,3,2] row_mask:0xf bank_mask:0xf
    v_add_f32_dpp v235, v31, v30 quad_perm:[1,0,3,2] row_mask:0xf bank_mask:0xf
    s_mov_b64 exec, -1
    s_waitcnt vmcnt(4)
    buffer_load_dwordx4 a[164:167], v1, s[28:31], s79 offen offset:128 nt
    s_waitcnt vmcnt(36)
    v_mfma_f32_16x16x32_bf16 v[24:27], a[32:35], v[16:19], 0
    v_mfma_f32_16x16x32_bf16 v[28:31], a[40:43], v[16:19], 0
    v_mfma_f32_16x16x32_bf16 v[24:27], a[36:39], v[20:23], v[24:27]
    v_mfma_f32_16x16x32_bf16 v[28:31], a[44:47], v[20:23], v[28:31]
    s_mov_b32 exec_lo, 0x3000300
    s_mov_b32 exec_hi, 0x3000300
    s_nop 4
    v_add_f32_dpp v232, v25, v24 quad_perm:[1,0,3,2] row_mask:0xf bank_mask:0xf
    v_add_f32_dpp v233, v27, v26 quad_perm:[1,0,3,2] row_mask:0xf bank_mask:0xf
    v_add_f32_dpp v234, v29, v28 quad_perm:[1,0,3,2] row_mask:0xf bank_mask:0xf
    v_add_f32_dpp v235, v31, v30 quad_perm:[1,0,3,2] row_mask:0xf bank_mask:0xf
    s_mov_b64 exec, -1
    s_waitcnt vmcnt(4)
    buffer_load_dwordx4 a[168:171], v1, s[28:31], s79 offen offset:2048 nt
    s_waitcnt vmcnt(31)
    v_mfma_f32_16x16x32_bf16 v[24:27], a[48:51], v[16:19], 0
    v_mfma_f32_16x16x32_bf16 v[28:31], a[56:59], v[16:19], 0
    v_mfma_f32_16x16x32_bf16 v[24:27], a[52:55], v[20:23], v[24:27]
    v_mfma_f32_16x16x32_bf16 v[28:31], a[60:63], v[20:23], v[28:31]
    s_mov_b32 exec_lo, 0x30003000
    s_mov_b32 exec_hi, 0x30003000
    s_nop 4
    v_add_f32_dpp v232, v25, v24 quad_perm:[1,0,3,2] row_mask:0xf bank_mask:0xf
    v_add_f32_dpp v233, v27, v26 quad_perm:[1,0,3,2] row_mask:0xf bank_mask:0xf
    v_add_f32_dpp v234, v29, v28 quad_perm:[1,0,3,2] row_mask:0xf bank_mask:0xf
    v_add_f32_dpp v235, v31, v30 quad_perm:[1,0,3,2] row_mask:0xf bank_mask:0xf
    s_mov_b64 exec, -1
    s_waitcnt vmcnt(4)
    buffer_load_dwordx4 a[172:175], v1, s[28:31], s79 offen offset:2176 nt
    s_waitcnt vmcnt(26)
    v_mfma_f32_16x16x32_bf16 v[24:27], a[64:67], v[16:19], 0
    v_mfma_f32_16x16x32_bf16 v[28:31], a[72:75], v[16:19], 0
    v_mfma_f32_16x16x32_bf16 v[24:27], a[68:71], v[20:23], v[24:27]
    v_mfma_f32_16x16x32_bf16 v[28:31], a[76:79], v[20:23], v[28:31]
    s_mov_b32 exec_lo, 0xc000c000
    s_mov_b32 exec_hi, 0xc000c000
    s_nop 4
    v_add_f32_dpp v232, v25, v24 quad_perm:[1,0,3,2] row_mask:0xf bank_mask:0xf
    v_add_f32_dpp v233, v27, v26 quad_perm:[1,0,3,2] row_mask:0xf bank_mask:0xf
    v_add_f32_dpp v234, v29, v28 quad_perm:[1,0,3,2] row_mask:0xf bank_mask:0xf
    v_add_f32_dpp v235, v31, v30 quad_perm:[1,0,3,2] row_mask:0xf bank_mask:0xf
    s_mov_b64 exec, -1
    s_add_u32 s68, s67, 2883584
    s_xor_b32 s78, s68, s67
    s_and_b32 s78, s78, 0xff800000
    s_xor_b32 s68, s68, s78
    s_waitcnt vmcnt(5)
    buffer_load_dwordx4 a[176:179], v1, s[28:31], s68 offen offset:0
    s_waitcnt vmcnt(22)
    v_mfma_f32_16x16x32_bf16 v[24:27], a[80:83], v[16:19], 0
    v_mfma_f32_16x16x32_bf16 v[28:31], a[88:91], v[16:19], 0
    v_mfma_f32_16x16x32_bf16 v[24:27], a[84:87], v[20:23], v[24:27]
    v_mfma_f32_16x16x32_bf16 v[28:31], a[92:95], v[20:23], v[28:31]
    s_mov_b32 exec_lo, 0xc000c
    s_mov_b32 exec_hi, 0xc000c
    s_nop 4
    v_add_f32_dpp v236, v25, v24 quad_perm:[1,0,3,2] row_mask:0xf bank_mask:0xf
    v_add_f32_dpp v237, v27, v26 quad_perm:[1,0,3,2] row_mask:0xf bank_mask:0xf
    v_add_f32_dpp v238, v29, v28 quad_perm:[1,0,3,2] row_mask:0xf bank_mask:0xf
    v_add_f32_dpp v239, v31, v30 quad_perm:[1,0,3,2] row_mask:0xf bank_mask:0xf
    s_mov_b64 exec, -1
    s_waitcnt vmcnt(5)
    buffer_load_dwordx4 a[180:183], v1, s[28:31], s68 offen offset:128
    s_waitcnt vmcnt(19)
    v_mfma_f32_16x16x32_bf16 v[24:27], a[96:99], v[16:19], 0
    v_mfma_f32_16x16x32_bf16 v[28:31], a[104:107], v[16:19], 0
    v_mfma_f32_16x16x32_bf16 v[24:27], a[100:103], v[20:23], v[24:27]
    v_mfma_f32_16x16x32_bf16 v[28:31], a[108:111], v[20:23], v[28:31]
    s_mov_b32 exec_lo, 0x300030
    s_mov_b32 exec_hi, 0x300030
    s_nop 4
    v_add_f32_dpp v236, v25, v24 quad_perm:[1,0,3,2] row_mask:0xf bank_mask:0xf
    v_add_f32_dpp v237, v27, v26 quad_perm:[1,0,3,2] row_mask:0xf bank_mask:0xf
    v_add_f32_dpp v238, v29, v28 quad_perm:[1,0,3,2] row_mask:0xf bank_mask:0xf
    v_add_f32_dpp v239, v31, v30 quad_perm:[1,0,3,2] row_mask:0xf bank_mask:0xf
    s_mov_b64 exec, -1
    s_waitcnt vmcnt(5)
    buffer_load_dwordx4 a[184:187], v1, s[28:31], s68 offen offset:2048
    s_waitcnt vmcnt(15)
    v_mfma_f32_16x16x32_bf16 v[24:27], a[112:115], v[16:19], 0
    v_mfma_f32_16x16x32_bf16 v[28:31], a[120:123], v[16:19], 0
    v_mfma_f32_16x16x32_bf16 v[24:27], a[116:119], v[20:23], v[24:27]
    v_mfma_f32_16x16x32_bf16 v[28:31], a[124:127], v[20:23], v[28:31]
    s_mov_b32 exec_lo, 0x3000300
    s_mov_b32 exec_hi, 0x3000300
    s_nop 4
    v_add_f32_dpp v236, v25, v24 quad_perm:[1,0,3,2] row_mask:0xf bank_mask:0xf
    v_add_f32_dpp v237, v27, v26 quad_perm:[1,0,3,2] row_mask:0xf bank_mask:0xf
    v_add_f32_dpp v238, v29, v28 quad_perm:[1,0,3,2] row_mask:0xf bank_mask:0xf
    v_add_f32_dpp v239, v31, v30 quad_perm:[1,0,3,2] row_mask:0xf bank_mask:0xf
    s_mov_b64 exec, -1
    s_add_u32 s79, s67, 3014656
    s_xor_b32 s78, s79, s67
    s_and_b32 s78, s78, 0xff800000
    s_xor_b32 s79, s79, s78
    s_waitcnt vmcnt(5)
    buffer_load_dwordx4 a[188:191], v1, s[28:31], s68 offen offset:2176
    s_waitcnt vmcnt(4)
    buffer_load_dwordx4 v[96:99], v1, s[28:31], s79 offen offset:0 nt
    s_waitcnt vmcnt(13)
    v_mfma_f32_16x16x32_bf16 v[24:27], a[128:131], v[16:19], 0
    v_mfma_f32_16x16x32_bf16 v[28:31], a[136:139], v[16:19], 0
    v_mfma_f32_16x16x32_bf16 v[24:27], a[132:135], v[20:23], v[24:27]
    v_mfma_f32_16x16x32_bf16 v[28:31], a[140:143], v[20:23], v[28:31]
    s_waitcnt vmcnt(4)
    buffer_load_dwordx4 v[100:103], v1, s[28:31], s79 offen offset:128 nt
    s_waitcnt vmcnt(4)
    buffer_load_dwordx4 v[104:107], v1, s[28:31], s79 offen offset:2048 nt
    s_mov_b32 exec_lo, 0xc000c00
    s_mov_b32 exec_hi, 0xc000c00
    s_nop 0
    v_add_f32_dpp v236, v25, v24 quad_perm:[1,0,3,2] row_mask:0xf bank_mask:0xf
    v_add_f32_dpp v237, v27, v26 quad_perm:[1,0,3,2] row_mask:0xf bank_mask:0xf
    v_add_f32_dpp v238, v29, v28 quad_perm:[1,0,3,2] row_mask:0xf bank_mask:0xf
    v_add_f32_dpp v239, v31, v30 quad_perm:[1,0,3,2] row_mask:0xf bank_mask:0xf
    s_mov_b64 exec, -1
    s_add_u32 s68, s67, 3145728
    s_xor_b32 s78, s68, s67
    s_and_b32 s78, s78, 0xff800000
    s_xor_b32 s68, s68, s78
    s_waitcnt vmcnt(4)
    buffer_load_dwordx4 v[108:111], v1, s[28:31], s79 offen offset:2176 nt
    s_waitcnt vmcnt(4)
    buffer_load_dwordx4 v[128:131], v1, s[28:31], s68 offen offset:0 nt
    s_waitcnt vmcnt(13)
    v_mfma_f32_16x16x32_bf16 v[24:27], a[144:147], v[16:19], 0
    v_mfma_f32_16x16x32_bf16 v[28:31], a[152:155], v[16:19], 0
    v_mfma_f32_16x16x32_bf16 v[24:27], a[148:151], v[20:23], v[24:27]
    v_mfma_f32_16x16x32_bf16 v[28:31], a[156:159], v[20:23], v[28:31]
    s_waitcnt vmcnt(4)
    buffer_load_dwordx4 v[132:135], v1, s[28:31], s68 offen offset:128 nt
    s_waitcnt vmcnt(4)
    buffer_load_dwordx4 v[136:139], v1, s[28:31], s68 offen offset:2048 nt
    s_mov_b32 exec_lo, 0xc000c000
    s_mov_b32 exec_hi, 0xc000c000
    s_nop 0
    v_add_f32_dpp v236, v25, v24 quad_perm:[1,0,3,2] row_mask:0xf bank_mask:0xf
    v_add_f32_dpp v237, v27, v26 quad_perm:[1,0,3,2] row_mask:0xf bank_mask:0xf
    v_add_f32_dpp v238, v29, v28 quad_perm:[1,0,3,2] row_mask:0xf bank_mask:0xf
    v_add_f32_dpp v239, v31, v30 quad_perm:[1,0,3,2] row_mask:0xf bank_mask:0xf
    s_mov_b64 exec, -1
    s_add_u32 s79, s67, 3276800
    s_xor_b32 s78, s79, s67
    s_and_b32 s78, s78, 0xff800000
    s_xor_b32 s79, s79, s78
    s_waitcnt vmcnt(4)
    buffer_load_dwordx4 v[140:143], v1, s[28:31], s68 offen offset:2176 nt
    s_waitcnt vmcnt(5)
    buffer_load_dwordx4 v[48:51], v1, s[28:31], s79 offen offset:0
    s_waitcnt vmcnt(13)
    v_mfma_f32_16x16x32_bf16 v[24:27], a[160:163], v[16:19], 0
    v_mfma_f32_16x16x32_bf16 v[28:31], a[168:171], v[16:19], 0
    v_mfma_f32_16x16x32_bf16 v[24:27], a[164:167], v[20:23], v[24:27]
    v_mfma_f32_16x16x32_bf16 v[28:31], a[172:175], v[20:23], v[28:31]
    s_waitcnt vmcnt(5)
    buffer_load_dwordx4 v[52:55], v1, s[28:31], s79 offen offset:128
    s_waitcnt vmcnt(5)
    buffer_load_dwordx4 v[56:59], v1, s[28:31], s79 offen offset:2048
    s_mov_b32 exec_lo, 0x30003
    s_mov_b32 exec_hi, 0x30003
    s_nop 0
    v_add_f32_dpp v240, v25, v24 quad_perm:[1,0,3,2] row_mask:0xf bank_mask:0xf
    v_add_f32_dpp v241, v27, v26 quad_perm:[1,0,3,2] row_mask:0xf bank_mask:0xf
    v_add_f32_dpp v242, v29, v28 quad_perm:[1,0,3,2] row_mask:0xf bank_mask:0xf
    v_add_f32_dpp v243, v31, v30 quad_perm:[1,0,3,2] row_mask:0xf bank_mask:0xf
    s_mov_b64 exec, -1
    s_add_u32 s68, s67, 3407872
    s_xor_b32 s78, s68, s67
    s_and_b32 s78, s78, 0xff800000
    s_xor_b32 s68, s68, s78
    s_waitcnt vmcnt(5)
    buffer_load_dwordx4 v[60:63], v1, s[28:31], s79 offen offset:2176
    s_waitcnt vmcnt(4)
    buffer_load_dwordx4 v[80:83], v1, s[28:31], s68 offen offset:0 nt
    s_waitcnt vmcnt(13)
    v_mfma_f32_16x16x32_bf16 v[24:27], a[176:179], v[16:19], 0
    v_mfma_f32_16x16x32_bf16 v[28:31], a[184:187], v[16:19], 0
    v_mfma_f32_16x16x32_bf16 v[24:27], a[180:183], v[20:23], v[24:27]
    v_mfma_f32_16x16x32_bf16 v[28:31], a[188:191], v[20:23], v[28:31]
    s_waitcnt vmcnt(4)
    buffer_load_dwordx4 v[84:87], v1, s[28:31], s68 offen offset:128 nt
    s_waitcnt vmcnt(4)
    buffer_load_dwordx4 v[88:91], v1, s[28:31], s68 offen offset:2048 nt
    s_mov_b32 exec_lo, 0x300030
    s_mov_b32 exec_hi, 0x300030
    s_nop 0
    v_add_f32_dpp v240, v25, v24 quad_perm:[1,0,3,2] row_mask:0xf bank_mask:0xf
    v_add_f32_dpp v241, v27, v26 quad_perm:[1,0,3,2] row_mask:0xf bank_mask:0xf
    v_add_f32_dpp v242, v29, v28 quad_perm:[1,0,3,2] row_mask:0xf bank_mask:0xf
    v_add_f32_dpp v243, v31, v30 quad_perm:[1,0,3,2] row_mask:0xf bank_mask:0xf
    s_mov_b64 exec, -1
    s_add_u32 s79, s67, 3538944
    s_xor_b32 s78, s79, s67
    s_and_b32 s78, s78, 0xff800000
    s_xor_b32 s79, s79, s78
    s_waitcnt vmcnt(4)
    buffer_load_dwordx4 v[92:95], v1, s[28:31], s68 offen offset:2176 nt
    s_waitcnt vmcnt(4)
    buffer_load_dwordx4 v[112:115], v1, s[28:31], s79 offen offset:0 nt
    s_waitcnt vmcnt(13)
    v_mfma_f32_16x16x32_bf16 v[24:27], v[96:99], v[16:19], 0
    v_mfma_f32_16x16x32_bf16 v[28:31], v[104:107], v[16:19], 0
    v_mfma_f32_16x16x32_bf16 v[24:27], v[100:103], v[20:23], v[24:27]
    v_mfma_f32_16x16x32_bf16 v[28:31], v[108:111], v[20:23], v[28:31]
    s_waitcnt vmcnt(4)
    buffer_load_dwordx4 v[116:119], v1, s[28:31], s79 offen offset:128 nt
    s_waitcnt vmcnt(4)
    buffer_load_dwordx4 v[120:123], v1, s[28:31], s79 offen offset:2048 nt
    s_mov_b32 exec_lo, 0xc000c0
    s_mov_b32 exec_hi, 0xc000c0
    s_nop 0
    v_add_f32_dpp v240, v25, v24 quad_perm:[1,0,3,2] row_mask:0xf bank_mask:0xf
    v_add_f32_dpp v241, v27, v26 quad_perm:[1,0,3,2] row_mask:0xf bank_mask:0xf
    v_add_f32_dpp v242, v29, v28 quad_perm:[1,0,3,2] row_mask:0xf bank_mask:0xf
    v_add_f32_dpp v243, v31, v30 quad_perm:[1,0,3,2] row_mask:0xf bank_mask:0xf
    s_mov_b64 exec, -1
    s_add_u32 s68, s67, 3670016
    s_xor_b32 s78, s68, s67
    s_and_b32 s78, s78, 0xff800000
    s_xor_b32 s68, s68, s78
    s_waitcnt vmcnt(4)
    buffer_load_dwordx4 v[124:127], v1, s[28:31], s79 offen offset:2176 nt
    s_waitcnt vmcnt(4)
    buffer_load_dwordx4 v[64:67], v1, s[28:31], s68 offen offset:0 nt
    s_waitcnt vmcnt(13)
    v_mfma_f32_16x16x32_bf16 v[24:27], v[128:131], v[16:19], 0
    v_mfma_f32_16x16x32_bf16 v[28:31], v[136:139], v[16:19], 0
    v_mfma_f32_16x16x32_bf16 v[24:27], v[132:135], v[20:23], v[24:27]
    v_mfma_f32_16x16x32_bf16 v[28:31], v[140:143], v[20:23], v[28:31]
    s_waitcnt vmcnt(4)
    buffer_load_dwordx4 v[68:71], v1, s[28:31], s68 offen offset:128 nt
    s_waitcnt vmcnt(4)
    buffer_load_dwordx4 v[72:75], v1, s[28:31], s68 offen offset:2048 nt
    s_mov_b32 exec_lo, 0xc000c00
    s_mov_b32 exec_hi, 0xc000c00
    s_nop 0
    v_add_f32_dpp v240, v25, v24 quad_perm:[1,0,3,2] row_mask:0xf bank_mask:0xf
    v_add_f32_dpp v241, v27, v26 quad_perm:[1,0,3,2] row_mask:0xf bank_mask:0xf
    v_add_f32_dpp v242, v29, v28 quad_perm:[1,0,3,2] row_mask:0xf bank_mask:0xf
    v_add_f32_dpp v243, v31, v30 quad_perm:[1,0,3,2] row_mask:0xf bank_mask:0xf
    s_mov_b64 exec, -1
    s_add_u32 s79, s67, 3801088
    s_xor_b32 s78, s79, s67
    s_and_b32 s78, s78, 0xff800000
    s_xor_b32 s79, s79, s78
    s_waitcnt vmcnt(4)
    buffer_load_dwordx4 v[76:79], v1, s[28:31], s68 offen offset:2176 nt
    s_waitcnt vmcnt(4)
    buffer_load_dwordx4 v[96:99], v1, s[28:31], s79 offen offset:0 nt
    s_waitcnt vmcnt(13)
    v_mfma_f32_16x16x32_bf16 v[24:27], v[48:51], v[16:19], 0
    v_mfma_f32_16x16x32_bf16 v[28:31], v[56:59], v[16:19], 0
    v_mfma_f32_16x16x32_bf16 v[24:27], v[52:55], v[20:23], v[24:27]
    v_mfma_f32_16x16x32_bf16 v[28:31], v[60:63], v[20:23], v[28:31]
    s_waitcnt vmcnt(4)
    buffer_load_dwordx4 v[100:103], v1, s[28:31], s79 offen offset:128 nt
    s_waitcnt vmcnt(4)
    buffer_load_dwordx4 v[104:107], v1, s[28:31], s79 offen offset:2048 nt
    s_mov_b32 exec_lo, 0xc000c000
    s_mov_b32 exec_hi, 0xc000c000
    s_nop 0
    v_add_f32_dpp v240, v25, v24 quad_perm:[1,0,3,2] row_mask:0xf bank_mask:0xf
    v_add_f32_dpp v241, v27, v26 quad_perm:[1,0,3,2] row_mask:0xf bank_mask:0xf
    v_add_f32_dpp v242, v29, v28 quad_perm:[1,0,3,2] row_mask:0xf bank_mask:0xf
    v_add_f32_dpp v243, v31, v30 quad_perm:[1,0,3,2] row_mask:0xf bank_mask:0xf
    s_mov_b64 exec, -1
    s_waitcnt vmcnt(6)
    buffer_load_dwordx4 v[108:111], v1, s[28:31], s79 offen offset:2176 nt
    s_waitcnt vmcnt(12)
    v_mfma_f32_16x16x32_bf16 v[24:27], v[80:83], v[16:19], 0
    v_mfma_f32_16x16x32_bf16 v[28:31], v[88:91], v[16:19], 0
    v_mfma_f32_16x16x32_bf16 v[24:27], v[84:87], v[20:23], v[24:27]
    v_mfma_f32_16x16x32_bf16 v[28:31], v[92:95], v[20:23], v[28:31]
    s_add_u32 s68, s67, 3932160
    s_xor_b32 s78, s68, s67
    s_and_b32 s78, s78, 0xff800000
    s_xor_b32 s68, s68, s78
    s_waitcnt vmcnt(7)
    buffer_load_dwordx4 v[128:131], v1, s[28:31], s68 offen offset:0
    s_mov_b32 exec_lo, 0x300030
    s_mov_b32 exec_hi, 0x300030
    v_add_f32_dpp v224, v25, v24 quad_perm:[1,0,3,2] row_mask:0xf bank_mask:0xf
    v_add_f32_dpp v225, v27, v26 quad_perm:[1,0,3,2] row_mask:0xf bank_mask:0xf
    v_add_f32_dpp v226, v29, v28 quad_perm:[1,0,3,2] row_mask:0xf bank_mask:0xf
    v_add_f32_dpp v227, v31, v30 quad_perm:[1,0,3,2] row_mask:0xf bank_mask:0xf
    s_mov_b64 exec, -1
    s_waitcnt vmcnt(7)
    buffer_load_dwordx4 v[132:135], v1, s[28:31], s68 offen offset:128
    s_mov_b32 s91, s62
    s_call_b64 s[76:77], L_pack80_0
    s_waitcnt vmcnt(7)
    buffer_load_dwordx4 v[136:139], v1, s[28:31], s68 offen offset:2048
    s_call_b64 s[76:77], L_pack80_1
    v_mov_b32 v144, v80
    v_mov_b32 v145, v81
    v_mov_b32 v146, v82
    v_mov_b32 v147, v83
    v_mov_b32 v148, v84
    v_mov_b32 v149, v85
    v_mov_b32 v150, v86
    v_mov_b32 v151, v87
    v_mov_b32 v152, v88
    v_mov_b32 v153, v89
    v_mov_b32 v154, v90
    v_mov_b32 v155, v91
    v_mov_b32 v156, v32
    s_cmp_lg_u64 vcc, 0
    s_cselect_b32 s92, 1, 0
    s_or_b32 s82, s82, s92
    s_add_u32 s79, s67, 4063232
    s_xor_b32 s78, s79, s67
    s_and_b32 s78, s78, 0xff800000
    s_xor_b32 s79, s79, s78
    s_waitcnt vmcnt(5)
    buffer_load_dwordx4 v[140:143], v1, s[28:31], s68 offen offset:2176
    s_waitcnt vmcnt(4)
    buffer_load_dwordx4 v[48:51], v1, s[28:31], s79 offen offset:0 nt
    s_waitcnt vmcnt(13)
    v_mfma_f32_16x16x32_bf16 v[24:27], v[112:115], v[16:19], 0
    v_mfma_f32_16x16x32_bf16 v[28:31], v[120:123], v[16:19], 0
    v_mfma_f32_16x16x32_bf16 v[24:27], v[116:119], v[20:23], v[24:27]
    v_mfma_f32_16x16x32_bf16 v[28:31], v[124:127], v[20:23], v[28:31]
    s_waitcnt vmcnt(4)
    buffer_load_dwordx4 v[52:55], v1, s[28:31], s79 offen offset:128 nt
    s_waitcnt vmcnt(4)
    buffer_load_dwordx4 v[56:59], v1, s[28:31], s79 offen offset:2048 nt
    s_mov_b32 exec_lo, 0x30003
    s_mov_b32 exec_hi, 0x30003
    s_nop 0
    v_add_f32_dpp v244, v25, v24 quad_perm:[1,0,3,2] row_mask:0xf bank_mask:0xf
    v_add_f32_dpp v245, v27, v26 quad_perm:[1,0,3,2] row_mask:0xf bank_mask:0xf
    v_add_f32_dpp v246, v29, v28 quad_perm:[1,0,3,2] row_mask:0xf bank_mask:0xf
    v_add_f32_dpp v247, v31, v30 quad_perm:[1,0,3,2] row_mask:0xf bank_mask:0xf
    s_mov_b64 exec, -1
    s_waitcnt vmcnt(6)
    buffer_load_dwordx4 v[60:63], v1, s[28:31], s79 offen offset:2176 nt
    s_waitcnt vmcnt(12)
    v_mfma_f32_16x16x32_bf16 v[24:27], v[64:67], v[16:19], 0
    v_mfma_f32_16x16x32_bf16 v[28:31], v[72:75], v[16:19], 0
    v_mfma_f32_16x16x32_bf16 v[24:27], v[68:71], v[20:23], v[24:27]
    v_mfma_f32_16x16x32_bf16 v[28:31], v[76:79], v[20:23], v[28:31]
    s_add_u32 s68, s67, 4194304
    s_xor_b32 s78, s68, s67
    s_and_b32 s78, s78, 0xff800000
    s_xor_b32 s68, s68, s78
    s_waitcnt vmcnt(6)
    buffer_load_dwordx4 v[80:83], v1, s[28:31], s68 offen offset:0 nt
    s_mov_b32 exec_lo, 0x3000300
    s_mov_b32 exec_hi, 0x3000300
    v_add_f32_dpp v224, v25, v24 quad_perm:[1,0,3,2] row_mask:0xf bank_mask:0xf
    v_add_f32_dpp v225, v27, v26 quad_perm:[1,0,3,2] row_mask:0xf bank_mask:0xf
    v_add_f32_dpp v226, v29, v28 quad_perm:[1,0,3,2] row_mask:0xf bank_mask:0xf
    v_add_f32_dpp v227, v31, v30 quad_perm:[1,0,3,2] row_mask:0xf bank_mask:0xf
    s_mov_b64 exec, -1
    s_waitcnt vmcnt(6)
    buffer_load_dwordx4 v[84:87], v1, s[28:31], s68 offen offset:128 nt
    s_mov_b32 s91, s62
    s_call_b64 s[76:77], L_pack64_0
    s_waitcnt vmcnt(6)
    buffer_load_dwordx4 v[88:91], v1, s[28:31], s68 offen offset:2048 nt
    s_call_b64 s[76:77], L_pack64_1
    ds_write_b128 v3, v[64:67] offset:0
    ds_write_b128 v3, v[68:71] offset:1024
    ds_write_b128 v3, v[72:75] offset:2048
    v_and_b32 v34, 63, v0
    v_mul_u32_u24 v34, 12, v34
    v_sub_u32 v34, v3, v34
    ds_write_b32 v34, v32 offset:3072
    s_cmp_lg_u64 vcc, 0
    s_cselect_b32 s92, 2, 0
    s_or_b32 s82, s82, s92
    s_waitcnt vmcnt(6)
    buffer_load_dwordx4 v[92:95], v1, s[28:31], s68 offen offset:2176 nt
    s_waitcnt vmcnt(12)
    v_mfma_f32_16x16x32_bf16 v[24:27], v[96:99], v[16:19], 0
    v_mfma_f32_16x16x32_bf16 v[28:31], v[104:107], v[16:19], 0
    v_mfma_f32_16x16x32_bf16 v[24:27], v[100:103], v[20:23], v[24:27]
    v_mfma_f32_16x16x32_bf16 v[28:31], v[108:111], v[20:23], v[28:31]
    s_add_u32 s79, s67, 4325376
    s_xor_b32 s78, s79, s67
    s_and_b32 s78, s78, 0xff800000
    s_xor_b32 s79, s79, s78
    s_waitcnt vmcnt(6)
    buffer_load_dwordx4 v[112:115], v1, s[28:31], s79 offen offset:0 nt
    s_mov_b32 exec_lo, 0xc000c000
    s_mov_b32 exec_hi, 0xc000c000
    v_add_f32_dpp v224, v25, v24 quad_perm:[1,0,3,2] row_mask:0xf bank_mask:0xf
    v_add_f32_dpp v225, v27, v26 quad_perm:[1,0,3,2] row_mask:0xf bank_mask:0xf
    v_add_f32_dpp v226, v29, v28 quad_perm:[1,0,3,2] row_mask:0xf bank_mask:0xf
    v_add_f32_dpp v227, v31, v30 quad_perm:[1,0,3,2] row_mask:0xf bank_mask:0xf
    s_mov_b64 exec, -1
    s_waitcnt vmcnt(6)
    buffer_load_dwordx4 v[116:119], v1, s[28:31], s79 offen offset:128 nt
    s_mov_b32 s91, s62
    s_call_b64 s[76:77], L_pack96_0
    s_waitcnt vmcnt(6)
    buffer_load_dwordx4 v[120:123], v1, s[28:31], s79 offen offset:2048 nt
    s_call_b64 s[76:77], L_pack96_1
    ds_write_b128 v3, v[96:99] offset:6656
    ds_write_b128 v3, v[100:103] offset:7680
    ds_write_b128 v3, v[104:107] offset:8704
    v_and_b32 v34, 63, v0
    v_mul_u32_u24 v34, 12, v34
    v_sub_u32 v34, v3, v34
    ds_write_b32 v34, v32 offset:9728
    s_cmp_lg_u64 vcc, 0
    s_cselect_b32 s92, 4, 0
    s_or_b32 s82, s82, s92
    s_add_u32 s68, s67, 4456448
    s_xor_b32 s78, s68, s67
    s_and_b32 s78, s78, 0xff800000
    s_xor_b32 s68, s68, s78
    s_waitcnt vmcnt(4)
    buffer_load_dwordx4 v[124:127], v1, s[28:31], s79 offen offset:2176 nt
    s_waitcnt vmcnt(4)
    buffer_load_dwordx4 v[64:67], v1, s[28:31], s68 offen offset:0 nt
    s_waitcnt vmcnt(13)
    v_mfma_f32_16x16x32_bf16 v[24:27], v[128:131], v[16:19], 0
    v_mfma_f32_16x16x32_bf16 v[28:31], v[136:139], v[16:19], 0
    v_mfma_f32_16x16x32_bf16 v[24:27], v[132:135], v[20:23], v[24:27]
    v_mfma_f32_16x16x32_bf16 v[28:31], v[140:143], v[20:23], v[28:31]
    s_waitcnt vmcnt(4)
    buffer_load_dwordx4 v[68:71], v1, s[28:31], s68 offen offset:128 nt
    s_waitcnt vmcnt(4)
    buffer_load_dwordx4 v[72:75], v1, s[28:31], s68 offen offset:2048 nt
    s_mov_b32 exec_lo, 0x300030
    s_mov_b32 exec_hi, 0x300030
    s_nop 0
    v_add_f32_dpp v244, v25, v24 quad_perm:[1,0,3,2] row_mask:0xf bank_mask:0xf
    v_add_f32_dpp v245, v27, v26 quad_perm:[1,0,3,2] row_mask:0xf bank_mask:0xf
    v_add_f32_dpp v246, v29, v28 quad_perm:[1,0,3,2] row_mask:0xf bank_mask:0xf
    v_add_f32_dpp v247, v31, v30 quad_perm:[1,0,3,2] row_mask:0xf bank_mask:0xf
    s_mov_b64 exec, -1
    s_waitcnt vmcnt(6)
    buffer_load_dwordx4 v[76:79], v1, s[28:31], s68 offen offset:2176 nt
    s_waitcnt vmcnt(12)
    v_mfma_f32_16x16x32_bf16 v[24:27], v[48:51], v[16:19], 0
    v_mfma_f32_16x16x32_bf16 v[28:31], v[56:59], v[16:19], 0
    v_mfma_f32_16x16x32_bf16 v[24:27], v[52:55], v[20:23], v[24:27]
    v_mfma_f32_16x16x32_bf16 v[28:31], v[60:63], v[20:23], v[28:31]
    s_add_u32 s79, s67, 4587520
    s_xor_b32 s78, s79, s67
    s_and_b32 s78, s78, 0xff800000
    s_xor_b32 s79, s79, s78
    s_waitcnt vmcnt(7)
    buffer_load_dwordx4 v[96:99], v1, s[28:31], s79 offen offset:0
    s_mov_b32 exec_lo, 0x300030
    s_mov_b32 exec_hi, 0x300030
    v_add_f32_dpp v228, v25, v24 quad_perm:[1,0,3,2] row_mask:0xf bank_mask:0xf
    v_add_f32_dpp v229, v27, v26 quad_perm:[1,0,3,2] row_mask:0xf bank_mask:0xf
    v_add_f32_dpp v230, v29, v28 quad_perm:[1,0,3,2] row_mask:0xf bank_mask:0xf
    v_add_f32_dpp v231, v31, v30 quad_perm:[1,0,3,2] row_mask:0xf bank_mask:0xf
    s_mov_b64 exec, -1
    s_waitcnt vmcnt(7)
    buffer_load_dwordx4 v[100:103], v1, s[28:31], s79 offen offset:128
    s_mov_b32 s91, s62
    s_call_b64 s[76:77], L_pack48_0
    s_waitcnt vmcnt(7)
    buffer_load_dwordx4 v[104:107], v1, s[28:31], s79 offen offset:2048
    s_call_b64 s[76:77], L_pack48_1
    ds_write_b128 v3, v[48:51] offset:13312
    ds_write_b128 v3, v[52:55] offset:14336
    ds_write_b128 v3, v[56:59] offset:15360
    v_and_b32 v34, 63, v0
    v_mul_u32_u24 v34, 12, v34
    v_sub_u32 v34, v3, v34
    ds_write_b32 v34, v32 offset:16384
    s_cmp_lg_u64 vcc, 0
    s_cselect_b32 s92, 8, 0
    s_or_b32 s82, s82, s92
    s_waitcnt vmcnt(7)
    buffer_load_dwordx4 v[108:111], v1, s[28:31], s79 offen offset:2176
    s_waitcnt vmcnt(12)
    v_mfma_f32_16x16x32_bf16 v[24:27], v[80:83], v[16:19], 0
    v_mfma_f32_16x16x32_bf16 v[28:31], v[88:91], v[16:19], 0
    v_mfma_f32_16x16x32_bf16 v[24:27], v[84:87], v[20:23], v[24:27]
    v_mfma_f32_16x16x32_bf16 v[28:31], v[92:95], v[20:23], v[28:31]
    s_add_u32 s68, s67, 4718592
    s_xor_b32 s78, s68, s67
    s_and_b32 s78, s78, 0xff800000
    s_xor_b32 s68, s68, s78
    s_waitcnt vmcnt(6)
    buffer_load_dwordx4 v[128:131], v1, s[28:31], s68 offen offset:0 nt
    s_mov_b32 exec_lo, 0xc000c00
    s_mov_b32 exec_hi, 0xc000c00
    v_add_f32_dpp v228, v25, v24 quad_perm:[1,0,3,2] row_mask:0xf bank_mask:0xf
    v_add_f32_dpp v229, v27, v26 quad_perm:[1,0,3,2] row_mask:0xf bank_mask:0xf
    v_add_f32_dpp v230, v29, v28 quad_perm:[1,0,3,2] row_mask:0xf bank_mask:0xf
    v_add_f32_dpp v231, v31, v30 quad_perm:[1,0,3,2] row_mask:0xf bank_mask:0xf
    s_mov_b64 exec, -1
    s_waitcnt vmcnt(6)
    buffer_load_dwordx4 v[132:135], v1, s[28:31], s68 offen offset:128 nt
    s_mov_b32 s91, s62
    s_call_b64 s[76:77], L_pack80_0
    s_waitcnt vmcnt(6)
    buffer_load_dwordx4 v[136:139], v1, s[28:31], s68 offen offset:2048 nt
    s_call_b64 s[76:77], L_pack80_1
    ds_write_b128 v3, v[80:83] offset:19968
    ds_write_b128 v3, v[84:87] offset:20992
    ds_write_b128 v3, v[88:91] offset:22016
    v_and_b32 v34, 63, v0
    v_mul_u32_u24 v34, 12, v34
    v_sub_u32 v34, v3, v34
    ds_write_b32 v34, v32 offset:23040
    s_cmp_lg_u64 vcc, 0
    s_cselect_b32 s92, 16, 0
    s_or_b32 s82, s82, s92
    s_add_u32 s79, s67, 4849664
    s_xor_b32 s78, s79, s67
    s_and_b32 s78, s78, 0xff800000
    s_xor_b32 s79, s79, s78
    s_waitcnt vmcnt(4)
    buffer_load_dwordx4 v[140:143], v1, s[28:31], s68 offen offset:2176 nt
    s_waitcnt vmcnt(4)
    buffer_load_dwordx4 v[48:51], v1, s[28:31], s79 offen offset:0 nt
    s_waitcnt vmcnt(13)
    v_mfma_f32_16x16x32_bf16 v[24:27], v[112:115], v[16:19], 0
    v_mfma_f32_16x16x32_bf16 v[28:31], v[120:123], v[16:19], 0
    v_mfma_f32_16x16x32_bf16 v[24:27], v[116:119], v[20:23], v[24:27]
    v_mfma_f32_16x16x32_bf16 v[28:31], v[124:127], v[20:23], v[28:31]
    s_waitcnt vmcnt(4)
    buffer_load_dwordx4 v[52:55], v1, s[28:31], s79 offen offset:128 nt
    s_waitcnt vmcnt(4)
    buffer_load_dwordx4 v[56:59], v1, s[28:31], s79 offen offset:2048 nt
    s_mov_b32 exec_lo, 0xc000c0
    s_mov_b32 exec_hi, 0xc000c0
    s_nop 0
    v_add_f32_dpp v244, v25, v24 quad_perm:[1,0,3,2] row_mask:0xf bank_mask:0xf
    v_add_f32_dpp v245, v27, v26 quad_perm:[1,0,3,2] row_mask:0xf bank_mask:0xf
    v_add_f32_dpp v246, v29, v28 quad_perm:[1,0,3,2] row_mask:0xf bank_mask:0xf
    v_add_f32_dpp v247, v31, v30 quad_perm:[1,0,3,2] row_mask:0xf bank_mask:0xf
    s_mov_b64 exec, -1
    s_waitcnt vmcnt(6)
    buffer_load_dwordx4 v[60:63], v1, s[28:31], s79 offen offset:2176 nt
    s_waitcnt vmcnt(12)
    v_mfma_f32_16x16x32_bf16 v[24:27], v[64:67], v[16:19], 0
    v_mfma_f32_16x16x32_bf16 v[28:31], v[72:75], v[16:19], 0
    v_mfma_f32_16x16x32_bf16 v[24:27], v[68:71], v[20:23], v[24:27]
    v_mfma_f32_16x16x32_bf16 v[28:31], v[76:79], v[20:23], v[28:31]
    s_add_u32 s68, s67, 4980736
    s_xor_b32 s78, s68, s67
    s_and_b32 s78, s78, 0xff800000
    s_xor_b32 s68, s68, s78
    s_waitcnt vmcnt(6)
    buffer_load_dwordx4 v[80:83], v1, s[28:31], s68 offen offset:0 nt
    s_mov_b32 exec_lo, 0x30003
    s_mov_b32 exec_hi, 0x30003
    v_add_f32_dpp v232, v25, v24 quad_perm:[1,0,3,2] row_mask:0xf bank_mask:0xf
    v_add_f32_dpp v233, v27, v26 quad_perm:[1,0,3,2] row_mask:0xf bank_mask:0xf
    v_add_f32_dpp v234, v29, v28 quad_perm:[1,0,3,2] row_mask:0xf bank_mask:0xf
    v_add_f32_dpp v235, v31, v30 quad_perm:[1,0,3,2] row_mask:0xf bank_mask:0xf
    s_mov_b64 exec, -1
    s_waitcnt vmcnt(6)
    buffer_load_dwordx4 v[84:87], v1, s[28:31], s68 offen offset:128 nt
    s_mov_b32 s91, s62
    s_call_b64 s[76:77], L_pack64_0
    s_waitcnt vmcnt(6)
    buffer_load_dwordx4 v[88:91], v1, s[28:31], s68 offen offset:2048 nt
    s_call_b64 s[76:77], L_pack64_1
    ds_write_b128 v3, v[64:67] offset:26624
    ds_write_b128 v3, v[68:71] offset:27648
    ds_write_b128 v3, v[72:75] offset:28672
    v_and_b32 v34, 63, v0
    v_mul_u32_u24 v34, 12, v34
    v_sub_u32 v34, v3, v34
    ds_write_b32 v34, v32 offset:29696
    s_cmp_lg_u64 vcc, 0
    s_cselect_b32 s92, 32, 0
    s_or_b32 s82, s82, s92
    s_add_u32 s79, s67, 5111808
    s_xor_b32 s78, s79, s67
    s_and_b32 s78, s78, 0xff800000
    s_xor_b32 s79, s79, s78
    s_waitcnt vmcnt(4)
    buffer_load_dwordx4 v[92:95], v1, s[28:31], s68 offen offset:2176 nt
    s_waitcnt vmcnt(4)
    buffer_load_dwordx4 v[112:115], v1, s[28:31], s79 offen offset:0 nt
    s_waitcnt vmcnt(13)
    v_mfma_f32_16x16x32_bf16 v[24:27], v[96:99], v[16:19], 0
    v_mfma_f32_16x16x32_bf16 v[28:31], v[104:107], v[16:19], 0
    v_mfma_f32_16x16x32_bf16 v[24:27], v[100:103], v[20:23], v[24:27]
    v_mfma_f32_16x16x32_bf16 v[28:31], v[108:111], v[20:23], v[28:31]
    s_waitcnt vmcnt(4)
    buffer_load_dwordx4 v[116:119], v1, s[28:31], s79 offen offset:128 nt
    s_waitcnt vmcnt(4)
    buffer_load_dwordx4 v[120:123], v1, s[28:31], s79 offen offset:2048 nt
    s_mov_b32 exec_lo, 0xc000c00
    s_mov_b32 exec_hi, 0xc000c00
    s_nop 0
    v_add_f32_dpp v244, v25, v24 quad_perm:[1,0,3,2] row_mask:0xf bank_mask:0xf
    v_add_f32_dpp v245, v27, v26 quad_perm:[1,0,3,2] row_mask:0xf bank_mask:0xf
    v_add_f32_dpp v246, v29, v28 quad_perm:[1,0,3,2] row_mask:0xf bank_mask:0xf
    v_add_f32_dpp v247, v31, v30 quad_perm:[1,0,3,2] row_mask:0xf bank_mask:0xf
    s_mov_b64 exec, -1
    s_waitcnt vmcnt(6)
    buffer_load_dwordx4 v[124:127], v1, s[28:31], s79 offen offset:2176 nt
    s_waitcnt vmcnt(12)
    v_mfma_f32_16x16x32_bf16 v[24:27], v[128:131], v[16:19], 0
    v_mfma_f32_16x16x32_bf16 v[28:31], v[136:139], v[16:19], 0
    v_mfma_f32_16x16x32_bf16 v[24:27], v[132:135], v[20:23], v[24:27]
    v_mfma_f32_16x16x32_bf16 v[28:31], v[140:143], v[20:23], v[28:31]
    s_add_u32 s68, s67, 5242880
    s_xor_b32 s78, s68, s67
    s_and_b32 s78, s78, 0xff800000
    s_xor_b32 s68, s68, s78
    s_waitcnt vmcnt(6)
    buffer_load_dwordx4 v[64:67], v1, s[28:31], s68 offen offset:0 nt
    s_mov_b32 exec_lo, 0xc000c0
    s_mov_b32 exec_hi, 0xc000c0
    v_add_f32_dpp v232, v25, v24 quad_perm:[1,0,3,2] row_mask:0xf bank_mask:0xf
    v_add_f32_dpp v233, v27, v26 quad_perm:[1,0,3,2] row_mask:0xf bank_mask:0xf
    v_add_f32_dpp v234, v29, v28 quad_perm:[1,0,3,2] row_mask:0xf bank_mask:0xf
    v_add_f32_dpp v235, v31, v30 quad_perm:[1,0,3,2] row_mask:0xf bank_mask:0xf
    s_mov_b64 exec, -1
    s_waitcnt vmcnt(6)
    buffer_load_dwordx4 v[68:71], v1, s[28:31], s68 offen offset:128 nt
    s_mov_b32 s91, s62
    s_call_b64 s[76:77], L_pack128_0
    s_waitcnt vmcnt(6)
    buffer_load_dwordx4 v[72:75], v1, s[28:31], s68 offen offset:2048 nt
    s_call_b64 s[76:77], L_pack128_1
    ds_write_b128 v3, v[128:131] offset:33280
    ds_write_b128 v3, v[132:135] offset:34304
    ds_write_b128 v3, v[136:139] offset:35328
    v_and_b32 v34, 63, v0
    v_mul_u32_u24 v34, 12, v34
    v_sub_u32 v34, v3, v34
    ds_write_b32 v34, v32 offset:36352
    s_cmp_lg_u64 vcc, 0
    s_cselect_b32 s92, 64, 0
    s_or_b32 s82, s82, s92
    s_waitcnt vmcnt(6)
    buffer_load_dwordx4 v[76:79], v1, s[28:31], s68 offen offset:2176 nt
    s_waitcnt vmcnt(12)
    v_mfma_f32_16x16x32_bf16 v[24:27], v[48:51], v[16:19], 0
    v_mfma_f32_16x16x32_bf16 v[28:31], v[56:59], v[16:19], 0
    v_mfma_f32_16x16x32_bf16 v[24:27], v[52:55], v[20:23], v[24:27]
    v_mfma_f32_16x16x32_bf16 v[28:31], v[60:63], v[20:23], v[28:31]
    s_add_u32 s79, s67, 5373952
    s_xor_b32 s78, s79, s67
    s_and_b32 s78, s78, 0xff800000
    s_xor_b32 s79, s79, s78
    s_waitcnt vmcnt(7)
    buffer_load_dwordx4 v[96:99], v1, s[28:31], s79 offen offset:0
    s_mov_b32 exec_lo, 0xc000c00
    s_mov_b32 exec_hi, 0xc000c00
    v_add_f32_dpp v232, v25, v24 quad_perm:[1,0,3,2] row_mask:0xf bank_mask:0xf
    v_add_f32_dpp v233, v27, v26 quad_perm:[1,0,3,2] row_mask:0xf bank_mask:0xf
    v_add_f32_dpp v234, v29, v28 quad_perm:[1,0,3,2] row_mask:0xf bank_mask:0xf
    v_add_f32_dpp v235, v31, v30 quad_perm:[1,0,3,2] row_mask:0xf bank_mask:0xf
    s_mov_b64 exec, -1
    s_waitcnt vmcnt(7)
    buffer_load_dwordx4 v[100:103], v1, s[28:31], s79 offen offset:128
    s_mov_b32 s91, s62
    s_call_b64 s[76:77], L_pack48_0
    s_waitcnt vmcnt(7)
    buffer_load_dwordx4 v[104:107], v1, s[28:31], s79 offen offset:2048
    s_call_b64 s[76:77], L_pack48_1
    v_mov_b32 v173, v48
    v_mov_b32 v174, v49
    v_mov_b32 v175, v50
    v_mov_b32 v176, v51
    v_mov_b32 v177, v52
    v_mov_b32 v178, v53
    v_mov_b32 v179, v54
    v_mov_b32 v180, v55
    v_mov_b32 v181, v56
    v_mov_b32 v182, v57
    v_mov_b32 v183, v58
    v_mov_b32 v184, v59
    v_mov_b32 v185, v32
    s_cmp_lg_u64 vcc, 0
    s_cselect_b32 s92, 128, 0
    s_or_b32 s82, s82, s92
    s_add_u32 s68, s67, 5505024
    s_xor_b32 s78, s68, s67
    s_and_b32 s78, s78, 0xff800000
    s_xor_b32 s68, s68, s78
    s_waitcnt vmcnt(5)
    buffer_load_dwordx4 v[108:111], v1, s[28:31], s79 offen offset:2176
    s_waitcnt vmcnt(4)
    buffer_load_dwordx4 v[128:131], v1, s[28:31], s68 offen offset:0 nt
    s_waitcnt vmcnt(13)
    v_mfma_f32_16x16x32_bf16 v[24:27], v[80:83], v[16:19], 0
    v_mfma_f32_16x16x32_bf16 v[28:31], v[88:91], v[16:19], 0
    v_mfma_f32_16x16x32_bf16 v[24:27], v[84:87], v[20:23], v[24:27]
    v_mfma_f32_16x16x32_bf16 v[28:31], v[92:95], v[20:23], v[28:31]
    s_waitcnt vmcnt(4)
    buffer_load_dwordx4 v[132:135], v1, s[28:31], s68 offen offset:128 nt
    s_waitcnt vmcnt(4)
    buffer_load_dwordx4 v[136:139], v1, s[28:31], s68 offen offset:2048 nt
    s_mov_b32 exec_lo, 0x30003000
    s_mov_b32 exec_hi, 0x30003000
    s_nop 0
    v_add_f32_dpp v244, v25, v24 quad_perm:[1,0,3,2] row_mask:0xf bank_mask:0xf
    v_add_f32_dpp v245, v27, v26 quad_perm:[1,0,3,2] row_mask:0xf bank_mask:0xf
    v_add_f32_dpp v246, v29, v28 quad_perm:[1,0,3,2] row_mask:0xf bank_mask:0xf
    v_add_f32_dpp v247, v31, v30 quad_perm:[1,0,3,2] row_mask:0xf bank_mask:0xf
    s_mov_b64 exec, -1
    s_waitcnt vmcnt(6)
    buffer_load_dwordx4 v[140:143], v1, s[28:31], s68 offen offset:2176 nt
    s_waitcnt vmcnt(12)
    v_mfma_f32_16x16x32_bf16 v[24:27], v[112:115], v[16:19], 0
    v_mfma_f32_16x16x32_bf16 v[28:31], v[120:123], v[16:19], 0
    v_mfma_f32_16x16x32_bf16 v[24:27], v[116:119], v[20:23], v[24:27]
    v_mfma_f32_16x16x32_bf16 v[28:31], v[124:127], v[20:23], v[28:31]
    s_add_u32 s79, s67, 5636096
    s_xor_b32 s78, s79, s67
    s_and_b32 s78, s78, 0xff800000
    s_xor_b32 s79, s79, s78
    s_waitcnt vmcnt(6)
    buffer_load_dwordx4 v[48:51], v1, s[28:31], s79 offen offset:0 nt
    s_mov_b32 exec_lo, 0x30003
    s_mov_b32 exec_hi, 0x30003
    v_add_f32_dpp v236, v25, v24 quad_perm:[1,0,3,2] row_mask:0xf bank_mask:0xf
    v_add_f32_dpp v237, v27, v26 quad_perm:[1,0,3,2] row_mask:0xf bank_mask:0xf
    v_add_f32_dpp v238, v29, v28 quad_perm:[1,0,3,2] row_mask:0xf bank_mask:0xf
    v_add_f32_dpp v239, v31, v30 quad_perm:[1,0,3,2] row_mask:0xf bank_mask:0xf
    s_mov_b64 exec, -1
    s_waitcnt vmcnt(6)
    buffer_load_dwordx4 v[52:55], v1, s[28:31], s79 offen offset:128 nt
    s_mov_b32 s91, s62
    s_call_b64 s[76:77], L_pack112_0
    s_waitcnt vmcnt(6)
    buffer_load_dwordx4 v[56:59], v1, s[28:31], s79 offen offset:2048 nt
    s_call_b64 s[76:77], L_pack112_1
    v_mov_b32 v199, v112
    v_mov_b32 v200, v113
    v_mov_b32 v201, v114
    v_mov_b32 v202, v115
    v_mov_b32 v203, v116
    v_mov_b32 v204, v117
    v_mov_b32 v205, v118
    v_mov_b32 v206, v119
    v_mov_b32 v207, v120
    v_mov_b32 v208, v121
    v_mov_b32 v209, v122
    v_mov_b32 v210, v123
    v_mov_b32 v211, v32
    s_cmp_lg_u64 vcc, 0
    s_cselect_b32 s92, 256, 0
    s_or_b32 s82, s82, s92
    s_waitcnt vmcnt(6)
    buffer_load_dwordx4 v[60:63], v1, s[28:31], s79 offen offset:2176 nt
    s_waitcnt vmcnt(12)
    v_mfma_f32_16x16x32_bf16 v[24:27], v[64:67], v[16:19], 0
    v_mfma_f32_16x16x32_bf16 v[28:31], v[72:75], v[16:19], 0
    v_mfma_f32_16x16x32_bf16 v[24:27], v[68:71], v[20:23], v[24:27]
    v_mfma_f32_16x16x32_bf16 v[28:31], v[76:79], v[20:23], v[28:31]
    s_add_u32 s68, s67, 5767168
    s_xor_b32 s78, s68, s67
    s_and_b32 s78, s78, 0xff800000
    s_xor_b32 s68, s68, s78
    s_waitcnt vmcnt(6)
    buffer_load_dwordx4 v[80:83], v1, s[28:31], s68 offen offset:0 nt
    s_mov_b32 exec_lo, 0xc000c0
    s_mov_b32 exec_hi, 0xc000c0
    v_add_f32_dpp v236, v25, v24 quad_perm:[1,0,3,2] row_mask:0xf bank_mask:0xf
    v_add_f32_dpp v237, v27, v26 quad_perm:[1,0,3,2] row_mask:0xf bank_mask:0xf
    v_add_f32_dpp v238, v29, v28 quad_perm:[1,0,3,2] row_mask:0xf bank_mask:0xf
    v_add_f32_dpp v239, v31, v30 quad_perm:[1,0,3,2] row_mask:0xf bank_mask:0xf
    s_mov_b64 exec, -1
    s_waitcnt vmcnt(6)
    buffer_load_dwordx4 v[84:87], v1, s[28:31], s68 offen offset:128 nt
    s_mov_b32 s91, s62
    s_call_b64 s[76:77], L_pack64_0
    s_waitcnt vmcnt(6)
    buffer_load_dwordx4 v[88:91], v1, s[28:31], s68 offen offset:2048 nt
    s_call_b64 s[76:77], L_pack64_1
    v_accvgpr_write_b32 a1, v64
    v_accvgpr_write_b32 a2, v65
    v_accvgpr_write_b32 a3, v66
    v_accvgpr_write_b32 a4, v67
    v_accvgpr_write_b32 a5, v68
    v_accvgpr_write_b32 a6, v69
    v_accvgpr_write_b32 a7, v70
    v_accvgpr_write_b32 a8, v71
    v_accvgpr_write_b32 a9, v72
    v_accvgpr_write_b32 a10, v73
    v_accvgpr_write_b32 a11, v74
    v_accvgpr_write_b32 a12, v75
    v_accvgpr_write_b32 a13, v32
    s_cmp_lg_u64 vcc, 0
    s_cselect_b32 s92, 512, 0
    s_or_b32 s82, s82, s92
    s_add_u32 s79, s67, 5898240
    s_xor_b32 s78, s79, s67
    s_and_b32 s78, s78, 0xff800000
    s_xor_b32 s79, s79, s78
    s_waitcnt vmcnt(4)
    buffer_load_dwordx4 v[92:95], v1, s[28:31], s68 offen offset:2176 nt
    s_waitcnt vmcnt(4)
    buffer_load_dwordx4 v[112:115], v1, s[28:31], s79 offen offset:0 nt
    s_waitcnt vmcnt(13)
    v_mfma_f32_16x16x32_bf16 v[24:27], v[96:99], v[16:19], 0
    v_mfma_f32_16x16x32_bf16 v[28:31], v[104:107], v[16:19], 0
    v_mfma_f32_16x16x32_bf16 v[24:27], v[100:103], v[20:23], v[24:27]
    v_mfma_f32_16x16x32_bf16 v[28:31], v[108:111], v[20:23], v[28:31]
    s_waitcnt vmcnt(4)
    buffer_load_dwordx4 v[116:119], v1, s[28:31], s79 offen offset:128 nt
    s_waitcnt vmcnt(4)
    buffer_load_dwordx4 v[120:123], v1, s[28:31], s79 offen offset:2048 nt
    s_mov_b32 exec_lo, 0x30003
    s_mov_b32 exec_hi, 0x30003
    s_nop 0
    v_add_f32_dpp v248, v25, v24 quad_perm:[1,0,3,2] row_mask:0xf bank_mask:0xf
    v_add_f32_dpp v249, v27, v26 quad_perm:[1,0,3,2] row_mask:0xf bank_mask:0xf
    v_add_f32_dpp v250, v29, v28 quad_perm:[1,0,3,2] row_mask:0xf bank_mask:0xf
    v_add_f32_dpp v251, v31, v30 quad_perm:[1,0,3,2] row_mask:0xf bank_mask:0xf
    s_mov_b64 exec, -1
    s_waitcnt vmcnt(6)
    buffer_load_dwordx4 v[124:127], v1, s[28:31], s79 offen offset:2176 nt
    s_waitcnt vmcnt(12)
    v_mfma_f32_16x16x32_bf16 v[24:27], v[128:131], v[16:19], 0
    v_mfma_f32_16x16x32_bf16 v[28:31], v[136:139], v[16:19], 0
    v_mfma_f32_16x16x32_bf16 v[24:27], v[132:135], v[20:23], v[24:27]
    v_mfma_f32_16x16x32_bf16 v[28:31], v[140:143], v[20:23], v[28:31]
    s_add_u32 s68, s67, 6029312
    s_xor_b32 s78, s68, s67
    s_and_b32 s78, s78, 0xff800000
    s_xor_b32 s68, s68, s78
    s_waitcnt vmcnt(6)
    buffer_load_dwordx4 v[64:67], v1, s[28:31], s68 offen offset:0 nt
    s_mov_b32 exec_lo, 0x30003000
    s_mov_b32 exec_hi, 0x30003000
    v_add_f32_dpp v236, v25, v24 quad_perm:[1,0,3,2] row_mask:0xf bank_mask:0xf
    v_add_f32_dpp v237, v27, v26 quad_perm:[1,0,3,2] row_mask:0xf bank_mask:0xf
    v_add_f32_dpp v238, v29, v28 quad_perm:[1,0,3,2] row_mask:0xf bank_mask:0xf
    v_add_f32_dpp v239, v31, v30 quad_perm:[1,0,3,2] row_mask:0xf bank_mask:0xf
    s_mov_b64 exec, -1
    s_waitcnt vmcnt(6)
    buffer_load_dwordx4 v[68:71], v1, s[28:31], s68 offen offset:128 nt
    s_mov_b32 s91, s62
    s_call_b64 s[76:77], L_pack128_0
    s_waitcnt vmcnt(6)
    buffer_load_dwordx4 v[72:75], v1, s[28:31], s68 offen offset:2048 nt
    s_call_b64 s[76:77], L_pack128_1
    v_accvgpr_write_b32 a27, v128
    v_accvgpr_write_b32 a28, v129
    v_accvgpr_write_b32 a29, v130
    v_accvgpr_write_b32 a30, v131
    v_accvgpr_write_b32 a31, v132
    v_accvgpr_write_b32 a32, v133
    v_accvgpr_write_b32 a33, v134
    v_accvgpr_write_b32 a34, v135
    v_accvgpr_write_b32 a35, v136
    v_accvgpr_write_b32 a36, v137
    v_accvgpr_write_b32 a37, v138
    v_accvgpr_write_b32 a38, v139
    v_accvgpr_write_b32 a39, v32
    s_cmp_lg_u64 vcc, 0
    s_cselect_b32 s92, 1024, 0
    s_or_b32 s82, s82, s92
    s_waitcnt vmcnt(6)
    buffer_load_dwordx4 v[76:79], v1, s[28:31], s68 offen offset:2176 nt
    s_waitcnt vmcnt(12)
    v_mfma_f32_16x16x32_bf16 v[24:27], v[48:51], v[16:19], 0
    v_mfma_f32_16x16x32_bf16 v[28:31], v[56:59], v[16:19], 0
    v_mfma_f32_16x16x32_bf16 v[24:27], v[52:55], v[20:23], v[24:27]
    v_mfma_f32_16x16x32_bf16 v[28:31], v[60:63], v[20:23], v[28:31]
    s_add_u32 s79, s67, 6160384
    s_xor_b32 s78, s79, s67
    s_and_b32 s78, s78, 0xff800000
    s_xor_b32 s79, s79, s78
    s_waitcnt vmcnt(7)
    buffer_load_dwordx4 v[96:99], v1, s[28:31], s79 offen offset:0
    s_mov_b32 exec_lo, 0xc000c
    s_mov_b32 exec_hi, 0xc000c
    v_add_f32_dpp v240, v25, v24 quad_perm:[1,0,3,2] row_mask:0xf bank_mask:0xf
    v_add_f32_dpp v241, v27, v26 quad_perm:[1,0,3,2] row_mask:0xf bank_mask:0xf
    v_add_f32_dpp v242, v29, v28 quad_perm:[1,0,3,2] row_mask:0xf bank_mask:0xf
    v_add_f32_dpp v243, v31, v30 quad_perm:[1,0,3,2] row_mask:0xf bank_mask:0xf
    s_mov_b64 exec, -1
    s_waitcnt vmcnt(7)
    buffer_load_dwordx4 v[100:103], v1, s[28:31], s79 offen offset:128
    s_mov_b32 s91, s62
    s_call_b64 s[76:77], L_pack48_0
    s_waitcnt vmcnt(7)
    buffer_load_dwordx4 v[104:107], v1, s[28:31], s79 offen offset:2048
    s_call_b64 s[76:77], L_pack48_1
    v_accvgpr_write_b32 a53, v48
    v_accvgpr_write_b32 a54, v49
    v_accvgpr_write_b32 a55, v50
    v_accvgpr_write_b32 a56, v51
    v_accvgpr_write_b32 a57, v52
    v_accvgpr_write_b32 a58, v53
    v_accvgpr_write_b32 a59, v54
    v_accvgpr_write_b32 a60, v55
    v_accvgpr_write_b32 a61, v56
    v_accvgpr_write_b32 a62, v57
    v_accvgpr_write_b32 a63, v58
    v_accvgpr_write_b32 a64, v59
    v_accvgpr_write_b32 a65, v32
    s_cmp_lg_u64 vcc, 0
    s_cselect_b32 s92, 2048, 0
    s_or_b32 s82, s82, s92
    s_add_u32 s68, s67, 6291456
    s_xor_b32 s78, s68, s67
    s_and_b32 s78, s78, 0xff800000
    s_xor_b32 s68, s68, s78
    s_waitcnt vmcnt(5)
    buffer_load_dwordx4 v[108:111], v1, s[28:31], s79 offen offset:2176
    s_waitcnt vmcnt(4)
    buffer_load_dwordx4 v[128:131], v1, s[28:31], s68 offen offset:0 nt
    s_waitcnt vmcnt(13)
    v_mfma_f32_16x16x32_bf16 v[24:27], v[80:83], v[16:19], 0
    v_mfma_f32_16x16x32_bf16 v[28:31], v[88:91], v[16:19], 0
    v_mfma_f32_16x16x32_bf16 v[24:27], v[84:87], v[20:23], v[24:27]
    v_mfma_f32_16x16x32_bf16 v[28:31], v[92:95], v[20:23], v[28:31]
    s_waitcnt vmcnt(4)
    buffer_load_dwordx4 v[132:135], v1, s[28:31], s68 offen offset:128 nt
    s_waitcnt vmcnt(4)
    buffer_load_dwordx4 v[136:139], v1, s[28:31], s68 offen offset:2048 nt
    s_mov_b32 exec_lo, 0xc000c
    s_mov_b32 exec_hi, 0xc000c
    s_nop 0
    v_add_f32_dpp v248, v25, v24 quad_perm:[1,0,3,2] row_mask:0xf bank_mask:0xf
    v_add_f32_dpp v249, v27, v26 quad_perm:[1,0,3,2] row_mask:0xf bank_mask:0xf
    v_add_f32_dpp v250, v29, v28 quad_perm:[1,0,3,2] row_mask:0xf bank_mask:0xf
    v_add_f32_dpp v251, v31, v30 quad_perm:[1,0,3,2] row_mask:0xf bank_mask:0xf
    s_mov_b64 exec, -1
    s_waitcnt vmcnt(6)
    buffer_load_dwordx4 v[140:143], v1, s[28:31], s68 offen offset:2176 nt
    s_waitcnt vmcnt(12)
    v_mfma_f32_16x16x32_bf16 v[24:27], v[112:115], v[16:19], 0
    v_mfma_f32_16x16x32_bf16 v[28:31], v[120:123], v[16:19], 0
    v_mfma_f32_16x16x32_bf16 v[24:27], v[116:119], v[20:23], v[24:27]
    v_mfma_f32_16x16x32_bf16 v[28:31], v[124:127], v[20:23], v[28:31]
    s_add_u32 s79, s67, 6422528
    s_xor_b32 s78, s79, s67
    s_and_b32 s78, s78, 0xff800000
    s_xor_b32 s79, s79, s78
    s_waitcnt vmcnt(6)
    buffer_load_dwordx4 v[48:51], v1, s[28:31], s79 offen offset:0 nt
    s_mov_b32 exec_lo, 0x3000300
    s_mov_b32 exec_hi, 0x3000300
    v_add_f32_dpp v240, v25, v24 quad_perm:[1,0,3,2] row_mask:0xf bank_mask:0xf
    v_add_f32_dpp v241, v27, v26 quad_perm:[1,0,3,2] row_mask:0xf bank_mask:0xf
    v_add_f32_dpp v242, v29, v28 quad_perm:[1,0,3,2] row_mask:0xf bank_mask:0xf
    v_add_f32_dpp v243, v31, v30 quad_perm:[1,0,3,2] row_mask:0xf bank_mask:0xf
    s_mov_b64 exec, -1
    s_waitcnt vmcnt(6)
    buffer_load_dwordx4 v[52:55], v1, s[28:31], s79 offen offset:128 nt
    s_mov_b32 s91, s62
    s_call_b64 s[76:77], L_pack112_0
    s_waitcnt vmcnt(6)
    buffer_load_dwordx4 v[56:59], v1, s[28:31], s79 offen offset:2048 nt
    s_call_b64 s[76:77], L_pack112_1
    v_accvgpr_write_b32 a79, v112
    v_accvgpr_write_b32 a80, v113
    v_accvgpr_write_b32 a81, v114
    v_accvgpr_write_b32 a82, v115
    v_accvgpr_write_b32 a83, v116
    v_accvgpr_write_b32 a84, v117
    v_accvgpr_write_b32 a85, v118
    v_accvgpr_write_b32 a86, v119
    v_accvgpr_write_b32 a87, v120
    v_accvgpr_write_b32 a88, v121
    v_accvgpr_write_b32 a89, v122
    v_accvgpr_write_b32 a90, v123
    v_accvgpr_write_b32 a91, v32
    s_cmp_lg_u64 vcc, 0
    s_cselect_b32 s92, 4096, 0
    s_or_b32 s82, s82, s92
    s_waitcnt vmcnt(6)
    buffer_load_dwordx4 v[60:63], v1, s[28:31], s79 offen offset:2176 nt
    s_waitcnt vmcnt(12)
    v_mfma_f32_16x16x32_bf16 v[24:27], v[64:67], v[16:19], 0
    v_mfma_f32_16x16x32_bf16 v[28:31], v[72:75], v[16:19], 0
    v_mfma_f32_16x16x32_bf16 v[24:27], v[68:71], v[20:23], v[24:27]
    v_mfma_f32_16x16x32_bf16 v[28:31], v[76:79], v[20:23], v[28:31]
    s_add_u32 s68, s67, 6553600
    s_xor_b32 s78, s68, s67
    s_and_b32 s78, s78, 0xff800000
    s_xor_b32 s68, s68, s78
    s_waitcnt vmcnt(6)
    buffer_load_dwordx4 v[80:83], v1, s[28:31], s68 offen offset:0 nt
    s_mov_b32 exec_lo, 0x30003000
    s_mov_b32 exec_hi, 0x30003000
    v_add_f32_dpp v240, v25, v24 quad_perm:[1,0,3,2] row_mask:0xf bank_mask:0xf
    v_add_f32_dpp v241, v27, v26 quad_perm:[1,0,3,2] row_mask:0xf bank_mask:0xf
    v_add_f32_dpp v242, v29, v28 quad_perm:[1,0,3,2] row_mask:0xf bank_mask:0xf
    v_add_f32_dpp v243, v31, v30 quad_perm:[1,0,3,2] row_mask:0xf bank_mask:0xf
    s_mov_b64 exec, -1
    s_waitcnt vmcnt(6)
    buffer_load_dwordx4 v[84:87], v1, s[28:31], s68 offen offset:128 nt
    s_mov_b32 s91, s62
    s_call_b64 s[76:77], L_pack64_0
    s_waitcnt vmcnt(6)
    buffer_load_dwordx4 v[88:91], v1, s[28:31], s68 offen offset:2048 nt
    s_call_b64 s[76:77], L_pack64_1
    v_accvgpr_write_b32 a105, v64
    v_accvgpr_write_b32 a106, v65
    v_accvgpr_write_b32 a107, v66
    v_accvgpr_write_b32 a108, v67
    v_accvgpr_write_b32 a109, v68
    v_accvgpr_write_b32 a110, v69
    v_accvgpr_write_b32 a111, v70
    v_accvgpr_write_b32 a112, v71
    v_accvgpr_write_b32 a113, v72
    v_accvgpr_write_b32 a114, v73
    v_accvgpr_write_b32 a115, v74
    v_accvgpr_write_b32 a116, v75
    v_accvgpr_write_b32 a117, v32
    s_cmp_lg_u64 vcc, 0
    s_cselect_b32 s92, 8192, 0
    s_or_b32 s82, s82, s92
    s_add_u32 s79, s67, 6684672
    s_xor_b32 s78, s79, s67
    s_and_b32 s78, s78, 0xff800000
    s_xor_b32 s79, s79, s78
    s_waitcnt vmcnt(4)
    buffer_load_dwordx4 v[92:95], v1, s[28:31], s68 offen offset:2176 nt
    s_waitcnt vmcnt(4)
    buffer_load_dwordx4 v[112:115], v1, s[28:31], s79 offen offset:0 nt
    s_waitcnt vmcnt(13)
    v_mfma_f32_16x16x32_bf16 v[24:27], v[96:99], v[16:19], 0
    v_mfma_f32_16x16x32_bf16 v[28:31], v[104:107], v[16:19], 0
    v_mfma_f32_16x16x32_bf16 v[24:27], v[100:103], v[20:23], v[24:27]
    v_mfma_f32_16x16x32_bf16 v[28:31], v[108:111], v[20:23], v[28:31]
    s_waitcnt vmcnt(4)
    buffer_load_dwordx4 v[116:119], v1, s[28:31], s79 offen offset:128 nt
    s_waitcnt vmcnt(4)
    buffer_load_dwordx4 v[120:123], v1, s[28:31], s79 offen offset:2048 nt
    s_mov_b32 exec_lo, 0xc000c0
    s_mov_b32 exec_hi, 0xc000c0
    s_nop 0
    v_add_f32_dpp v248, v25, v24 quad_perm:[1,0,3,2] row_mask:0xf bank_mask:0xf
    v_add_f32_dpp v249, v27, v26 quad_perm:[1,0,3,2] row_mask:0xf bank_mask:0xf
    v_add_f32_dpp v250, v29, v28 quad_perm:[1,0,3,2] row_mask:0xf bank_mask:0xf
    v_add_f32_dpp v251, v31, v30 quad_perm:[1,0,3,2] row_mask:0xf bank_mask:0xf
    s_mov_b64 exec, -1
    s_waitcnt vmcnt(6)
    buffer_load_dwordx4 v[124:127], v1, s[28:31], s79 offen offset:2176 nt
    s_waitcnt vmcnt(12)
    v_mfma_f32_16x16x32_bf16 v[24:27], v[128:131], v[16:19], 0
    v_mfma_f32_16x16x32_bf16 v[28:31], v[136:139], v[16:19], 0
    v_mfma_f32_16x16x32_bf16 v[24:27], v[132:135], v[20:23], v[24:27]
    v_mfma_f32_16x16x32_bf16 v[28:31], v[140:143], v[20:23], v[28:31]
    s_add_u32 s68, s67, 6815744
    s_xor_b32 s78, s68, s67
    s_and_b32 s78, s78, 0xff800000
    s_xor_b32 s68, s68, s78
    s_waitcnt vmcnt(7)
    buffer_load_dwordx4 v[64:67], v1, s[28:31], s68 offen offset:0
    s_mov_b32 exec_lo, 0xc000c
    s_mov_b32 exec_hi, 0xc000c
    v_add_f32_dpp v244, v25, v24 quad_perm:[1,0,3,2] row_mask:0xf bank_mask:0xf
    v_add_f32_dpp v245, v27, v26 quad_perm:[1,0,3,2] row_mask:0xf bank_mask:0xf
    v_add_f32_dpp v246, v29, v28 quad_perm:[1,0,3,2] row_mask:0xf bank_mask:0xf
    v_add_f32_dpp v247, v31, v30 quad_perm:[1,0,3,2] row_mask:0xf bank_mask:0xf
    s_mov_b64 exec, -1
    s_waitcnt vmcnt(7)
    buffer_load_dwordx4 v[68:71], v1, s[28:31], s68 offen offset:128
    s_mov_b32 s91, s62
    s_call_b64 s[76:77], L_pack128_0
    s_waitcnt vmcnt(7)
    buffer_load_dwordx4 v[72:75], v1, s[28:31], s68 offen offset:2048
    s_call_b64 s[76:77], L_pack128_1
    v_accvgpr_write_b32 a131, v128
    v_accvgpr_write_b32 a132, v129
    v_accvgpr_write_b32 a133, v130
    v_accvgpr_write_b32 a134, v131
    v_accvgpr_write_b32 a135, v132
    v_accvgpr_write_b32 a136, v133
    v_accvgpr_write_b32 a137, v134
    v_accvgpr_write_b32 a138, v135
    v_accvgpr_write_b32 a139, v136
    v_accvgpr_write_b32 a140, v137
    v_accvgpr_write_b32 a141, v138
    v_accvgpr_write_b32 a142, v139
    v_accvgpr_write_b32 a143, v32
    s_cmp_lg_u64 vcc, 0
    s_cselect_b32 s92, 16384, 0
    s_or_b32 s82, s82, s92
    s_add_u32 s79, s67, 6946816
    s_xor_b32 s78, s79, s67
    s_and_b32 s78, s78, 0xff800000
    s_xor_b32 s79, s79, s78
    s_waitcnt vmcnt(5)
    buffer_load_dwordx4 v[76:79], v1, s[28:31], s68 offen offset:2176
    s_waitcnt vmcnt(4)
    buffer_load_dwordx4 v[96:99], v1, s[28:31], s79 offen offset:0 nt
    s_waitcnt vmcnt(13)
    v_mfma_f32_16x16x32_bf16 v[24:27], v[48:51], v[16:19], 0
    v_mfma_f32_16x16x32_bf16 v[28:31], v[56:59], v[16:19], 0
    v_mfma_f32_16x16x32_bf16 v[24:27], v[52:55], v[20:23], v[24:27]
    v_mfma_f32_16x16x32_bf16 v[28:31], v[60:63], v[20:23], v[28:31]
    s_waitcnt vmcnt(4)
    buffer_load_dwordx4 v[100:103], v1, s[28:31], s79 offen offset:128 nt
    s_waitcnt vmcnt(4)
    buffer_load_dwordx4 v[104:107], v1, s[28:31], s79 offen offset:2048 nt
    s_mov_b32 exec_lo, 0x3000300
    s_mov_b32 exec_hi, 0x3000300
    s_nop 0
    v_add_f32_dpp v248, v25, v24 quad_perm:[1,0,3,2] row_mask:0xf bank_mask:0xf
    v_add_f32_dpp v249, v27, v26 quad_perm:[1,0,3,2] row_mask:0xf bank_mask:0xf
    v_add_f32_dpp v250, v29, v28 quad_perm:[1,0,3,2] row_mask:0xf bank_mask:0xf
    v_add_f32_dpp v251, v31, v30 quad_perm:[1,0,3,2] row_mask:0xf bank_mask:0xf
    s_mov_b64 exec, -1
    s_waitcnt vmcnt(6)
    buffer_load_dwordx4 v[108:111], v1, s[28:31], s79 offen offset:2176 nt
    s_waitcnt vmcnt(12)
    v_mfma_f32_16x16x32_bf16 v[24:27], v[80:83], v[16:19], 0
    v_mfma_f32_16x16x32_bf16 v[28:31], v[88:91], v[16:19], 0
    v_mfma_f32_16x16x32_bf16 v[24:27], v[84:87], v[20:23], v[24:27]
    v_mfma_f32_16x16x32_bf16 v[28:31], v[92:95], v[20:23], v[28:31]
    s_add_u32 s68, s67, 7077888
    s_xor_b32 s78, s68, s67
    s_and_b32 s78, s78, 0xff800000
    s_xor_b32 s68, s68, s78
    s_waitcnt vmcnt(6)
    buffer_load_dwordx4 v[128:131], v1, s[28:31], s68 offen offset:0 nt
    s_mov_b32 exec_lo, 0x3000300
    s_mov_b32 exec_hi, 0x3000300
    v_add_f32_dpp v244, v25, v24 quad_perm:[1,0,3,2] row_mask:0xf bank_mask:0xf
    v_add_f32_dpp v245, v27, v26 quad_perm:[1,0,3,2] row_mask:0xf bank_mask:0xf
    v_add_f32_dpp v246, v29, v28 quad_perm:[1,0,3,2] row_mask:0xf bank_mask:0xf
    v_add_f32_dpp v247, v31, v30 quad_perm:[1,0,3,2] row_mask:0xf bank_mask:0xf
    s_mov_b64 exec, -1
    s_waitcnt vmcnt(6)
    buffer_load_dwordx4 v[132:135], v1, s[28:31], s68 offen offset:128 nt
    s_mov_b32 s91, s62
    s_call_b64 s[76:77], L_pack80_0
    s_waitcnt vmcnt(6)
    buffer_load_dwordx4 v[136:139], v1, s[28:31], s68 offen offset:2048 nt
    s_call_b64 s[76:77], L_pack80_1
    v_accvgpr_write_b32 a157, v80
    v_accvgpr_write_b32 a158, v81
    v_accvgpr_write_b32 a159, v82
    v_accvgpr_write_b32 a160, v83
    v_accvgpr_write_b32 a161, v84
    v_accvgpr_write_b32 a162, v85
    v_accvgpr_write_b32 a163, v86
    v_accvgpr_write_b32 a164, v87
    v_accvgpr_write_b32 a165, v88
    v_accvgpr_write_b32 a166, v89
    v_accvgpr_write_b32 a167, v90
    v_accvgpr_write_b32 a168, v91
    v_accvgpr_write_b32 a169, v32
    s_cmp_lg_u64 vcc, 0
    s_cselect_b32 s92, 32768, 0
    s_or_b32 s82, s82, s92
    s_waitcnt vmcnt(6)
    buffer_load_dwordx4 v[140:143], v1, s[28:31], s68 offen offset:2176 nt
    s_waitcnt vmcnt(12)
    v_mfma_f32_16x16x32_bf16 v[24:27], v[112:115], v[16:19], 0
    v_mfma_f32_16x16x32_bf16 v[28:31], v[120:123], v[16:19], 0
    v_mfma_f32_16x16x32_bf16 v[24:27], v[116:119], v[20:23], v[24:27]
    v_mfma_f32_16x16x32_bf16 v[28:31], v[124:127], v[20:23], v[28:31]
    s_add_u32 s79, s67, 7208960
    s_xor_b32 s78, s79, s67
    s_and_b32 s78, s78, 0xff800000
    s_xor_b32 s79, s79, s78
    s_waitcnt vmcnt(6)
    buffer_load_dwordx4 v[48:51], v1, s[28:31], s79 offen offset:0 nt
    s_mov_b32 exec_lo, 0xc000c000
    s_mov_b32 exec_hi, 0xc000c000
    v_add_f32_dpp v244, v25, v24 quad_perm:[1,0,3,2] row_mask:0xf bank_mask:0xf
    v_add_f32_dpp v245, v27, v26 quad_perm:[1,0,3,2] row_mask:0xf bank_mask:0xf
    v_add_f32_dpp v246, v29, v28 quad_perm:[1,0,3,2] row_mask:0xf bank_mask:0xf
    v_add_f32_dpp v247, v31, v30 quad_perm:[1,0,3,2] row_mask:0xf bank_mask:0xf
    s_mov_b64 exec, -1
    s_waitcnt vmcnt(6)
    buffer_load_dwordx4 v[52:55], v1, s[28:31], s79 offen offset:128 nt
    s_mov_b32 s91, s62
    s_call_b64 s[76:77], L_pack112_0
    s_waitcnt vmcnt(6)
    buffer_load_dwordx4 v[56:59], v1, s[28:31], s79 offen offset:2048 nt
    s_call_b64 s[76:77], L_pack112_1
    v_accvgpr_write_b32 a183, v112
    v_accvgpr_write_b32 a184, v113
    v_accvgpr_write_b32 a185, v114
    v_accvgpr_write_b32 a186, v115
    v_accvgpr_write_b32 a187, v116
    v_accvgpr_write_b32 a188, v117
    v_accvgpr_write_b32 a189, v118
    v_accvgpr_write_b32 a190, v119
    v_accvgpr_write_b32 a191, v120
    v_accvgpr_write_b32 a192, v121
    v_accvgpr_write_b32 a193, v122
    v_accvgpr_write_b32 a194, v123
    v_accvgpr_write_b32 a195, v32
    s_cmp_lg_u64 vcc, 0
    s_cselect_b32 s92, 65536, 0
    s_or_b32 s82, s82, s92
    s_add_u32 s68, s67, 7340032
    s_xor_b32 s78, s68, s67
    s_and_b32 s78, s78, 0xff800000
    s_xor_b32 s68, s68, s78
    s_waitcnt vmcnt(4)
    buffer_load_dwordx4 v[60:63], v1, s[28:31], s79 offen offset:2176 nt
    s_waitcnt vmcnt(4)
    buffer_load_dwordx4 v[80:83], v1, s[28:31], s68 offen offset:0 nt
    s_waitcnt vmcnt(13)
    v_mfma_f32_16x16x32_bf16 v[24:27], v[64:67], v[16:19], 0
    v_mfma_f32_16x16x32_bf16 v[28:31], v[72:75], v[16:19], 0
    v_mfma_f32_16x16x32_bf16 v[24:27], v[68:71], v[20:23], v[24:27]
    v_mfma_f32_16x16x32_bf16 v[28:31], v[76:79], v[20:23], v[28:31]
    s_waitcnt vmcnt(4)
    buffer_load_dwordx4 v[84:87], v1, s[28:31], s68 offen offset:128 nt
    s_waitcnt vmcnt(4)
    buffer_load_dwordx4 v[88:91], v1, s[28:31], s68 offen offset:2048 nt
    s_mov_b32 exec_lo, 0x30003000
    s_mov_b32 exec_hi, 0x30003000
    s_nop 0
    v_add_f32_dpp v248, v25, v24 quad_perm:[1,0,3,2] row_mask:0xf bank_mask:0xf
    v_add_f32_dpp v249, v27, v26 quad_perm:[1,0,3,2] row_mask:0xf bank_mask:0xf
    v_add_f32_dpp v250, v29, v28 quad_perm:[1,0,3,2] row_mask:0xf bank_mask:0xf
    v_add_f32_dpp v251, v31, v30 quad_perm:[1,0,3,2] row_mask:0xf bank_mask:0xf
    s_mov_b64 exec, -1
    s_waitcnt vmcnt(6)
    buffer_load_dwordx4 v[92:95], v1, s[28:31], s68 offen offset:2176 nt
    s_waitcnt vmcnt(12)
    v_mfma_f32_16x16x32_bf16 v[24:27], v[96:99], v[16:19], 0
    v_mfma_f32_16x16x32_bf16 v[28:31], v[104:107], v[16:19], 0
    v_mfma_f32_16x16x32_bf16 v[24:27], v[100:103], v[20:23], v[24:27]
    v_mfma_f32_16x16x32_bf16 v[28:31], v[108:111], v[20:23], v[28:31]
    s_add_u32 s79, s67, 7471104
    s_xor_b32 s78, s79, s67
    s_and_b32 s78, s78, 0xff800000
    s_xor_b32 s79, s79, s78
    s_waitcnt vmcnt(7)
    buffer_load_dwordx4 v[112:115], v1, s[28:31], s79 offen offset:0
    s_mov_b32 exec_lo, 0x300030
    s_mov_b32 exec_hi, 0x300030
    v_add_f32_dpp v248, v25, v24 quad_perm:[1,0,3,2] row_mask:0xf bank_mask:0xf
    v_add_f32_dpp v249, v27, v26 quad_perm:[1,0,3,2] row_mask:0xf bank_mask:0xf
    v_add_f32_dpp v250, v29, v28 quad_perm:[1,0,3,2] row_mask:0xf bank_mask:0xf
    v_add_f32_dpp v251, v31, v30 quad_perm:[1,0,3,2] row_mask:0xf bank_mask:0xf
    s_mov_b64 exec, -1
    s_waitcnt vmcnt(7)
    buffer_load_dwordx4 v[116:119], v1, s[28:31], s79 offen offset:128
    s_mov_b32 s91, s62
    s_call_b64 s[76:77], L_pack96_0
    s_waitcnt vmcnt(7)
    buffer_load_dwordx4 v[120:123], v1, s[28:31], s79 offen offset:2048
    s_call_b64 s[76:77], L_pack96_1
    v_accvgpr_write_b32 a209, v96
    v_accvgpr_write_b32 a210, v97
    v_accvgpr_write_b32 a211, v98
    v_accvgpr_write_b32 a212, v99
    v_accvgpr_write_b32 a213, v100
    v_accvgpr_write_b32 a214, v101
    v_accvgpr_write_b32 a215, v102
    v_accvgpr_write_b32 a216, v103
    v_accvgpr_write_b32 a217, v104
    v_accvgpr_write_b32 a218, v105
    v_accvgpr_write_b32 a219, v106
    v_accvgpr_write_b32 a220, v107
    v_accvgpr_write_b32 a221, v32
    s_cmp_lg_u64 vcc, 0
    s_cselect_b32 s92, 131072, 0
    s_or_b32 s82, s82, s92
    s_waitcnt vmcnt(7)
    buffer_load_dwordx4 v[124:127], v1, s[28:31], s79 offen offset:2176
    s_waitcnt vmcnt(12)
    v_mfma_f32_16x16x32_bf16 v[24:27], v[128:131], v[16:19], 0
    v_mfma_f32_16x16x32_bf16 v[28:31], v[136:139], v[16:19], 0
    v_mfma_f32_16x16x32_bf16 v[24:27], v[132:135], v[20:23], v[24:27]
    v_mfma_f32_16x16x32_bf16 v[28:31], v[140:143], v[20:23], v[28:31]
    s_add_u32 s68, s67, 7602176
    s_xor_b32 s78, s68, s67
    s_and_b32 s78, s78, 0xff800000
    s_xor_b32 s68, s68, s78
    s_waitcnt vmcnt(7)
    buffer_load_dwordx4 v[64:67], v1, s[28:31], s68 offen offset:0
    s_mov_b32 exec_lo, 0xc000c00
    s_mov_b32 exec_hi, 0xc000c00
    v_add_f32_dpp v248, v25, v24 quad_perm:[1,0,3,2] row_mask:0xf bank_mask:0xf
    v_add_f32_dpp v249, v27, v26 quad_perm:[1,0,3,2] row_mask:0xf bank_mask:0xf
    v_add_f32_dpp v250, v29, v28 quad_perm:[1,0,3,2] row_mask:0xf bank_mask:0xf
    v_add_f32_dpp v251, v31, v30 quad_perm:[1,0,3,2] row_mask:0xf bank_mask:0xf
    s_mov_b64 exec, -1
    s_waitcnt vmcnt(7)
    buffer_load_dwordx4 v[68:71], v1, s[28:31], s68 offen offset:128
    s_mov_b32 s91, s62
    s_call_b64 s[76:77], L_pack128_0
    s_waitcnt vmcnt(7)
    buffer_load_dwordx4 v[72:75], v1, s[28:31], s68 offen offset:2048
    s_call_b64 s[76:77], L_pack128_1
    v_accvgpr_write_b32 a222, v128
    v_accvgpr_write_b32 a223, v129
    v_accvgpr_write_b32 a224, v130
    v_accvgpr_write_b32 a225, v131
    v_accvgpr_write_b32 a226, v132
    v_accvgpr_write_b32 a227, v133
    v_accvgpr_write_b32 a228, v134
    v_accvgpr_write_b32 a229, v135
    v_accvgpr_write_b32 a230, v136
    v_accvgpr_write_b32 a231, v137
    v_accvgpr_write_b32 a232, v138
    v_accvgpr_write_b32 a233, v139
    v_accvgpr_write_b32 a234, v32
    s_cmp_lg_u64 vcc, 0
    s_cselect_b32 s92, 262144, 0
    s_or_b32 s82, s82, s92
    s_add_u32 s79, s67, 7733248
    s_xor_b32 s78, s79, s67
    s_and_b32 s78, s78, 0xff800000
    s_xor_b32 s79, s79, s78
    s_waitcnt vmcnt(5)
    buffer_load_dwordx4 v[76:79], v1, s[28:31], s68 offen offset:2176
    s_waitcnt vmcnt(5)
    buffer_load_dwordx4 v[96:99], v1, s[28:31], s79 offen offset:0
    s_waitcnt vmcnt(13)
    v_mfma_f32_16x16x32_bf16 v[24:27], v[48:51], v[16:19], 0
    v_mfma_f32_16x16x32_bf16 v[28:31], v[56:59], v[16:19], 0
    v_mfma_f32_16x16x32_bf16 v[24:27], v[52:55], v[20:23], v[24:27]
    v_mfma_f32_16x16x32_bf16 v[28:31], v[60:63], v[20:23], v[28:31]
    s_waitcnt vmcnt(5)
    buffer_load_dwordx4 v[100:103], v1, s[28:31], s79 offen offset:128
    s_waitcnt vmcnt(5)
    buffer_load_dwordx4 v[104:107], v1, s[28:31], s79 offen offset:2048
    s_mov_b32 exec_lo, 0xc000c000
    s_mov_b32 exec_hi, 0xc000c000
    s_nop 0
    v_add_f32_dpp v248, v25, v24 quad_perm:[1,0,3,2] row_mask:0xf bank_mask:0xf
    v_add_f32_dpp v249, v27, v26 quad_perm:[1,0,3,2] row_mask:0xf bank_mask:0xf
    v_add_f32_dpp v250, v29, v28 quad_perm:[1,0,3,2] row_mask:0xf bank_mask:0xf
    v_add_f32_dpp v251, v31, v30 quad_perm:[1,0,3,2] row_mask:0xf bank_mask:0xf
    s_mov_b64 exec, -1
    s_waitcnt vmcnt(7)
    buffer_load_dwordx4 v[108:111], v1, s[28:31], s79 offen offset:2176
    s_waitcnt vmcnt(12)
    v_mfma_f32_16x16x32_bf16 v[24:27], v[80:83], v[16:19], 0
    v_mfma_f32_16x16x32_bf16 v[28:31], v[88:91], v[16:19], 0
    v_mfma_f32_16x16x32_bf16 v[24:27], v[84:87], v[20:23], v[24:27]
    v_mfma_f32_16x16x32_bf16 v[28:31], v[92:95], v[20:23], v[28:31]
    s_add_u32 s68, s67, 7864320
    s_xor_b32 s78, s68, s67
    s_and_b32 s78, s78, 0xff800000
    s_xor_b32 s68, s68, s78
    s_waitcnt vmcnt(7)
    buffer_load_dwordx4 v[128:131], v1, s[28:31], s68 offen offset:0
    s_mov_b32 exec_lo, 0x30003
    s_mov_b32 exec_hi, 0x30003
    v_add_f32_dpp v252, v25, v24 quad_perm:[1,0,3,2] row_mask:0xf bank_mask:0xf
    v_add_f32_dpp v253, v27, v26 quad_perm:[1,0,3,2] row_mask:0xf bank_mask:0xf
    v_add_f32_dpp v254, v29, v28 quad_perm:[1,0,3,2] row_mask:0xf bank_mask:0xf
    v_add_f32_dpp v255, v31, v30 quad_perm:[1,0,3,2] row_mask:0xf bank_mask:0xf
    s_mov_b64 exec, -1
    s_waitcnt vmcnt(7)
    buffer_load_dwordx4 v[132:135], v1, s[28:31], s68 offen offset:128
    s_mov_b32 s91, s62
    s_call_b64 s[76:77], L_pack80_0
    s_waitcnt vmcnt(7)
    buffer_load_dwordx4 v[136:139], v1, s[28:31], s68 offen offset:2048
    s_call_b64 s[76:77], L_pack80_1
    v_accvgpr_write_b32 a235, v80
    v_accvgpr_write_b32 a236, v81
    v_accvgpr_write_b32 a237, v82
    v_accvgpr_write_b32 a238, v83
    v_accvgpr_write_b32 a239, v84
    v_accvgpr_write_b32 a240, v85
    v_accvgpr_write_b32 a241, v86
    v_accvgpr_write_b32 a242, v87
    v_accvgpr_write_b32 a243, v88
    v_accvgpr_write_b32 a244, v89
    v_accvgpr_write_b32 a245, v90
    v_accvgpr_write_b32 a246, v91
    v_accvgpr_write_b32 a247, v32
    s_cmp_lg_u64 vcc, 0
    s_cselect_b32 s92, 524288, 0
    s_or_b32 s82, s82, s92
    s_add_u32 s79, s67, 7995392
    s_xor_b32 s78, s79, s67
    s_and_b32 s78, s78, 0xff800000
    s_xor_b32 s79, s79, s78
    s_waitcnt vmcnt(5)
    buffer_load_dwordx4 v[140:143], v1, s[28:31], s68 offen offset:2176
    s_waitcnt vmcnt(4)
    buffer_load_dwordx4 v[48:51], v1, s[28:31], s79 offen offset:0 nt
    s_waitcnt vmcnt(13)
    v_mfma_f32_16x16x32_bf16 v[24:27], v[112:115], v[16:19], 0
    v_mfma_f32_16x16x32_bf16 v[28:31], v[120:123], v[16:19], 0
    v_mfma_f32_16x16x32_bf16 v[24:27], v[116:119], v[20:23], v[24:27]
    v_mfma_f32_16x16x32_bf16 v[28:31], v[124:127], v[20:23], v[28:31]
    s_waitcnt vmcnt(4)
    buffer_load_dwordx4 v[52:55], v1, s[28:31], s79 offen offset:128 nt
    s_waitcnt vmcnt(4)
    buffer_load_dwordx4 v[56:59], v1, s[28:31], s79 offen offset:2048 nt
    s_mov_b32 exec_lo, 0xc000c
    s_mov_b32 exec_hi, 0xc000c
    s_nop 0
    v_add_f32_dpp v252, v25, v24 quad_perm:[1,0,3,2] row_mask:0xf bank_mask:0xf
    v_add_f32_dpp v253, v27, v26 quad_perm:[1,0,3,2] row_mask:0xf bank_mask:0xf
    v_add_f32_dpp v254, v29, v28 quad_perm:[1,0,3,2] row_mask:0xf bank_mask:0xf
    v_add_f32_dpp v255, v31, v30 quad_perm:[1,0,3,2] row_mask:0xf bank_mask:0xf
    s_mov_b64 exec, -1
    s_add_u32 s68, s67, 8126464
    s_xor_b32 s78, s68, s67
    s_and_b32 s78, s78, 0xff800000
    s_xor_b32 s68, s68, s78
    s_waitcnt vmcnt(4)
    buffer_load_dwordx4 v[60:63], v1, s[28:31], s79 offen offset:2176 nt
    s_waitcnt vmcnt(4)
    buffer_load_dwordx4 v[80:83], v1, s[28:31], s68 offen offset:0 nt
    s_waitcnt vmcnt(13)
    v_mfma_f32_16x16x32_bf16 v[24:27], v[64:67], v[16:19], 0
    v_mfma_f32_16x16x32_bf16 v[28:31], v[72:75], v[16:19], 0
    v_mfma_f32_16x16x32_bf16 v[24:27], v[68:71], v[20:23], v[24:27]
    v_mfma_f32_16x16x32_bf16 v[28:31], v[76:79], v[20:23], v[28:31]
    s_waitcnt vmcnt(4)
    buffer_load_dwordx4 v[84:87], v1, s[28:31], s68 offen offset:128 nt
    s_waitcnt vmcnt(4)
    buffer_load_dwordx4 v[88:91], v1, s[28:31], s68 offen offset:2048 nt
    s_mov_b32 exec_lo, 0x300030
    s_mov_b32 exec_hi, 0x300030
    s_nop 0
    v_add_f32_dpp v252, v25, v24 quad_perm:[1,0,3,2] row_mask:0xf bank_mask:0xf
    v_add_f32_dpp v253, v27, v26 quad_perm:[1,0,3,2] row_mask:0xf bank_mask:0xf
    v_add_f32_dpp v254, v29, v28 quad_perm:[1,0,3,2] row_mask:0xf bank_mask:0xf
    v_add_f32_dpp v255, v31, v30 quad_perm:[1,0,3,2] row_mask:0xf bank_mask:0xf
    s_mov_b64 exec, -1
    s_add_u32 s79, s67, 8257536
    s_xor_b32 s78, s79, s67
    s_and_b32 s78, s78, 0xff800000
    s_xor_b32 s79, s79, s78
    s_waitcnt vmcnt(4)
    buffer_load_dwordx4 v[92:95], v1, s[28:31], s68 offen offset:2176 nt
    s_waitcnt vmcnt(4)
    buffer_load_dwordx4 v[112:115], v1, s[28:31], s79 offen offset:0 nt
    s_waitcnt vmcnt(13)
    v_mfma_f32_16x16x32_bf16 v[24:27], v[96:99], v[16:19], 0
    v_mfma_f32_16x16x32_bf16 v[28:31], v[104:107], v[16:19], 0
    v_mfma_f32_16x16x32_bf16 v[24:27], v[100:103], v[20:23], v[24:27]
    v_mfma_f32_16x16x32_bf16 v[28:31], v[108:111], v[20:23], v[28:31]
    s_waitcnt vmcnt(4)
    buffer_load_dwordx4 v[116:119], v1, s[28:31], s79 offen offset:128 nt
    s_waitcnt vmcnt(4)
    buffer_load_dwordx4 v[120:123], v1, s[28:31], s79 offen offset:2048 nt
    s_mov_b32 exec_lo, 0xc000c0
    s_mov_b32 exec_hi, 0xc000c0
    s_nop 0
    v_add_f32_dpp v252, v25, v24 quad_perm:[1,0,3,2] row_mask:0xf bank_mask:0xf
    v_add_f32_dpp v253, v27, v26 quad_perm:[1,0,3,2] row_mask:0xf bank_mask:0xf
    v_add_f32_dpp v254, v29, v28 quad_perm:[1,0,3,2] row_mask:0xf bank_mask:0xf
    v_add_f32_dpp v255, v31, v30 quad_perm:[1,0,3,2] row_mask:0xf bank_mask:0xf
    s_mov_b64 exec, -1
    s_waitcnt vmcnt(4)
    buffer_load_dwordx4 v[124:127], v1, s[28:31], s79 offen offset:2176 nt
    s_waitcnt vmcnt(12)
    v_mfma_f32_16x16x32_bf16 v[24:27], v[128:131], v[16:19], 0
    v_mfma_f32_16x16x32_bf16 v[28:31], v[136:139], v[16:19], 0
    v_mfma_f32_16x16x32_bf16 v[24:27], v[132:135], v[20:23], v[24:27]
    v_mfma_f32_16x16x32_bf16 v[28:31], v[140:143], v[20:23], v[28:31]
    s_mov_b32 exec_lo, 0x3000300
    s_mov_b32 exec_hi, 0x3000300
    s_nop 4
    v_add_f32_dpp v252, v25, v24 quad_perm:[1,0,3,2] row_mask:0xf bank_mask:0xf
    v_add_f32_dpp v253, v27, v26 quad_perm:[1,0,3,2] row_mask:0xf bank_mask:0xf
    v_add_f32_dpp v254, v29, v28 quad_perm:[1,0,3,2] row_mask:0xf bank_mask:0xf
    v_add_f32_dpp v255, v31, v30 quad_perm:[1,0,3,2] row_mask:0xf bank_mask:0xf
    s_mov_b64 exec, -1
    v_and_b32 v46, 31, v0
    v_lshlrev_b32 v46, 7, v46
    s_lshl_b32 s93, s65, 12
    s_add_u32 s93, s93, 524288
    buffer_load_dword v47, v46, s[36:39], s93 offen sc1
    s_add_u32 s68, s67, 0
    s_xor_b32 s78, s68, s67
    s_and_b32 s78, s78, 0xff800000
    s_xor_b32 s68, s68, s78
    s_waitcnt vmcnt(5)
    buffer_load_dwordx4 v[128:131], v2, s[32:35], s68 offen offset:0 nt
    s_waitcnt vmcnt(5)
    buffer_load_dwordx4 v[132:135], v2, s[32:35], s68 offen offset:256 nt
    s_waitcnt vmcnt(11)
    v_mfma_f32_16x16x32_bf16 v[24:27], v[48:51], v[16:19], 0
    v_mfma_f32_16x16x32_bf16 v[28:31], v[56:59], v[16:19], 0
    v_mfma_f32_16x16x32_bf16 v[24:27], v[52:55], v[20:23], v[24:27]
    v_mfma_f32_16x16x32_bf16 v[28:31], v[60:63], v[20:23], v[28:31]
    s_waitcnt vmcnt(5)
    buffer_load_dwordx4 v[136:139], v2, s[32:35], s68 offen offset:2048 nt
    s_waitcnt vmcnt(5)
    buffer_load_dwordx4 v[140:143], v2, s[32:35], s68 offen offset:2304 nt
    s_mov_b32 exec_lo, 0xc000c00
    s_mov_b32 exec_hi, 0xc000c00
    s_nop 0
    v_add_f32_dpp v252, v25, v24 quad_perm:[1,0,3,2] row_mask:0xf bank_mask:0xf
    v_add_f32_dpp v253, v27, v26 quad_perm:[1,0,3,2] row_mask:0xf bank_mask:0xf
    v_add_f32_dpp v254, v29, v28 quad_perm:[1,0,3,2] row_mask:0xf bank_mask:0xf
    v_add_f32_dpp v255, v31, v30 quad_perm:[1,0,3,2] row_mask:0xf bank_mask:0xf
    s_mov_b64 exec, -1
    s_add_u32 s79, s67, 131072
    s_xor_b32 s78, s79, s67
    s_and_b32 s78, s78, 0xff800000
    s_xor_b32 s79, s79, s78
    s_waitcnt vmcnt(6)
    buffer_load_dwordx4 v[64:67], v2, s[32:35], s79 offen offset:0
    s_waitcnt vmcnt(6)
    buffer_load_dwordx4 v[68:71], v2, s[32:35], s79 offen offset:256
    s_waitcnt vmcnt(11)
    v_mfma_f32_16x16x32_bf16 v[24:27], v[80:83], v[16:19], 0
    v_mfma_f32_16x16x32_bf16 v[28:31], v[88:91], v[16:19], 0
    v_mfma_f32_16x16x32_bf16 v[24:27], v[84:87], v[20:23], v[24:27]
    v_mfma_f32_16x16x32_bf16 v[28:31], v[92:95], v[20:23], v[28:31]
    s_waitcnt vmcnt(5)
    buffer_load_dwordx4 v[72:75], v2, s[32:35], s79 offen offset:2048
    s_waitcnt vmcnt(5)
    buffer_load_dwordx4 v[76:79], v2, s[32:35], s79 offen offset:2304
    s_mov_b32 exec_lo, 0x30003000
    s_mov_b32 exec_hi, 0x30003000
    s_nop 0
    v_add_f32_dpp v252, v25, v24 quad_perm:[1,0,3,2] row_mask:0xf bank_mask:0xf
    v_add_f32_dpp v253, v27, v26 quad_perm:[1,0,3,2] row_mask:0xf bank_mask:0xf
    v_add_f32_dpp v254, v29, v28 quad_perm:[1,0,3,2] row_mask:0xf bank_mask:0xf
    v_add_f32_dpp v255, v31, v30 quad_perm:[1,0,3,2] row_mask:0xf bank_mask:0xf
    s_mov_b64 exec, -1
    s_add_u32 s68, s67, 3407872
    s_xor_b32 s78, s68, s67
    s_and_b32 s78, s78, 0xff800000
    s_xor_b32 s68, s68, s78
    s_waitcnt vmcnt(4)
    buffer_load_dwordx4 v[96:99], v2, s[32:35], s68 offen offset:0 nt
    s_waitcnt vmcnt(4)
    buffer_load_dwordx4 v[100:103], v2, s[32:35], s68 offen offset:256 nt
    s_waitcnt vmcnt(11)
    v_mfma_f32_16x16x32_bf16 v[24:27], v[112:115], v[16:19], 0
    v_mfma_f32_16x16x32_bf16 v[28:31], v[120:123], v[16:19], 0
    v_mfma_f32_16x16x32_bf16 v[24:27], v[116:119], v[20:23], v[24:27]
    v_mfma_f32_16x16x32_bf16 v[28:31], v[124:127], v[20:23], v[28:31]
    s_waitcnt vmcnt(4)
    buffer_load_dwordx4 v[104:107], v2, s[32:35], s68 offen offset:2048 nt
    s_waitcnt vmcnt(4)
    buffer_load_dwordx4 v[108:111], v2, s[32:35], s68 offen offset:2304 nt
    s_mov_b32 exec_lo, 0xc000c000
    s_mov_b32 exec_hi, 0xc000c000
    s_nop 0
    v_add_f32_dpp v252, v25, v24 quad_perm:[1,0,3,2] row_mask:0xf bank_mask:0xf
    v_add_f32_dpp v253, v27, v26 quad_perm:[1,0,3,2] row_mask:0xf bank_mask:0xf
    v_add_f32_dpp v254, v29, v28 quad_perm:[1,0,3,2] row_mask:0xf bank_mask:0xf
    v_add_f32_dpp v255, v31, v30 quad_perm:[1,0,3,2] row_mask:0xf bank_mask:0xf
    s_mov_b64 exec, -1
    v_max3_f32 v36, v224, v225, v226
    v_max3_f32 v37, v227, v228, v229
    v_max3_f32 v37, v37, v230, v231
    v_max3_f32 v36, v36, v232, v233
    v_max3_f32 v37, v37, v234, v235
    v_max3_f32 v36, v36, v236, v237
    v_max3_f32 v37, v37, v238, v239
    v_max3_f32 v36, v36, v240, v241
    v_max3_f32 v37, v37, v242, v243
    v_max3_f32 v36, v36, v244, v245
    v_max3_f32 v37, v37, v246, v247
    v_max3_f32 v36, v36, v248, v249
    v_max3_f32 v37, v37, v250, v251
    v_max3_f32 v36, v36, v252, v253
    v_max3_f32 v37, v37, v254, v255
    v_max_f32 v36, v36, v37
    v_mov_b32 v16, v248
    v_mov_b32 v17, v249
    v_mov_b32 v18, v250
    v_mov_b32 v19, v251
    v_mov_b32 v20, v252
    v_mov_b32 v21, v253
    v_mov_b32 v22, v254
    v_mov_b32 v23, v255
    v_mov_b32_dpp v36, v36 quad_perm:[0,0,2,2] row_mask:0xf bank_mask:0xf
    s_nop 1
    v_max_f32_dpp v36, v36, v36 row_ror:8 row_mask:0xf bank_mask:0xf
    s_nop 1
    v_max_f32_dpp v36, v36, v36 row_ror:4 row_mask:0xf bank_mask:0xf
    s_nop 1
    v_max_f32_dpp v36, v36, v36 row_ror:2 row_mask:0xf bank_mask:0xf
    v_mov_b32 v37, v36
    s_nop 1
    v_permlane32_swap_b32 v36, v37
    v_max_f32 v36, v36, v37
    v_mov_b32 v37, v36
    s_nop 1
    v_permlane16_swap_b32 v36, v37
    v_max_f32 v36, v36, v37
    v_mul_f32 v13, s69, v36
    v_mov_b32_dpp v32, v224 row_newbcast:0 row_mask:0xf bank_mask:0xf
    v_mov_b32_dpp v33, v225 row_newbcast:0 row_mask:0xf bank_mask:0xf
    v_mov_b32_dpp v34, v226 row_newbcast:0 row_mask:0xf bank_mask:0xf
    v_mov_b32_dpp v35, v227 row_newbcast:0 row_mask:0xf bank_mask:0xf
    s_call_b64 s[76:77], L_exp0
    s_waitcnt vmcnt(8)
    v_mfma_f32_16x16x32_bf16 v[8:11], v[36:39], v[128:131], v[8:11]
    v_and_b32 v36, v34, v4
    v_and_b32 v37, v34, v5
    v_and_b32 v38, v34, v6
    v_and_b32 v39, v34, v7
    v_mfma_f32_16x16x32_bf16 v[8:11], v[40:43], v[132:135], v[8:11]
    v_and_b32 v40, v35, v4
    v_and_b32 v41, v35, v5
    v_and_b32 v42, v35, v6
    v_and_b32 v43, v35, v7
    v_mfma_f32_16x16x32_bf16 v[8:11], v[36:39], v[136:139], v[8:11]
    s_nop 0
    v_mfma_f32_16x16x32_bf16 v[8:11], v[40:43], v[140:143], v[8:11]
    v_and_b32 v24, 0x7fff7fff, v128
    v_and_b32 v26, 0x7fff7fff, v129
    v_pk_max_u16 v24, v24, v26
    v_and_b32 v25, 0x7fff7fff, v130
    v_pk_max_u16 v24, v24, v25
    v_and_b32 v26, 0x7fff7fff, v131
    v_pk_max_u16 v24, v24, v26
    v_and_b32 v25, 0x7fff7fff, v132
    v_pk_max_u16 v24, v24, v25
    v_and_b32 v26, 0x7fff7fff, v133
    v_pk_max_u16 v24, v24, v26
    v_and_b32 v25, 0x7fff7fff, v134
    v_pk_max_u16 v24, v24, v25
    v_and_b32 v26, 0x7fff7fff, v135
    v_pk_max_u16 v24, v24, v26
    v_and_b32 v25, 0x7fff7fff, v136
    v_pk_max_u16 v24, v24, v25
    v_and_b32 v26, 0x7fff7fff, v137
    v_pk_max_u16 v24, v24, v26
    v_and_b32 v25, 0x7fff7fff, v138
    v_pk_max_u16 v24, v24, v25
    v_and_b32 v26, 0x7fff7fff, v139
    v_pk_max_u16 v24, v24, v26
    v_and_b32 v25, 0x7fff7fff, v140
    v_pk_max_u16 v24, v24, v25
    v_and_b32 v26, 0x7fff7fff, v141
    v_pk_max_u16 v24, v24, v26
    v_and_b32 v25, 0x7fff7fff, v142
    v_pk_max_u16 v24, v24, v25
    v_and_b32 v26, 0x7fff7fff, v143
    v_pk_max_u16 v24, v24, v26
    v_lshrrev_b32 v25, 16, v24
    v_and_b32 v24, 0xffff, v24
    v_max_u32 v24, v24, v25
    s_nop 1
    v_max_u32_dpp v24, v24, v24 row_ror:8 row_mask:0xf bank_mask:0xf
    s_nop 1
    v_max_u32_dpp v24, v24, v24 row_ror:4 row_mask:0xf bank_mask:0xf
    s_nop 1
    v_max_u32_dpp v24, v24, v24 row_ror:2 row_mask:0xf bank_mask:0xf
    s_nop 1
    v_max_u32_dpp v24, v24, v24 row_ror:1 row_mask:0xf bank_mask:0xf
    v_mov_b32 v25, v24
    s_nop 1
    v_permlane32_swap_b32 v24, v25
    v_max_u32 v24, v24, v25
    v_mov_b32 v25, v24
    s_nop 1
    v_permlane16_swap_b32 v24, v25
    v_max_u32 v24, v24, v25
    s_nop 0
    v_readfirstlane_b32 s63, v24
    s_nop 1
    s_lshr_b32 s63, s63, 8
    s_max_u32 s63, s63, 14
    s_sub_u32 s63, s63, 14
    s_min_u32 s63, s63, 62
    s_mul_i32 s63, s63, 0x01000100
    s_waitcnt vmcnt(12)
    s_lshl_b32 s92, s96, 12
    s_or_b32 s92, s92, s97
    v_cmp_ne_u32 vcc, s92, v47
    s_nop 1
    s_cmp_eq_u64 vcc, 0
    s_cselect_b32 s2, 1, 0
    s_lshl_b32 s0, s65, 8
    s_add_u32 s0, s0, 589824
    s_lshl_b32 s93, s64, 3
    s_lshl_b32 s92, s3, 1
    s_add_u32 s93, s93, s92
    s_add_u32 s93, s93, 589824
    s_and_b32 s92, s3, 1
    s_cmp_lt_u32 s92, s2
    s_cselect_b32 s1, s93, 0x7ffffff0
    s_mov_b32 s100, 1
    s_add_u32 s79, s67, 262144
    s_xor_b32 s78, s79, s67
    s_and_b32 s78, s78, 0xff800000
    s_xor_b32 s79, s79, s78
    s_waitcnt vmcnt(4)
    buffer_load_dwordx4 v[128:131], v2, s[32:35], s79 offen offset:0 nt
    s_waitcnt vmcnt(4)
    buffer_load_dwordx4 v[132:135], v2, s[32:35], s79 offen offset:256 nt
    v_mov_b32_dpp v32, v224 row_newbcast:2 row_mask:0xf bank_mask:0xf
    v_mov_b32_dpp v33, v225 row_newbcast:2 row_mask:0xf bank_mask:0xf
    v_mov_b32_dpp v34, v226 row_newbcast:2 row_mask:0xf bank_mask:0xf
    v_mov_b32_dpp v35, v227 row_newbcast:2 row_mask:0xf bank_mask:0xf
    s_call_b64 s[76:77], L_exp0
    s_waitcnt vmcnt(4)
    buffer_load_dwordx4 v[136:139], v2, s[32:35], s79 offen offset:2048 nt
    s_waitcnt vmcnt(4)
    buffer_load_dwordx4 v[140:143], v2, s[32:35], s79 offen offset:2304 nt
    s_waitcnt vmcnt(8)
    v_mfma_f32_16x16x32_bf16 v[8:11], v[36:39], v[64:67], v[8:11]
    v_and_b32 v36, v34, v4
    v_and_b32 v37, v34, v5
    v_and_b32 v38, v34, v6
    v_and_b32 v39, v34, v7
    v_mfma_f32_16x16x32_bf16 v[8:11], v[40:43], v[68:71], v[8:11]
    v_and_b32 v40, v35, v4
    v_and_b32 v41, v35, v5
    v_and_b32 v42, v35, v6
    v_and_b32 v43, v35, v7
    v_mfma_f32_16x16x32_bf16 v[8:11], v[36:39], v[72:75], v[8:11]
    s_nop 0
    v_mfma_f32_16x16x32_bf16 v[8:11], v[40:43], v[76:79], v[8:11]
    s_add_u32 s68, s67, 3670016
    s_xor_b32 s78, s68, s67
    s_and_b32 s78, s78, 0xff800000
    s_xor_b32 s68, s68, s78
    s_waitcnt vmcnt(6)
    buffer_load_dwordx4 v[64:67], v2, s[32:35], s68 offen offset:0 nt
    v_mov_b32_dpp v32, v224 row_newbcast:4 row_mask:0xf bank_mask:0xf
    v_mov_b32_dpp v33, v225 row_newbcast:4 row_mask:0xf bank_mask:0xf
    v_mov_b32_dpp v34, v226 row_newbcast:4 row_mask:0xf bank_mask:0xf
    v_mov_b32_dpp v35, v227 row_newbcast:4 row_mask:0xf bank_mask:0xf
    s_call_b64 s[76:77], L_exp0
    s_waitcnt vmcnt(6)
    buffer_load_dwordx4 v[68:71], v2, s[32:35], s68 offen offset:256 nt
    s_waitcnt vmcnt(6)
    v_mfma_f32_16x16x32_bf16 v[8:11], v[36:39], v[96:99], v[8:11]
    v_and_b32 v36, v34, v4
    v_and_b32 v37, v34, v5
    v_and_b32 v38, v34, v6
    v_and_b32 v39, v34, v7
    v_mfma_f32_16x16x32_bf16 v[8:11], v[40:43], v[100:103], v[8:11]
    v_and_b32 v40, v35, v4
    v_and_b32 v41, v35, v5
    v_and_b32 v42, v35, v6
    v_and_b32 v43, v35, v7
    v_mfma_f32_16x16x32_bf16 v[8:11], v[36:39], v[104:107], v[8:11]
    s_nop 0
    v_mfma_f32_16x16x32_bf16 v[8:11], v[40:43], v[108:111], v[8:11]
    s_waitcnt vmcnt(6)
    buffer_load_dwordx4 v[72:75], v2, s[32:35], s68 offen offset:2048 nt
    s_mov_b32 s91, s63
    s_call_b64 s[76:77], L_pack96_0
    s_waitcnt vmcnt(6)
    buffer_load_dwordx4 v[76:79], v2, s[32:35], s68 offen offset:2304 nt
    s_call_b64 s[76:77], L_pack96_1
    v_mov_b32 v160, v96
    v_mov_b32 v161, v97
    v_mov_b32 v162, v98
    v_mov_b32 v163, v99
    v_mov_b32 v164, v100
    v_mov_b32 v165, v101
    v_mov_b32 v166, v102
    v_mov_b32 v167, v103
    v_mov_b32 v168, v104
    v_mov_b32 v169, v105
    v_mov_b32 v170, v106
    v_mov_b32 v171, v107
    v_mov_b32 v172, v32
    s_cmp_lg_u64 vcc, 0
    s_cselect_b32 s92, 1, 0
    s_or_b32 s82, s82, s92
    s_add_u32 s79, s67, 393216
    s_xor_b32 s78, s79, s67
    s_and_b32 s78, s78, 0xff800000
    s_xor_b32 s79, s79, s78
    s_waitcnt vmcnt(5)
    buffer_load_dwordx4 v[96:99], v2, s[32:35], s79 offen offset:0
    s_waitcnt vmcnt(5)
    buffer_load_dwordx4 v[100:103], v2, s[32:35], s79 offen offset:256
    v_mov_b32_dpp v32, v224 row_newbcast:6 row_mask:0xf bank_mask:0xf
    v_mov_b32_dpp v33, v225 row_newbcast:6 row_mask:0xf bank_mask:0xf
    v_mov_b32_dpp v34, v226 row_newbcast:6 row_mask:0xf bank_mask:0xf
    v_mov_b32_dpp v35, v227 row_newbcast:6 row_mask:0xf bank_mask:0xf
    s_call_b64 s[76:77], L_exp0
    s_waitcnt vmcnt(5)
    buffer_load_dwordx4 v[104:107], v2, s[32:35], s79 offen offset:2048
    s_waitcnt vmcnt(5)
    buffer_load_dwordx4 v[108:111], v2, s[32:35], s79 offen offset:2304
    s_waitcnt vmcnt(8)
    v_mfma_f32_16x16x32_bf16 v[8:11], v[36:39], v[128:131], v[8:11]
    v_and_b32 v36, v34, v4
    v_and_b32 v37, v34, v5
    v_and_b32 v38, v34, v6
    v_and_b32 v39, v34, v7
    v_mfma_f32_16x16x32_bf16 v[8:11], v[40:43], v[132:135], v[8:11]
    v_and_b32 v40, v35, v4
    v_and_b32 v41, v35, v5
    v_and_b32 v42, v35, v6
    v_and_b32 v43, v35, v7
    v_mfma_f32_16x16x32_bf16 v[8:11], v[36:39], v[136:139], v[8:11]
    s_nop 0
    v_mfma_f32_16x16x32_bf16 v[8:11], v[40:43], v[140:143], v[8:11]
    s_add_u32 s68, s67, 524288
    s_xor_b32 s78, s68, s67
    s_and_b32 s78, s78, 0xff800000
    s_xor_b32 s68, s68, s78
    s_waitcnt vmcnt(6)
    buffer_load_dwordx4 v[128:131], v2, s[32:35], s68 offen offset:0 nt
    v_mov_b32_dpp v32, v224 row_newbcast:8 row_mask:0xf bank_mask:0xf
    v_mov_b32_dpp v33, v225 row_newbcast:8 row_mask:0xf bank_mask:0xf
    v_mov_b32_dpp v34, v226 row_newbcast:8 row_mask:0xf bank_mask:0xf
    v_mov_b32_dpp v35, v227 row_newbcast:8 row_mask:0xf bank_mask:0xf
    s_call_b64 s[76:77], L_exp0
    s_waitcnt vmcnt(6)
    buffer_load_dwordx4 v[132:135], v2, s[32:35], s68 offen offset:256 nt
    s_waitcnt vmcnt(6)
    v_mfma_f32_16x16x32_bf16 v[8:11], v[36:39], v[64:67], v[8:11]
    v_and_b32 v36, v34, v4
    v_and_b32 v37, v34, v5
    v_and_b32 v38, v34, v6
    v_and_b32 v39, v34, v7
    v_mfma_f32_16x16x32_bf16 v[8:11], v[40:43], v[68:71], v[8:11]
    v_and_b32 v40, v35, v4
    v_and_b32 v41, v35, v5
    v_and_b32 v42, v35, v6
    v_and_b32 v43, v35, v7
    v_mfma_f32_16x16x32_bf16 v[8:11], v[36:39], v[72:75], v[8:11]
    s_nop 0
    v_mfma_f32_16x16x32_bf16 v[8:11], v[40:43], v[76:79], v[8:11]
    s_waitcnt vmcnt(6)
    buffer_load_dwordx4 v[136:139], v2, s[32:35], s68 offen offset:2048 nt
    s_mov_b32 s91, s63
    s_call_b64 s[76:77], L_pack64_0
    s_waitcnt vmcnt(6)
    buffer_load_dwordx4 v[140:143], v2, s[32:35], s68 offen offset:2304 nt
    s_call_b64 s[76:77], L_pack64_1
    ds_write_b128 v3, v[64:67] offset:3328
    ds_write_b128 v3, v[68:71] offset:4352
    ds_write_b128 v3, v[72:75] offset:5376
    v_and_b32 v34, 63, v0
    v_mul_u32_u24 v34, 12, v34
    v_sub_u32 v34, v3, v34
    ds_write_b32 v34, v32 offset:6400
    s_cmp_lg_u64 vcc, 0
    s_cselect_b32 s92, 2, 0
    s_or_b32 s82, s82, s92
    s_add_u32 s79, s67, 3801088
    s_xor_b32 s78, s79, s67
    s_and_b32 s78, s78, 0xff800000
    s_xor_b32 s79, s79, s78
    s_waitcnt vmcnt(4)
    buffer_load_dwordx4 v[64:67], v2, s[32:35], s79 offen offset:0 nt
    s_waitcnt vmcnt(4)
    buffer_load_dwordx4 v[68:71], v2, s[32:35], s79 offen offset:256 nt
    v_mov_b32_dpp v32, v224 row_newbcast:10 row_mask:0xf bank_mask:0xf
    v_mov_b32_dpp v33, v225 row_newbcast:10 row_mask:0xf bank_mask:0xf
    v_mov_b32_dpp v34, v226 row_newbcast:10 row_mask:0xf bank_mask:0xf
    v_mov_b32_dpp v35, v227 row_newbcast:10 row_mask:0xf bank_mask:0xf
    s_call_b64 s[76:77], L_exp0
    s_waitcnt vmcnt(4)
    buffer_load_dwordx4 v[72:75], v2, s[32:35], s79 offen offset:2048 nt
    s_waitcnt vmcnt(4)
    buffer_load_dwordx4 v[76:79], v2, s[32:35], s79 offen offset:2304 nt
    s_waitcnt vmcnt(8)
    v_mfma_f32_16x16x32_bf16 v[8:11], v[36:39], v[96:99], v[8:11]
    v_and_b32 v36, v34, v4
    v_and_b32 v37, v34, v5
    v_and_b32 v38, v34, v6
    v_and_b32 v39, v34, v7
    v_mfma_f32_16x16x32_bf16 v[8:11], v[40:43], v[100:103], v[8:11]
    v_and_b32 v40, v35, v4
    v_and_b32 v41, v35, v5
    v_and_b32 v42, v35, v6
    v_and_b32 v43, v35, v7
    v_mfma_f32_16x16x32_bf16 v[8:11], v[36:39], v[104:107], v[8:11]
    s_nop 0
    v_mfma_f32_16x16x32_bf16 v[8:11], v[40:43], v[108:111], v[8:11]
    s_add_u32 s68, s67, 655360
    s_xor_b32 s78, s68, s67
    s_and_b32 s78, s78, 0xff800000
    s_xor_b32 s68, s68, s78
    s_waitcnt vmcnt(5)
    buffer_load_dwordx4 v[96:99], v2, s[32:35], s68 offen offset:0
    s_waitcnt vmcnt(5)
    buffer_load_dwordx4 v[100:103], v2, s[32:35], s68 offen offset:256
    v_mov_b32_dpp v32, v224 row_newbcast:12 row_mask:0xf bank_mask:0xf
    v_mov_b32_dpp v33, v225 row_newbcast:12 row_mask:0xf bank_mask:0xf
    v_mov_b32_dpp v34, v226 row_newbcast:12 row_mask:0xf bank_mask:0xf
    v_mov_b32_dpp v35, v227 row_newbcast:12 row_mask:0xf bank_mask:0xf
    s_call_b64 s[76:77], L_exp0
    s_waitcnt vmcnt(5)
    buffer_load_dwordx4 v[104:107], v2, s[32:35], s68 offen offset:2048
    s_waitcnt vmcnt(5)
    buffer_load_dwordx4 v[108:111], v2, s[32:35], s68 offen offset:2304
    s_waitcnt vmcnt(8)
    v_mfma_f32_16x16x32_bf16 v[8:11], v[36:39], v[128:131], v[8:11]
    v_and_b32 v36, v34, v4
    v_and_b32 v37, v34, v5
    v_and_b32 v38, v34, v6
    v_and_b32 v39, v34, v7
    v_mfma_f32_16x16x32_bf16 v[8:11], v[40:43], v[132:135], v[8:11]
    v_and_b32 v40, v35, v4
    v_and_b32 v41, v35, v5
    v_and_b32 v42, v35, v6
    v_and_b32 v43, v35, v7
    v_mfma_f32_16x16x32_bf16 v[8:11], v[36:39], v[136:139], v[8:11]
    s_nop 0
    v_mfma_f32_16x16x32_bf16 v[8:11], v[40:43], v[140:143], v[8:11]
    s_add_u32 s79, s67, 786432
    s_xor_b32 s78, s79, s67
    s_and_b32 s78, s78, 0xff800000
    s_xor_b32 s79, s79, s78
    s_waitcnt vmcnt(6)
    buffer_load_dwordx4 v[128:131], v2, s[32:35], s79 offen offset:0 nt
    v_mov_b32_dpp v32, v224 row_newbcast:14 row_mask:0xf bank_mask:0xf
    v_mov_b32_dpp v33, v225 row_newbcast:14 row_mask:0xf bank_mask:0xf
    v_mov_b32_dpp v34, v226 row_newbcast:14 row_mask:0xf bank_mask:0xf
    v_mov_b32_dpp v35, v227 row_newbcast:14 row_mask:0xf bank_mask:0xf
    s_call_b64 s[76:77], L_exp0
    s_waitcnt vmcnt(6)
    buffer_load_dwordx4 v[132:135], v2, s[32:35], s79 offen offset:256 nt
    s_waitcnt vmcnt(6)
    v_mfma_f32_16x16x32_bf16 v[8:11], v[36:39], v[64:67], v[8:11]
    v_and_b32 v36, v34, v4
    v_and_b32 v37, v34, v5
    v_and_b32 v38, v34, v6
    v_and_b32 v39, v34, v7
    v_mfma_f32_16x16x32_bf16 v[8:11], v[40:43], v[68:71], v[8:11]
    v_and_b32 v40, v35, v4
    v_and_b32 v41, v35, v5
    v_and_b32 v42, v35, v6
    v_and_b32 v43, v35, v7
    v_mfma_f32_16x16x32_bf16 v[8:11], v[36:39], v[72:75], v[8:11]
    s_nop 0
    v_mfma_f32_16x16x32_bf16 v[8:11], v[40:43], v[76:79], v[8:11]
    s_waitcnt vmcnt(6)
    buffer_load_dwordx4 v[136:139], v2, s[32:35], s79 offen offset:2048 nt
    s_mov_b32 s91, s63
    s_call_b64 s[76:77], L_pack64_0
    s_waitcnt vmcnt(6)
    buffer_load_dwordx4 v[140:143], v2, s[32:35], s79 offen offset:2304 nt
    s_call_b64 s[76:77], L_pack64_1
    ds_write_b128 v3, v[64:67] offset:9984
    ds_write_b128 v3, v[68:71] offset:11008
    ds_write_b128 v3, v[72:75] offset:12032
    v_and_b32 v34, 63, v0
    v_mul_u32_u24 v34, 12, v34
    v_sub_u32 v34, v3, v34
    ds_write_b32 v34, v32 offset:13056
    s_cmp_lg_u64 vcc, 0
    s_cselect_b32 s92, 4, 0
    s_or_b32 s82, s82, s92
    s_add_u32 s68, s67, 4063232
    s_xor_b32 s78, s68, s67
    s_and_b32 s78, s78, 0xff800000
    s_xor_b32 s68, s68, s78
    s_waitcnt vmcnt(4)
    buffer_load_dwordx4 v[64:67], v2, s[32:35], s68 offen offset:0 nt
    s_waitcnt vmcnt(4)
    buffer_load_dwordx4 v[68:71], v2, s[32:35], s68 offen offset:256 nt
    v_mov_b32_dpp v32, v228 row_newbcast:0 row_mask:0xf bank_mask:0xf
    v_mov_b32_dpp v33, v229 row_newbcast:0 row_mask:0xf bank_mask:0xf
    v_mov_b32_dpp v34, v230 row_newbcast:0 row_mask:0xf bank_mask:0xf
    v_mov_b32_dpp v35, v231 row_newbcast:0 row_mask:0xf bank_mask:0xf
    s_call_b64 s[76:77], L_exp0
    s_waitcnt vmcnt(4)
    buffer_load_dwordx4 v[72:75], v2, s[32:35], s68 offen offset:2048 nt
    s_waitcnt vmcnt(4)
    buffer_load_dwordx4 v[76:79], v2, s[32:35], s68 offen offset:2304 nt
    s_waitcnt vmcnt(8)
    v_mfma_f32_16x16x32_bf16 v[8:11], v[36:39], v[96:99], v[8:11]
    v_and_b32 v36, v34, v4
    v_and_b32 v37, v34, v5
    v_and_b32 v38, v34, v6
    v_and_b32 v39, v34, v7
    v_mfma_f32_16x16x32_bf16 v[8:11], v[40:43], v[100:103], v[8:11]
    v_and_b32 v40, v35, v4
    v_and_b32 v41, v35, v5
    v_and_b32 v42, v35, v6
    v_and_b32 v43, v35, v7
    v_mfma_f32_16x16x32_bf16 v[8:11], v[36:39], v[104:107], v[8:11]
    s_nop 0
    v_mfma_f32_16x16x32_bf16 v[8:11], v[40:43], v[108:111], v[8:11]
    s_add_u32 s79, s67, 917504
    s_xor_b32 s78, s79, s67
    s_and_b32 s78, s78, 0xff800000
    s_xor_b32 s79, s79, s78
    s_waitcnt vmcnt(5)
    buffer_load_dwordx4 v[96:99], v2, s[32:35], s79 offen offset:0
    s_waitcnt vmcnt(5)
    buffer_load_dwordx4 v[100:103], v2, s[32:35], s79 offen offset:256
    v_mov_b32_dpp v32, v228 row_newbcast:2 row_mask:0xf bank_mask:0xf
    v_mov_b32_dpp v33, v229 row_newbcast:2 row_mask:0xf bank_mask:0xf
    v_mov_b32_dpp v34, v230 row_newbcast:2 row_mask:0xf bank_mask:0xf
    v_mov_b32_dpp v35, v231 row_newbcast:2 row_mask:0xf bank_mask:0xf
    s_call_b64 s[76:77], L_exp0
    s_waitcnt vmcnt(5)
    buffer_load_dwordx4 v[104:107], v2, s[32:35], s79 offen offset:2048
    s_waitcnt vmcnt(5)
    buffer_load_dwordx4 v[108:111], v2, s[32:35], s79 offen offset:2304
    s_waitcnt vmcnt(8)
    v_mfma_f32_16x16x32_bf16 v[8:11], v[36:39], v[128:131], v[8:11]
    v_and_b32 v36, v34, v4
    v_and_b32 v37, v34, v5
    v_and_b32 v38, v34, v6
    v_and_b32 v39, v34, v7
    v_mfma_f32_16x16x32_bf16 v[8:11], v[40:43], v[132:135], v[8:11]
    v_and_b32 v40, v35, v4
    v_and_b32 v41, v35, v5
    v_and_b32 v42, v35, v6
    v_and_b32 v43, v35, v7
    v_mfma_f32_16x16x32_bf16 v[8:11], v[36:39], v[136:139], v[8:11]
    s_nop 0
    v_mfma_f32_16x16x32_bf16 v[8:11], v[40:43], v[140:143], v[8:11]
    s_add_u32 s68, s67, 1048576
    s_xor_b32 s78, s68, s67
    s_and_b32 s78, s78, 0xff800000
    s_xor_b32 s68, s68, s78
    s_waitcnt vmcnt(6)
    buffer_load_dwordx4 v[128:131], v2, s[32:35], s68 offen offset:0 nt
    v_mov_b32_dpp v32, v228 row_newbcast:4 row_mask:0xf bank_mask:0xf
    v_mov_b32_dpp v33, v229 row_newbcast:4 row_mask:0xf bank_mask:0xf
    v_mov_b32_dpp v34, v230 row_newbcast:4 row_mask:0xf bank_mask:0xf
    v_mov_b32_dpp v35, v231 row_newbcast:4 row_mask:0xf bank_mask:0xf
    s_call_b64 s[76:77], L_exp0
    s_waitcnt vmcnt(6)
    buffer_load_dwordx4 v[132:135], v2, s[32:35], s68 offen offset:256 nt
    s_waitcnt vmcnt(6)
    v_mfma_f32_16x16x32_bf16 v[8:11], v[36:39], v[64:67], v[8:11]
    v_and_b32 v36, v34, v4
    v_and_b32 v37, v34, v5
    v_and_b32 v38, v34, v6
    v_and_b32 v39, v34, v7
    v_mfma_f32_16x16x32_bf16 v[8:11], v[40:43], v[68:71], v[8:11]
    v_and_b32 v40, v35, v4
    v_and_b32 v41, v35, v5
    v_and_b32 v42, v35, v6
    v_and_b32 v43, v35, v7
    v_mfma_f32_16x16x32_bf16 v[8:11], v[36:39], v[72:75], v[8:11]
    s_nop 0
    v_mfma_f32_16x16x32_bf16 v[8:11], v[40:43], v[76:79], v[8:11]
    s_waitcnt vmcnt(6)
    buffer_load_dwordx4 v[136:139], v2, s[32:35], s68 offen offset:2048 nt
    s_mov_b32 s91, s63
    s_call_b64 s[76:77], L_pack64_0
    s_waitcnt vmcnt(6)
    buffer_load_dwordx4 v[140:143], v2, s[32:35], s68 offen offset:2304 nt
    s_call_b64 s[76:77], L_pack64_1
    ds_write_b128 v3, v[64:67] offset:16640
    ds_write_b128 v3, v[68:71] offset:17664
    ds_write_b128 v3, v[72:75] offset:18688
    v_and_b32 v34, 63, v0
    v_mul_u32_u24 v34, 12, v34
    v_sub_u32 v34, v3, v34
    ds_write_b32 v34, v32 offset:19712
    s_cmp_lg_u64 vcc, 0
    s_cselect_b32 s92, 8, 0
    s_or_b32 s82, s82, s92
    s_add_u32 s79, s67, 4194304
    s_xor_b32 s78, s79, s67
    s_and_b32 s78, s78, 0xff800000
    s_xor_b32 s79, s79, s78
    s_waitcnt vmcnt(4)
    buffer_load_dwordx4 v[64:67], v2, s[32:35], s79 offen offset:0 nt
    s_waitcnt vmcnt(4)
    buffer_load_dwordx4 v[68:71], v2, s[32:35], s79 offen offset:256 nt
    v_mov_b32_dpp v32, v228 row_newbcast:6 row_mask:0xf bank_mask:0xf
    v_mov_b32_dpp v33, v229 row_newbcast:6 row_mask:0xf bank_mask:0xf
    v_mov_b32_dpp v34, v230 row_newbcast:6 row_mask:0xf bank_mask:0xf
    v_mov_b32_dpp v35, v231 row_newbcast:6 row_mask:0xf bank_mask:0xf
    s_call_b64 s[76:77], L_exp0
    s_waitcnt vmcnt(4)
    buffer_load_dwordx4 v[72:75], v2, s[32:35], s79 offen offset:2048 nt
    s_waitcnt vmcnt(4)
    buffer_load_dwordx4 v[76:79], v2, s[32:35], s79 offen offset:2304 nt
    s_waitcnt vmcnt(8)
    v_mfma_f32_16x16x32_bf16 v[8:11], v[36:39], v[96:99], v[8:11]
    v_and_b32 v36, v34, v4
    v_and_b32 v37, v34, v5
    v_and_b32 v38, v34, v6
    v_and_b32 v39, v34, v7
    v_mfma_f32_16x16x32_bf16 v[8:11], v[40:43], v[100:103], v[8:11]
    v_and_b32 v40, v35, v4
    v_and_b32 v41, v35, v5
    v_and_b32 v42, v35, v6
    v_and_b32 v43, v35, v7
    v_mfma_f32_16x16x32_bf16 v[8:11], v[36:39], v[104:107], v[8:11]
    s_nop 0
    v_mfma_f32_16x16x32_bf16 v[8:11], v[40:43], v[108:111], v[8:11]
    s_add_u32 s68, s67, 1179648
    s_xor_b32 s78, s68, s67
    s_and_b32 s78, s78, 0xff800000
    s_xor_b32 s68, s68, s78
    s_waitcnt vmcnt(5)
    buffer_load_dwordx4 v[96:99], v2, s[32:35], s68 offen offset:0
    s_waitcnt vmcnt(5)
    buffer_load_dwordx4 v[100:103], v2, s[32:35], s68 offen offset:256
    v_mov_b32_dpp v32, v228 row_newbcast:8 row_mask:0xf bank_mask:0xf
    v_mov_b32_dpp v33, v229 row_newbcast:8 row_mask:0xf bank_mask:0xf
    v_mov_b32_dpp v34, v230 row_newbcast:8 row_mask:0xf bank_mask:0xf
    v_mov_b32_dpp v35, v231 row_newbcast:8 row_mask:0xf bank_mask:0xf
    s_call_b64 s[76:77], L_exp0
    s_waitcnt vmcnt(5)
    buffer_load_dwordx4 v[104:107], v2, s[32:35], s68 offen offset:2048
    s_waitcnt vmcnt(5)
    buffer_load_dwordx4 v[108:111], v2, s[32:35], s68 offen offset:2304
    s_waitcnt vmcnt(8)
    v_mfma_f32_16x16x32_bf16 v[8:11], v[36:39], v[128:131], v[8:11]
    v_and_b32 v36, v34, v4
    v_and_b32 v37, v34, v5
    v_and_b32 v38, v34, v6
    v_and_b32 v39, v34, v7
    v_mfma_f32_16x16x32_bf16 v[8:11], v[40:43], v[132:135], v[8:11]
    v_and_b32 v40, v35, v4
    v_and_b32 v41, v35, v5
    v_and_b32 v42, v35, v6
    v_and_b32 v43, v35, v7
    v_mfma_f32_16x16x32_bf16 v[8:11], v[36:39], v[136:139], v[8:11]
    s_nop 0
    v_mfma_f32_16x16x32_bf16 v[8:11], v[40:43], v[140:143], v[8:11]
    s_add_u32 s79, s67, 1310720
    s_xor_b32 s78, s79, s67
    s_and_b32 s78, s78, 0xff800000
    s_xor_b32 s79, s79, s78
    s_waitcnt vmcnt(6)
    buffer_load_dwordx4 v[128:131], v2, s[32:35], s79 offen offset:0 nt
    v_mov_b32_dpp v32, v228 row_newbcast:10 row_mask:0xf bank_mask:0xf
    v_mov_b32_dpp v33, v229 row_newbcast:10 row_mask:0xf bank_mask:0xf
    v_mov_b32_dpp v34, v230 row_newbcast:10 row_mask:0xf bank_mask:0xf
    v_mov_b32_dpp v35, v231 row_newbcast:10 row_mask:0xf bank_mask:0xf
    s_call_b64 s[76:77], L_exp0
    s_waitcnt vmcnt(6)
    buffer_load_dwordx4 v[132:135], v2, s[32:35], s79 offen offset:256 nt
    s_waitcnt vmcnt(6)
    v_mfma_f32_16x16x32_bf16 v[8:11], v[36:39], v[64:67], v[8:11]
    v_and_b32 v36, v34, v4
    v_and_b32 v37, v34, v5
    v_and_b32 v38, v34, v6
    v_and_b32 v39, v34, v7
    v_mfma_f32_16x16x32_bf16 v[8:11], v[40:43], v[68:71], v[8:11]
    v_and_b32 v40, v35, v4
    v_and_b32 v41, v35, v5
    v_and_b32 v42, v35, v6
    v_and_b32 v43, v35, v7
    v_mfma_f32_16x16x32_bf16 v[8:11], v[36:39], v[72:75], v[8:11]
    s_nop 0
    v_mfma_f32_16x16x32_bf16 v[8:11], v[40:43], v[76:79], v[8:11]
    s_waitcnt vmcnt(6)
    buffer_load_dwordx4 v[136:139], v2, s[32:35], s79 offen offset:2048 nt
    s_mov_b32 s91, s63
    s_call_b64 s[76:77], L_pack64_0
    s_waitcnt vmcnt(6)
    buffer_load_dwordx4 v[140:143], v2, s[32:35], s79 offen offset:2304 nt
    s_call_b64 s[76:77], L_pack64_1
    ds_write_b128 v3, v[64:67] offset:23296
    ds_write_b128 v3, v[68:71] offset:24320
    ds_write_b128 v3, v[72:75] offset:25344
    v_and_b32 v34, 63, v0
    v_mul_u32_u24 v34, 12, v34
    v_sub_u32 v34, v3, v34
    ds_write_b32 v34, v32 offset:26368
    s_cmp_lg_u64 vcc, 0
    s_cselect_b32 s92, 16, 0
    s_or_b32 s82, s82, s92
    s_add_u32 s68, s67, 4456448
    s_xor_b32 s78, s68, s67
    s_and_b32 s78, s78, 0xff800000
    s_xor_b32 s68, s68, s78
    s_waitcnt vmcnt(4)
    buffer_load_dwordx4 v[64:67], v2, s[32:35], s68 offen offset:0 nt
    s_waitcnt vmcnt(4)
    buffer_load_dwordx4 v[68:71], v2, s[32:35], s68 offen offset:256 nt
    v_mov_b32_dpp v32, v228 row_newbcast:12 row_mask:0xf bank_mask:0xf
    v_mov_b32_dpp v33, v229 row_newbcast:12 row_mask:0xf bank_mask:0xf
    v_mov_b32_dpp v34, v230 row_newbcast:12 row_mask:0xf bank_mask:0xf
    v_mov_b32_dpp v35, v231 row_newbcast:12 row_mask:0xf bank_mask:0xf
    s_call_b64 s[76:77], L_exp0
    s_waitcnt vmcnt(4)
    buffer_load_dwordx4 v[72:75], v2, s[32:35], s68 offen offset:2048 nt
    s_waitcnt vmcnt(4)
    buffer_load_dwordx4 v[76:79], v2, s[32:35], s68 offen offset:2304 nt
    s_waitcnt vmcnt(8)
    v_mfma_f32_16x16x32_bf16 v[8:11], v[36:39], v[96:99], v[8:11]
    v_and_b32 v36, v34, v4
    v_and_b32 v37, v34, v5
    v_and_b32 v38, v34, v6
    v_and_b32 v39, v34, v7
    v_mfma_f32_16x16x32_bf16 v[8:11], v[40:43], v[100:103], v[8:11]
    v_and_b32 v40, v35, v4
    v_and_b32 v41, v35, v5
    v_and_b32 v42, v35, v6
    v_and_b32 v43, v35, v7
    v_mfma_f32_16x16x32_bf16 v[8:11], v[36:39], v[104:107], v[8:11]
    s_nop 0
    v_mfma_f32_16x16x32_bf16 v[8:11], v[40:43], v[108:111], v[8:11]
    s_add_u32 s79, s67, 1441792
    s_xor_b32 s78, s79, s67
    s_and_b32 s78, s78, 0xff800000
    s_xor_b32 s79, s79, s78
    s_waitcnt vmcnt(5)
    buffer_load_dwordx4 v[96:99], v2, s[32:35], s79 offen offset:0
    s_waitcnt vmcnt(5)
    buffer_load_dwordx4 v[100:103], v2, s[32:35], s79 offen offset:256
    v_mov_b32_dpp v32, v228 row_newbcast:14 row_mask:0xf bank_mask:0xf
    v_mov_b32_dpp v33, v229 row_newbcast:14 row_mask:0xf bank_mask:0xf
    v_mov_b32_dpp v34, v230 row_newbcast:14 row_mask:0xf bank_mask:0xf
    v_mov_b32_dpp v35, v231 row_newbcast:14 row_mask:0xf bank_mask:0xf
    s_call_b64 s[76:77], L_exp0
    s_waitcnt vmcnt(5)
    buffer_load_dwordx4 v[104:107], v2, s[32:35], s79 offen offset:2048
    s_waitcnt vmcnt(5)
    buffer_load_dwordx4 v[108:111], v2, s[32:35], s79 offen offset:2304
    s_waitcnt vmcnt(8)
    v_mfma_f32_16x16x32_bf16 v[8:11], v[36:39], v[128:131], v[8:11]
    v_and_b32 v36, v34, v4
    v_and_b32 v37, v34, v5
    v_and_b32 v38, v34, v6
    v_and_b32 v39, v34, v7
    v_mfma_f32_16x16x32_bf16 v[8:11], v[40:43], v[132:135], v[8:11]
    v_and_b32 v40, v35, v4
    v_and_b32 v41, v35, v5
    v_and_b32 v42, v35, v6
    v_and_b32 v43, v35, v7
    v_mfma_f32_16x16x32_bf16 v[8:11], v[36:39], v[136:139], v[8:11]
    s_nop 0
    v_mfma_f32_16x16x32_bf16 v[8:11], v[40:43], v[140:143], v[8:11]
    s_add_u32 s68, s67, 1572864
    s_xor_b32 s78, s68, s67
    s_and_b32 s78, s78, 0xff800000
    s_xor_b32 s68, s68, s78
    s_waitcnt vmcnt(6)
    buffer_load_dwordx4 v[128:131], v2, s[32:35], s68 offen offset:0 nt
    v_mov_b32_dpp v32, v232 row_newbcast:0 row_mask:0xf bank_mask:0xf
    v_mov_b32_dpp v33, v233 row_newbcast:0 row_mask:0xf bank_mask:0xf
    v_mov_b32_dpp v34, v234 row_newbcast:0 row_mask:0xf bank_mask:0xf
    v_mov_b32_dpp v35, v235 row_newbcast:0 row_mask:0xf bank_mask:0xf
    s_call_b64 s[76:77], L_exp0
    s_waitcnt vmcnt(6)
    buffer_load_dwordx4 v[132:135], v2, s[32:35], s68 offen offset:256 nt
    s_waitcnt vmcnt(6)
    v_mfma_f32_16x16x32_bf16 v[8:11], v[36:39], v[64:67], v[8:11]
    v_and_b32 v36, v34, v4
    v_and_b32 v37, v34, v5
    v_and_b32 v38, v34, v6
    v_and_b32 v39, v34, v7
    v_mfma_f32_16x16x32_bf16 v[8:11], v[40:43], v[68:71], v[8:11]
    v_and_b32 v40, v35, v4
    v_and_b32 v41, v35, v5
    v_and_b32 v42, v35, v6
    v_and_b32 v43, v35, v7
    v_mfma_f32_16x16x32_bf16 v[8:11], v[36:39], v[72:75], v[8:11]
    s_nop 0
    v_mfma_f32_16x16x32_bf16 v[8:11], v[40:43], v[76:79], v[8:11]
    s_waitcnt vmcnt(6)
    buffer_load_dwordx4 v[136:139], v2, s[32:35], s68 offen offset:2048 nt
    s_mov_b32 s91, s63
    s_call_b64 s[76:77], L_pack64_0
    s_waitcnt vmcnt(6)
    buffer_load_dwordx4 v[140:143], v2, s[32:35], s68 offen offset:2304 nt
    s_call_b64 s[76:77], L_pack64_1
    ds_write_b128 v3, v[64:67] offset:29952
    ds_write_b128 v3, v[68:71] offset:30976
    ds_write_b128 v3, v[72:75] offset:32000
    v_and_b32 v34, 63, v0
    v_mul_u32_u24 v34, 12, v34
    v_sub_u32 v34, v3, v34
    ds_write_b32 v34, v32 offset:33024
    s_cmp_lg_u64 vcc, 0
    s_cselect_b32 s92, 32, 0
    s_or_b32 s82, s82, s92
    s_add_u32 s79, s67, 4718592
    s_xor_b32 s78, s79, s67
    s_and_b32 s78, s78, 0xff800000
    s_xor_b32 s79, s79, s78
    s_waitcnt vmcnt(4)
    buffer_load_dwordx4 v[64:67], v2, s[32:35], s79 offen offset:0 nt
    s_waitcnt vmcnt(4)
    buffer_load_dwordx4 v[68:71], v2, s[32:35], s79 offen offset:256 nt
    v_mov_b32_dpp v32, v232 row_newbcast:2 row_mask:0xf bank_mask:0xf
    v_mov_b32_dpp v33, v233 row_newbcast:2 row_mask:0xf bank_mask:0xf
    v_mov_b32_dpp v34, v234 row_newbcast:2 row_mask:0xf bank_mask:0xf
    v_mov_b32_dpp v35, v235 row_newbcast:2 row_mask:0xf bank_mask:0xf
    s_call_b64 s[76:77], L_exp0
    s_waitcnt vmcnt(4)
    buffer_load_dwordx4 v[72:75], v2, s[32:35], s79 offen offset:2048 nt
    s_waitcnt vmcnt(4)
    buffer_load_dwordx4 v[76:79], v2, s[32:35], s79 offen offset:2304 nt
    s_waitcnt vmcnt(8)
    v_mfma_f32_16x16x32_bf16 v[8:11], v[36:39], v[96:99], v[8:11]
    v_and_b32 v36, v34, v4
    v_and_b32 v37, v34, v5
    v_and_b32 v38, v34, v6
    v_and_b32 v39, v34, v7
    v_mfma_f32_16x16x32_bf16 v[8:11], v[40:43], v[100:103], v[8:11]
    v_and_b32 v40, v35, v4
    v_and_b32 v41, v35, v5
    v_and_b32 v42, v35, v6
    v_and_b32 v43, v35, v7
    v_mfma_f32_16x16x32_bf16 v[8:11], v[36:39], v[104:107], v[8:11]
    s_nop 0
    v_mfma_f32_16x16x32_bf16 v[8:11], v[40:43], v[108:111], v[8:11]
    s_add_u32 s68, s67, 1703936
    s_xor_b32 s78, s68, s67
    s_and_b32 s78, s78, 0xff800000
    s_xor_b32 s68, s68, s78
    s_waitcnt vmcnt(4)
    buffer_load_dwordx4 v[96:99], v2, s[32:35], s68 offen offset:0 nt
    s_waitcnt vmcnt(4)
    buffer_load_dwordx4 v[100:103], v2, s[32:35], s68 offen offset:256 nt
    v_mov_b32_dpp v32, v232 row_newbcast:4 row_mask:0xf bank_mask:0xf
    v_mov_b32_dpp v33, v233 row_newbcast:4 row_mask:0xf bank_mask:0xf
    v_mov_b32_dpp v34, v234 row_newbcast:4 row_mask:0xf bank_mask:0xf
    v_mov_b32_dpp v35, v235 row_newbcast:4 row_mask:0xf bank_mask:0xf
    s_call_b64 s[76:77], L_exp0
    s_waitcnt vmcnt(4)
    buffer_load_dwordx4 v[104:107], v2, s[32:35], s68 offen offset:2048 nt
    s_waitcnt vmcnt(4)
    buffer_load_dwordx4 v[108:111], v2, s[32:35], s68 offen offset:2304 nt
    s_waitcnt vmcnt(8)
    v_mfma_f32_16x16x32_bf16 v[8:11], v[36:39], v[128:131], v[8:11]
    v_and_b32 v36, v34, v4
    v_and_b32 v37, v34, v5
    v_and_b32 v38, v34, v6
    v_and_b32 v39, v34, v7
    v_mfma_f32_16x16x32_bf16 v[8:11], v[40:43], v[132:135], v[8:11]
    v_and_b32 v40, v35, v4
    v_and_b32 v41, v35, v5
    v_and_b32 v42, v35, v6
    v_and_b32 v43, v35, v7
    v_mfma_f32_16x16x32_bf16 v[8:11], v[36:39], v[136:139], v[8:11]
    s_nop 0
    v_mfma_f32_16x16x32_bf16 v[8:11], v[40:43], v[140:143], v[8:11]
    s_add_u32 s79, s67, 4849664
    s_xor_b32 s78, s79, s67
    s_and_b32 s78, s78, 0xff800000
    s_xor_b32 s79, s79, s78
    s_waitcnt vmcnt(6)
    buffer_load_dwordx4 v[128:131], v2, s[32:35], s79 offen offset:0 nt
    v_mov_b32_dpp v32, v232 row_newbcast:6 row_mask:0xf bank_mask:0xf
    v_mov_b32_dpp v33, v233 row_newbcast:6 row_mask:0xf bank_mask:0xf
    v_mov_b32_dpp v34, v234 row_newbcast:6 row_mask:0xf bank_mask:0xf
    v_mov_b32_dpp v35, v235 row_newbcast:6 row_mask:0xf bank_mask:0xf
    s_call_b64 s[76:77], L_exp0
    s_waitcnt vmcnt(6)
    buffer_load_dwordx4 v[132:135], v2, s[32:35], s79 offen offset:256 nt
    s_waitcnt vmcnt(6)
    v_mfma_f32_16x16x32_bf16 v[8:11], v[36:39], v[64:67], v[8:11]
    v_and_b32 v36, v34, v4
    v_and_b32 v37, v34, v5
    v_and_b32 v38, v34, v6
    v_and_b32 v39, v34, v7
    v_mfma_f32_16x16x32_bf16 v[8:11], v[40:43], v[68:71], v[8:11]
    v_and_b32 v40, v35, v4
    v_and_b32 v41, v35, v5
    v_and_b32 v42, v35, v6
    v_and_b32 v43, v35, v7
    v_mfma_f32_16x16x32_bf16 v[8:11], v[36:39], v[72:75], v[8:11]
    s_nop 0
    v_mfma_f32_16x16x32_bf16 v[8:11], v[40:43], v[76:79], v[8:11]
    s_waitcnt vmcnt(6)
    buffer_load_dwordx4 v[136:139], v2, s[32:35], s79 offen offset:2048 nt
    s_mov_b32 s91, s63
    s_call_b64 s[76:77], L_pack64_0
    s_waitcnt vmcnt(6)
    buffer_load_dwordx4 v[140:143], v2, s[32:35], s79 offen offset:2304 nt
    s_call_b64 s[76:77], L_pack64_1
    ds_write_b128 v3, v[64:67] offset:36608
    ds_write_b128 v3, v[68:71] offset:37632
    ds_write_b128 v3, v[72:75] offset:38656
    v_and_b32 v34, 63, v0
    v_mul_u32_u24 v34, 12, v34
    v_sub_u32 v34, v3, v34
    ds_write_b32 v34, v32 offset:39680
    s_cmp_lg_u64 vcc, 0
    s_cselect_b32 s92, 64, 0
    s_or_b32 s82, s82, s92
    s_add_u32 s68, s67, 1835008
    s_xor_b32 s78, s68, s67
    s_and_b32 s78, s78, 0xff800000
    s_xor_b32 s68, s68, s78
    s_waitcnt vmcnt(5)
    buffer_load_dwordx4 v[64:67], v2, s[32:35], s68 offen offset:0
    s_waitcnt vmcnt(5)
    buffer_load_dwordx4 v[68:71], v2, s[32:35], s68 offen offset:256
    v_mov_b32_dpp v32, v232 row_newbcast:8 row_mask:0xf bank_mask:0xf
    v_mov_b32_dpp v33, v233 row_newbcast:8 row_mask:0xf bank_mask:0xf
    v_mov_b32_dpp v34, v234 row_newbcast:8 row_mask:0xf bank_mask:0xf
    v_mov_b32_dpp v35, v235 row_newbcast:8 row_mask:0xf bank_mask:0xf
    s_call_b64 s[76:77], L_exp0
    s_waitcnt vmcnt(5)
    buffer_load_dwordx4 v[72:75], v2, s[32:35], s68 offen offset:2048
    s_waitcnt vmcnt(5)
    buffer_load_dwordx4 v[76:79], v2, s[32:35], s68 offen offset:2304
    s_waitcnt vmcnt(8)
    v_mfma_f32_16x16x32_bf16 v[8:11], v[36:39], v[96:99], v[8:11]
    v_and_b32 v36, v34, v4
    v_and_b32 v37, v34, v5
    v_and_b32 v38, v34, v6
    v_and_b32 v39, v34, v7
    v_mfma_f32_16x16x32_bf16 v[8:11], v[40:43], v[100:103], v[8:11]
    v_and_b32 v40, v35, v4
    v_and_b32 v41, v35, v5
    v_and_b32 v42, v35, v6
    v_and_b32 v43, v35, v7
    v_mfma_f32_16x16x32_bf16 v[8:11], v[36:39], v[104:107], v[8:11]
    s_nop 0
    v_mfma_f32_16x16x32_bf16 v[8:11], v[40:43], v[108:111], v[8:11]
    s_add_u32 s79, s67, 1966080
    s_xor_b32 s78, s79, s67
    s_and_b32 s78, s78, 0xff800000
    s_xor_b32 s79, s79, s78
    s_waitcnt vmcnt(6)
    buffer_load_dwordx4 v[96:99], v2, s[32:35], s79 offen offset:0 nt
    v_mov_b32_dpp v32, v232 row_newbcast:10 row_mask:0xf bank_mask:0xf
    v_mov_b32_dpp v33, v233 row_newbcast:10 row_mask:0xf bank_mask:0xf
    v_mov_b32_dpp v34, v234 row_newbcast:10 row_mask:0xf bank_mask:0xf
    v_mov_b32_dpp v35, v235 row_newbcast:10 row_mask:0xf bank_mask:0xf
    s_call_b64 s[76:77], L_exp0
    s_waitcnt vmcnt(6)
    buffer_load_dwordx4 v[100:103], v2, s[32:35], s79 offen offset:256 nt
    s_waitcnt vmcnt(6)
    v_mfma_f32_16x16x32_bf16 v[8:11], v[36:39], v[128:131], v[8:11]
    v_and_b32 v36, v34, v4
    v_and_b32 v37, v34, v5
    v_and_b32 v38, v34, v6
    v_and_b32 v39, v34, v7
    v_mfma_f32_16x16x32_bf16 v[8:11], v[40:43], v[132:135], v[8:11]
    v_and_b32 v40, v35, v4
    v_and_b32 v41, v35, v5
    v_and_b32 v42, v35, v6
    v_and_b32 v43, v35, v7
    v_mfma_f32_16x16x32_bf16 v[8:11], v[36:39], v[136:139], v[8:11]
    s_nop 0
    v_mfma_f32_16x16x32_bf16 v[8:11], v[40:43], v[140:143], v[8:11]
    s_waitcnt vmcnt(6)
    buffer_load_dwordx4 v[104:107], v2, s[32:35], s79 offen offset:2048 nt
    s_mov_b32 s91, s63
    s_call_b64 s[76:77], L_pack128_0
    s_waitcnt vmcnt(6)
    buffer_load_dwordx4 v[108:111], v2, s[32:35], s79 offen offset:2304 nt
    s_call_b64 s[76:77], L_pack128_1
    v_mov_b32 v186, v128
    v_mov_b32 v187, v129
    v_mov_b32 v188, v130
    v_mov_b32 v189, v131
    v_mov_b32 v190, v132
    v_mov_b32 v191, v133
    v_mov_b32 v192, v134
    v_mov_b32 v193, v135
    v_mov_b32 v194, v136
    v_mov_b32 v195, v137
    v_mov_b32 v196, v138
    v_mov_b32 v197, v139
    v_mov_b32 v198, v32
    s_cmp_lg_u64 vcc, 0
    s_cselect_b32 s92, 128, 0
    s_or_b32 s82, s82, s92
    s_add_u32 s68, s67, 5111808
    s_xor_b32 s78, s68, s67
    s_and_b32 s78, s78, 0xff800000
    s_xor_b32 s68, s68, s78
    s_waitcnt vmcnt(4)
    buffer_load_dwordx4 v[128:131], v2, s[32:35], s68 offen offset:0 nt
    s_waitcnt vmcnt(4)
    buffer_load_dwordx4 v[132:135], v2, s[32:35], s68 offen offset:256 nt
    v_mov_b32_dpp v32, v232 row_newbcast:12 row_mask:0xf bank_mask:0xf
    v_mov_b32_dpp v33, v233 row_newbcast:12 row_mask:0xf bank_mask:0xf
    v_mov_b32_dpp v34, v234 row_newbcast:12 row_mask:0xf bank_mask:0xf
    v_mov_b32_dpp v35, v235 row_newbcast:12 row_mask:0xf bank_mask:0xf
    s_call_b64 s[76:77], L_exp0
    s_waitcnt vmcnt(4)
    buffer_load_dwordx4 v[136:139], v2, s[32:35], s68 offen offset:2048 nt
    s_waitcnt vmcnt(4)
    buffer_load_dwordx4 v[140:143], v2, s[32:35], s68 offen offset:2304 nt
    s_waitcnt vmcnt(8)
    v_mfma_f32_16x16x32_bf16 v[8:11], v[36:39], v[64:67], v[8:11]
    v_and_b32 v36, v34, v4
    v_and_b32 v37, v34, v5
    v_and_b32 v38, v34, v6
    v_and_b32 v39, v34, v7
    v_mfma_f32_16x16x32_bf16 v[8:11], v[40:43], v[68:71], v[8:11]
    v_and_b32 v40, v35, v4
    v_and_b32 v41, v35, v5
    v_and_b32 v42, v35, v6
    v_and_b32 v43, v35, v7
    v_mfma_f32_16x16x32_bf16 v[8:11], v[36:39], v[72:75], v[8:11]
    s_nop 0
    v_mfma_f32_16x16x32_bf16 v[8:11], v[40:43], v[76:79], v[8:11]
    s_add_u32 s79, s67, 2097152
    s_xor_b32 s78, s79, s67
    s_and_b32 s78, s78, 0xff800000
    s_xor_b32 s79, s79, s78
    s_waitcnt vmcnt(5)
    buffer_load_dwordx4 v[64:67], v2, s[32:35], s79 offen offset:0
    s_waitcnt vmcnt(5)
    buffer_load_dwordx4 v[68:71], v2, s[32:35], s79 offen offset:256
    v_mov_b32_dpp v32, v232 row_newbcast:14 row_mask:0xf bank_mask:0xf
    v_mov_b32_dpp v33, v233 row_newbcast:14 row_mask:0xf bank_mask:0xf
    v_mov_b32_dpp v34, v234 row_newbcast:14 row_mask:0xf bank_mask:0xf
    v_mov_b32_dpp v35, v235 row_newbcast:14 row_mask:0xf bank_mask:0xf
    s_call_b64 s[76:77], L_exp0
    s_waitcnt vmcnt(5)
    buffer_load_dwordx4 v[72:75], v2, s[32:35], s79 offen offset:2048
    s_waitcnt vmcnt(5)
    buffer_load_dwordx4 v[76:79], v2, s[32:35], s79 offen offset:2304
    s_waitcnt vmcnt(8)
    v_mfma_f32_16x16x32_bf16 v[8:11], v[36:39], v[96:99], v[8:11]
    v_and_b32 v36, v34, v4
    v_and_b32 v37, v34, v5
    v_and_b32 v38, v34, v6
    v_and_b32 v39, v34, v7
    v_mfma_f32_16x16x32_bf16 v[8:11], v[40:43], v[100:103], v[8:11]
    v_and_b32 v40, v35, v4
    v_and_b32 v41, v35, v5
    v_and_b32 v42, v35, v6
    v_and_b32 v43, v35, v7
    v_mfma_f32_16x16x32_bf16 v[8:11], v[36:39], v[104:107], v[8:11]
    s_nop 0
    v_mfma_f32_16x16x32_bf16 v[8:11], v[40:43], v[108:111], v[8:11]
    s_add_u32 s68, s67, 2228224
    s_xor_b32 s78, s68, s67
    s_and_b32 s78, s78, 0xff800000
    s_xor_b32 s68, s68, s78
    s_waitcnt vmcnt(6)
    buffer_load_dwordx4 v[96:99], v2, s[32:35], s68 offen offset:0 nt
    v_mov_b32_dpp v32, v236 row_newbcast:0 row_mask:0xf bank_mask:0xf
    v_mov_b32_dpp v33, v237 row_newbcast:0 row_mask:0xf bank_mask:0xf
    v_mov_b32_dpp v34, v238 row_newbcast:0 row_mask:0xf bank_mask:0xf
    v_mov_b32_dpp v35, v239 row_newbcast:0 row_mask:0xf bank_mask:0xf
    s_call_b64 s[76:77], L_exp0
    s_waitcnt vmcnt(6)
    buffer_load_dwordx4 v[100:103], v2, s[32:35], s68 offen offset:256 nt
    s_waitcnt vmcnt(6)
    v_mfma_f32_16x16x32_bf16 v[8:11], v[36:39], v[128:131], v[8:11]
    v_and_b32 v36, v34, v4
    v_and_b32 v37, v34, v5
    v_and_b32 v38, v34, v6
    v_and_b32 v39, v34, v7
    v_mfma_f32_16x16x32_bf16 v[8:11], v[40:43], v[132:135], v[8:11]
    v_and_b32 v40, v35, v4
    v_and_b32 v41, v35, v5
    v_and_b32 v42, v35, v6
    v_and_b32 v43, v35, v7
    v_mfma_f32_16x16x32_bf16 v[8:11], v[36:39], v[136:139], v[8:11]
    s_nop 0
    v_mfma_f32_16x16x32_bf16 v[8:11], v[40:43], v[140:143], v[8:11]
    s_waitcnt vmcnt(6)
    buffer_load_dwordx4 v[104:107], v2, s[32:35], s68 offen offset:2048 nt
    s_mov_b32 s91, s63
    s_call_b64 s[76:77], L_pack128_0
    s_waitcnt vmcnt(6)
    buffer_load_dwordx4 v[108:111], v2, s[32:35], s68 offen offset:2304 nt
    s_call_b64 s[76:77], L_pack128_1
    v_mov_b32 v212, v128
    v_mov_b32 v213, v129
    v_mov_b32 v214, v130
    v_mov_b32 v215, v131
    v_mov_b32 v216, v132
    v_mov_b32 v217, v133
    v_mov_b32 v218, v134
    v_mov_b32 v219, v135
    v_mov_b32 v220, v136
    v_mov_b32 v221, v137
    v_mov_b32 v222, v138
    v_mov_b32 v223, v139
    v_accvgpr_write_b32 a0, v32
    s_cmp_lg_u64 vcc, 0
    s_cselect_b32 s92, 256, 0
    s_or_b32 s82, s82, s92
    s_add_u32 s79, s67, 5242880
    s_xor_b32 s78, s79, s67
    s_and_b32 s78, s78, 0xff800000
    s_xor_b32 s79, s79, s78
    s_waitcnt vmcnt(4)
    buffer_load_dwordx4 v[128:131], v2, s[32:35], s79 offen offset:0 nt
    s_waitcnt vmcnt(4)
    buffer_load_dwordx4 v[132:135], v2, s[32:35], s79 offen offset:256 nt
    v_mov_b32_dpp v32, v236 row_newbcast:2 row_mask:0xf bank_mask:0xf
    v_mov_b32_dpp v33, v237 row_newbcast:2 row_mask:0xf bank_mask:0xf
    v_mov_b32_dpp v34, v238 row_newbcast:2 row_mask:0xf bank_mask:0xf
    v_mov_b32_dpp v35, v239 row_newbcast:2 row_mask:0xf bank_mask:0xf
    s_call_b64 s[76:77], L_exp0
    s_waitcnt vmcnt(4)
    buffer_load_dwordx4 v[136:139], v2, s[32:35], s79 offen offset:2048 nt
    s_waitcnt vmcnt(4)
    buffer_load_dwordx4 v[140:143], v2, s[32:35], s79 offen offset:2304 nt
    s_waitcnt vmcnt(8)
    v_mfma_f32_16x16x32_bf16 v[8:11], v[36:39], v[64:67], v[8:11]
    v_and_b32 v36, v34, v4
    v_and_b32 v37, v34, v5
    v_and_b32 v38, v34, v6
    v_and_b32 v39, v34, v7
    v_mfma_f32_16x16x32_bf16 v[8:11], v[40:43], v[68:71], v[8:11]
    v_and_b32 v40, v35, v4
    v_and_b32 v41, v35, v5
    v_and_b32 v42, v35, v6
    v_and_b32 v43, v35, v7
    v_mfma_f32_16x16x32_bf16 v[8:11], v[36:39], v[72:75], v[8:11]
    s_nop 0
    v_mfma_f32_16x16x32_bf16 v[8:11], v[40:43], v[76:79], v[8:11]
    s_add_u32 s68, s67, 2359296
    s_xor_b32 s78, s68, s67
    s_and_b32 s78, s78, 0xff800000
    s_xor_b32 s68, s68, s78
    s_waitcnt vmcnt(5)
    buffer_load_dwordx4 v[64:67], v2, s[32:35], s68 offen offset:0
    s_waitcnt vmcnt(5)
    buffer_load_dwordx4 v[68:71], v2, s[32:35], s68 offen offset:256
    v_mov_b32_dpp v32, v236 row_newbcast:4 row_mask:0xf bank_mask:0xf
    v_mov_b32_dpp v33, v237 row_newbcast:4 row_mask:0xf bank_mask:0xf
    v_mov_b32_dpp v34, v238 row_newbcast:4 row_mask:0xf bank_mask:0xf
    v_mov_b32_dpp v35, v239 row_newbcast:4 row_mask:0xf bank_mask:0xf
    s_call_b64 s[76:77], L_exp0
    s_waitcnt vmcnt(5)
    buffer_load_dwordx4 v[72:75], v2, s[32:35], s68 offen offset:2048
    s_waitcnt vmcnt(5)
    buffer_load_dwordx4 v[76:79], v2, s[32:35], s68 offen offset:2304
    s_waitcnt vmcnt(8)
    v_mfma_f32_16x16x32_bf16 v[8:11], v[36:39], v[96:99], v[8:11]
    v_and_b32 v36, v34, v4
    v_and_b32 v37, v34, v5
    v_and_b32 v38, v34, v6
    v_and_b32 v39, v34, v7
    v_mfma_f32_16x16x32_bf16 v[8:11], v[40:43], v[100:103], v[8:11]
    v_and_b32 v40, v35, v4
    v_and_b32 v41, v35, v5
    v_and_b32 v42, v35, v6
    v_and_b32 v43, v35, v7
    v_mfma_f32_16x16x32_bf16 v[8:11], v[36:39], v[104:107], v[8:11]
    s_nop 0
    v_mfma_f32_16x16x32_bf16 v[8:11], v[40:43], v[108:111], v[8:11]
    s_add_u32 s79, s67, 2490368
    s_xor_b32 s78, s79, s67
    s_and_b32 s78, s78, 0xff800000
    s_xor_b32 s79, s79, s78
    s_waitcnt vmcnt(6)
    buffer_load_dwordx4 v[96:99], v2, s[32:35], s79 offen offset:0 nt
    v_mov_b32_dpp v32, v236 row_newbcast:6 row_mask:0xf bank_mask:0xf
    v_mov_b32_dpp v33, v237 row_newbcast:6 row_mask:0xf bank_mask:0xf
    v_mov_b32_dpp v34, v238 row_newbcast:6 row_mask:0xf bank_mask:0xf
    v_mov_b32_dpp v35, v239 row_newbcast:6 row_mask:0xf bank_mask:0xf
    s_call_b64 s[76:77], L_exp0
    s_waitcnt vmcnt(6)
    buffer_load_dwordx4 v[100:103], v2, s[32:35], s79 offen offset:256 nt
    s_waitcnt vmcnt(6)
    v_mfma_f32_16x16x32_bf16 v[8:11], v[36:39], v[128:131], v[8:11]
    v_and_b32 v36, v34, v4
    v_and_b32 v37, v34, v5
    v_and_b32 v38, v34, v6
    v_and_b32 v39, v34, v7
    v_mfma_f32_16x16x32_bf16 v[8:11], v[40:43], v[132:135], v[8:11]
    v_and_b32 v40, v35, v4
    v_and_b32 v41, v35, v5
    v_and_b32 v42, v35, v6
    v_and_b32 v43, v35, v7
    v_mfma_f32_16x16x32_bf16 v[8:11], v[36:39], v[136:139], v[8:11]
    s_nop 0
    v_mfma_f32_16x16x32_bf16 v[8:11], v[40:43], v[140:143], v[8:11]
    s_waitcnt vmcnt(6)
    buffer_load_dwordx4 v[104:107], v2, s[32:35], s79 offen offset:2048 nt
    s_mov_b32 s91, s63
    s_call_b64 s[76:77], L_pack128_0
    s_waitcnt vmcnt(6)
    buffer_load_dwordx4 v[108:111], v2, s[32:35], s79 offen offset:2304 nt
    s_call_b64 s[76:77], L_pack128_1
    v_accvgpr_write_b32 a14, v128
    v_accvgpr_write_b32 a15, v129
    v_accvgpr_write_b32 a16, v130
    v_accvgpr_write_b32 a17, v131
    v_accvgpr_write_b32 a18, v132
    v_accvgpr_write_b32 a19, v133
    v_accvgpr_write_b32 a20, v134
    v_accvgpr_write_b32 a21, v135
    v_accvgpr_write_b32 a22, v136
    v_accvgpr_write_b32 a23, v137
    v_accvgpr_write_b32 a24, v138
    v_accvgpr_write_b32 a25, v139
    v_accvgpr_write_b32 a26, v32
    s_cmp_lg_u64 vcc, 0
    s_cselect_b32 s92, 512, 0
    s_or_b32 s82, s82, s92
    s_add_u32 s68, s67, 5505024
    s_xor_b32 s78, s68, s67
    s_and_b32 s78, s78, 0xff800000
    s_xor_b32 s68, s68, s78
    s_waitcnt vmcnt(4)
    buffer_load_dwordx4 v[128:131], v2, s[32:35], s68 offen offset:0 nt
    s_waitcnt vmcnt(4)
    buffer_load_dwordx4 v[132:135], v2, s[32:35], s68 offen offset:256 nt
    v_mov_b32_dpp v32, v236 row_newbcast:8 row_mask:0xf bank_mask:0xf
    v_mov_b32_dpp v33, v237 row_newbcast:8 row_mask:0xf bank_mask:0xf
    v_mov_b32_dpp v34, v238 row_newbcast:8 row_mask:0xf bank_mask:0xf
    v_mov_b32_dpp v35, v239 row_newbcast:8 row_mask:0xf bank_mask:0xf
    s_call_b64 s[76:77], L_exp0
    s_waitcnt vmcnt(4)
    buffer_load_dwordx4 v[136:139], v2, s[32:35], s68 offen offset:2048 nt
    s_waitcnt vmcnt(4)
    buffer_load_dwordx4 v[140:143], v2, s[32:35], s68 offen offset:2304 nt
    s_waitcnt vmcnt(8)
    v_mfma_f32_16x16x32_bf16 v[8:11], v[36:39], v[64:67], v[8:11]
    v_and_b32 v36, v34, v4
    v_and_b32 v37, v34, v5
    v_and_b32 v38, v34, v6
    v_and_b32 v39, v34, v7
    v_mfma_f32_16x16x32_bf16 v[8:11], v[40:43], v[68:71], v[8:11]
    v_and_b32 v40, v35, v4
    v_and_b32 v41, v35, v5
    v_and_b32 v42, v35, v6
    v_and_b32 v43, v35, v7
    v_mfma_f32_16x16x32_bf16 v[8:11], v[36:39], v[72:75], v[8:11]
    s_nop 0
    v_mfma_f32_16x16x32_bf16 v[8:11], v[40:43], v[76:79], v[8:11]
    s_add_u32 s79, s67, 2621440
    s_xor_b32 s78, s79, s67
    s_and_b32 s78, s78, 0xff800000
    s_xor_b32 s79, s79, s78
    s_waitcnt vmcnt(5)
    buffer_load_dwordx4 v[64:67], v2, s[32:35], s79 offen offset:0
    s_waitcnt vmcnt(5)
    buffer_load_dwordx4 v[68:71], v2, s[32:35], s79 offen offset:256
    v_mov_b32_dpp v32, v236 row_newbcast:10 row_mask:0xf bank_mask:0xf
    v_mov_b32_dpp v33, v237 row_newbcast:10 row_mask:0xf bank_mask:0xf
    v_mov_b32_dpp v34, v238 row_newbcast:10 row_mask:0xf bank_mask:0xf
    v_mov_b32_dpp v35, v239 row_newbcast:10 row_mask:0xf bank_mask:0xf
    s_call_b64 s[76:77], L_exp0
    s_waitcnt vmcnt(5)
    buffer_load_dwordx4 v[72:75], v2, s[32:35], s79 offen offset:2048
    s_waitcnt vmcnt(5)
    buffer_load_dwordx4 v[76:79], v2, s[32:35], s79 offen offset:2304
    s_waitcnt vmcnt(8)
    v_mfma_f32_16x16x32_bf16 v[8:11], v[36:39], v[96:99], v[8:11]
    v_and_b32 v36, v34, v4
    v_and_b32 v37, v34, v5
    v_and_b32 v38, v34, v6
    v_and_b32 v39, v34, v7
    v_mfma_f32_16x16x32_bf16 v[8:11], v[40:43], v[100:103], v[8:11]
    v_and_b32 v40, v35, v4
    v_and_b32 v41, v35, v5
    v_and_b32 v42, v35, v6
    v_and_b32 v43, v35, v7
    v_mfma_f32_16x16x32_bf16 v[8:11], v[36:39], v[104:107], v[8:11]
    s_nop 0
    v_mfma_f32_16x16x32_bf16 v[8:11], v[40:43], v[108:111], v[8:11]
    s_add_u32 s68, s67, 2752512
    s_xor_b32 s78, s68, s67
    s_and_b32 s78, s78, 0xff800000
    s_xor_b32 s68, s68, s78
    s_waitcnt vmcnt(6)
    buffer_load_dwordx4 v[96:99], v2, s[32:35], s68 offen offset:0 nt
    v_mov_b32_dpp v32, v236 row_newbcast:12 row_mask:0xf bank_mask:0xf
    v_mov_b32_dpp v33, v237 row_newbcast:12 row_mask:0xf bank_mask:0xf
    v_mov_b32_dpp v34, v238 row_newbcast:12 row_mask:0xf bank_mask:0xf
    v_mov_b32_dpp v35, v239 row_newbcast:12 row_mask:0xf bank_mask:0xf
    s_call_b64 s[76:77], L_exp0
    s_waitcnt vmcnt(6)
    buffer_load_dwordx4 v[100:103], v2, s[32:35], s68 offen offset:256 nt
    s_waitcnt vmcnt(6)
    v_mfma_f32_16x16x32_bf16 v[8:11], v[36:39], v[128:131], v[8:11]
    v_and_b32 v36, v34, v4
    v_and_b32 v37, v34, v5
    v_and_b32 v38, v34, v6
    v_and_b32 v39, v34, v7
    v_mfma_f32_16x16x32_bf16 v[8:11], v[40:43], v[132:135], v[8:11]
    v_and_b32 v40, v35, v4
    v_and_b32 v41, v35, v5
    v_and_b32 v42, v35, v6
    v_and_b32 v43, v35, v7
    v_mfma_f32_16x16x32_bf16 v[8:11], v[36:39], v[136:139], v[8:11]
    s_nop 0
    v_mfma_f32_16x16x32_bf16 v[8:11], v[40:43], v[140:143], v[8:11]
    s_waitcnt vmcnt(6)
    buffer_load_dwordx4 v[104:107], v2, s[32:35], s68 offen offset:2048 nt
    s_mov_b32 s91, s63
    s_call_b64 s[76:77], L_pack128_0
    s_waitcnt vmcnt(6)
    buffer_load_dwordx4 v[108:111], v2, s[32:35], s68 offen offset:2304 nt
    s_call_b64 s[76:77], L_pack128_1
    v_accvgpr_write_b32 a40, v128
    v_accvgpr_write_b32 a41, v129
    v_accvgpr_write_b32 a42, v130
    v_accvgpr_write_b32 a43, v131
    v_accvgpr_write_b32 a44, v132
    v_accvgpr_write_b32 a45, v133
    v_accvgpr_write_b32 a46, v134
    v_accvgpr_write_b32 a47, v135
    v_accvgpr_write_b32 a48, v136
    v_accvgpr_write_b32 a49, v137
    v_accvgpr_write_b32 a50, v138
    v_accvgpr_write_b32 a51, v139
    v_accvgpr_write_b32 a52, v32
    s_cmp_lg_u64 vcc, 0
    s_cselect_b32 s92, 1024, 0
    s_or_b32 s82, s82, s92
    s_add_u32 s79, s67, 5636096
    s_xor_b32 s78, s79, s67
    s_and_b32 s78, s78, 0xff800000
    s_xor_b32 s79, s79, s78
    s_waitcnt vmcnt(4)
    buffer_load_dwordx4 v[128:131], v2, s[32:35], s79 offen offset:0 nt
    s_waitcnt vmcnt(4)
    buffer_load_dwordx4 v[132:135], v2, s[32:35], s79 offen offset:256 nt
    v_mov_b32_dpp v32, v236 row_newbcast:14 row_mask:0xf bank_mask:0xf
    v_mov_b32_dpp v33, v237 row_newbcast:14 row_mask:0xf bank_mask:0xf
    v_mov_b32_dpp v34, v238 row_newbcast:14 row_mask:0xf bank_mask:0xf
    v_mov_b32_dpp v35, v239 row_newbcast:14 row_mask:0xf bank_mask:0xf
    s_call_b64 s[76:77], L_exp0
    s_waitcnt vmcnt(4)
    buffer_load_dwordx4 v[136:139], v2, s[32:35], s79 offen offset:2048 nt
    s_waitcnt vmcnt(4)
    buffer_load_dwordx4 v[140:143], v2, s[32:35], s79 offen offset:2304 nt
    s_waitcnt vmcnt(8)
    v_mfma_f32_16x16x32_bf16 v[8:11], v[36:39], v[64:67], v[8:11]
    v_and_b32 v36, v34, v4
    v_and_b32 v37, v34, v5
    v_and_b32 v38, v34, v6
    v_and_b32 v39, v34, v7
    v_mfma_f32_16x16x32_bf16 v[8:11], v[40:43], v[68:71], v[8:11]
    v_and_b32 v40, v35, v4
    v_and_b32 v41, v35, v5
    v_and_b32 v42, v35, v6
    v_and_b32 v43, v35, v7
    v_mfma_f32_16x16x32_bf16 v[8:11], v[36:39], v[72:75], v[8:11]
    s_nop 0
    v_mfma_f32_16x16x32_bf16 v[8:11], v[40:43], v[76:79], v[8:11]
    s_add_u32 s68, s67, 2883584
    s_xor_b32 s78, s68, s67
    s_and_b32 s78, s78, 0xff800000
    s_xor_b32 s68, s68, s78
    s_waitcnt vmcnt(5)
    buffer_load_dwordx4 v[64:67], v2, s[32:35], s68 offen offset:0
    s_waitcnt vmcnt(5)
    buffer_load_dwordx4 v[68:71], v2, s[32:35], s68 offen offset:256
    v_mov_b32_dpp v32, v240 row_newbcast:0 row_mask:0xf bank_mask:0xf
    v_mov_b32_dpp v33, v241 row_newbcast:0 row_mask:0xf bank_mask:0xf
    v_mov_b32_dpp v34, v242 row_newbcast:0 row_mask:0xf bank_mask:0xf
    v_mov_b32_dpp v35, v243 row_newbcast:0 row_mask:0xf bank_mask:0xf
    s_call_b64 s[76:77], L_exp0
    s_waitcnt vmcnt(5)
    buffer_load_dwordx4 v[72:75], v2, s[32:35], s68 offen offset:2048
    s_waitcnt vmcnt(5)
    buffer_load_dwordx4 v[76:79], v2, s[32:35], s68 offen offset:2304
    s_waitcnt vmcnt(8)
    v_mfma_f32_16x16x32_bf16 v[8:11], v[36:39], v[96:99], v[8:11]
    v_and_b32 v36, v34, v4
    v_and_b32 v37, v34, v5
    v_and_b32 v38, v34, v6
    v_and_b32 v39, v34, v7
    v_mfma_f32_16x16x32_bf16 v[8:11], v[40:43], v[100:103], v[8:11]
    v_and_b32 v40, v35, v4
    v_and_b32 v41, v35, v5
    v_and_b32 v42, v35, v6
    v_and_b32 v43, v35, v7
    v_mfma_f32_16x16x32_bf16 v[8:11], v[36:39], v[104:107], v[8:11]
    s_nop 0
    v_mfma_f32_16x16x32_bf16 v[8:11], v[40:43], v[108:111], v[8:11]
    s_add_u32 s79, s67, 3014656
    s_xor_b32 s78, s79, s67
    s_and_b32 s78, s78, 0xff800000
    s_xor_b32 s79, s79, s78
    s_waitcnt vmcnt(6)
    buffer_load_dwordx4 v[96:99], v2, s[32:35], s79 offen offset:0 nt
    v_mov_b32_dpp v32, v240 row_newbcast:2 row_mask:0xf bank_mask:0xf
    v_mov_b32_dpp v33, v241 row_newbcast:2 row_mask:0xf bank_mask:0xf
    v_mov_b32_dpp v34, v242 row_newbcast:2 row_mask:0xf bank_mask:0xf
    v_mov_b32_dpp v35, v243 row_newbcast:2 row_mask:0xf bank_mask:0xf
    s_call_b64 s[76:77], L_exp0
    s_waitcnt vmcnt(6)
    buffer_load_dwordx4 v[100:103], v2, s[32:35], s79 offen offset:256 nt
    s_waitcnt vmcnt(6)
    v_mfma_f32_16x16x32_bf16 v[8:11], v[36:39], v[128:131], v[8:11]
    v_and_b32 v36, v34, v4
    v_and_b32 v37, v34, v5
    v_and_b32 v38, v34, v6
    v_and_b32 v39, v34, v7
    v_mfma_f32_16x16x32_bf16 v[8:11], v[40:43], v[132:135], v[8:11]
    v_and_b32 v40, v35, v4
    v_and_b32 v41, v35, v5
    v_and_b32 v42, v35, v6
    v_and_b32 v43, v35, v7
    v_mfma_f32_16x16x32_bf16 v[8:11], v[36:39], v[136:139], v[8:11]
    s_nop 0
    v_mfma_f32_16x16x32_bf16 v[8:11], v[40:43], v[140:143], v[8:11]
    s_waitcnt vmcnt(6)
    buffer_load_dwordx4 v[104:107], v2, s[32:35], s79 offen offset:2048 nt
    s_mov_b32 s91, s63
    s_call_b64 s[76:77], L_pack128_0
    s_waitcnt vmcnt(6)
    buffer_load_dwordx4 v[108:111], v2, s[32:35], s79 offen offset:2304 nt
    s_call_b64 s[76:77], L_pack128_1
    v_accvgpr_write_b32 a66, v128
    v_accvgpr_write_b32 a67, v129
    v_accvgpr_write_b32 a68, v130
    v_accvgpr_write_b32 a69, v131
    v_accvgpr_write_b32 a70, v132
    v_accvgpr_write_b32 a71, v133
    v_accvgpr_write_b32 a72, v134
    v_accvgpr_write_b32 a73, v135
    v_accvgpr_write_b32 a74, v136
    v_accvgpr_write_b32 a75, v137
    v_accvgpr_write_b32 a76, v138
    v_accvgpr_write_b32 a77, v139
    v_accvgpr_write_b32 a78, v32
    s_cmp_lg_u64 vcc, 0
    s_cselect_b32 s92, 2048, 0
    s_or_b32 s82, s82, s92
    s_add_u32 s68, s67, 5898240
    s_xor_b32 s78, s68, s67
    s_and_b32 s78, s78, 0xff800000
    s_xor_b32 s68, s68, s78
    s_waitcnt vmcnt(4)
    buffer_load_dwordx4 v[128:131], v2, s[32:35], s68 offen offset:0 nt
    s_waitcnt vmcnt(4)
    buffer_load_dwordx4 v[132:135], v2, s[32:35], s68 offen offset:256 nt
    v_mov_b32_dpp v32, v240 row_newbcast:4 row_mask:0xf bank_mask:0xf
    v_mov_b32_dpp v33, v241 row_newbcast:4 row_mask:0xf bank_mask:0xf
    v_mov_b32_dpp v34, v242 row_newbcast:4 row_mask:0xf bank_mask:0xf
    v_mov_b32_dpp v35, v243 row_newbcast:4 row_mask:0xf bank_mask:0xf
    s_call_b64 s[76:77], L_exp0
    s_waitcnt vmcnt(4)
    buffer_load_dwordx4 v[136:139], v2, s[32:35], s68 offen offset:2048 nt
    s_waitcnt vmcnt(4)
    buffer_load_dwordx4 v[140:143], v2, s[32:35], s68 offen offset:2304 nt
    s_waitcnt vmcnt(8)
    v_mfma_f32_16x16x32_bf16 v[8:11], v[36:39], v[64:67], v[8:11]
    v_and_b32 v36, v34, v4
    v_and_b32 v37, v34, v5
    v_and_b32 v38, v34, v6
    v_and_b32 v39, v34, v7
    v_mfma_f32_16x16x32_bf16 v[8:11], v[40:43], v[68:71], v[8:11]
    v_and_b32 v40, v35, v4
    v_and_b32 v41, v35, v5
    v_and_b32 v42, v35, v6
    v_and_b32 v43, v35, v7
    v_mfma_f32_16x16x32_bf16 v[8:11], v[36:39], v[72:75], v[8:11]
    s_nop 0
    v_mfma_f32_16x16x32_bf16 v[8:11], v[40:43], v[76:79], v[8:11]
    s_add_u32 s79, s67, 3145728
    s_xor_b32 s78, s79, s67
    s_and_b32 s78, s78, 0xff800000
    s_xor_b32 s79, s79, s78
    s_waitcnt vmcnt(4)
    buffer_load_dwordx4 v[64:67], v2, s[32:35], s79 offen offset:0 nt
    s_waitcnt vmcnt(4)
    buffer_load_dwordx4 v[68:71], v2, s[32:35], s79 offen offset:256 nt
    v_mov_b32_dpp v32, v240 row_newbcast:6 row_mask:0xf bank_mask:0xf
    v_mov_b32_dpp v33, v241 row_newbcast:6 row_mask:0xf bank_mask:0xf
    v_mov_b32_dpp v34, v242 row_newbcast:6 row_mask:0xf bank_mask:0xf
    v_mov_b32_dpp v35, v243 row_newbcast:6 row_mask:0xf bank_mask:0xf
    s_call_b64 s[76:77], L_exp0
    s_waitcnt vmcnt(4)
    buffer_load_dwordx4 v[72:75], v2, s[32:35], s79 offen offset:2048 nt
    s_waitcnt vmcnt(4)
    buffer_load_dwordx4 v[76:79], v2, s[32:35], s79 offen offset:2304 nt
    s_waitcnt vmcnt(8)
    v_mfma_f32_16x16x32_bf16 v[8:11], v[36:39], v[96:99], v[8:11]
    v_and_b32 v36, v34, v4
    v_and_b32 v37, v34, v5
    v_and_b32 v38, v34, v6
    v_and_b32 v39, v34, v7
    v_mfma_f32_16x16x32_bf16 v[8:11], v[40:43], v[100:103], v[8:11]
    v_and_b32 v40, v35, v4
    v_and_b32 v41, v35, v5
    v_and_b32 v42, v35, v6
    v_and_b32 v43, v35, v7
    v_mfma_f32_16x16x32_bf16 v[8:11], v[36:39], v[104:107], v[8:11]
    s_nop 0
    v_mfma_f32_16x16x32_bf16 v[8:11], v[40:43], v[108:111], v[8:11]
    s_add_u32 s68, s67, 6029312
    s_xor_b32 s78, s68, s67
    s_and_b32 s78, s78, 0xff800000
    s_xor_b32 s68, s68, s78
    s_waitcnt vmcnt(6)
    buffer_load_dwordx4 v[96:99], v2, s[32:35], s68 offen offset:0 nt
    v_mov_b32_dpp v32, v240 row_newbcast:8 row_mask:0xf bank_mask:0xf
    v_mov_b32_dpp v33, v241 row_newbcast:8 row_mask:0xf bank_mask:0xf
    v_mov_b32_dpp v34, v242 row_newbcast:8 row_mask:0xf bank_mask:0xf
    v_mov_b32_dpp v35, v243 row_newbcast:8 row_mask:0xf bank_mask:0xf
    s_call_b64 s[76:77], L_exp0
    s_waitcnt vmcnt(6)
    buffer_load_dwordx4 v[100:103], v2, s[32:35], s68 offen offset:256 nt
    s_waitcnt vmcnt(6)
    v_mfma_f32_16x16x32_bf16 v[8:11], v[36:39], v[128:131], v[8:11]
    v_and_b32 v36, v34, v4
    v_and_b32 v37, v34, v5
    v_and_b32 v38, v34, v6
    v_and_b32 v39, v34, v7
    v_mfma_f32_16x16x32_bf16 v[8:11], v[40:43], v[132:135], v[8:11]
    v_and_b32 v40, v35, v4
    v_and_b32 v41, v35, v5
    v_and_b32 v42, v35, v6
    v_and_b32 v43, v35, v7
    v_mfma_f32_16x16x32_bf16 v[8:11], v[36:39], v[136:139], v[8:11]
    s_nop 0
    v_mfma_f32_16x16x32_bf16 v[8:11], v[40:43], v[140:143], v[8:11]
    s_waitcnt vmcnt(6)
    buffer_load_dwordx4 v[104:107], v2, s[32:35], s68 offen offset:2048 nt
    s_mov_b32 s91, s63
    s_call_b64 s[76:77], L_pack128_0
    s_waitcnt vmcnt(6)
    buffer_load_dwordx4 v[108:111], v2, s[32:35], s68 offen offset:2304 nt
    s_call_b64 s[76:77], L_pack128_1
    v_accvgpr_write_b32 a92, v128
    v_accvgpr_write_b32 a93, v129
    v_accvgpr_write_b32 a94, v130
    v_accvgpr_write_b32 a95, v131
    v_accvgpr_write_b32 a96, v132
    v_accvgpr_write_b32 a97, v133
    v_accvgpr_write_b32 a98, v134
    v_accvgpr_write_b32 a99, v135
    v_accvgpr_write_b32 a100, v136
    v_accvgpr_write_b32 a101, v137
    v_accvgpr_write_b32 a102, v138
    v_accvgpr_write_b32 a103, v139
    v_accvgpr_write_b32 a104, v32
    s_cmp_lg_u64 vcc, 0
    s_cselect_b32 s92, 4096, 0
    s_or_b32 s82, s82, s92
    s_add_u32 s79, s67, 3276800
    s_xor_b32 s78, s79, s67
    s_and_b32 s78, s78, 0xff800000
    s_xor_b32 s79, s79, s78
    s_waitcnt vmcnt(5)
    buffer_load_dwordx4 v[128:131], v2, s[32:35], s79 offen offset:0
    s_waitcnt vmcnt(5)
    buffer_load_dwordx4 v[132:135], v2, s[32:35], s79 offen offset:256
    v_mov_b32_dpp v32, v240 row_newbcast:10 row_mask:0xf bank_mask:0xf
    v_mov_b32_dpp v33, v241 row_newbcast:10 row_mask:0xf bank_mask:0xf
    v_mov_b32_dpp v34, v242 row_newbcast:10 row_mask:0xf bank_mask:0xf
    v_mov_b32_dpp v35, v243 row_newbcast:10 row_mask:0xf bank_mask:0xf
    s_call_b64 s[76:77], L_exp0
    s_waitcnt vmcnt(5)
    buffer_load_dwordx4 v[136:139], v2, s[32:35], s79 offen offset:2048
    s_waitcnt vmcnt(5)
    buffer_load_dwordx4 v[140:143], v2, s[32:35], s79 offen offset:2304
    s_waitcnt vmcnt(8)
    v_mfma_f32_16x16x32_bf16 v[8:11], v[36:39], v[64:67], v[8:11]
    v_and_b32 v36, v34, v4
    v_and_b32 v37, v34, v5
    v_and_b32 v38, v34, v6
    v_and_b32 v39, v34, v7
    v_mfma_f32_16x16x32_bf16 v[8:11], v[40:43], v[68:71], v[8:11]
    v_and_b32 v40, v35, v4
    v_and_b32 v41, v35, v5
    v_and_b32 v42, v35, v6
    v_and_b32 v43, v35, v7
    v_mfma_f32_16x16x32_bf16 v[8:11], v[36:39], v[72:75], v[8:11]
    s_nop 0
    v_mfma_f32_16x16x32_bf16 v[8:11], v[40:43], v[76:79], v[8:11]
    v_mov_b32 v45, 416
    v_and_b32 v44, 63, v0
    v_lshlrev_b32 v44, 2, v44
    s_mov_b64 exec, 1
    buffer_store_dword v45, v44, s[36:39], s1 offen
    s_mov_b64 exec, -1
    buffer_load_dword v14, v44, s[36:39], s0 offen sc1
    s_add_u32 s68, s67, 3538944
    s_xor_b32 s78, s68, s67
    s_and_b32 s78, s78, 0xff800000
    s_xor_b32 s68, s68, s78
    s_cmp_eq_u32 s100, 0
    s_cbranch_scc1 L_bv_9
    s_cmp_eq_u32 s100, 2
    s_cbranch_scc1 L_bv_11
    s_waitcnt vmcnt(6)
    buffer_load_dwordx4 v[64:67], v2, s[32:35], s68 offen offset:0 nt
    s_branch L_be_8
L_bv_9:
    s_waitcnt vmcnt(5)
    buffer_load_dwordx4 v[64:67], v2, s[32:35], s68 offen offset:0 nt
    s_branch L_be_8
L_bv_11:
    s_waitcnt vmcnt(9)
    buffer_load_dwordx4 v[64:67], v2, s[32:35], s68 offen offset:0 nt
L_be_8:
    v_mov_b32_dpp v32, v240 row_newbcast:12 row_mask:0xf bank_mask:0xf
    v_mov_b32_dpp v33, v241 row_newbcast:12 row_mask:0xf bank_mask:0xf
    v_mov_b32_dpp v34, v242 row_newbcast:12 row_mask:0xf bank_mask:0xf
    v_mov_b32_dpp v35, v243 row_newbcast:12 row_mask:0xf bank_mask:0xf
    s_call_b64 s[76:77], L_exp0
    s_cmp_eq_u32 s100, 0
    s_cbranch_scc1 L_bv_13
    s_cmp_eq_u32 s100, 2
    s_cbranch_scc1 L_bv_15
    s_waitcnt vmcnt(6)
    buffer_load_dwordx4 v[68:71], v2, s[32:35], s68 offen offset:256 nt
    s_branch L_be_12
L_bv_13:
    s_waitcnt vmcnt(5)
    buffer_load_dwordx4 v[68:71], v2, s[32:35], s68 offen offset:256 nt
    s_branch L_be_12
L_bv_15:
    s_waitcnt vmcnt(9)
    buffer_load_dwordx4 v[68:71], v2, s[32:35], s68 offen offset:256 nt
L_be_12:
    s_waitcnt vmcnt(8)
    v_mfma_f32_16x16x32_bf16 v[8:11], v[36:39], v[96:99], v[8:11]
    v_and_b32 v36, v34, v4
    v_and_b32 v37, v34, v5
    v_and_b32 v38, v34, v6
    v_and_b32 v39, v34, v7
    v_mfma_f32_16x16x32_bf16 v[8:11], v[40:43], v[100:103], v[8:11]
    v_and_b32 v40, v35, v4
    v_and_b32 v41, v35, v5
    v_and_b32 v42, v35, v6
    v_and_b32 v43, v35, v7
    v_mfma_f32_16x16x32_bf16 v[8:11], v[36:39], v[104:107], v[8:11]
    s_nop 0
    v_mfma_f32_16x16x32_bf16 v[8:11], v[40:43], v[108:111], v[8:11]
    s_cmp_eq_u32 s100, 0
    s_cbranch_scc1 L_bv_17
    s_cmp_eq_u32 s100, 2
    s_cbranch_scc1 L_bv_19
    s_waitcnt vmcnt(6)
    buffer_load_dwordx4 v[72:75], v2, s[32:35], s68 offen offset:2048 nt
    s_branch L_be_16
L_bv_17:
    s_waitcnt vmcnt(5)
    buffer_load_dwordx4 v[72:75], v2, s[32:35], s68 offen offset:2048 nt
    s_branch L_be_16
L_bv_19:
    s_waitcnt vmcnt(9)
    buffer_load_dwordx4 v[72:75], v2, s[32:35], s68 offen offset:2048 nt
L_be_16:
    s_mov_b32 s91, s63
    s_call_b64 s[76:77], L_pack96_0
    s_cmp_eq_u32 s100, 0
    s_cbranch_scc1 L_bv_21
    s_cmp_eq_u32 s100, 2
    s_cbranch_scc1 L_bv_23
    s_waitcnt vmcnt(6)
    buffer_load_dwordx4 v[76:79], v2, s[32:35], s68 offen offset:2304 nt
    s_branch L_be_20
L_bv_21:
    s_waitcnt vmcnt(5)
    buffer_load_dwordx4 v[76:79], v2, s[32:35], s68 offen offset:2304 nt
    s_branch L_be_20
L_bv_23:
    s_waitcnt vmcnt(9)
    buffer_load_dwordx4 v[76:79], v2, s[32:35], s68 offen offset:2304 nt
L_be_20:
    s_call_b64 s[76:77], L_pack96_1
    v_accvgpr_write_b32 a118, v96
    v_accvgpr_write_b32 a119, v97
    v_accvgpr_write_b32 a120, v98
    v_accvgpr_write_b32 a121, v99
    v_accvgpr_write_b32 a122, v100
    v_accvgpr_write_b32 a123, v101
    v_accvgpr_write_b32 a124, v102
    v_accvgpr_write_b32 a125, v103
    v_accvgpr_write_b32 a126, v104
    v_accvgpr_write_b32 a127, v105
    v_accvgpr_write_b32 a128, v106
    v_accvgpr_write_b32 a129, v107
    v_accvgpr_write_b32 a130, v32
    s_cmp_lg_u64 vcc, 0
    s_cselect_b32 s92, 8192, 0
    s_or_b32 s82, s82, s92
    s_add_u32 s79, s67, 6291456
    s_xor_b32 s78, s79, s67
    s_and_b32 s78, s78, 0xff800000
    s_xor_b32 s79, s79, s78
    s_cmp_eq_u32 s100, 0
    s_cbranch_scc1 L_bv_25
    s_cmp_eq_u32 s100, 2
    s_cbranch_scc1 L_bv_27
    s_waitcnt vmcnt(6)
    buffer_load_dwordx4 v[96:99], v2, s[32:35], s79 offen offset:0 nt
    s_waitcnt vmcnt(4)
    buffer_load_dwordx4 v[100:103], v2, s[32:35], s79 offen offset:256 nt
    s_branch L_be_24
L_bv_25:
    s_waitcnt vmcnt(3)
    buffer_load_dwordx4 v[96:99], v2, s[32:35], s79 offen offset:0 nt
    s_waitcnt vmcnt(3)
    buffer_load_dwordx4 v[100:103], v2, s[32:35], s79 offen offset:256 nt
    s_branch L_be_24
L_bv_27:
    s_waitcnt vmcnt(9)
    buffer_load_dwordx4 v[96:99], v2, s[32:35], s79 offen offset:0 nt
    s_waitcnt vmcnt(9)
    buffer_load_dwordx4 v[100:103], v2, s[32:35], s79 offen offset:256 nt
L_be_24:
    v_mov_b32_dpp v32, v240 row_newbcast:14 row_mask:0xf bank_mask:0xf
    v_mov_b32_dpp v33, v241 row_newbcast:14 row_mask:0xf bank_mask:0xf
    v_mov_b32_dpp v34, v242 row_newbcast:14 row_mask:0xf bank_mask:0xf
    v_mov_b32_dpp v35, v243 row_newbcast:14 row_mask:0xf bank_mask:0xf
    s_call_b64 s[76:77], L_exp0
    s_cmp_eq_u32 s100, 0
    s_cbranch_scc1 L_bv_29
    s_cmp_eq_u32 s100, 2
    s_cbranch_scc1 L_bv_31
    s_waitcnt vmcnt(4)
    buffer_load_dwordx4 v[104:107], v2, s[32:35], s79 offen offset:2048 nt
    s_waitcnt vmcnt(4)
    buffer_load_dwordx4 v[108:111], v2, s[32:35], s79 offen offset:2304 nt
    s_branch L_be_28
L_bv_29:
    s_waitcnt vmcnt(3)
    buffer_load_dwordx4 v[104:107], v2, s[32:35], s79 offen offset:2048 nt
    s_waitcnt vmcnt(3)
    buffer_load_dwordx4 v[108:111], v2, s[32:35], s79 offen offset:2304 nt
    s_branch L_be_28
L_bv_31:
    s_waitcnt vmcnt(9)
    buffer_load_dwordx4 v[104:107], v2, s[32:35], s79 offen offset:2048 nt
    s_waitcnt vmcnt(9)
    buffer_load_dwordx4 v[108:111], v2, s[32:35], s79 offen offset:2304 nt
L_be_28:
    s_waitcnt vmcnt(10)
    v_mfma_f32_16x16x32_bf16 v[8:11], v[36:39], v[128:131], v[8:11]
    v_and_b32 v36, v34, v4
    v_and_b32 v37, v34, v5
    v_and_b32 v38, v34, v6
    v_and_b32 v39, v34, v7
    v_mfma_f32_16x16x32_bf16 v[8:11], v[40:43], v[132:135], v[8:11]
    v_and_b32 v40, v35, v4
    v_and_b32 v41, v35, v5
    v_and_b32 v42, v35, v6
    v_and_b32 v43, v35, v7
    v_mfma_f32_16x16x32_bf16 v[8:11], v[36:39], v[136:139], v[8:11]
    s_nop 0
    v_mfma_f32_16x16x32_bf16 v[8:11], v[40:43], v[140:143], v[8:11]
    s_waitcnt vmcnt(8)
    s_movk_i32 s101, 412
    v_mov_b32 v47, v14
    s_call_b64 s[76:77], L_pace1
    v_mov_b32 v45, 424
    v_and_b32 v44, 63, v0
    v_lshlrev_b32 v44, 2, v44
    s_mov_b64 exec, 1
    buffer_store_dword v45, v44, s[36:39], s1 offen
    s_mov_b64 exec, -1
    buffer_load_dword v14, v44, s[36:39], s0 offen sc1
    s_add_u32 s68, s67, 3932160
    s_xor_b32 s78, s68, s67
    s_and_b32 s78, s78, 0xff800000
    s_xor_b32 s68, s68, s78
    s_cmp_eq_u32 s100, 0
    s_cbranch_scc1 L_bv_33
    s_cmp_eq_u32 s100, 2
    s_cbranch_scc1 L_bv_35
    s_waitcnt vmcnt(7)
    buffer_load_dwordx4 v[128:131], v2, s[32:35], s68 offen offset:0
    s_waitcnt vmcnt(7)
    buffer_load_dwordx4 v[132:135], v2, s[32:35], s68 offen offset:256
    s_branch L_be_32
L_bv_33:
    s_waitcnt vmcnt(6)
    buffer_load_dwordx4 v[128:131], v2, s[32:35], s68 offen offset:0
    s_waitcnt vmcnt(6)
    buffer_load_dwordx4 v[132:135], v2, s[32:35], s68 offen offset:256
    s_branch L_be_32
L_bv_35:
    s_waitcnt vmcnt(12)
    buffer_load_dwordx4 v[128:131], v2, s[32:35], s68 offen offset:0
    s_waitcnt vmcnt(10)
    buffer_load_dwordx4 v[132:135], v2, s[32:35], s68 offen offset:256
L_be_32:
    v_mov_b32_dpp v32, v244 row_newbcast:0 row_mask:0xf bank_mask:0xf
    v_mov_b32_dpp v33, v245 row_newbcast:0 row_mask:0xf bank_mask:0xf
    v_mov_b32_dpp v34, v246 row_newbcast:0 row_mask:0xf bank_mask:0xf
    v_mov_b32_dpp v35, v247 row_newbcast:0 row_mask:0xf bank_mask:0xf
    s_call_b64 s[76:77], L_exp0
    s_cmp_eq_u32 s100, 0
    s_cbranch_scc1 L_bv_37
    s_cmp_eq_u32 s100, 2
    s_cbranch_scc1 L_bv_39
    s_waitcnt vmcnt(7)
    buffer_load_dwordx4 v[136:139], v2, s[32:35], s68 offen offset:2048
    s_waitcnt vmcnt(7)
    buffer_load_dwordx4 v[140:143], v2, s[32:35], s68 offen offset:2304
    s_branch L_be_36
L_bv_37:
    s_waitcnt vmcnt(6)
    buffer_load_dwordx4 v[136:139], v2, s[32:35], s68 offen offset:2048
    s_waitcnt vmcnt(6)
    buffer_load_dwordx4 v[140:143], v2, s[32:35], s68 offen offset:2304
    s_branch L_be_36
L_bv_39:
    s_waitcnt vmcnt(10)
    buffer_load_dwordx4 v[136:139], v2, s[32:35], s68 offen offset:2048
    s_waitcnt vmcnt(10)
    buffer_load_dwordx4 v[140:143], v2, s[32:35], s68 offen offset:2304
L_be_36:
    s_waitcnt vmcnt(10)
    v_mfma_f32_16x16x32_bf16 v[8:11], v[36:39], v[64:67], v[8:11]
    v_and_b32 v36, v34, v4
    v_and_b32 v37, v34, v5
    v_and_b32 v38, v34, v6
    v_and_b32 v39, v34, v7
    v_mfma_f32_16x16x32_bf16 v[8:11], v[40:43], v[68:71], v[8:11]
    v_and_b32 v40, v35, v4
    v_and_b32 v41, v35, v5
    v_and_b32 v42, v35, v6
    v_and_b32 v43, v35, v7
    v_mfma_f32_16x16x32_bf16 v[8:11], v[36:39], v[72:75], v[8:11]
    s_nop 0
    v_mfma_f32_16x16x32_bf16 v[8:11], v[40:43], v[76:79], v[8:11]
    s_add_u32 s79, s67, 4325376
    s_xor_b32 s78, s79, s67
    s_and_b32 s78, s78, 0xff800000
    s_xor_b32 s79, s79, s78
    s_cmp_eq_u32 s100, 0
    s_cbranch_scc1 L_bv_41
    s_cmp_eq_u32 s100, 2
    s_cbranch_scc1 L_bv_43
    s_waitcnt vmcnt(6)
    buffer_load_dwordx4 v[64:67], v2, s[32:35], s79 offen offset:0 nt
    s_branch L_be_40
L_bv_41:
    s_waitcnt vmcnt(3)
    buffer_load_dwordx4 v[64:67], v2, s[32:35], s79 offen offset:0 nt
    s_branch L_be_40
L_bv_43:
    s_waitcnt vmcnt(9)
    buffer_load_dwordx4 v[64:67], v2, s[32:35], s79 offen offset:0 nt
L_be_40:
    v_mov_b32_dpp v32, v244 row_newbcast:2 row_mask:0xf bank_mask:0xf
    v_mov_b32_dpp v33, v245 row_newbcast:2 row_mask:0xf bank_mask:0xf
    v_mov_b32_dpp v34, v246 row_newbcast:2 row_mask:0xf bank_mask:0xf
    v_mov_b32_dpp v35, v247 row_newbcast:2 row_mask:0xf bank_mask:0xf
    s_call_b64 s[76:77], L_exp0
    s_cmp_eq_u32 s100, 0
    s_cbranch_scc1 L_bv_45
    s_cmp_eq_u32 s100, 2
    s_cbranch_scc1 L_bv_47
    s_waitcnt vmcnt(4)
    buffer_load_dwordx4 v[68:71], v2, s[32:35], s79 offen offset:256 nt
    s_branch L_be_44
L_bv_45:
    s_waitcnt vmcnt(3)
    buffer_load_dwordx4 v[68:71], v2, s[32:35], s79 offen offset:256 nt
    s_branch L_be_44
L_bv_47:
    s_waitcnt vmcnt(9)
    buffer_load_dwordx4 v[68:71], v2, s[32:35], s79 offen offset:256 nt
L_be_44:
    s_waitcnt vmcnt(8)
    v_mfma_f32_16x16x32_bf16 v[8:11], v[36:39], v[96:99], v[8:11]
    v_and_b32 v36, v34, v4
    v_and_b32 v37, v34, v5
    v_and_b32 v38, v34, v6
    v_and_b32 v39, v34, v7
    v_mfma_f32_16x16x32_bf16 v[8:11], v[40:43], v[100:103], v[8:11]
    v_and_b32 v40, v35, v4
    v_and_b32 v41, v35, v5
    v_and_b32 v42, v35, v6
    v_and_b32 v43, v35, v7
    v_mfma_f32_16x16x32_bf16 v[8:11], v[36:39], v[104:107], v[8:11]
    s_nop 0
    v_mfma_f32_16x16x32_bf16 v[8:11], v[40:43], v[108:111], v[8:11]
    s_cmp_eq_u32 s100, 0
    s_cbranch_scc1 L_bv_49
    s_cmp_eq_u32 s100, 2
    s_cbranch_scc1 L_bv_51
    s_waitcnt vmcnt(4)
    buffer_load_dwordx4 v[72:75], v2, s[32:35], s79 offen offset:2048 nt
    s_branch L_be_48
L_bv_49:
    s_waitcnt vmcnt(3)
    buffer_load_dwordx4 v[72:75], v2, s[32:35], s79 offen offset:2048 nt
    s_branch L_be_48
L_bv_51:
    s_waitcnt vmcnt(9)
    buffer_load_dwordx4 v[72:75], v2, s[32:35], s79 offen offset:2048 nt
L_be_48:
    s_mov_b32 s91, s63
    s_call_b64 s[76:77], L_pack96_0
    s_cmp_eq_u32 s100, 0
    s_cbranch_scc1 L_bv_53
    s_cmp_eq_u32 s100, 2
    s_cbranch_scc1 L_bv_55
    s_waitcnt vmcnt(4)
    buffer_load_dwordx4 v[76:79], v2, s[32:35], s79 offen offset:2304 nt
    s_branch L_be_52
L_bv_53:
    s_waitcnt vmcnt(3)
    buffer_load_dwordx4 v[76:79], v2, s[32:35], s79 offen offset:2304 nt
    s_branch L_be_52
L_bv_55:
    s_waitcnt vmcnt(9)
    buffer_load_dwordx4 v[76:79], v2, s[32:35], s79 offen offset:2304 nt
L_be_52:
    s_call_b64 s[76:77], L_pack96_1
    v_accvgpr_write_b32 a144, v96
    v_accvgpr_write_b32 a145, v97
    v_accvgpr_write_b32 a146, v98
    v_accvgpr_write_b32 a147, v99
    v_accvgpr_write_b32 a148, v100
    v_accvgpr_write_b32 a149, v101
    v_accvgpr_write_b32 a150, v102
    v_accvgpr_write_b32 a151, v103
    v_accvgpr_write_b32 a152, v104
    v_accvgpr_write_b32 a153, v105
    v_accvgpr_write_b32 a154, v106
    v_accvgpr_write_b32 a155, v107
    v_accvgpr_write_b32 a156, v32
    s_cmp_lg_u64 vcc, 0
    s_cselect_b32 s92, 16384, 0
    s_or_b32 s82, s82, s92
    s_waitcnt vmcnt(8)
    s_movk_i32 s101, 420
    v_mov_b32 v47, v14
    s_call_b64 s[76:77], L_pace1
    v_mov_b32 v45, 432
    v_and_b32 v44, 63, v0
    v_lshlrev_b32 v44, 2, v44
    s_mov_b64 exec, 1
    buffer_store_dword v45, v44, s[36:39], s1 offen
    s_mov_b64 exec, -1
    buffer_load_dword v14, v44, s[36:39], s0 offen sc1
    s_add_u32 s68, s67, 6553600
    s_xor_b32 s78, s68, s67
    s_and_b32 s78, s78, 0xff800000
    s_xor_b32 s68, s68, s78
    s_cmp_eq_u32 s100, 0
    s_cbranch_scc1 L_bv_57
    s_cmp_eq_u32 s100, 2
    s_cbranch_scc1 L_bv_59
    s_waitcnt vmcnt(6)
    buffer_load_dwordx4 v[96:99], v2, s[32:35], s68 offen offset:0 nt
    s_waitcnt vmcnt(6)
    buffer_load_dwordx4 v[100:103], v2, s[32:35], s68 offen offset:256 nt
    s_branch L_be_56
L_bv_57:
    s_waitcnt vmcnt(5)
    buffer_load_dwordx4 v[96:99], v2, s[32:35], s68 offen offset:0 nt
    s_waitcnt vmcnt(5)
    buffer_load_dwordx4 v[100:103], v2, s[32:35], s68 offen offset:256 nt
    s_branch L_be_56
L_bv_59:
    s_waitcnt vmcnt(9)
    buffer_load_dwordx4 v[96:99], v2, s[32:35], s68 offen offset:0 nt
    s_waitcnt vmcnt(9)
    buffer_load_dwordx4 v[100:103], v2, s[32:35], s68 offen offset:256 nt
L_be_56:
    v_mov_b32_dpp v32, v244 row_newbcast:4 row_mask:0xf bank_mask:0xf
    v_mov_b32_dpp v33, v245 row_newbcast:4 row_mask:0xf bank_mask:0xf
    v_mov_b32_dpp v34, v246 row_newbcast:4 row_mask:0xf bank_mask:0xf
    v_mov_b32_dpp v35, v247 row_newbcast:4 row_mask:0xf bank_mask:0xf
    s_call_b64 s[76:77], L_exp0
    s_cmp_eq_u32 s100, 0
    s_cbranch_scc1 L_bv_61
    s_cmp_eq_u32 s100, 2
    s_cbranch_scc1 L_bv_63
    s_waitcnt vmcnt(6)
    buffer_load_dwordx4 v[104:107], v2, s[32:35], s68 offen offset:2048 nt
    s_waitcnt vmcnt(6)
    buffer_load_dwordx4 v[108:111], v2, s[32:35], s68 offen offset:2304 nt
    s_branch L_be_60
L_bv_61:
    s_waitcnt vmcnt(5)
    buffer_load_dwordx4 v[104:107], v2, s[32:35], s68 offen offset:2048 nt
    s_waitcnt vmcnt(5)
    buffer_load_dwordx4 v[108:111], v2, s[32:35], s68 offen offset:2304 nt
    s_branch L_be_60
L_bv_63:
    s_waitcnt vmcnt(9)
    buffer_load_dwordx4 v[104:107], v2, s[32:35], s68 offen offset:2048 nt
    s_waitcnt vmcnt(9)
    buffer_load_dwordx4 v[108:111], v2, s[32:35], s68 offen offset:2304 nt
L_be_60:
    s_waitcnt vmcnt(10)
    v_mfma_f32_16x16x32_bf16 v[8:11], v[36:39], v[128:131], v[8:11]
    v_and_b32 v36, v34, v4
    v_and_b32 v37, v34, v5
    v_and_b32 v38, v34, v6
    v_and_b32 v39, v34, v7
    v_mfma_f32_16x16x32_bf16 v[8:11], v[40:43], v[132:135], v[8:11]
    v_and_b32 v40, v35, v4
    v_and_b32 v41, v35, v5
    v_and_b32 v42, v35, v6
    v_and_b32 v43, v35, v7
    v_mfma_f32_16x16x32_bf16 v[8:11], v[36:39], v[136:139], v[8:11]
    s_nop 0
    v_mfma_f32_16x16x32_bf16 v[8:11], v[40:43], v[140:143], v[8:11]
    s_add_u32 s79, s67, 4587520
    s_xor_b32 s78, s79, s67
    s_and_b32 s78, s78, 0xff800000
    s_xor_b32 s79, s79, s78
    s_cmp_eq_u32 s100, 0
    s_cbranch_scc1 L_bv_65
    s_cmp_eq_u32 s100, 2
    s_cbranch_scc1 L_bv_67
    s_waitcnt vmcnt(7)
    buffer_load_dwordx4 v[128:131], v2, s[32:35], s79 offen offset:0
    s_waitcnt vmcnt(7)
    buffer_load_dwordx4 v[132:135], v2, s[32:35], s79 offen offset:256
    s_branch L_be_64
L_bv_65:
    s_waitcnt vmcnt(6)
    buffer_load_dwordx4 v[128:131], v2, s[32:35], s79 offen offset:0
    s_waitcnt vmcnt(4)
    buffer_load_dwordx4 v[132:135], v2, s[32:35], s79 offen offset:256
    s_branch L_be_64
L_bv_67:
    s_waitcnt vmcnt(10)
    buffer_load_dwordx4 v[128:131], v2, s[32:35], s79 offen offset:0
    s_waitcnt vmcnt(10)
    buffer_load_dwordx4 v[132:135], v2, s[32:35], s79 offen offset:256
L_be_64:
    v_mov_b32_dpp v32, v244 row_newbcast:6 row_mask:0xf bank_mask:0xf
    v_mov_b32_dpp v33, v245 row_newbcast:6 row_mask:0xf bank_mask:0xf
    v_mov_b32_dpp v34, v246 row_newbcast:6 row_mask:0xf bank_mask:0xf
    v_mov_b32_dpp v35, v247 row_newbcast:6 row_mask:0xf bank_mask:0xf
    s_call_b64 s[76:77], L_exp0
    s_cmp_eq_u32 s100, 0
    s_cbranch_scc1 L_bv_69
    s_cmp_eq_u32 s100, 2
    s_cbranch_scc1 L_bv_71
    s_waitcnt vmcnt(5)
    buffer_load_dwordx4 v[136:139], v2, s[32:35], s79 offen offset:2048
    s_waitcnt vmcnt(5)
    buffer_load_dwordx4 v[140:143], v2, s[32:35], s79 offen offset:2304
    s_branch L_be_68
L_bv_69:
    s_waitcnt vmcnt(4)
    buffer_load_dwordx4 v[136:139], v2, s[32:35], s79 offen offset:2048
    s_waitcnt vmcnt(4)
    buffer_load_dwordx4 v[140:143], v2, s[32:35], s79 offen offset:2304
    s_branch L_be_68
L_bv_71:
    s_waitcnt vmcnt(10)
    buffer_load_dwordx4 v[136:139], v2, s[32:35], s79 offen offset:2048
    s_waitcnt vmcnt(10)
    buffer_load_dwordx4 v[140:143], v2, s[32:35], s79 offen offset:2304
L_be_68:
    s_waitcnt vmcnt(10)
    v_mfma_f32_16x16x32_bf16 v[8:11], v[36:39], v[64:67], v[8:11]
    v_and_b32 v36, v34, v4
    v_and_b32 v37, v34, v5
    v_and_b32 v38, v34, v6
    v_and_b32 v39, v34, v7
    v_mfma_f32_16x16x32_bf16 v[8:11], v[40:43], v[68:71], v[8:11]
    v_and_b32 v40, v35, v4
    v_and_b32 v41, v35, v5
    v_and_b32 v42, v35, v6
    v_and_b32 v43, v35, v7
    v_mfma_f32_16x16x32_bf16 v[8:11], v[36:39], v[72:75], v[8:11]
    s_nop 0
    v_mfma_f32_16x16x32_bf16 v[8:11], v[40:43], v[76:79], v[8:11]
    s_waitcnt vmcnt(8)
    s_movk_i32 s101, 428
    v_mov_b32 v47, v14
    s_call_b64 s[76:77], L_pace1
    v_mov_b32 v45, 440
    v_and_b32 v44, 63, v0
    v_lshlrev_b32 v44, 2, v44
    s_mov_b64 exec, 1
    buffer_store_dword v45, v44, s[36:39], s1 offen
    s_mov_b64 exec, -1
    buffer_load_dword v14, v44, s[36:39], s0 offen sc1
    s_add_u32 s68, s67, 4980736
    s_xor_b32 s78, s68, s67
    s_and_b32 s78, s78, 0xff800000
    s_xor_b32 s68, s68, s78
    s_cmp_eq_u32 s100, 0
    s_cbranch_scc1 L_bv_73
    s_cmp_eq_u32 s100, 2
    s_cbranch_scc1 L_bv_75
    s_waitcnt vmcnt(6)
    buffer_load_dwordx4 v[64:67], v2, s[32:35], s68 offen offset:0 nt
    s_branch L_be_72
L_bv_73:
    s_waitcnt vmcnt(5)
    buffer_load_dwordx4 v[64:67], v2, s[32:35], s68 offen offset:0 nt
    s_branch L_be_72
L_bv_75:
    s_waitcnt vmcnt(9)
    buffer_load_dwordx4 v[64:67], v2, s[32:35], s68 offen offset:0 nt
L_be_72:
    v_mov_b32_dpp v32, v244 row_newbcast:8 row_mask:0xf bank_mask:0xf
    v_mov_b32_dpp v33, v245 row_newbcast:8 row_mask:0xf bank_mask:0xf
    v_mov_b32_dpp v34, v246 row_newbcast:8 row_mask:0xf bank_mask:0xf
    v_mov_b32_dpp v35, v247 row_newbcast:8 row_mask:0xf bank_mask:0xf
    s_call_b64 s[76:77], L_exp0
    s_cmp_eq_u32 s100, 0
    s_cbranch_scc1 L_bv_77
    s_cmp_eq_u32 s100, 2
    s_cbranch_scc1 L_bv_79
    s_waitcnt vmcnt(6)
    buffer_load_dwordx4 v[68:71], v2, s[32:35], s68 offen offset:256 nt
    s_branch L_be_76
L_bv_77:
    s_waitcnt vmcnt(5)
    buffer_load_dwordx4 v[68:71], v2, s[32:35], s68 offen offset:256 nt
    s_branch L_be_76
L_bv_79:
    s_waitcnt vmcnt(9)
    buffer_load_dwordx4 v[68:71], v2, s[32:35], s68 offen offset:256 nt
L_be_76:
    s_waitcnt vmcnt(8)
    v_mfma_f32_16x16x32_bf16 v[8:11], v[36:39], v[96:99], v[8:11]
    v_and_b32 v36, v34, v4
    v_and_b32 v37, v34, v5
    v_and_b32 v38, v34, v6
    v_and_b32 v39, v34, v7
    v_mfma_f32_16x16x32_bf16 v[8:11], v[40:43], v[100:103], v[8:11]
    v_and_b32 v40, v35, v4
    v_and_b32 v41, v35, v5
    v_and_b32 v42, v35, v6
    v_and_b32 v43, v35, v7
    v_mfma_f32_16x16x32_bf16 v[8:11], v[36:39], v[104:107], v[8:11]
    s_nop 0
    v_mfma_f32_16x16x32_bf16 v[8:11], v[40:43], v[108:111], v[8:11]
    s_cmp_eq_u32 s100, 0
    s_cbranch_scc1 L_bv_81
    s_cmp_eq_u32 s100, 2
    s_cbranch_scc1 L_bv_83
    s_waitcnt vmcnt(6)
    buffer_load_dwordx4 v[72:75], v2, s[32:35], s68 offen offset:2048 nt
    s_branch L_be_80
L_bv_81:
    s_waitcnt vmcnt(5)
    buffer_load_dwordx4 v[72:75], v2, s[32:35], s68 offen offset:2048 nt
    s_branch L_be_80
L_bv_83:
    s_waitcnt vmcnt(9)
    buffer_load_dwordx4 v[72:75], v2, s[32:35], s68 offen offset:2048 nt
L_be_80:
    s_mov_b32 s91, s63
    s_call_b64 s[76:77], L_pack96_0
    s_cmp_eq_u32 s100, 0
    s_cbranch_scc1 L_bv_85
    s_cmp_eq_u32 s100, 2
    s_cbranch_scc1 L_bv_87
    s_waitcnt vmcnt(6)
    buffer_load_dwordx4 v[76:79], v2, s[32:35], s68 offen offset:2304 nt
    s_branch L_be_84
L_bv_85:
    s_waitcnt vmcnt(5)
    buffer_load_dwordx4 v[76:79], v2, s[32:35], s68 offen offset:2304 nt
    s_branch L_be_84
L_bv_87:
    s_waitcnt vmcnt(9)
    buffer_load_dwordx4 v[76:79], v2, s[32:35], s68 offen offset:2304 nt
L_be_84:
    s_call_b64 s[76:77], L_pack96_1
    v_accvgpr_write_b32 a170, v96
    v_accvgpr_write_b32 a171, v97
    v_accvgpr_write_b32 a172, v98
    v_accvgpr_write_b32 a173, v99
    v_accvgpr_write_b32 a174, v100
    v_accvgpr_write_b32 a175, v101
    v_accvgpr_write_b32 a176, v102
    v_accvgpr_write_b32 a177, v103
    v_accvgpr_write_b32 a178, v104
    v_accvgpr_write_b32 a179, v105
    v_accvgpr_write_b32 a180, v106
    v_accvgpr_write_b32 a181, v107
    v_accvgpr_write_b32 a182, v32
    s_cmp_lg_u64 vcc, 0
    s_cselect_b32 s92, 32768, 0
    s_or_b32 s82, s82, s92
    s_add_u32 s79, s67, 6684672
    s_xor_b32 s78, s79, s67
    s_and_b32 s78, s78, 0xff800000
    s_xor_b32 s79, s79, s78
    s_cmp_eq_u32 s100, 0
    s_cbranch_scc1 L_bv_89
    s_cmp_eq_u32 s100, 2
    s_cbranch_scc1 L_bv_91
    s_waitcnt vmcnt(6)
    buffer_load_dwordx4 v[96:99], v2, s[32:35], s79 offen offset:0 nt
    s_waitcnt vmcnt(4)
    buffer_load_dwordx4 v[100:103], v2, s[32:35], s79 offen offset:256 nt
    s_branch L_be_88
L_bv_89:
    s_waitcnt vmcnt(3)
    buffer_load_dwordx4 v[96:99], v2, s[32:35], s79 offen offset:0 nt
    s_waitcnt vmcnt(3)
    buffer_load_dwordx4 v[100:103], v2, s[32:35], s79 offen offset:256 nt
    s_branch L_be_88
L_bv_91:
    s_waitcnt vmcnt(9)
    buffer_load_dwordx4 v[96:99], v2, s[32:35], s79 offen offset:0 nt
    s_waitcnt vmcnt(9)
    buffer_load_dwordx4 v[100:103], v2, s[32:35], s79 offen offset:256 nt
L_be_88:
    v_mov_b32_dpp v32, v244 row_newbcast:10 row_mask:0xf bank_mask:0xf
    v_mov_b32_dpp v33, v245 row_newbcast:10 row_mask:0xf bank_mask:0xf
    v_mov_b32_dpp v34, v246 row_newbcast:10 row_mask:0xf bank_mask:0xf
    v_mov_b32_dpp v35, v247 row_newbcast:10 row_mask:0xf bank_mask:0xf
    s_call_b64 s[76:77], L_exp0
    s_cmp_eq_u32 s100, 0
    s_cbranch_scc1 L_bv_93
    s_cmp_eq_u32 s100, 2
    s_cbranch_scc1 L_bv_95
    s_waitcnt vmcnt(4)
    buffer_load_dwordx4 v[104:107], v2, s[32:35], s79 offen offset:2048 nt
    s_waitcnt vmcnt(4)
    buffer_load_dwordx4 v[108:111], v2, s[32:35], s79 offen offset:2304 nt
    s_branch L_be_92
L_bv_93:
    s_waitcnt vmcnt(3)
    buffer_load_dwordx4 v[104:107], v2, s[32:35], s79 offen offset:2048 nt
    s_waitcnt vmcnt(3)
    buffer_load_dwordx4 v[108:111], v2, s[32:35], s79 offen offset:2304 nt
    s_branch L_be_92
L_bv_95:
    s_waitcnt vmcnt(9)
    buffer_load_dwordx4 v[104:107], v2, s[32:35], s79 offen offset:2048 nt
    s_waitcnt vmcnt(9)
    buffer_load_dwordx4 v[108:111], v2, s[32:35], s79 offen offset:2304 nt
L_be_92:
    s_waitcnt vmcnt(10)
    v_mfma_f32_16x16x32_bf16 v[8:11], v[36:39], v[128:131], v[8:11]
    v_and_b32 v36, v34, v4
    v_and_b32 v37, v34, v5
    v_and_b32 v38, v34, v6
    v_and_b32 v39, v34, v7
    v_mfma_f32_16x16x32_bf16 v[8:11], v[40:43], v[132:135], v[8:11]
    v_and_b32 v40, v35, v4
    v_and_b32 v41, v35, v5
    v_and_b32 v42, v35, v6
    v_and_b32 v43, v35, v7
    v_mfma_f32_16x16x32_bf16 v[8:11], v[36:39], v[136:139], v[8:11]
    s_nop 0
    v_mfma_f32_16x16x32_bf16 v[8:11], v[40:43], v[140:143], v[8:11]
    s_waitcnt vmcnt(8)
    s_movk_i32 s101, 436
    v_mov_b32 v47, v14
    s_call_b64 s[76:77], L_pace1
    v_mov_b32 v45, 448
    v_and_b32 v44, 63, v0
    v_lshlrev_b32 v44, 2, v44
    s_mov_b64 exec, 1
    buffer_store_dword v45, v44, s[36:39], s1 offen
    s_mov_b64 exec, -1
    buffer_load_dword v14, v44, s[36:39], s0 offen sc1
    s_add_u32 s68, s67, 5373952
    s_xor_b32 s78, s68, s67
    s_and_b32 s78, s78, 0xff800000
    s_xor_b32 s68, s68, s78
    s_cmp_eq_u32 s100, 0
    s_cbranch_scc1 L_bv_97
    s_cmp_eq_u32 s100, 2
    s_cbranch_scc1 L_bv_99
    s_waitcnt vmcnt(7)
    buffer_load_dwordx4 v[128:131], v2, s[32:35], s68 offen offset:0
    s_waitcnt vmcnt(7)
    buffer_load_dwordx4 v[132:135], v2, s[32:35], s68 offen offset:256
    s_branch L_be_96
L_bv_97:
    s_waitcnt vmcnt(6)
    buffer_load_dwordx4 v[128:131], v2, s[32:35], s68 offen offset:0
    s_waitcnt vmcnt(6)
    buffer_load_dwordx4 v[132:135], v2, s[32:35], s68 offen offset:256
    s_branch L_be_96
L_bv_99:
    s_waitcnt vmcnt(12)
    buffer_load_dwordx4 v[128:131], v2, s[32:35], s68 offen offset:0
    s_waitcnt vmcnt(10)
    buffer_load_dwordx4 v[132:135], v2, s[32:35], s68 offen offset:256
L_be_96:
    v_mov_b32_dpp v32, v244 row_newbcast:12 row_mask:0xf bank_mask:0xf
    v_mov_b32_dpp v33, v245 row_newbcast:12 row_mask:0xf bank_mask:0xf
    v_mov_b32_dpp v34, v246 row_newbcast:12 row_mask:0xf bank_mask:0xf
    v_mov_b32_dpp v35, v247 row_newbcast:12 row_mask:0xf bank_mask:0xf
    s_call_b64 s[76:77], L_exp0
    s_cmp_eq_u32 s100, 0
    s_cbranch_scc1 L_bv_101
    s_cmp_eq_u32 s100, 2
    s_cbranch_scc1 L_bv_103
    s_waitcnt vmcnt(7)
    buffer_load_dwordx4 v[136:139], v2, s[32:35], s68 offen offset:2048
    s_waitcnt vmcnt(7)
    buffer_load_dwordx4 v[140:143], v2, s[32:35], s68 offen offset:2304
    s_branch L_be_100
L_bv_101:
    s_waitcnt vmcnt(6)
    buffer_load_dwordx4 v[136:139], v2, s[32:35], s68 offen offset:2048
    s_waitcnt vmcnt(6)
    buffer_load_dwordx4 v[140:143], v2, s[32:35], s68 offen offset:2304
    s_branch L_be_100
L_bv_103:
    s_waitcnt vmcnt(10)
    buffer_load_dwordx4 v[136:139], v2, s[32:35], s68 offen offset:2048
    s_waitcnt vmcnt(10)
    buffer_load_dwordx4 v[140:143], v2, s[32:35], s68 offen offset:2304
L_be_100:
    s_waitcnt vmcnt(10)
    v_mfma_f32_16x16x32_bf16 v[8:11], v[36:39], v[64:67], v[8:11]
    v_and_b32 v36, v34, v4
    v_and_b32 v37, v34, v5
    v_and_b32 v38, v34, v6
    v_and_b32 v39, v34, v7
    v_mfma_f32_16x16x32_bf16 v[8:11], v[40:43], v[68:71], v[8:11]
    v_and_b32 v40, v35, v4
    v_and_b32 v41, v35, v5
    v_and_b32 v42, v35, v6
    v_and_b32 v43, v35, v7
    v_mfma_f32_16x16x32_bf16 v[8:11], v[36:39], v[72:75], v[8:11]
    s_nop 0
    v_mfma_f32_16x16x32_bf16 v[8:11], v[40:43], v[76:79], v[8:11]
    s_add_u32 s79, s67, 5767168
    s_xor_b32 s78, s79, s67
    s_and_b32 s78, s78, 0xff800000
    s_xor_b32 s79, s79, s78
    s_cmp_eq_u32 s100, 0
    s_cbranch_scc1 L_bv_105
    s_cmp_eq_u32 s100, 2
    s_cbranch_scc1 L_bv_107
    s_waitcnt vmcnt(6)
    buffer_load_dwordx4 v[64:67], v2, s[32:35], s79 offen offset:0 nt
    s_branch L_be_104
L_bv_105:
    s_waitcnt vmcnt(3)
    buffer_load_dwordx4 v[64:67], v2, s[32:35], s79 offen offset:0 nt
    s_branch L_be_104
L_bv_107:
    s_waitcnt vmcnt(9)
    buffer_load_dwordx4 v[64:67], v2, s[32:35], s79 offen offset:0 nt
L_be_104:
    v_mov_b32_dpp v32, v244 row_newbcast:14 row_mask:0xf bank_mask:0xf
    v_mov_b32_dpp v33, v245 row_newbcast:14 row_mask:0xf bank_mask:0xf
    v_mov_b32_dpp v34, v246 row_newbcast:14 row_mask:0xf bank_mask:0xf
    v_mov_b32_dpp v35, v247 row_newbcast:14 row_mask:0xf bank_mask:0xf
    s_call_b64 s[76:77], L_exp0
    s_cmp_eq_u32 s100, 0
    s_cbranch_scc1 L_bv_109
    s_cmp_eq_u32 s100, 2
    s_cbranch_scc1 L_bv_111
    s_waitcnt vmcnt(4)
    buffer_load_dwordx4 v[68:71], v2, s[32:35], s79 offen offset:256 nt
    s_branch L_be_108
L_bv_109:
    s_waitcnt vmcnt(3)
    buffer_load_dwordx4 v[68:71], v2, s[32:35], s79 offen offset:256 nt
    s_branch L_be_108
L_bv_111:
    s_waitcnt vmcnt(9)
    buffer_load_dwordx4 v[68:71], v2, s[32:35], s79 offen offset:256 nt
L_be_108:
    s_waitcnt vmcnt(8)
    v_mfma_f32_16x16x32_bf16 v[8:11], v[36:39], v[96:99], v[8:11]
    v_and_b32 v36, v34, v4
    v_and_b32 v37, v34, v5
    v_and_b32 v38, v34, v6
    v_and_b32 v39, v34, v7
    v_mfma_f32_16x16x32_bf16 v[8:11], v[40:43], v[100:103], v[8:11]
    v_and_b32 v40, v35, v4
    v_and_b32 v41, v35, v5
    v_and_b32 v42, v35, v6
    v_and_b32 v43, v35, v7
    v_mfma_f32_16x16x32_bf16 v[8:11], v[36:39], v[104:107], v[8:11]
    s_nop 0
    v_mfma_f32_16x16x32_bf16 v[8:11], v[40:43], v[108:111], v[8:11]
    s_cmp_eq_u32 s100, 0
    s_cbranch_scc1 L_bv_113
    s_cmp_eq_u32 s100, 2
    s_cbranch_scc1 L_bv_115
    s_waitcnt vmcnt(4)
    buffer_load_dwordx4 v[72:75], v2, s[32:35], s79 offen offset:2048 nt
    s_branch L_be_112
L_bv_113:
    s_waitcnt vmcnt(3)
    buffer_load_dwordx4 v[72:75], v2, s[32:35], s79 offen offset:2048 nt
    s_branch L_be_112
L_bv_115:
    s_waitcnt vmcnt(9)
    buffer_load_dwordx4 v[72:75], v2, s[32:35], s79 offen offset:2048 nt
L_be_112:
    s_mov_b32 s91, s63
    s_call_b64 s[76:77], L_pack96_0
    s_cmp_eq_u32 s100, 0
    s_cbranch_scc1 L_bv_117
    s_cmp_eq_u32 s100, 2
    s_cbranch_scc1 L_bv_119
    s_waitcnt vmcnt(4)
    buffer_load_dwordx4 v[76:79], v2, s[32:35], s79 offen offset:2304 nt
    s_branch L_be_116
L_bv_117:
    s_waitcnt vmcnt(3)
    buffer_load_dwordx4 v[76:79], v2, s[32:35], s79 offen offset:2304 nt
    s_branch L_be_116
L_bv_119:
    s_waitcnt vmcnt(9)
    buffer_load_dwordx4 v[76:79], v2, s[32:35], s79 offen offset:2304 nt
L_be_116:
    s_call_b64 s[76:77], L_pack96_1
    v_accvgpr_write_b32 a196, v96
    v_accvgpr_write_b32 a197, v97
    v_accvgpr_write_b32 a198, v98
    v_accvgpr_write_b32 a199, v99
    v_accvgpr_write_b32 a200, v100
    v_accvgpr_write_b32 a201, v101
    v_accvgpr_write_b32 a202, v102
    v_accvgpr_write_b32 a203, v103
    v_accvgpr_write_b32 a204, v104
    v_accvgpr_write_b32 a205, v105
    v_accvgpr_write_b32 a206, v106
    v_accvgpr_write_b32 a207, v107
    v_accvgpr_write_b32 a208, v32
    s_cmp_lg_u64 vcc, 0
    s_cselect_b32 s92, 65536, 0
    s_or_b32 s82, s82, s92
    s_waitcnt vmcnt(8)
    s_movk_i32 s101, 444
    v_mov_b32 v47, v14
    s_call_b64 s[76:77], L_pace1
    v_mov_b32 v45, 456
    v_and_b32 v44, 63, v0
    v_lshlrev_b32 v44, 2, v44
    s_mov_b64 exec, 1
    buffer_store_dword v45, v44, s[36:39], s1 offen
    s_mov_b64 exec, -1
    buffer_load_dword v14, v44, s[36:39], s0 offen sc1
    s_add_u32 s68, s67, 6946816
    s_xor_b32 s78, s68, s67
    s_and_b32 s78, s78, 0xff800000
    s_xor_b32 s68, s68, s78
    s_cmp_eq_u32 s100, 0
    s_cbranch_scc1 L_bv_121
    s_cmp_eq_u32 s100, 2
    s_cbranch_scc1 L_bv_123
    s_waitcnt vmcnt(6)
    buffer_load_dwordx4 v[96:99], v2, s[32:35], s68 offen offset:0 nt
    s_waitcnt vmcnt(6)
    buffer_load_dwordx4 v[100:103], v2, s[32:35], s68 offen offset:256 nt
    s_branch L_be_120
L_bv_121:
    s_waitcnt vmcnt(5)
    buffer_load_dwordx4 v[96:99], v2, s[32:35], s68 offen offset:0 nt
    s_waitcnt vmcnt(5)
    buffer_load_dwordx4 v[100:103], v2, s[32:35], s68 offen offset:256 nt
    s_branch L_be_120
L_bv_123:
    s_waitcnt vmcnt(9)
    buffer_load_dwordx4 v[96:99], v2, s[32:35], s68 offen offset:0 nt
    s_waitcnt vmcnt(9)
    buffer_load_dwordx4 v[100:103], v2, s[32:35], s68 offen offset:256 nt
L_be_120:
    v_mov_b32_dpp v32, v16 row_newbcast:0 row_mask:0xf bank_mask:0xf
    v_mov_b32_dpp v33, v17 row_newbcast:0 row_mask:0xf bank_mask:0xf
    v_mov_b32_dpp v34, v18 row_newbcast:0 row_mask:0xf bank_mask:0xf
    v_mov_b32_dpp v35, v19 row_newbcast:0 row_mask:0xf bank_mask:0xf
    s_call_b64 s[76:77], L_exp0
    s_cmp_eq_u32 s100, 0
    s_cbranch_scc1 L_bv_125
    s_cmp_eq_u32 s100, 2
    s_cbranch_scc1 L_bv_127
    s_waitcnt vmcnt(6)
    buffer_load_dwordx4 v[104:107], v2, s[32:35], s68 offen offset:2048 nt
    s_waitcnt vmcnt(6)
    buffer_load_dwordx4 v[108:111], v2, s[32:35], s68 offen offset:2304 nt
    s_branch L_be_124
L_bv_125:
    s_waitcnt vmcnt(5)
    buffer_load_dwordx4 v[104:107], v2, s[32:35], s68 offen offset:2048 nt
    s_waitcnt vmcnt(5)
    buffer_load_dwordx4 v[108:111], v2, s[32:35], s68 offen offset:2304 nt
    s_branch L_be_124
L_bv_127:
    s_waitcnt vmcnt(9)
    buffer_load_dwordx4 v[104:107], v2, s[32:35], s68 offen offset:2048 nt
    s_waitcnt vmcnt(9)
    buffer_load_dwordx4 v[108:111], v2, s[32:35], s68 offen offset:2304 nt
L_be_124:
    s_waitcnt vmcnt(10)
    v_mfma_f32_16x16x32_bf16 v[8:11], v[36:39], v[128:131], v[8:11]
    v_and_b32 v36, v34, v4
    v_and_b32 v37, v34, v5
    v_and_b32 v38, v34, v6
    v_and_b32 v39, v34, v7
    v_mfma_f32_16x16x32_bf16 v[8:11], v[40:43], v[132:135], v[8:11]
    v_and_b32 v40, v35, v4
    v_and_b32 v41, v35, v5
    v_and_b32 v42, v35, v6
    v_and_b32 v43, v35, v7
    v_mfma_f32_16x16x32_bf16 v[8:11], v[36:39], v[136:139], v[8:11]
    s_nop 0
    v_mfma_f32_16x16x32_bf16 v[8:11], v[40:43], v[140:143], v[8:11]
    s_add_u32 s79, s67, 6160384
    s_xor_b32 s78, s79, s67
    s_and_b32 s78, s78, 0xff800000
    s_xor_b32 s79, s79, s78
    s_cmp_eq_u32 s100, 0
    s_cbranch_scc1 L_bv_129
    s_cmp_eq_u32 s100, 2
    s_cbranch_scc1 L_bv_131
    s_waitcnt vmcnt(7)
    buffer_load_dwordx4 v[128:131], v2, s[32:35], s79 offen offset:0
    s_waitcnt vmcnt(7)
    buffer_load_dwordx4 v[132:135], v2, s[32:35], s79 offen offset:256
    s_branch L_be_128
L_bv_129:
    s_waitcnt vmcnt(6)
    buffer_load_dwordx4 v[128:131], v2, s[32:35], s79 offen offset:0
    s_waitcnt vmcnt(4)
    buffer_load_dwordx4 v[132:135], v2, s[32:35], s79 offen offset:256
    s_branch L_be_128
L_bv_131:
    s_waitcnt vmcnt(10)
    buffer_load_dwordx4 v[128:131], v2, s[32:35], s79 offen offset:0
    s_waitcnt vmcnt(10)
    buffer_load_dwordx4 v[132:135], v2, s[32:35], s79 offen offset:256
L_be_128:
    v_mov_b32_dpp v32, v16 row_newbcast:2 row_mask:0xf bank_mask:0xf
    v_mov_b32_dpp v33, v17 row_newbcast:2 row_mask:0xf bank_mask:0xf
    v_mov_b32_dpp v34, v18 row_newbcast:2 row_mask:0xf bank_mask:0xf
    v_mov_b32_dpp v35, v19 row_newbcast:2 row_mask:0xf bank_mask:0xf
    s_call_b64 s[76:77], L_exp0
    s_cmp_eq_u32 s100, 0
    s_cbranch_scc1 L_bv_133
    s_cmp_eq_u32 s100, 2
    s_cbranch_scc1 L_bv_135
    s_waitcnt vmcnt(5)
    buffer_load_dwordx4 v[136:139], v2, s[32:35], s79 offen offset:2048
    s_waitcnt vmcnt(5)
    buffer_load_dwordx4 v[140:143], v2, s[32:35], s79 offen offset:2304
    s_branch L_be_132
L_bv_133:
    s_waitcnt vmcnt(4)
    buffer_load_dwordx4 v[136:139], v2, s[32:35], s79 offen offset:2048
    s_waitcnt vmcnt(4)
    buffer_load_dwordx4 v[140:143], v2, s[32:35], s79 offen offset:2304
    s_branch L_be_132
L_bv_135:
    s_waitcnt vmcnt(10)
    buffer_load_dwordx4 v[136:139], v2, s[32:35], s79 offen offset:2048
    s_waitcnt vmcnt(10)
    buffer_load_dwordx4 v[140:143], v2, s[32:35], s79 offen offset:2304
L_be_132:
    s_waitcnt vmcnt(10)
    v_mfma_f32_16x16x32_bf16 v[8:11], v[36:39], v[64:67], v[8:11]
    v_and_b32 v36, v34, v4
    v_and_b32 v37, v34, v5
    v_and_b32 v38, v34, v6
    v_and_b32 v39, v34, v7
    v_mfma_f32_16x16x32_bf16 v[8:11], v[40:43], v[68:71], v[8:11]
    v_and_b32 v40, v35, v4
    v_and_b32 v41, v35, v5
    v_and_b32 v42, v35, v6
    v_and_b32 v43, v35, v7
    v_mfma_f32_16x16x32_bf16 v[8:11], v[36:39], v[72:75], v[8:11]
    s_nop 0
    v_mfma_f32_16x16x32_bf16 v[8:11], v[40:43], v[76:79], v[8:11]
    s_waitcnt vmcnt(8)
    s_movk_i32 s101, 452
    v_mov_b32 v47, v14
    s_call_b64 s[76:77], L_pace1
    v_mov_b32 v45, 464
    v_and_b32 v44, 63, v0
    v_lshlrev_b32 v44, 2, v44
    s_mov_b64 exec, 1
    buffer_store_dword v45, v44, s[36:39], s1 offen
    s_mov_b64 exec, -1
    buffer_load_dword v14, v44, s[36:39], s0 offen sc1
    s_add_u32 s68, s67, 6422528
    s_xor_b32 s78, s68, s67
    s_and_b32 s78, s78, 0xff800000
    s_xor_b32 s68, s68, s78
    s_cmp_eq_u32 s100, 0
    s_cbranch_scc1 L_bv_137
    s_cmp_eq_u32 s100, 2
    s_cbranch_scc1 L_bv_139
    s_waitcnt vmcnt(6)
    buffer_load_dwordx4 v[64:67], v2, s[32:35], s68 offen offset:0 nt
    s_branch L_be_136
L_bv_137:
    s_waitcnt vmcnt(5)
    buffer_load_dwordx4 v[64:67], v2, s[32:35], s68 offen offset:0 nt
    s_branch L_be_136
L_bv_139:
    s_waitcnt vmcnt(9)
    buffer_load_dwordx4 v[64:67], v2, s[32:35], s68 offen offset:0 nt
L_be_136:
    v_mov_b32_dpp v32, v16 row_newbcast:4 row_mask:0xf bank_mask:0xf
    v_mov_b32_dpp v33, v17 row_newbcast:4 row_mask:0xf bank_mask:0xf
    v_mov_b32_dpp v34, v18 row_newbcast:4 row_mask:0xf bank_mask:0xf
    v_mov_b32_dpp v35, v19 row_newbcast:4 row_mask:0xf bank_mask:0xf
    s_call_b64 s[76:77], L_exp0
    s_cmp_eq_u32 s100, 0
    s_cbranch_scc1 L_bv_141
    s_cmp_eq_u32 s100, 2
    s_cbranch_scc1 L_bv_143
    s_waitcnt vmcnt(6)
    buffer_load_dwordx4 v[68:71], v2, s[32:35], s68 offen offset:256 nt
    s_branch L_be_140
L_bv_141:
    s_waitcnt vmcnt(5)
    buffer_load_dwordx4 v[68:71], v2, s[32:35], s68 offen offset:256 nt
    s_branch L_be_140
L_bv_143:
    s_waitcnt vmcnt(9)
    buffer_load_dwordx4 v[68:71], v2, s[32:35], s68 offen offset:256 nt
L_be_140:
    s_waitcnt vmcnt(8)
    v_mfma_f32_16x16x32_bf16 v[8:11], v[36:39], v[96:99], v[8:11]
    v_and_b32 v36, v34, v4
    v_and_b32 v37, v34, v5
    v_and_b32 v38, v34, v6
    v_and_b32 v39, v34, v7
    v_mfma_f32_16x16x32_bf16 v[8:11], v[40:43], v[100:103], v[8:11]
    v_and_b32 v40, v35, v4
    v_and_b32 v41, v35, v5
    v_and_b32 v42, v35, v6
    v_and_b32 v43, v35, v7
    v_mfma_f32_16x16x32_bf16 v[8:11], v[36:39], v[104:107], v[8:11]
    s_nop 0
    v_mfma_f32_16x16x32_bf16 v[8:11], v[40:43], v[108:111], v[8:11]
    s_cmp_eq_u32 s100, 0
    s_cbranch_scc1 L_bv_145
    s_cmp_eq_u32 s100, 2
    s_cbranch_scc1 L_bv_147
    s_waitcnt vmcnt(6)
    buffer_load_dwordx4 v[72:75], v2, s[32:35], s68 offen offset:2048 nt
    s_branch L_be_144
L_bv_145:
    s_waitcnt vmcnt(5)
    buffer_load_dwordx4 v[72:75], v2, s[32:35], s68 offen offset:2048 nt
    s_branch L_be_144
L_bv_147:
    s_waitcnt vmcnt(9)
    buffer_load_dwordx4 v[72:75], v2, s[32:35], s68 offen offset:2048 nt
L_be_144:
    s_mov_b32 s91, s63
    s_call_b64 s[76:77], L_pack96_0
    s_cmp_eq_u32 s100, 0
    s_cbranch_scc1 L_bv_149
    s_cmp_eq_u32 s100, 2
    s_cbranch_scc1 L_bv_151
    s_waitcnt vmcnt(6)
    buffer_load_dwordx4 v[76:79], v2, s[32:35], s68 offen offset:2304 nt
    s_branch L_be_148
L_bv_149:
    s_waitcnt vmcnt(5)
    buffer_load_dwordx4 v[76:79], v2, s[32:35], s68 offen offset:2304 nt
    s_branch L_be_148
L_bv_151:
    s_waitcnt vmcnt(9)
    buffer_load_dwordx4 v[76:79], v2, s[32:35], s68 offen offset:2304 nt
L_be_148:
    s_call_b64 s[76:77], L_pack96_1
    v_mov_b32 v224, v96
    v_mov_b32 v225, v97
    v_mov_b32 v226, v98
    v_mov_b32 v227, v99
    v_mov_b32 v228, v100
    v_mov_b32 v229, v101
    v_mov_b32 v230, v102
    v_mov_b32 v231, v103
    v_mov_b32 v232, v104
    v_mov_b32 v233, v105
    v_mov_b32 v234, v106
    v_mov_b32 v235, v107
    v_mov_b32 v236, v32
    s_cmp_lg_u64 vcc, 0
    s_cselect_b32 s92, 131072, 0
    s_or_b32 s82, s82, s92
    s_add_u32 s79, s67, 7077888
    s_xor_b32 s78, s79, s67
    s_and_b32 s78, s78, 0xff800000
    s_xor_b32 s79, s79, s78
    s_cmp_eq_u32 s100, 0
    s_cbranch_scc1 L_bv_153
    s_cmp_eq_u32 s100, 2
    s_cbranch_scc1 L_bv_155
    s_waitcnt vmcnt(6)
    buffer_load_dwordx4 v[96:99], v2, s[32:35], s79 offen offset:0 nt
    s_waitcnt vmcnt(4)
    buffer_load_dwordx4 v[100:103], v2, s[32:35], s79 offen offset:256 nt
    s_branch L_be_152
L_bv_153:
    s_waitcnt vmcnt(3)
    buffer_load_dwordx4 v[96:99], v2, s[32:35], s79 offen offset:0 nt
    s_waitcnt vmcnt(3)
    buffer_load_dwordx4 v[100:103], v2, s[32:35], s79 offen offset:256 nt
    s_branch L_be_152
L_bv_155:
    s_waitcnt vmcnt(9)
    buffer_load_dwordx4 v[96:99], v2, s[32:35], s79 offen offset:0 nt
    s_waitcnt vmcnt(9)
    buffer_load_dwordx4 v[100:103], v2, s[32:35], s79 offen offset:256 nt
L_be_152:
    v_mov_b32_dpp v32, v16 row_newbcast:6 row_mask:0xf bank_mask:0xf
    v_mov_b32_dpp v33, v17 row_newbcast:6 row_mask:0xf bank_mask:0xf
    v_mov_b32_dpp v34, v18 row_newbcast:6 row_mask:0xf bank_mask:0xf
    v_mov_b32_dpp v35, v19 row_newbcast:6 row_mask:0xf bank_mask:0xf
    s_call_b64 s[76:77], L_exp0
    s_cmp_eq_u32 s100, 0
    s_cbranch_scc1 L_bv_157
    s_cmp_eq_u32 s100, 2
    s_cbranch_scc1 L_bv_159
    s_waitcnt vmcnt(4)
    buffer_load_dwordx4 v[104:107], v2, s[32:35], s79 offen offset:2048 nt
    s_waitcnt vmcnt(4)
    buffer_load_dwordx4 v[108:111], v2, s[32:35], s79 offen offset:2304 nt
    s_branch L_be_156
L_bv_157:
    s_waitcnt vmcnt(3)
    buffer_load_dwordx4 v[104:107], v2, s[32:35], s79 offen offset:2048 nt
    s_waitcnt vmcnt(3)
    buffer_load_dwordx4 v[108:111], v2, s[32:35], s79 offen offset:2304 nt
    s_branch L_be_156
L_bv_159:
    s_waitcnt vmcnt(9)
    buffer_load_dwordx4 v[104:107], v2, s[32:35], s79 offen offset:2048 nt
    s_waitcnt vmcnt(9)
    buffer_load_dwordx4 v[108:111], v2, s[32:35], s79 offen offset:2304 nt
L_be_156:
    s_waitcnt vmcnt(10)
    v_mfma_f32_16x16x32_bf16 v[8:11], v[36:39], v[128:131], v[8:11]
    v_and_b32 v36, v34, v4
    v_and_b32 v37, v34, v5
    v_and_b32 v38, v34, v6
    v_and_b32 v39, v34, v7
    v_mfma_f32_16x16x32_bf16 v[8:11], v[40:43], v[132:135], v[8:11]
    v_and_b32 v40, v35, v4
    v_and_b32 v41, v35, v5
    v_and_b32 v42, v35, v6
    v_and_b32 v43, v35, v7
    v_mfma_f32_16x16x32_bf16 v[8:11], v[36:39], v[136:139], v[8:11]
    s_nop 0
    v_mfma_f32_16x16x32_bf16 v[8:11], v[40:43], v[140:143], v[8:11]
    s_waitcnt vmcnt(8)
    s_movk_i32 s101, 460
    v_mov_b32 v47, v14
    s_call_b64 s[76:77], L_pace1
    v_mov_b32 v45, 472
    v_and_b32 v44, 63, v0
    v_lshlrev_b32 v44, 2, v44
    s_mov_b64 exec, 1
    buffer_store_dword v45, v44, s[36:39], s1 offen
    s_mov_b64 exec, -1
    buffer_load_dword v14, v44, s[36:39], s0 offen sc1
    s_add_u32 s68, s67, 6815744
    s_xor_b32 s78, s68, s67
    s_and_b32 s78, s78, 0xff800000
    s_xor_b32 s68, s68, s78
    s_cmp_eq_u32 s100, 0
    s_cbranch_scc1 L_bv_161
    s_cmp_eq_u32 s100, 2
    s_cbranch_scc1 L_bv_163
    s_waitcnt vmcnt(7)
    buffer_load_dwordx4 v[128:131], v2, s[32:35], s68 offen offset:0
    s_waitcnt vmcnt(7)
    buffer_load_dwordx4 v[132:135], v2, s[32:35], s68 offen offset:256
    s_branch L_be_160
L_bv_161:
    s_waitcnt vmcnt(6)
    buffer_load_dwordx4 v[128:131], v2, s[32:35], s68 offen offset:0
    s_waitcnt vmcnt(6)
    buffer_load_dwordx4 v[132:135], v2, s[32:35], s68 offen offset:256
    s_branch L_be_160
L_bv_163:
    s_waitcnt vmcnt(12)
    buffer_load_dwordx4 v[128:131], v2, s[32:35], s68 offen offset:0
    s_waitcnt vmcnt(10)
    buffer_load_dwordx4 v[132:135], v2, s[32:35], s68 offen offset:256
L_be_160:
    v_mov_b32_dpp v32, v16 row_newbcast:8 row_mask:0xf bank_mask:0xf
    v_mov_b32_dpp v33, v17 row_newbcast:8 row_mask:0xf bank_mask:0xf
    v_mov_b32_dpp v34, v18 row_newbcast:8 row_mask:0xf bank_mask:0xf
    v_mov_b32_dpp v35, v19 row_newbcast:8 row_mask:0xf bank_mask:0xf
    s_call_b64 s[76:77], L_exp0
    s_cmp_eq_u32 s100, 0
    s_cbranch_scc1 L_bv_165
    s_cmp_eq_u32 s100, 2
    s_cbranch_scc1 L_bv_167
    s_waitcnt vmcnt(7)
    buffer_load_dwordx4 v[136:139], v2, s[32:35], s68 offen offset:2048
    s_waitcnt vmcnt(7)
    buffer_load_dwordx4 v[140:143], v2, s[32:35], s68 offen offset:2304
    s_branch L_be_164
L_bv_165:
    s_waitcnt vmcnt(6)
    buffer_load_dwordx4 v[136:139], v2, s[32:35], s68 offen offset:2048
    s_waitcnt vmcnt(6)
    buffer_load_dwordx4 v[140:143], v2, s[32:35], s68 offen offset:2304
    s_branch L_be_164
L_bv_167:
    s_waitcnt vmcnt(10)
    buffer_load_dwordx4 v[136:139], v2, s[32:35], s68 offen offset:2048
    s_waitcnt vmcnt(10)
    buffer_load_dwordx4 v[140:143], v2, s[32:35], s68 offen offset:2304
L_be_164:
    s_waitcnt vmcnt(10)
    v_mfma_f32_16x16x32_bf16 v[8:11], v[36:39], v[64:67], v[8:11]
    v_and_b32 v36, v34, v4
    v_and_b32 v37, v34, v5
    v_and_b32 v38, v34, v6
    v_and_b32 v39, v34, v7
    v_mfma_f32_16x16x32_bf16 v[8:11], v[40:43], v[68:71], v[8:11]
    v_and_b32 v40, v35, v4
    v_and_b32 v41, v35, v5
    v_and_b32 v42, v35, v6
    v_and_b32 v43, v35, v7
    v_mfma_f32_16x16x32_bf16 v[8:11], v[36:39], v[72:75], v[8:11]
    s_nop 0
    v_mfma_f32_16x16x32_bf16 v[8:11], v[40:43], v[76:79], v[8:11]
    s_add_u32 s79, s67, 7208960
    s_xor_b32 s78, s79, s67
    s_and_b32 s78, s78, 0xff800000
    s_xor_b32 s79, s79, s78
    s_cmp_eq_u32 s100, 0
    s_cbranch_scc1 L_bv_169
    s_cmp_eq_u32 s100, 2
    s_cbranch_scc1 L_bv_171
    s_waitcnt vmcnt(6)
    buffer_load_dwordx4 v[64:67], v2, s[32:35], s79 offen offset:0 nt
    s_branch L_be_168
L_bv_169:
    s_waitcnt vmcnt(3)
    buffer_load_dwordx4 v[64:67], v2, s[32:35], s79 offen offset:0 nt
    s_branch L_be_168
L_bv_171:
    s_waitcnt vmcnt(9)
    buffer_load_dwordx4 v[64:67], v2, s[32:35], s79 offen offset:0 nt
L_be_168:
    v_mov_b32_dpp v32, v16 row_newbcast:10 row_mask:0xf bank_mask:0xf
    v_mov_b32_dpp v33, v17 row_newbcast:10 row_mask:0xf bank_mask:0xf
    v_mov_b32_dpp v34, v18 row_newbcast:10 row_mask:0xf bank_mask:0xf
    v_mov_b32_dpp v35, v19 row_newbcast:10 row_mask:0xf bank_mask:0xf
    s_call_b64 s[76:77], L_exp0
    s_cmp_eq_u32 s100, 0
    s_cbranch_scc1 L_bv_173
    s_cmp_eq_u32 s100, 2
    s_cbranch_scc1 L_bv_175
    s_waitcnt vmcnt(4)
    buffer_load_dwordx4 v[68:71], v2, s[32:35], s79 offen offset:256 nt
    s_branch L_be_172
L_bv_173:
    s_waitcnt vmcnt(3)
    buffer_load_dwordx4 v[68:71], v2, s[32:35], s79 offen offset:256 nt
    s_branch L_be_172
L_bv_175:
    s_waitcnt vmcnt(9)
    buffer_load_dwordx4 v[68:71], v2, s[32:35], s79 offen offset:256 nt
L_be_172:
    s_waitcnt vmcnt(8)
    v_mfma_f32_16x16x32_bf16 v[8:11], v[36:39], v[96:99], v[8:11]
    v_and_b32 v36, v34, v4
    v_and_b32 v37, v34, v5
    v_and_b32 v38, v34, v6
    v_and_b32 v39, v34, v7
    v_mfma_f32_16x16x32_bf16 v[8:11], v[40:43], v[100:103], v[8:11]
    v_and_b32 v40, v35, v4
    v_and_b32 v41, v35, v5
    v_and_b32 v42, v35, v6
    v_and_b32 v43, v35, v7
    v_mfma_f32_16x16x32_bf16 v[8:11], v[36:39], v[104:107], v[8:11]
    s_nop 0
    v_mfma_f32_16x16x32_bf16 v[8:11], v[40:43], v[108:111], v[8:11]
    s_cmp_eq_u32 s100, 0
    s_cbranch_scc1 L_bv_177
    s_cmp_eq_u32 s100, 2
    s_cbranch_scc1 L_bv_179
    s_waitcnt vmcnt(4)
    buffer_load_dwordx4 v[72:75], v2, s[32:35], s79 offen offset:2048 nt
    s_branch L_be_176
L_bv_177:
    s_waitcnt vmcnt(3)
    buffer_load_dwordx4 v[72:75], v2, s[32:35], s79 offen offset:2048 nt
    s_branch L_be_176
L_bv_179:
    s_waitcnt vmcnt(9)
    buffer_load_dwordx4 v[72:75], v2, s[32:35], s79 offen offset:2048 nt
L_be_176:
    s_mov_b32 s91, s63
    s_call_b64 s[76:77], L_pack96_0
    s_cmp_eq_u32 s100, 0
    s_cbranch_scc1 L_bv_181
    s_cmp_eq_u32 s100, 2
    s_cbranch_scc1 L_bv_183
    s_waitcnt vmcnt(4)
    buffer_load_dwordx4 v[76:79], v2, s[32:35], s79 offen offset:2304 nt
    s_branch L_be_180
L_bv_181:
    s_waitcnt vmcnt(3)
    buffer_load_dwordx4 v[76:79], v2, s[32:35], s79 offen offset:2304 nt
    s_branch L_be_180
L_bv_183:
    s_waitcnt vmcnt(9)
    buffer_load_dwordx4 v[76:79], v2, s[32:35], s79 offen offset:2304 nt
L_be_180:
    s_call_b64 s[76:77], L_pack96_1
    v_mov_b32 v237, v96
    v_mov_b32 v238, v97
    v_mov_b32 v239, v98
    v_mov_b32 v240, v99
    v_mov_b32 v241, v100
    v_mov_b32 v242, v101
    v_mov_b32 v243, v102
    v_mov_b32 v244, v103
    v_mov_b32 v245, v104
    v_mov_b32 v246, v105
    v_mov_b32 v247, v106
    v_mov_b32 v248, v107
    v_mov_b32 v249, v32
    s_cmp_lg_u64 vcc, 0
    s_cselect_b32 s92, 262144, 0
    s_or_b32 s82, s82, s92
    s_waitcnt vmcnt(8)
    s_movk_i32 s101, 468
    v_mov_b32 v47, v14
    s_call_b64 s[76:77], L_pace1
    v_mov_b32 v45, 480
    v_and_b32 v44, 63, v0
    v_lshlrev_b32 v44, 2, v44
    s_mov_b64 exec, 1
    buffer_store_dword v45, v44, s[36:39], s1 offen
    s_mov_b64 exec, -1
    buffer_load_dword v14, v44, s[36:39], s0 offen sc1
    s_add_u32 s68, s67, 7340032
    s_xor_b32 s78, s68, s67
    s_and_b32 s78, s78, 0xff800000
    s_xor_b32 s68, s68, s78
    s_cmp_eq_u32 s100, 0
    s_cbranch_scc1 L_bv_185
    s_cmp_eq_u32 s100, 2
    s_cbranch_scc1 L_bv_187
    s_waitcnt vmcnt(6)
    buffer_load_dwordx4 v[96:99], v2, s[32:35], s68 offen offset:0 nt
    s_waitcnt vmcnt(6)
    buffer_load_dwordx4 v[100:103], v2, s[32:35], s68 offen offset:256 nt
    s_branch L_be_184
L_bv_185:
    s_waitcnt vmcnt(5)
    buffer_load_dwordx4 v[96:99], v2, s[32:35], s68 offen offset:0 nt
    s_waitcnt vmcnt(5)
    buffer_load_dwordx4 v[100:103], v2, s[32:35], s68 offen offset:256 nt
    s_branch L_be_184
L_bv_187:
    s_waitcnt vmcnt(9)
    buffer_load_dwordx4 v[96:99], v2, s[32:35], s68 offen offset:0 nt
    s_waitcnt vmcnt(9)
    buffer_load_dwordx4 v[100:103], v2, s[32:35], s68 offen offset:256 nt
L_be_184:
    v_mov_b32_dpp v32, v16 row_newbcast:12 row_mask:0xf bank_mask:0xf
    v_mov_b32_dpp v33, v17 row_newbcast:12 row_mask:0xf bank_mask:0xf
    v_mov_b32_dpp v34, v18 row_newbcast:12 row_mask:0xf bank_mask:0xf
    v_mov_b32_dpp v35, v19 row_newbcast:12 row_mask:0xf bank_mask:0xf
    s_call_b64 s[76:77], L_exp0
    s_cmp_eq_u32 s100, 0
    s_cbranch_scc1 L_bv_189
    s_cmp_eq_u32 s100, 2
    s_cbranch_scc1 L_bv_191
    s_waitcnt vmcnt(6)
    buffer_load_dwordx4 v[104:107], v2, s[32:35], s68 offen offset:2048 nt
    s_waitcnt vmcnt(6)
    buffer_load_dwordx4 v[108:111], v2, s[32:35], s68 offen offset:2304 nt
    s_branch L_be_188
L_bv_189:
    s_waitcnt vmcnt(5)
    buffer_load_dwordx4 v[104:107], v2, s[32:35], s68 offen offset:2048 nt
    s_waitcnt vmcnt(5)
    buffer_load_dwordx4 v[108:111], v2, s[32:35], s68 offen offset:2304 nt
    s_branch L_be_188
L_bv_191:
    s_waitcnt vmcnt(9)
    buffer_load_dwordx4 v[104:107], v2, s[32:35], s68 offen offset:2048 nt
    s_waitcnt vmcnt(9)
    buffer_load_dwordx4 v[108:111], v2, s[32:35], s68 offen offset:2304 nt
L_be_188:
    s_waitcnt vmcnt(10)
    v_mfma_f32_16x16x32_bf16 v[8:11], v[36:39], v[128:131], v[8:11]
    v_and_b32 v36, v34, v4
    v_and_b32 v37, v34, v5
    v_and_b32 v38, v34, v6
    v_and_b32 v39, v34, v7
    v_mfma_f32_16x16x32_bf16 v[8:11], v[40:43], v[132:135], v[8:11]
    v_and_b32 v40, v35, v4
    v_and_b32 v41, v35, v5
    v_and_b32 v42, v35, v6
    v_and_b32 v43, v35, v7
    v_mfma_f32_16x16x32_bf16 v[8:11], v[36:39], v[136:139], v[8:11]
    s_nop 0
    v_mfma_f32_16x16x32_bf16 v[8:11], v[40:43], v[140:143], v[8:11]
    s_add_u32 s79, s67, 7471104
    s_xor_b32 s78, s79, s67
    s_and_b32 s78, s78, 0xff800000
    s_xor_b32 s79, s79, s78
    s_cmp_eq_u32 s100, 0
    s_cbranch_scc1 L_bv_193
    s_cmp_eq_u32 s100, 2
    s_cbranch_scc1 L_bv_195
    s_waitcnt vmcnt(7)
    buffer_load_dwordx4 v[128:131], v2, s[32:35], s79 offen offset:0
    s_waitcnt vmcnt(7)
    buffer_load_dwordx4 v[132:135], v2, s[32:35], s79 offen offset:256
    s_branch L_be_192
L_bv_193:
    s_waitcnt vmcnt(6)
    buffer_load_dwordx4 v[128:131], v2, s[32:35], s79 offen offset:0
    s_waitcnt vmcnt(4)
    buffer_load_dwordx4 v[132:135], v2, s[32:35], s79 offen offset:256
    s_branch L_be_192
L_bv_195:
    s_waitcnt vmcnt(10)
    buffer_load_dwordx4 v[128:131], v2, s[32:35], s79 offen offset:0
    s_waitcnt vmcnt(10)
    buffer_load_dwordx4 v[132:135], v2, s[32:35], s79 offen offset:256
L_be_192:
    v_mov_b32_dpp v32, v16 row_newbcast:14 row_mask:0xf bank_mask:0xf
    v_mov_b32_dpp v33, v17 row_newbcast:14 row_mask:0xf bank_mask:0xf
    v_mov_b32_dpp v34, v18 row_newbcast:14 row_mask:0xf bank_mask:0xf
    v_mov_b32_dpp v35, v19 row_newbcast:14 row_mask:0xf bank_mask:0xf
    s_call_b64 s[76:77], L_exp0
    s_cmp_eq_u32 s100, 0
    s_cbranch_scc1 L_bv_197
    s_cmp_eq_u32 s100, 2
    s_cbranch_scc1 L_bv_199
    s_waitcnt vmcnt(5)
    buffer_load_dwordx4 v[136:139], v2, s[32:35], s79 offen offset:2048
    s_waitcnt vmcnt(5)
    buffer_load_dwordx4 v[140:143], v2, s[32:35], s79 offen offset:2304
    s_branch L_be_196
L_bv_197:
    s_waitcnt vmcnt(4)
    buffer_load_dwordx4 v[136:139], v2, s[32:35], s79 offen offset:2048
    s_waitcnt vmcnt(4)
    buffer_load_dwordx4 v[140:143], v2, s[32:35], s79 offen offset:2304
    s_branch L_be_196
L_bv_199:
    s_waitcnt vmcnt(10)
    buffer_load_dwordx4 v[136:139], v2, s[32:35], s79 offen offset:2048
    s_waitcnt vmcnt(10)
    buffer_load_dwordx4 v[140:143], v2, s[32:35], s79 offen offset:2304
L_be_196:
    s_waitcnt vmcnt(10)
    v_mfma_f32_16x16x32_bf16 v[8:11], v[36:39], v[64:67], v[8:11]
    v_and_b32 v36, v34, v4
    v_and_b32 v37, v34, v5
    v_and_b32 v38, v34, v6
    v_and_b32 v39, v34, v7
    v_mfma_f32_16x16x32_bf16 v[8:11], v[40:43], v[68:71], v[8:11]
    v_and_b32 v40, v35, v4
    v_and_b32 v41, v35, v5
    v_and_b32 v42, v35, v6
    v_and_b32 v43, v35, v7
    v_mfma_f32_16x16x32_bf16 v[8:11], v[36:39], v[72:75], v[8:11]
    s_nop 0
    v_mfma_f32_16x16x32_bf16 v[8:11], v[40:43], v[76:79], v[8:11]
    s_waitcnt vmcnt(8)
    s_movk_i32 s101, 476
    v_mov_b32 v47, v14
    s_call_b64 s[76:77], L_pace1
    v_mov_b32 v45, 488
    v_and_b32 v44, 63, v0
    v_lshlrev_b32 v44, 2, v44
    s_mov_b64 exec, 1
    buffer_store_dword v45, v44, s[36:39], s1 offen
    s_mov_b64 exec, -1
    buffer_load_dword v14, v44, s[36:39], s0 offen sc1
    s_add_u32 s68, s67, 7602176
    s_xor_b32 s78, s68, s67
    s_and_b32 s78, s78, 0xff800000
    s_xor_b32 s68, s68, s78
    s_cmp_eq_u32 s100, 0
    s_cbranch_scc1 L_bv_201
    s_cmp_eq_u32 s100, 2
    s_cbranch_scc1 L_bv_203
    s_waitcnt vmcnt(7)
    buffer_load_dwordx4 v[64:67], v2, s[32:35], s68 offen offset:0
    s_branch L_be_200
L_bv_201:
    s_waitcnt vmcnt(6)
    buffer_load_dwordx4 v[64:67], v2, s[32:35], s68 offen offset:0
    s_branch L_be_200
L_bv_203:
    s_waitcnt vmcnt(12)
    buffer_load_dwordx4 v[64:67], v2, s[32:35], s68 offen offset:0
L_be_200:
    v_mov_b32_dpp v32, v20 row_newbcast:0 row_mask:0xf bank_mask:0xf
    v_mov_b32_dpp v33, v21 row_newbcast:0 row_mask:0xf bank_mask:0xf
    v_mov_b32_dpp v34, v22 row_newbcast:0 row_mask:0xf bank_mask:0xf
    v_mov_b32_dpp v35, v23 row_newbcast:0 row_mask:0xf bank_mask:0xf
    s_call_b64 s[76:77], L_exp0
    s_cmp_eq_u32 s100, 0
    s_cbranch_scc1 L_bv_205
    s_cmp_eq_u32 s100, 2
    s_cbranch_scc1 L_bv_207
    s_waitcnt vmcnt(7)
    buffer_load_dwordx4 v[68:71], v2, s[32:35], s68 offen offset:256
    s_branch L_be_204
L_bv_205:
    s_waitcnt vmcnt(6)
    buffer_load_dwordx4 v[68:71], v2, s[32:35], s68 offen offset:256
    s_branch L_be_204
L_bv_207:
    s_waitcnt vmcnt(10)
    buffer_load_dwordx4 v[68:71], v2, s[32:35], s68 offen offset:256
L_be_204:
    s_waitcnt vmcnt(8)
    v_mfma_f32_16x16x32_bf16 v[8:11], v[36:39], v[96:99], v[8:11]
    v_and_b32 v36, v34, v4
    v_and_b32 v37, v34, v5
    v_and_b32 v38, v34, v6
    v_and_b32 v39, v34, v7
    v_mfma_f32_16x16x32_bf16 v[8:11], v[40:43], v[100:103], v[8:11]
    v_and_b32 v40, v35, v4
    v_and_b32 v41, v35, v5
    v_and_b32 v42, v35, v6
    v_and_b32 v43, v35, v7
    v_mfma_f32_16x16x32_bf16 v[8:11], v[36:39], v[104:107], v[8:11]
    s_nop 0
    v_mfma_f32_16x16x32_bf16 v[8:11], v[40:43], v[108:111], v[8:11]
    s_cmp_eq_u32 s100, 0
    s_cbranch_scc1 L_bv_209
    s_cmp_eq_u32 s100, 2
    s_cbranch_scc1 L_bv_211
    s_waitcnt vmcnt(7)
    buffer_load_dwordx4 v[72:75], v2, s[32:35], s68 offen offset:2048
    s_branch L_be_208
L_bv_209:
    s_waitcnt vmcnt(6)
    buffer_load_dwordx4 v[72:75], v2, s[32:35], s68 offen offset:2048
    s_branch L_be_208
L_bv_211:
    s_waitcnt vmcnt(10)
    buffer_load_dwordx4 v[72:75], v2, s[32:35], s68 offen offset:2048
L_be_208:
    s_mov_b32 s91, s63
    s_call_b64 s[76:77], L_pack96_0
    s_cmp_eq_u32 s100, 0
    s_cbranch_scc1 L_bv_213
    s_cmp_eq_u32 s100, 2
    s_cbranch_scc1 L_bv_215
    s_waitcnt vmcnt(7)
    buffer_load_dwordx4 v[76:79], v2, s[32:35], s68 offen offset:2304
    s_branch L_be_212
L_bv_213:
    s_waitcnt vmcnt(6)
    buffer_load_dwordx4 v[76:79], v2, s[32:35], s68 offen offset:2304
    s_branch L_be_212
L_bv_215:
    s_waitcnt vmcnt(10)
    buffer_load_dwordx4 v[76:79], v2, s[32:35], s68 offen offset:2304
L_be_212:
    s_call_b64 s[76:77], L_pack96_1
    v_mov_b32 v250, v96
    v_mov_b32 v251, v97
    v_mov_b32 v252, v98
    v_mov_b32 v253, v99
    v_mov_b32 v254, v100
    v_mov_b32 v255, v101
    v_accvgpr_write_b32 a248, v102
    v_accvgpr_write_b32 a249, v103
    v_accvgpr_write_b32 a250, v104
    v_accvgpr_write_b32 a251, v105
    v_accvgpr_write_b32 a252, v106
    v_accvgpr_write_b32 a253, v107
    v_accvgpr_write_b32 a254, v32
    s_cmp_lg_u64 vcc, 0
    s_cselect_b32 s92, 524288, 0
    s_or_b32 s82, s82, s92
    s_add_u32 s79, s67, 7733248
    s_xor_b32 s78, s79, s67
    s_and_b32 s78, s78, 0xff800000
    s_xor_b32 s79, s79, s78
    s_cmp_eq_u32 s100, 0
    s_cbranch_scc1 L_bv_217
    s_cmp_eq_u32 s100, 2
    s_cbranch_scc1 L_bv_219
    s_waitcnt vmcnt(7)
    buffer_load_dwordx4 v[96:99], v2, s[32:35], s79 offen offset:0
    s_waitcnt vmcnt(7)
    buffer_load_dwordx4 v[100:103], v2, s[32:35], s79 offen offset:256
    s_branch L_be_216
L_bv_217:
    s_waitcnt vmcnt(6)
    buffer_load_dwordx4 v[96:99], v2, s[32:35], s79 offen offset:0
    s_waitcnt vmcnt(4)
    buffer_load_dwordx4 v[100:103], v2, s[32:35], s79 offen offset:256
    s_branch L_be_216
L_bv_219:
    s_waitcnt vmcnt(10)
    buffer_load_dwordx4 v[96:99], v2, s[32:35], s79 offen offset:0
    s_waitcnt vmcnt(10)
    buffer_load_dwordx4 v[100:103], v2, s[32:35], s79 offen offset:256
L_be_216:
    v_mov_b32_dpp v32, v20 row_newbcast:2 row_mask:0xf bank_mask:0xf
    v_mov_b32_dpp v33, v21 row_newbcast:2 row_mask:0xf bank_mask:0xf
    v_mov_b32_dpp v34, v22 row_newbcast:2 row_mask:0xf bank_mask:0xf
    v_mov_b32_dpp v35, v23 row_newbcast:2 row_mask:0xf bank_mask:0xf
    s_call_b64 s[76:77], L_exp0
    s_cmp_eq_u32 s100, 0
    s_cbranch_scc1 L_bv_221
    s_cmp_eq_u32 s100, 2
    s_cbranch_scc1 L_bv_223
    s_waitcnt vmcnt(5)
    buffer_load_dwordx4 v[104:107], v2, s[32:35], s79 offen offset:2048
    s_waitcnt vmcnt(5)
    buffer_load_dwordx4 v[108:111], v2, s[32:35], s79 offen offset:2304
    s_branch L_be_220
L_bv_221:
    s_waitcnt vmcnt(4)
    buffer_load_dwordx4 v[104:107], v2, s[32:35], s79 offen offset:2048
    s_waitcnt vmcnt(4)
    buffer_load_dwordx4 v[108:111], v2, s[32:35], s79 offen offset:2304
    s_branch L_be_220
L_bv_223:
    s_waitcnt vmcnt(10)
    buffer_load_dwordx4 v[104:107], v2, s[32:35], s79 offen offset:2048
    s_waitcnt vmcnt(10)
    buffer_load_dwordx4 v[108:111], v2, s[32:35], s79 offen offset:2304
L_be_220:
    s_waitcnt vmcnt(10)
    v_mfma_f32_16x16x32_bf16 v[8:11], v[36:39], v[128:131], v[8:11]
    v_and_b32 v36, v34, v4
    v_and_b32 v37, v34, v5
    v_and_b32 v38, v34, v6
    v_and_b32 v39, v34, v7
    v_mfma_f32_16x16x32_bf16 v[8:11], v[40:43], v[132:135], v[8:11]
    v_and_b32 v40, v35, v4
    v_and_b32 v41, v35, v5
    v_and_b32 v42, v35, v6
    v_and_b32 v43, v35, v7
    v_mfma_f32_16x16x32_bf16 v[8:11], v[36:39], v[136:139], v[8:11]
    s_nop 0
    v_mfma_f32_16x16x32_bf16 v[8:11], v[40:43], v[140:143], v[8:11]
    s_add_u32 s68, s67, 7864320
    s_xor_b32 s78, s68, s67
    s_and_b32 s78, s78, 0xff800000
    s_xor_b32 s68, s68, s78
    s_waitcnt vmcnt(14)
    buffer_load_dwordx4 v[128:131], v2, s[32:35], s68 offen offset:0
    s_waitcnt vmcnt(14)
    buffer_load_dwordx4 v[132:135], v2, s[32:35], s68 offen offset:256
    v_mov_b32_dpp v32, v20 row_newbcast:4 row_mask:0xf bank_mask:0xf
    v_mov_b32_dpp v33, v21 row_newbcast:4 row_mask:0xf bank_mask:0xf
    v_mov_b32_dpp v34, v22 row_newbcast:4 row_mask:0xf bank_mask:0xf
    v_mov_b32_dpp v35, v23 row_newbcast:4 row_mask:0xf bank_mask:0xf
    s_call_b64 s[76:77], L_exp0
    s_waitcnt vmcnt(14)
    buffer_load_dwordx4 v[136:139], v2, s[32:35], s68 offen offset:2048
    s_waitcnt vmcnt(14)
    buffer_load_dwordx4 v[140:143], v2, s[32:35], s68 offen offset:2304
    s_waitcnt vmcnt(8)
    v_mfma_f32_16x16x32_bf16 v[8:11], v[36:39], v[64:67], v[8:11]
    v_and_b32 v36, v34, v4
    v_and_b32 v37, v34, v5
    v_and_b32 v38, v34, v6
    v_and_b32 v39, v34, v7
    v_mfma_f32_16x16x32_bf16 v[8:11], v[40:43], v[68:71], v[8:11]
    v_and_b32 v40, v35, v4
    v_and_b32 v41, v35, v5
    v_and_b32 v42, v35, v6
    v_and_b32 v43, v35, v7
    v_mfma_f32_16x16x32_bf16 v[8:11], v[36:39], v[72:75], v[8:11]
    s_nop 0
    v_mfma_f32_16x16x32_bf16 v[8:11], v[40:43], v[76:79], v[8:11]
    s_add_u32 s79, s67, 7995392
    s_xor_b32 s78, s79, s67
    s_and_b32 s78, s78, 0xff800000
    s_xor_b32 s79, s79, s78
    s_waitcnt vmcnt(11)
    buffer_load_dwordx4 v[64:67], v2, s[32:35], s79 offen offset:0 nt
    s_waitcnt vmcnt(11)
    buffer_load_dwordx4 v[68:71], v2, s[32:35], s79 offen offset:256 nt
    v_mov_b32_dpp v32, v20 row_newbcast:6 row_mask:0xf bank_mask:0xf
    v_mov_b32_dpp v33, v21 row_newbcast:6 row_mask:0xf bank_mask:0xf
    v_mov_b32_dpp v34, v22 row_newbcast:6 row_mask:0xf bank_mask:0xf
    v_mov_b32_dpp v35, v23 row_newbcast:6 row_mask:0xf bank_mask:0xf
    s_call_b64 s[76:77], L_exp0
    s_waitcnt vmcnt(11)
    buffer_load_dwordx4 v[72:75], v2, s[32:35], s79 offen offset:2048 nt
    s_waitcnt vmcnt(11)
    buffer_load_dwordx4 v[76:79], v2, s[32:35], s79 offen offset:2304 nt
    s_waitcnt vmcnt(8)
    v_mfma_f32_16x16x32_bf16 v[8:11], v[36:39], v[96:99], v[8:11]
    v_and_b32 v36, v34, v4
    v_and_b32 v37, v34, v5
    v_and_b32 v38, v34, v6
    v_and_b32 v39, v34, v7
    v_mfma_f32_16x16x32_bf16 v[8:11], v[40:43], v[100:103], v[8:11]
    v_and_b32 v40, v35, v4
    v_and_b32 v41, v35, v5
    v_and_b32 v42, v35, v6
    v_and_b32 v43, v35, v7
    v_mfma_f32_16x16x32_bf16 v[8:11], v[36:39], v[104:107], v[8:11]
    s_nop 0
    v_mfma_f32_16x16x32_bf16 v[8:11], v[40:43], v[108:111], v[8:11]
    s_lshr_b32 s93, s65, 1
    s_add_u32 s93, s93, s3
    s_and_b32 s93, s93, 3
    s_mul_i32 s93, s93, 8192
    s_add_u32 s93, s93, 524288
    v_and_b32 v46, 63, v0
    v_mul_u32_u24 v46, 128, v46
    buffer_load_dword v47, v46, s[36:39], s93 offen sc1
    s_add_u32 s68, s67, 8126464
    s_xor_b32 s78, s68, s67
    s_and_b32 s78, s78, 0xff800000
    s_xor_b32 s68, s68, s78
    s_waitcnt vmcnt(12)
    buffer_load_dwordx4 v[96:99], v2, s[32:35], s68 offen offset:0 nt
    s_waitcnt vmcnt(12)
    buffer_load_dwordx4 v[100:103], v2, s[32:35], s68 offen offset:256 nt
    v_mov_b32_dpp v32, v20 row_newbcast:8 row_mask:0xf bank_mask:0xf
    v_mov_b32_dpp v33, v21 row_newbcast:8 row_mask:0xf bank_mask:0xf
    v_mov_b32_dpp v34, v22 row_newbcast:8 row_mask:0xf bank_mask:0xf
    v_mov_b32_dpp v35, v23 row_newbcast:8 row_mask:0xf bank_mask:0xf
    s_call_b64 s[76:77], L_exp0
    s_waitcnt vmcnt(12)
    buffer_load_dwordx4 v[104:107], v2, s[32:35], s68 offen offset:2048 nt
    s_waitcnt vmcnt(12)
    buffer_load_dwordx4 v[108:111], v2, s[32:35], s68 offen offset:2304 nt
    s_waitcnt vmcnt(9)
    v_mfma_f32_16x16x32_bf16 v[8:11], v[36:39], v[128:131], v[8:11]
    v_and_b32 v36, v34, v4
    v_and_b32 v37, v34, v5
    v_and_b32 v38, v34, v6
    v_and_b32 v39, v34, v7
    v_mfma_f32_16x16x32_bf16 v[8:11], v[40:43], v[132:135], v[8:11]
    v_and_b32 v40, v35, v4
    v_and_b32 v41, v35, v5
    v_and_b32 v42, v35, v6
    v_and_b32 v43, v35, v7
    v_mfma_f32_16x16x32_bf16 v[8:11], v[36:39], v[136:139], v[8:11]
    s_nop 0
    v_mfma_f32_16x16x32_bf16 v[8:11], v[40:43], v[140:143], v[8:11]
    s_add_u32 s79, s67, 8257536
    s_xor_b32 s78, s79, s67
    s_and_b32 s78, s78, 0xff800000
    s_xor_b32 s79, s79, s78
    s_waitcnt vmcnt(12)
    buffer_load_dwordx4 v[128:131], v2, s[32:35], s79 offen offset:0 nt
    s_waitcnt vmcnt(12)
    buffer_load_dwordx4 v[132:135], v2, s[32:35], s79 offen offset:256 nt
    v_mov_b32_dpp v32, v20 row_newbcast:10 row_mask:0xf bank_mask:0xf
    v_mov_b32_dpp v33, v21 row_newbcast:10 row_mask:0xf bank_mask:0xf
    v_mov_b32_dpp v34, v22 row_newbcast:10 row_mask:0xf bank_mask:0xf
    v_mov_b32_dpp v35, v23 row_newbcast:10 row_mask:0xf bank_mask:0xf
    s_call_b64 s[76:77], L_exp0
    s_waitcnt vmcnt(12)
    buffer_load_dwordx4 v[136:139], v2, s[32:35], s79 offen offset:2048 nt
    s_waitcnt vmcnt(12)
    buffer_load_dwordx4 v[140:143], v2, s[32:35], s79 offen offset:2304 nt
    v_and_b32 v44, 63, v0
    s_cmp_ge_u32 s3, 2
    s_cbranch_scc1 L_w2_224
    s_getpc_b64 s[94:95]
L_here_227:
    s_add_u32 s94, s94, L_mid-L_here_227
    s_addc_u32 s95, s95, 0
    v_lshlrev_b32 v44, 7, v44
    global_load_dword v2, v44, s[94:95]
    s_branch L_we_226
L_w2_224:
    v_lshrrev_b32 v45, 2, v44
    v_mul_u32_u24 v45, 2752, v45
    v_and_b32 v46, 3, v44
    v_mul_u32_u24 v46, 112, v46
    v_add_u32 v45, v45, v46
    s_mul_i32 s92, s66, 44032
    s_lshl_b32 s93, s74, 5
    s_add_u32 s92, s92, s93
    s_cmp_eq_u32 s3, 3
    s_cbranch_scc1 L_w3_225
    buffer_load_dword v2, v45, s[48:51], s92 offen
    s_branch L_we_226
L_w3_225:
    buffer_load_dword v2, v45, s[52:55], s92 offen
L_we_226:
    s_waitcnt vmcnt(10)
    v_mfma_f32_16x16x32_bf16 v[8:11], v[36:39], v[64:67], v[8:11]
    v_and_b32 v36, v34, v4
    v_and_b32 v37, v34, v5
    v_and_b32 v38, v34, v6
    v_and_b32 v39, v34, v7
    v_mfma_f32_16x16x32_bf16 v[8:11], v[40:43], v[68:71], v[8:11]
    v_and_b32 v40, v35, v4
    v_and_b32 v41, v35, v5
    v_and_b32 v42, v35, v6
    v_and_b32 v43, v35, v7
    v_mfma_f32_16x16x32_bf16 v[8:11], v[36:39], v[72:75], v[8:11]
    s_nop 0
    v_mfma_f32_16x16x32_bf16 v[8:11], v[40:43], v[76:79], v[8:11]
    v_mov_b32_dpp v32, v20 row_newbcast:12 row_mask:0xf bank_mask:0xf
    v_mov_b32_dpp v33, v21 row_newbcast:12 row_mask:0xf bank_mask:0xf
    v_mov_b32_dpp v34, v22 row_newbcast:12 row_mask:0xf bank_mask:0xf
    v_mov_b32_dpp v35, v23 row_newbcast:12 row_mask:0xf bank_mask:0xf
    s_call_b64 s[76:77], L_exp0
    s_waitcnt vmcnt(5)
    v_mfma_f32_16x16x32_bf16 v[8:11], v[36:39], v[96:99], v[8:11]
    v_and_b32 v36, v34, v4
    v_and_b32 v37, v34, v5
    v_and_b32 v38, v34, v6
    v_and_b32 v39, v34, v7
    v_mfma_f32_16x16x32_bf16 v[8:11], v[40:43], v[100:103], v[8:11]
    v_and_b32 v40, v35, v4
    v_and_b32 v41, v35, v5
    v_and_b32 v42, v35, v6
    v_and_b32 v43, v35, v7
    v_mfma_f32_16x16x32_bf16 v[8:11], v[36:39], v[104:107], v[8:11]
    s_nop 0
    v_mfma_f32_16x16x32_bf16 v[8:11], v[40:43], v[108:111], v[8:11]
    s_waitcnt vmcnt(9)
    v_xor_b32 v32, s97, v47
    v_and_b32 v32, 0x1ff, v32
    v_cmp_ne_u32 vcc, 0, v32
    v_mov_b32 v33, v47
    s_cbranch_vccz L_flok_228
    s_call_b64 s[76:77], L_flagspin
L_flok_228:
    v_bfe_u32 v33, v33, 12, 4
    v_cmp_ne_u32 vcc, s96, v33
    s_and_b32 s93, s65, 1
    s_lshl_b32 s93, s93, 5
    s_lshr_b64 s[94:95], vcc, s93
    s_cmp_eq_u32 s94, 0
    s_cselect_b32 s73, 1, 0
    v_mov_b32_dpp v32, v20 row_newbcast:14 row_mask:0xf bank_mask:0xf
    v_mov_b32_dpp v33, v21 row_newbcast:14 row_mask:0xf bank_mask:0xf
    v_mov_b32_dpp v34, v22 row_newbcast:14 row_mask:0xf bank_mask:0xf
    v_mov_b32_dpp v35, v23 row_newbcast:14 row_mask:0xf bank_mask:0xf
    v_lshlrev_b32 v40, 11, v0
    s_lshl_b32 s92, s65, 19
    s_lshl_b32 s93, s66, 5
    s_add_u32 s92, s92, s93
    buffer_load_dwordx4 v[16:19], v40, s[44:47], s92 offen offset:0
    buffer_load_dwordx4 v[20:23], v40, s[44:47], s92 offen offset:16
    buffer_load_dwordx4 v[24:27], v40, s[44:47], s92 offen offset:1024
    buffer_load_dwordx4 v[28:31], v40, s[44:47], s92 offen offset:1040
    v_and_b32 v44, 15, v0
    v_lshlrev_b32 v44, 5, v44
    v_and_b32 v45, 48, v0
    v_lshrrev_b32 v45, 1, v45
    v_add_u32 v44, v44, v45
    v_lshrrev_b32 v45, 6, v0
    v_lshl_add_u32 v44, v45, 9, v44
    v_lshlrev_b32 v45, 3, v45
    v_add_u32 v45, 2048, v45
    s_call_b64 s[76:77], L_exp0
    s_waitcnt vmcnt(5)
    v_mfma_f32_16x16x32_bf16 v[8:11], v[36:39], v[128:131], v[8:11]
    v_and_b32 v36, v34, v4
    v_and_b32 v37, v34, v5
    v_and_b32 v38, v34, v6
    v_and_b32 v39, v34, v7
    v_mfma_f32_16x16x32_bf16 v[8:11], v[40:43], v[132:135], v[8:11]
    v_and_b32 v40, v35, v4
    v_and_b32 v41, v35, v5
    v_and_b32 v42, v35, v6
    v_and_b32 v43, v35, v7
    v_mfma_f32_16x16x32_bf16 v[8:11], v[36:39], v[136:139], v[8:11]
    s_nop 0
    v_mfma_f32_16x16x32_bf16 v[8:11], v[40:43], v[140:143], v[8:11]
L_mid:
    v_mov_b32 v46, v12
    s_nop 6
    v_mov_b32 v9, v10
    v_permlane32_swap_b32 v12, v46
    ds_write_b64 v44, v[8:9] offset:0
    v_add_f32 v12, v12, v46
    v_mov_b32 v46, v12
    v_and_b32 v3, 63, v0
    v_lshlrev_b32 v3, 3, v3
    v_permlane16_swap_b32 v12, v46
    v_add_f32 v14, v12, v46
    v_mov_b32 v9, 0
    s_mov_b64 exec, 1
    ds_write2_b32 v45, v13, v14 offset0:0 offset1:1
    s_mov_b64 exec, -1
    s_lshl_b32 s92, s64, 9
    s_add_u32 s92, s92, s72
    s_lshl_b32 s93, s64, 3
    s_add_u32 s93, s93, s72
    s_add_u32 s93, s93, 131072
    s_waitcnt lgkmcnt(0)
    s_barrier
    s_cmp_lg_u32 s3, 0
    s_cbranch_scc1 L_nopub_229
    ds_read_b128 v[40:43], v9 offset:2048
    ds_read_b128 v[44:47], v9 offset:2064
    ds_read_b64 v[32:33], v3 offset:0
    ds_read_b64 v[34:35], v3 offset:512
    ds_read_b64 v[36:37], v3 offset:1024
    ds_read_b64 v[38:39], v3 offset:1536
    s_waitcnt lgkmcnt(4)
    v_max3_f32 v10, v40, v42, v44
    v_max_f32 v10, v10, v46
    v_sub_f32 v40, v40, v10
    v_sub_f32 v42, v42, v10
    v_sub_f32 v44, v44, v10
    v_sub_f32 v46, v46, v10
    v_exp_f32 v40, v40
    v_exp_f32 v42, v42
    v_exp_f32 v44, v44
    v_exp_f32 v46, v46
    s_waitcnt lgkmcnt(0)
    v_mul_f32 v12, v40, v32
    v_mul_f32 v13, v40, v33
    v_mul_f32 v11, v40, v41
    v_fmac_f32 v12, v42, v34
    v_fmac_f32 v13, v42, v35
    v_fmac_f32 v11, v42, v43
    v_fmac_f32 v12, v44, v36
    v_fmac_f32 v13, v44, v37
    v_fmac_f32 v11, v44, v45
    v_fmac_f32 v12, v46, v38
    v_fmac_f32 v13, v46, v39
    v_fmac_f32 v11, v46, v47
    v_min_u32 v12, -2, v12
    v_min_u32 v13, -2, v13
    v_min_u32 v10, -2, v10
    v_min_u32 v11, -2, v11
    s_cmp_eq_u32 s73, 0
    s_cbranch_scc1 L_stg_230
    buffer_store_dwordx2 v[12:13], v3, s[36:39], s92 offen
    s_mov_b64 exec, 1
    buffer_store_dwordx2 v[10:11], v9, s[36:39], s93 offen
    s_mov_b64 exec, -1
    s_branch L_std_231
L_stg_230:
    buffer_store_dwordx2 v[12:13], v3, s[36:39], s92 offen sc1
    s_mov_b64 exec, 1
    buffer_store_dwordx2 v[10:11], v9, s[36:39], s93 offen sc1
    s_mov_b64 exec, -1
L_std_231:
L_nopub_229:
    v_and_b32 v1, 7, v0
    v_lshlrev_b32 v1, 3, v1
    s_lshl_b32 s92, s65, 5
    s_lshl_b32 s93, s3, 3
    s_add_u32 s92, s92, s93
    s_lshl_b32 s93, s92, 3
    s_add_u32 s93, s93, s72
    s_add_u32 s93, s93, 131072
    s_lshl_b32 s92, s92, 9
    s_add_u32 s92, s92, s72
    s_barrier
    s_mov_b32 s78, 4194304
    buffer_load_dwordx2 v[10:11], v1, s[36:39], s93 offen sc1
    buffer_load_dwordx2 v[32:33], v3, s[36:39], s92 offen offset:0 sc1
    buffer_load_dwordx2 v[34:35], v3, s[36:39], s92 offen offset:512 sc1
    buffer_load_dwordx2 v[36:37], v3, s[36:39], s92 offen offset:1024 sc1
    buffer_load_dwordx2 v[38:39], v3, s[36:39], s92 offen offset:1536 sc1
    buffer_load_dwordx2 v[40:41], v3, s[36:39], s92 offen offset:2048 sc1
    buffer_load_dwordx2 v[42:43], v3, s[36:39], s92 offen offset:2560 sc1
    buffer_load_dwordx2 v[44:45], v3, s[36:39], s92 offen offset:3072 sc1
    buffer_load_dwordx2 v[46:47], v3, s[36:39], s92 offen offset:3584 sc1
    v_lshrrev_b32 v4, 4, v0
    v_and_b32 v5, 3, v4
    v_lshrrev_b32 v4, 2, v4
    v_lshlrev_b32 v4, 7, v4
    v_lshl_add_u32 v6, v5, 1, v4
    v_lshl_add_u32 v4, v5, 4, v4
    v_mov_b32 v5, v6
    v_and_b32 v6, 15, v0
    v_lshlrev_b32 v6, 2, v6
    v_lshlrev_b32 v7, 3, v0
    s_waitcnt vmcnt(9)
    v_perm_b32 v14, v24, v16, s70
    v_perm_b32 v24, v24, v16, s71
    v_perm_b32 v16, v25, v17, s70
    v_perm_b32 v25, v25, v17, s71
    v_perm_b32 v17, v26, v18, s70
    v_perm_b32 v26, v26, v18, s71
    v_perm_b32 v18, v27, v19, s70
    v_perm_b32 v27, v27, v19, s71
    v_perm_b32 v19, v28, v20, s70
    v_perm_b32 v28, v28, v20, s71
    v_perm_b32 v20, v29, v21, s70
    v_perm_b32 v29, v29, v21, s71
    v_perm_b32 v21, v30, v22, s70
    v_perm_b32 v30, v30, v22, s71
    v_perm_b32 v22, v31, v23, s70
    v_perm_b32 v31, v31, v23, s71
    s_branch L_chk_234
L_poll_232:
    buffer_load_dwordx2 v[10:11], v1, s[36:39], s93 offen sc1
    buffer_load_dwordx2 v[32:33], v3, s[36:39], s92 offen offset:0 sc1
    buffer_load_dwordx2 v[34:35], v3, s[36:39], s92 offen offset:512 sc1
    buffer_load_dwordx2 v[36:37], v3, s[36:39], s92 offen offset:1024 sc1
    buffer_load_dwordx2 v[38:39], v3, s[36:39], s92 offen offset:1536 sc1
    buffer_load_dwordx2 v[40:41], v3, s[36:39], s92 offen offset:2048 sc1
    buffer_load_dwordx2 v[42:43], v3, s[36:39], s92 offen offset:2560 sc1
    buffer_load_dwordx2 v[44:45], v3, s[36:39], s92 offen offset:3072 sc1
    buffer_load_dwordx2 v[46:47], v3, s[36:39], s92 offen offset:3584 sc1
L_chk_234:
    s_waitcnt vmcnt(0)
    v_max3_u32 v12, v10, v11, v32
    v_max3_u32 v12, v12, v33, v34
    v_max3_u32 v12, v12, v35, v36
    v_max3_u32 v12, v12, v37, v38
    v_max3_u32 v12, v12, v39, v40
    v_max3_u32 v12, v12, v41, v42
    v_max3_u32 v12, v12, v43, v44
    v_max3_u32 v12, v12, v45, v46
    v_max3_u32 v12, v12, v47, v47
    v_cmp_eq_u32 vcc, -1, v12
    s_cbranch_vccz L_got_233
    s_sub_u32 s78, s78, 1
    s_cbranch_scc0 L_poll_232
    s_branch L_exit
L_got_233:
    v_max_f32_dpp v12, v10, v10 row_ror:4 row_mask:0xf bank_mask:0xf
    s_nop 1
    v_max_f32_dpp v12, v12, v12 row_ror:2 row_mask:0xf bank_mask:0xf
    s_nop 1
    v_max_f32_dpp v12, v12, v12 row_ror:1 row_mask:0xf bank_mask:0xf
    v_sub_f32 v10, v10, v12
    v_exp_f32 v10, v10
    s_nop 0
    v_readlane_b32 s84, v10, 0
    v_mul_f32 v11, v10, v11
    v_readlane_b32 s85, v10, 1
    v_readlane_b32 s86, v10, 2
    v_add_f32_dpp v11, v11, v11 row_ror:4 row_mask:0xf bank_mask:0xf
    v_readlane_b32 s87, v10, 3
    v_readlane_b32 s88, v10, 4
    v_add_f32_dpp v11, v11, v11 row_ror:2 row_mask:0xf bank_mask:0xf
    v_readlane_b32 s89, v10, 5
    v_readlane_b32 s90, v10, 6
    v_add_f32_dpp v11, v11, v11 row_ror:1 row_mask:0xf bank_mask:0xf
    v_readlane_b32 s91, v10, 7
    v_mul_f32 v12, s84, v32
    v_rcp_f32 v11, v11
    v_mul_f32 v13, s84, v33
    v_fmac_f32 v12, s85, v34
    v_fmac_f32 v13, s85, v35
    v_fmac_f32 v12, s86, v36
    v_fmac_f32 v13, s86, v37
    v_fmac_f32 v12, s87, v38
    v_fmac_f32 v13, s87, v39
    v_fmac_f32 v12, s88, v40
    v_fmac_f32 v13, s88, v41
    v_fmac_f32 v12, s89, v42
    v_fmac_f32 v13, s89, v43
    v_fmac_f32 v12, s90, v44
    v_fmac_f32 v13, s90, v45
    v_fmac_f32 v12, s91, v46
    v_fmac_f32 v13, s91, v47
    v_mul_f32 v12, v12, v11
    v_mul_f32 v13, v13, v11
    v_cvt_pk_bf16_f32 v12, v12, v13
    v_dot2_f32_bf16 v32, v14, v12, 0
    v_dot2_f32_bf16 v33, v24, v12, 0
    v_dot2_f32_bf16 v34, v16, v12, 0
    v_dot2_f32_bf16 v35, v25, v12, 0
    v_dot2_f32_bf16 v36, v17, v12, 0
    v_dot2_f32_bf16 v37, v26, v12, 0
    v_dot2_f32_bf16 v38, v18, v12, 0
    v_dot2_f32_bf16 v39, v27, v12, 0
    v_dot2_f32_bf16 v40, v19, v12, 0
    v_dot2_f32_bf16 v41, v28, v12, 0
    v_dot2_f32_bf16 v42, v20, v12, 0
    v_dot2_f32_bf16 v43, v29, v12, 0
    v_dot2_f32_bf16 v44, v21, v12, 0
    v_dot2_f32_bf16 v45, v30, v12, 0
    v_dot2_f32_bf16 v46, v22, v12, 0
    v_dot2_f32_bf16 v47, v31, v12, 0
    v_permlane32_swap_b32 v32, v40
    v_permlane32_swap_b32 v33, v41
    v_permlane32_swap_b32 v34, v42
    v_permlane32_swap_b32 v35, v43
    v_permlane32_swap_b32 v36, v44
    v_permlane32_swap_b32 v37, v45
    v_permlane32_swap_b32 v38, v46
    v_permlane32_swap_b32 v39, v47
    v_pk_add_f32 v[32:33], v[32:33], v[40:41]
    v_pk_add_f32 v[34:35], v[34:35], v[42:43]
    v_pk_add_f32 v[36:37], v[36:37], v[44:45]
    v_pk_add_f32 v[38:39], v[38:39], v[46:47]
    s_nop 0
    v_permlane16_swap_b32 v32, v36
    v_permlane16_swap_b32 v33, v37
    v_permlane16_swap_b32 v34, v38
    v_permlane16_swap_b32 v35, v39
    v_pk_add_f32 v[32:33], v[32:33], v[36:37]
    v_pk_add_f32 v[34:35], v[34:35], v[38:39]
    s_nop 0
    v_add_f32_dpp v32, v32, v32 row_ror:8 row_mask:0xf bank_mask:0xf
    v_add_f32_dpp v33, v33, v33 row_ror:8 row_mask:0xf bank_mask:0xf
    v_add_f32_dpp v34, v34, v34 row_ror:8 row_mask:0xf bank_mask:0xf
    v_add_f32_dpp v35, v35, v35 row_ror:8 row_mask:0xf bank_mask:0xf
    v_add_f32_dpp v32, v32, v32 row_ror:4 row_mask:0xf bank_mask:0xf
    v_add_f32_dpp v33, v33, v33 row_ror:4 row_mask:0xf bank_mask:0xf
    v_add_f32_dpp v34, v34, v34 row_ror:4 row_mask:0xf bank_mask:0xf
    v_add_f32_dpp v35, v35, v35 row_ror:4 row_mask:0xf bank_mask:0xf
    v_add_f32_dpp v32, v32, v32 row_ror:2 row_mask:0xf bank_mask:0xf
    v_add_f32_dpp v33, v33, v33 row_ror:2 row_mask:0xf bank_mask:0xf
    v_add_f32_dpp v34, v34, v34 row_ror:2 row_mask:0xf bank_mask:0xf
    v_add_f32_dpp v35, v35, v35 row_ror:2 row_mask:0xf bank_mask:0xf
    v_add_f32_dpp v32, v32, v32 row_ror:1 row_mask:0xf bank_mask:0xf
    v_add_f32_dpp v33, v33, v33 row_ror:1 row_mask:0xf bank_mask:0xf
    v_add_f32_dpp v34, v34, v34 row_ror:1 row_mask:0xf bank_mask:0xf
    v_add_f32_dpp v35, v35, v35 row_ror:1 row_mask:0xf bank_mask:0xf
    s_mov_b32 exec_lo, 0x10001
    s_mov_b32 exec_hi, 0x10001
    ds_write_b128 v4, v[32:35] offset:2176
    s_mov_b64 exec, -1
    s_lshl_b32 s92, s64, 6
    s_add_u32 s92, s92, s72
    s_add_u32 s92, s92, 135168
    s_waitcnt lgkmcnt(0)
    s_barrier
    s_cmp_lg_u32 s3, 0
    s_cbranch_scc1 L_nopub_235
    ds_read_b32 v32, v6 offset:2176
    ds_read_b32 v33, v6 offset:2304
    ds_read_b32 v34, v6 offset:2432
    ds_read_b32 v35, v6 offset:2560
    s_waitcnt lgkmcnt(0)
    v_pk_add_f32 v[32:33], v[32:33], v[34:35]
    v_add_f32 v10, v32, v33
    v_min_u32 v10, -2, v10
    s_mov_b32 exec_lo, 0xffff
    s_mov_b32 exec_hi, 0x0
    buffer_store_dword v10, v6, s[36:39], s92 offen sc1
    s_mov_b64 exec, -1
L_nopub_235:
    s_barrier
    s_cmp_ge_u32 s66, s75
    s_cbranch_scc1 L_notworker_236
    v_mul_u32_u24 v8, 5504, v0
    s_lshr_b32 s92, s66, 1
    s_add_u32 s92, s92, s74
    s_lshl_b32 s92, s92, 5
    s_bitcmp1_b32 s66, 0
    s_cbranch_scc1 L_wu_238
    buffer_load_dwordx4 v[16:19], v8, s[48:51], s92 offen offset:0
    buffer_load_dwordx4 v[20:23], v8, s[48:51], s92 offen offset:16
    buffer_load_dwordx4 v[24:27], v8, s[48:51], s92 offen offset:2752
    buffer_load_dwordx4 v[28:31], v8, s[48:51], s92 offen offset:2768
    s_branch L_wge_239
L_wu_238:
    buffer_load_dwordx4 v[16:19], v8, s[52:55], s92 offen offset:0
    buffer_load_dwordx4 v[20:23], v8, s[52:55], s92 offen offset:16
    buffer_load_dwordx4 v[24:27], v8, s[52:55], s92 offen offset:2752
    buffer_load_dwordx4 v[28:31], v8, s[52:55], s92 offen offset:2768
L_wge_239:
    s_branch L_wdone_237
L_notworker_236:
    s_cmp_ge_u32 s3, 2
    s_cbranch_scc1 L_nowd_240
    v_lshlrev_b32 v8, 11, v0
    s_lshl_b32 s92, s74, 14
    s_lshl_b32 s93, s66, 5
    s_add_u32 s92, s92, s93
    s_mov_b64 exec, s[80:81]
    buffer_load_dwordx4 v[16:19], v8, s[56:59], s92 offen offset:0
    buffer_load_dwordx4 v[20:23], v8, s[56:59], s92 offen offset:16
    buffer_load_dwordx4 v[24:27], v8, s[56:59], s92 offen offset:1024
    buffer_load_dwordx4 v[28:31], v8, s[56:59], s92 offen offset:1040
    s_mov_b64 exec, -1
L_nowd_240:
L_wdone_237:
    s_cmp_lt_u32 s66, 22
    s_cbranch_scc1 L_niw_241
    s_sub_u32 s94, s66, 22
    s_lshl_b32 s94, s94, 2
    s_add_u32 s94, s94, s3
    v_and_b32 v45, 63, v0
    v_min_u32 v46, 35, v45
    v_lshlrev_b32 v46, 7, v46
    s_mul_i32 s92, s94, 4608
    s_lshl_b32 s93, s74, 14
    s_add_u32 s92, s92, s93
    buffer_load_dword v2, v46, s[56:59], s92 offen
    s_cmp_lg_u32 s72, 0
    s_cbranch_scc1 L_niw_241
    v_lshrrev_b32 v46, 3, v45
    v_lshlrev_b32 v46, 13, v46
    v_and_b32 v45, 7, v45
    v_lshl_add_u32 v46, v45, 7, v46
    s_mul_i32 s92, s94, 106496
    s_lshl_b32 s93, s65, 10
    s_add_u32 s92, s92, s93
    s_add_u32 s93, s92, 40960
    buffer_load_dword v2, v46, s[40:43], s92 offen
    buffer_load_dword v2, v46, s[40:43], s93 offen
L_niw_241:
    s_cmp_ge_u32 s66, s75
    s_cbranch_scc1 L_skipC_242
    s_add_u32 s84, s72, 135168
    s_add_u32 s85, s72, 139264
    s_add_u32 s86, s72, 143360
    s_add_u32 s87, s72, 147456
    s_waitcnt vmcnt(0)
    v_perm_b32 v14, v24, v16, s70
    v_perm_b32 v24, v24, v16, s71
    v_perm_b32 v16, v25, v17, s70
    v_perm_b32 v25, v25, v17, s71
    v_perm_b32 v17, v26, v18, s70
    v_perm_b32 v26, v26, v18, s71
    v_perm_b32 v18, v27, v19, s70
    v_perm_b32 v27, v27, v19, s71
    v_perm_b32 v19, v28, v20, s70
    v_perm_b32 v28, v28, v20, s71
    v_perm_b32 v20, v29, v21, s70
    v_perm_b32 v29, v29, v21, s71
    v_perm_b32 v21, v30, v22, s70
    v_perm_b32 v30, v30, v22, s71
    v_perm_b32 v22, v31, v23, s70
    v_perm_b32 v31, v31, v23, s71
    s_cmp_lg_u32 s72, 0
    s_cbranch_scc1 L_nocs_243
    v_dot2_f32_bf16 v32, v14, s83, 0
    v_dot2_f32_bf16 v33, v24, s83, 0
    v_dot2_f32_bf16 v34, v16, s83, 0
    v_dot2_f32_bf16 v35, v25, s83, 0
    v_dot2_f32_bf16 v36, v17, s83, 0
    v_dot2_f32_bf16 v37, v26, s83, 0
    v_dot2_f32_bf16 v38, v18, s83, 0
    v_dot2_f32_bf16 v39, v27, s83, 0
    v_dot2_f32_bf16 v40, v19, s83, 0
    v_dot2_f32_bf16 v41, v28, s83, 0
    v_dot2_f32_bf16 v42, v20, s83, 0
    v_dot2_f32_bf16 v43, v29, s83, 0
    v_dot2_f32_bf16 v44, v21, s83, 0
    v_dot2_f32_bf16 v45, v30, s83, 0
    v_dot2_f32_bf16 v46, v22, s83, 0
    v_dot2_f32_bf16 v47, v31, s83, 0
    v_permlane32_swap_b32 v32, v40
    v_permlane32_swap_b32 v33, v41
    v_permlane32_swap_b32 v34, v42
    v_permlane32_swap_b32 v35, v43
    v_permlane32_swap_b32 v36, v44
    v_permlane32_swap_b32 v37, v45
    v_permlane32_swap_b32 v38, v46
    v_permlane32_swap_b32 v39, v47
    v_pk_add_f32 v[32:33], v[32:33], v[40:41]
    v_pk_add_f32 v[34:35], v[34:35], v[42:43]
    v_pk_add_f32 v[36:37], v[36:37], v[44:45]
    v_pk_add_f32 v[38:39], v[38:39], v[46:47]
    s_nop 0
    v_permlane16_swap_b32 v32, v36
    v_permlane16_swap_b32 v33, v37
    v_permlane16_swap_b32 v34, v38
    v_permlane16_swap_b32 v35, v39
    v_pk_add_f32 v[32:33], v[32:33], v[36:37]
    v_pk_add_f32 v[34:35], v[34:35], v[38:39]
    s_nop 0
    v_add_f32_dpp v32, v32, v32 row_ror:8 row_mask:0xf bank_mask:0xf
    v_add_f32_dpp v33, v33, v33 row_ror:8 row_mask:0xf bank_mask:0xf
    v_add_f32_dpp v34, v34, v34 row_ror:8 row_mask:0xf bank_mask:0xf
    v_add_f32_dpp v35, v35, v35 row_ror:8 row_mask:0xf bank_mask:0xf
    v_add_f32_dpp v32, v32, v32 row_ror:4 row_mask:0xf bank_mask:0xf
    v_add_f32_dpp v33, v33, v33 row_ror:4 row_mask:0xf bank_mask:0xf
    v_add_f32_dpp v34, v34, v34 row_ror:4 row_mask:0xf bank_mask:0xf
    v_add_f32_dpp v35, v35, v35 row_ror:4 row_mask:0xf bank_mask:0xf
    v_add_f32_dpp v32, v32, v32 row_ror:2 row_mask:0xf bank_mask:0xf
    v_add_f32_dpp v33, v33, v33 row_ror:2 row_mask:0xf bank_mask:0xf
    v_add_f32_dpp v34, v34, v34 row_ror:2 row_mask:0xf bank_mask:0xf
    v_add_f32_dpp v35, v35, v35 row_ror:2 row_mask:0xf bank_mask:0xf
    v_add_f32_dpp v32, v32, v32 row_ror:1 row_mask:0xf bank_mask:0xf
    v_add_f32_dpp v33, v33, v33 row_ror:1 row_mask:0xf bank_mask:0xf
    v_add_f32_dpp v34, v34, v34 row_ror:1 row_mask:0xf bank_mask:0xf
    v_add_f32_dpp v35, v35, v35 row_ror:1 row_mask:0xf bank_mask:0xf
    s_mov_b32 exec_lo, 0x10001
    s_mov_b32 exec_hi, 0x10001
    ds_write_b128 v4, v[32:35] offset:3200
    s_mov_b64 exec, -1
L_nocs_243:
    v_lshlrev_b32 v10, 16, v15
    v_and_b32 v11, 0xffff0000, v15
    buffer_load_dwordx2 v[32:33], v7, s[36:39], s84 offen offset:0 sc1
    buffer_load_dwordx2 v[34:35], v7, s[36:39], s84 offen offset:2048 sc1
    buffer_load_dwordx2 v[36:37], v7, s[36:39], s85 offen offset:0 sc1
    buffer_load_dwordx2 v[38:39], v7, s[36:39], s85 offen offset:2048 sc1
    buffer_load_dwordx2 v[40:41], v7, s[36:39], s86 offen offset:0 sc1
    buffer_load_dwordx2 v[42:43], v7, s[36:39], s86 offen offset:2048 sc1
    buffer_load_dwordx2 v[44:45], v7, s[36:39], s87 offen offset:0 sc1
    buffer_load_dwordx2 v[46:47], v7, s[36:39], s87 offen offset:2048 sc1
    s_waitcnt vmcnt(0)
    v_pk_add_f32 v[32:33], v[32:33], v[34:35]
    v_pk_add_f32 v[36:37], v[36:37], v[38:39]
    v_pk_add_f32 v[40:41], v[40:41], v[42:43]
    v_pk_add_f32 v[44:45], v[44:45], v[46:47]
    v_pk_add_f32 v[32:33], v[32:33], v[36:37]
    v_pk_add_f32 v[40:41], v[40:41], v[44:45]
    v_pk_add_f32 v[32:33], v[32:33], v[40:41]
    v_cmp_u_f32 vcc, v32, v33
    s_cbranch_vccz L_fast_244
    s_mov_b32 s78, 4194304
L_poll_245:
    buffer_load_dwordx2 v[32:33], v7, s[36:39], s84 offen offset:0 sc1
    buffer_load_dwordx2 v[34:35], v7, s[36:39], s84 offen offset:2048 sc1
    buffer_load_dwordx2 v[36:37], v7, s[36:39], s85 offen offset:0 sc1
    buffer_load_dwordx2 v[38:39], v7, s[36:39], s85 offen offset:2048 sc1
    buffer_load_dwordx2 v[40:41], v7, s[36:39], s86 offen offset:0 sc1
    buffer_load_dwordx2 v[42:43], v7, s[36:39], s86 offen offset:2048 sc1
    buffer_load_dwordx2 v[44:45], v7, s[36:39], s87 offen offset:0 sc1
    buffer_load_dwordx2 v[46:47], v7, s[36:39], s87 offen offset:2048 sc1
L_chk_247:
    s_waitcnt vmcnt(0)
    v_max3_u32 v12, v32, v33, v34
    v_max3_u32 v12, v12, v35, v36
    v_max3_u32 v12, v12, v37, v38
    v_max3_u32 v12, v12, v39, v40
    v_max3_u32 v12, v12, v41, v42
    v_max3_u32 v12, v12, v43, v44
    v_max3_u32 v12, v12, v45, v46
    v_max3_u32 v12, v12, v47, v47
    v_cmp_eq_u32 vcc, -1, v12
    s_cbranch_vccz L_got_246
    s_sub_u32 s78, s78, 1
    s_cbranch_scc0 L_poll_245
    s_branch L_exit
L_got_246:
    v_pk_add_f32 v[32:33], v[32:33], v[34:35]
    v_pk_add_f32 v[36:37], v[36:37], v[38:39]
    v_pk_add_f32 v[40:41], v[40:41], v[42:43]
    v_pk_add_f32 v[44:45], v[44:45], v[46:47]
    v_pk_add_f32 v[32:33], v[32:33], v[36:37]
    v_pk_add_f32 v[40:41], v[40:41], v[44:45]
    v_pk_add_f32 v[32:33], v[32:33], v[40:41]
L_fast_244:
    v_pk_add_f32 v[32:33], v[32:33], v[10:11]
    v_cvt_pk_bf16_f32 v15, v32, v33
    v_dot2_f32_bf16 v10, v15, s83, 0
    v_dot2_f32_bf16 v11, v15, v15, 0
    v_dot2_f32_bf16 v32, v14, v15, 0
    v_dot2_f32_bf16 v33, v24, v15, 0
    v_dot2_f32_bf16 v34, v16, v15, 0
    v_dot2_f32_bf16 v35, v25, v15, 0
    v_dot2_f32_bf16 v36, v17, v15, 0
    v_dot2_f32_bf16 v37, v26, v15, 0
    v_dot2_f32_bf16 v38, v18, v15, 0
    v_dot2_f32_bf16 v39, v27, v15, 0
    v_dot2_f32_bf16 v40, v19, v15, 0
    v_dot2_f32_bf16 v41, v28, v15, 0
    v_dot2_f32_bf16 v42, v20, v15, 0
    v_dot2_f32_bf16 v43, v29, v15, 0
    v_dot2_f32_bf16 v44, v21, v15, 0
    v_dot2_f32_bf16 v45, v30, v15, 0
    v_dot2_f32_bf16 v46, v22, v15, 0
    v_dot2_f32_bf16 v47, v31, v15, 0
    v_permlane32_swap_b32 v32, v40
    v_permlane32_swap_b32 v33, v41
    v_permlane32_swap_b32 v34, v42
    v_permlane32_swap_b32 v35, v43
    v_permlane32_swap_b32 v36, v44
    v_permlane32_swap_b32 v37, v45
    v_permlane32_swap_b32 v38, v46
    v_permlane32_swap_b32 v39, v47
    v_permlane32_swap_b32 v10, v11
    v_pk_add_f32 v[32:33], v[32:33], v[40:41]
    v_pk_add_f32 v[34:35], v[34:35], v[42:43]
    v_pk_add_f32 v[36:37], v[36:37], v[44:45]
    v_pk_add_f32 v[38:39], v[38:39], v[46:47]
    v_add_f32 v10, v10, v11
    v_permlane16_swap_b32 v32, v36
    v_permlane16_swap_b32 v33, v37
    v_permlane16_swap_b32 v34, v38
    v_permlane16_swap_b32 v35, v39
    v_mov_b32 v11, v10
    v_pk_add_f32 v[32:33], v[32:33], v[36:37]
    v_pk_add_f32 v[34:35], v[34:35], v[38:39]
    v_permlane16_swap_b32 v10, v11
    v_add_f32_dpp v32, v32, v32 row_ror:8 row_mask:0xf bank_mask:0xf
    v_add_f32_dpp v33, v33, v33 row_ror:8 row_mask:0xf bank_mask:0xf
    v_add_f32_dpp v34, v34, v34 row_ror:8 row_mask:0xf bank_mask:0xf
    v_add_f32_dpp v35, v35, v35 row_ror:8 row_mask:0xf bank_mask:0xf
    v_add_f32 v10, v10, v11
    v_add_f32_dpp v32, v32, v32 row_ror:4 row_mask:0xf bank_mask:0xf
    v_add_f32_dpp v33, v33, v33 row_ror:4 row_mask:0xf bank_mask:0xf
    v_add_f32_dpp v34, v34, v34 row_ror:4 row_mask:0xf bank_mask:0xf
    v_add_f32_dpp v35, v35, v35 row_ror:4 row_mask:0xf bank_mask:0xf
    v_add_f32_dpp v10, v10, v10 row_ror:8 row_mask:0xf bank_mask:0xf
    v_add_f32_dpp v32, v32, v32 row_ror:2 row_mask:0xf bank_mask:0xf
    v_add_f32_dpp v33, v33, v33 row_ror:2 row_mask:0xf bank_mask:0xf
    v_add_f32_dpp v34, v34, v34 row_ror:2 row_mask:0xf bank_mask:0xf
    v_add_f32_dpp v35, v35, v35 row_ror:2 row_mask:0xf bank_mask:0xf
    v_add_f32_dpp v10, v10, v10 row_ror:4 row_mask:0xf bank_mask:0xf
    v_add_f32_dpp v32, v32, v32 row_ror:1 row_mask:0xf bank_mask:0xf
    v_add_f32_dpp v33, v33, v33 row_ror:1 row_mask:0xf bank_mask:0xf
    v_add_f32_dpp v34, v34, v34 row_ror:1 row_mask:0xf bank_mask:0xf
    v_add_f32_dpp v35, v35, v35 row_ror:1 row_mask:0xf bank_mask:0xf
    v_add_f32_dpp v10, v10, v10 row_ror:2 row_mask:0xf bank_mask:0xf
    s_mov_b32 exec_lo, 0x10001
    s_mov_b32 exec_hi, 0x10001
    ds_write_b128 v4, v[32:35] offset:2688
    s_mov_b64 exec, -1
    v_add_f32_dpp v10, v10, v10 row_ror:1 row_mask:0xf bank_mask:0xf
    s_mov_b32 exec_lo, 0x1
    s_mov_b32 exec_hi, 0x1
    ds_write_b32 v5, v10 offset:2752
    s_mov_b64 exec, -1
    s_cmp_ge_u32 s3, 2
    s_cbranch_scc1 L_nowd_248
    v_lshlrev_b32 v8, 11, v0
    s_lshl_b32 s92, s74, 14
    s_lshl_b32 s93, s66, 5
    s_add_u32 s92, s92, s93
    s_mov_b64 exec, s[80:81]
    buffer_load_dwordx4 v[16:19], v8, s[56:59], s92 offen offset:0
    buffer_load_dwordx4 v[20:23], v8, s[56:59], s92 offen offset:16
    buffer_load_dwordx4 v[24:27], v8, s[56:59], s92 offen offset:1024
    buffer_load_dwordx4 v[28:31], v8, s[56:59], s92 offen offset:1040
    s_mov_b64 exec, -1
L_nowd_248:
    s_lshr_b32 s92, s66, 1
    s_add_u32 s92, s92, s74
    s_lshl_b32 s92, s92, 6
    s_bitcmp1_b32 s66, 0
    s_cselect_b32 s93, 5632, 0
    s_add_u32 s92, s92, s93
    s_add_u32 s92, s92, 176128
    s_add_u32 s92, s92, s72
    s_waitcnt lgkmcnt(0)
    s_barrier
    s_cmp_lg_u32 s3, 0
    s_cbranch_scc1 L_nopub_249
    ds_read_b64 v[36:37], v9 offset:2752
    ds_read_b64 v[38:39], v9 offset:2880
    ds_read_b64 v[40:41], v9 offset:3008
    ds_read_b64 v[42:43], v9 offset:3136
    ds_read_b32 v32, v6 offset:2688
    ds_read_b32 v33, v6 offset:2816
    ds_read_b32 v34, v6 offset:2944
    ds_read_b32 v35, v6 offset:3072
    ds_read_b32 v44, v6 offset:3200
    ds_read_b32 v45, v6 offset:3328
    ds_read_b32 v46, v6 offset:3456
    ds_read_b32 v47, v6 offset:3584
    s_waitcnt lgkmcnt(8)
    v_pk_add_f32 v[36:37], v[36:37], v[38:39]
    v_pk_add_f32 v[40:41], v[40:41], v[42:43]
    v_pk_add_f32 v[12:13], v[36:37], v[40:41]
    v_mul_f32 v12, 0x3b000000, v12
    v_mov_b32 v36, 0x3727c5ac
    v_fmac_f32 v36, 0x3b000000, v13
    v_fma_f32 v13, -v12, v12, v36
    v_max_f32 v13, 0x3727c5ac, v13
    v_rsq_f32 v13, v13
    s_waitcnt lgkmcnt(0)
    v_pk_add_f32 v[32:33], v[32:33], v[34:35]
    v_pk_add_f32 v[44:45], v[44:45], v[46:47]
    v_add_f32 v10, v32, v33
    v_add_f32 v44, v44, v45
    v_fma_f32 v10, -v12, v44, v10
    v_mul_f32 v10, v10, v13
    v_min_u32 v10, -2, v10
    s_mov_b32 exec_lo, 0xffff
    s_mov_b32 exec_hi, 0x0
    s_cmp_eq_u32 s73, 0
    s_cbranch_scc1 L_stg_250
    buffer_store_dword v10, v6, s[36:39], s92 offen
    s_branch L_std_251
L_stg_250:
    buffer_store_dword v10, v6, s[36:39], s92 offen sc1
L_std_251:
    s_mov_b64 exec, -1
L_nopub_249:
L_skipC_242:
    s_lshl_b32 s92, s74, 6
    s_add_u32 s92, s92, s72
    s_add_u32 s92, s92, 176128
    s_add_u32 s93, s92, 5632
    v_and_b32 v8, 0x3f8, v7
    v_mov_b32 v32, 0
    v_mov_b32 v33, 0
    v_mov_b32 v34, 0
    v_mov_b32 v35, 0
    v_mov_b32 v36, 0
    v_mov_b32 v37, 0
    v_mov_b32 v38, 0
    v_mov_b32 v39, 0
    v_mov_b32 v40, 0
    v_mov_b32 v41, 0
    v_mov_b32 v42, 0
    v_mov_b32 v43, 0
    v_mov_b32 v44, 0
    v_mov_b32 v45, 0
    v_mov_b32 v46, 0
    v_mov_b32 v47, 0
    s_mov_b64 exec, s[80:81]
    s_mov_b32 s78, 4194304
    buffer_load_dwordx2 v[10:11], v8, s[36:39], s92 offen sc1
    buffer_load_dwordx2 v[12:13], v8, s[36:39], s93 offen sc1
    s_waitcnt vmcnt(2)
    v_perm_b32 v14, v24, v16, s70
    v_perm_b32 v24, v24, v16, s71
    v_perm_b32 v16, v25, v17, s70
    v_perm_b32 v25, v25, v17, s71
    v_perm_b32 v17, v26, v18, s70
    v_perm_b32 v26, v26, v18, s71
    v_perm_b32 v18, v27, v19, s70
    v_perm_b32 v27, v27, v19, s71
    v_perm_b32 v19, v28, v20, s70
    v_perm_b32 v28, v28, v20, s71
    v_perm_b32 v20, v29, v21, s70
    v_perm_b32 v29, v29, v21, s71
    v_perm_b32 v21, v30, v22, s70
    v_perm_b32 v30, v30, v22, s71
    v_perm_b32 v22, v31, v23, s70
    v_perm_b32 v31, v31, v23, s71
    s_branch L_chk_254
L_poll_252:
    buffer_load_dwordx2 v[10:11], v8, s[36:39], s92 offen sc1
    buffer_load_dwordx2 v[12:13], v8, s[36:39], s93 offen sc1
L_chk_254:
    s_waitcnt vmcnt(0)
    v_max3_u32 v1, v10, v11, v12
    v_max3_u32 v1, v1, v13, v13
    v_cmp_eq_u32 vcc, -1, v1
    s_cbranch_vccz L_got_253
    s_sub_u32 s78, s78, 1
    s_cbranch_scc0 L_poll_252
    s_branch L_exit
L_got_253:
    s_cmp_ge_u32 s3, 2
    s_cbranch_scc1 L_skipD_255
    v_pk_mul_f32 v[10:11], v[10:11], v[12:13]
    v_cvt_pk_bf16_f32 v10, v10, v11
    v_dot2_f32_bf16 v32, v14, v10, 0
    v_dot2_f32_bf16 v33, v24, v10, 0
    v_dot2_f32_bf16 v34, v16, v10, 0
    v_dot2_f32_bf16 v35, v25, v10, 0
    v_dot2_f32_bf16 v36, v17, v10, 0
    v_dot2_f32_bf16 v37, v26, v10, 0
    v_dot2_f32_bf16 v38, v18, v10, 0
    v_dot2_f32_bf16 v39, v27, v10, 0
    v_dot2_f32_bf16 v40, v19, v10, 0
    v_dot2_f32_bf16 v41, v28, v10, 0
    v_dot2_f32_bf16 v42, v20, v10, 0
    v_dot2_f32_bf16 v43, v29, v10, 0
    v_dot2_f32_bf16 v44, v21, v10, 0
    v_dot2_f32_bf16 v45, v30, v10, 0
    v_dot2_f32_bf16 v46, v22, v10, 0
    v_dot2_f32_bf16 v47, v31, v10, 0
    s_mov_b64 exec, -1
    v_permlane32_swap_b32 v32, v40
    v_permlane32_swap_b32 v33, v41
    v_permlane32_swap_b32 v34, v42
    v_permlane32_swap_b32 v35, v43
    v_permlane32_swap_b32 v36, v44
    v_permlane32_swap_b32 v37, v45
    v_permlane32_swap_b32 v38, v46
    v_permlane32_swap_b32 v39, v47
    v_pk_add_f32 v[32:33], v[32:33], v[40:41]
    v_pk_add_f32 v[34:35], v[34:35], v[42:43]
    v_pk_add_f32 v[36:37], v[36:37], v[44:45]
    v_pk_add_f32 v[38:39], v[38:39], v[46:47]
    s_nop 0
    v_permlane16_swap_b32 v32, v36
    v_permlane16_swap_b32 v33, v37
    v_permlane16_swap_b32 v34, v38
    v_permlane16_swap_b32 v35, v39
    v_pk_add_f32 v[32:33], v[32:33], v[36:37]
    v_pk_add_f32 v[34:35], v[34:35], v[38:39]
    s_nop 0
    v_add_f32_dpp v32, v32, v32 row_ror:8 row_mask:0xf bank_mask:0xf
    v_add_f32_dpp v33, v33, v33 row_ror:8 row_mask:0xf bank_mask:0xf
    v_add_f32_dpp v34, v34, v34 row_ror:8 row_mask:0xf bank_mask:0xf
    v_add_f32_dpp v35, v35, v35 row_ror:8 row_mask:0xf bank_mask:0xf
    v_add_f32_dpp v32, v32, v32 row_ror:4 row_mask:0xf bank_mask:0xf
    v_add_f32_dpp v33, v33, v33 row_ror:4 row_mask:0xf bank_mask:0xf
    v_add_f32_dpp v34, v34, v34 row_ror:4 row_mask:0xf bank_mask:0xf
    v_add_f32_dpp v35, v35, v35 row_ror:4 row_mask:0xf bank_mask:0xf
    v_add_f32_dpp v32, v32, v32 row_ror:2 row_mask:0xf bank_mask:0xf
    v_add_f32_dpp v33, v33, v33 row_ror:2 row_mask:0xf bank_mask:0xf
    v_add_f32_dpp v34, v34, v34 row_ror:2 row_mask:0xf bank_mask:0xf
    v_add_f32_dpp v35, v35, v35 row_ror:2 row_mask:0xf bank_mask:0xf
    v_add_f32_dpp v32, v32, v32 row_ror:1 row_mask:0xf bank_mask:0xf
    v_add_f32_dpp v33, v33, v33 row_ror:1 row_mask:0xf bank_mask:0xf
    v_add_f32_dpp v34, v34, v34 row_ror:1 row_mask:0xf bank_mask:0xf
    v_add_f32_dpp v35, v35, v35 row_ror:1 row_mask:0xf bank_mask:0xf
    s_mov_b32 exec_lo, 0x10001
    s_mov_b32 exec_hi, 0x10001
    ds_write_b128 v4, v[32:35] offset:2176
    s_mov_b64 exec, -1
    s_branch L_jd_256
L_skipD_255:
    s_mov_b64 exec, -1
    s_cmp_lg_u32 s72, 0
    s_cbranch_scc1 L_jd_256
    v_lshlrev_b32 v8, 14, v0
    s_lshl_b32 s92, s64, 5
    s_add_u32 s93, s92, 8192
    buffer_load_dwordx4 v[16:19], v8, s[40:43], s92 offen offset:0
    buffer_load_dwordx4 v[20:23], v8, s[40:43], s92 offen offset:16
    buffer_load_dwordx4 v[24:27], v8, s[40:43], s93 offen offset:0
    buffer_load_dwordx4 v[28:31], v8, s[40:43], s93 offen offset:16
L_jd_256:
    s_lshl_b32 s92, s64, 6
    s_add_u32 s92, s92, s72
    s_add_u32 s92, s92, 155648
    s_waitcnt lgkmcnt(0)
    s_barrier
    s_cmp_lg_u32 s3, 0
    s_cbranch_scc1 L_nopub_257
    ds_read_b32 v32, v6 offset:2176
    ds_read_b32 v33, v6 offset:2304
    s_waitcnt lgkmcnt(0)
    v_add_f32 v10, v32, v33
    v_min_u32 v10, -2, v10
    s_mov_b32 exec_lo, 0xffff
    s_mov_b32 exec_hi, 0x0
    buffer_store_dword v10, v6, s[36:39], s92 offen sc1
    s_mov_b64 exec, -1
L_nopub_257:
    s_cmp_eq_u32 s72, 0
    s_cbranch_scc1 L_stage_e
L_final:
    s_cmp_lg_u32 s64, 0
    s_cbranch_scc1 L_exit
    s_add_u32 s84, s72, 155648
    s_add_u32 s85, s72, 159744
    s_add_u32 s86, s72, 163840
    s_add_u32 s87, s72, 167936
    v_lshlrev_b32 v8, 2, v0
    s_waitcnt vmcnt(0)
    s_barrier
    v_lshlrev_b32 v10, 16, v15
    v_and_b32 v11, 0xffff0000, v15
    buffer_load_dwordx2 v[32:33], v7, s[36:39], s84 offen offset:0 sc1
    buffer_load_dwordx2 v[34:35], v7, s[36:39], s84 offen offset:2048 sc1
    buffer_load_dwordx2 v[36:37], v7, s[36:39], s85 offen offset:0 sc1
    buffer_load_dwordx2 v[38:39], v7, s[36:39], s85 offen offset:2048 sc1
    buffer_load_dwordx2 v[40:41], v7, s[36:39], s86 offen offset:0 sc1
    buffer_load_dwordx2 v[42:43], v7, s[36:39], s86 offen offset:2048 sc1
    buffer_load_dwordx2 v[44:45], v7, s[36:39], s87 offen offset:0 sc1
    buffer_load_dwordx2 v[46:47], v7, s[36:39], s87 offen offset:2048 sc1
    s_waitcnt vmcnt(0)
    v_pk_add_f32 v[32:33], v[32:33], v[34:35]
    v_pk_add_f32 v[36:37], v[36:37], v[38:39]
    v_pk_add_f32 v[40:41], v[40:41], v[42:43]
    v_pk_add_f32 v[44:45], v[44:45], v[46:47]
    v_pk_add_f32 v[32:33], v[32:33], v[36:37]
    v_pk_add_f32 v[40:41], v[40:41], v[44:45]
    v_pk_add_f32 v[32:33], v[32:33], v[40:41]
    v_cmp_u_f32 vcc, v32, v33
    s_cbranch_vccz L_fast_258
    s_mov_b32 s78, 4194304
L_poll_259:
    buffer_load_dwordx2 v[32:33], v7, s[36:39], s84 offen offset:0 sc1
    buffer_load_dwordx2 v[34:35], v7, s[36:39], s84 offen offset:2048 sc1
    buffer_load_dwordx2 v[36:37], v7, s[36:39], s85 offen offset:0 sc1
    buffer_load_dwordx2 v[38:39], v7, s[36:39], s85 offen offset:2048 sc1
    buffer_load_dwordx2 v[40:41], v7, s[36:39], s86 offen offset:0 sc1
    buffer_load_dwordx2 v[42:43], v7, s[36:39], s86 offen offset:2048 sc1
    buffer_load_dwordx2 v[44:45], v7, s[36:39], s87 offen offset:0 sc1
    buffer_load_dwordx2 v[46:47], v7, s[36:39], s87 offen offset:2048 sc1
L_chk_261:
    s_waitcnt vmcnt(0)
    v_max3_u32 v12, v32, v33, v34
    v_max3_u32 v12, v12, v35, v36
    v_max3_u32 v12, v12, v37, v38
    v_max3_u32 v12, v12, v39, v40
    v_max3_u32 v12, v12, v41, v42
    v_max3_u32 v12, v12, v43, v44
    v_max3_u32 v12, v12, v45, v46
    v_max3_u32 v12, v12, v47, v47
    v_cmp_eq_u32 vcc, -1, v12
    s_cbranch_vccz L_got_260
    s_sub_u32 s78, s78, 1
    s_cbranch_scc0 L_poll_259
    s_branch L_exit
L_got_260:
    v_pk_add_f32 v[32:33], v[32:33], v[34:35]
    v_pk_add_f32 v[36:37], v[36:37], v[38:39]
    v_pk_add_f32 v[40:41], v[40:41], v[42:43]
    v_pk_add_f32 v[44:45], v[44:45], v[46:47]
    v_pk_add_f32 v[32:33], v[32:33], v[36:37]
    v_pk_add_f32 v[40:41], v[40:41], v[44:45]
    v_pk_add_f32 v[32:33], v[32:33], v[40:41]
L_fast_258:
    v_pk_add_f32 v[32:33], v[32:33], v[10:11]
    v_cvt_pk_bf16_f32 v15, v32, v33
    global_store_dword v8, v15, s[60:61]
L_exit:
L_end:
    s_endpgm
L_stage_e:
    s_barrier
    s_cmp_ge_u32 s3, 2
    s_cbranch_scc1 L_haveq_262
    v_lshlrev_b32 v8, 14, v0
    s_lshl_b32 s92, s64, 5
    s_add_u32 s93, s92, 8192
    buffer_load_dwordx4 v[16:19], v8, s[40:43], s92 offen offset:0
    buffer_load_dwordx4 v[20:23], v8, s[40:43], s92 offen offset:16
    buffer_load_dwordx4 v[24:27], v8, s[40:43], s93 offen offset:0
    buffer_load_dwordx4 v[28:31], v8, s[40:43], s93 offen offset:16
L_haveq_262:
    s_cmp_lt_u32 s66, s75
    s_cbranch_scc1 L_havex1_263
    s_add_u32 s84, s72, 135168
    s_add_u32 s85, s72, 139264
    s_add_u32 s86, s72, 143360
    s_add_u32 s87, s72, 147456
    v_lshlrev_b32 v10, 16, v15
    v_and_b32 v11, 0xffff0000, v15
    buffer_load_dwordx2 v[32:33], v7, s[36:39], s84 offen offset:0 sc1
    buffer_load_dwordx2 v[34:35], v7, s[36:39], s84 offen offset:2048 sc1
    buffer_load_dwordx2 v[36:37], v7, s[36:39], s85 offen offset:0 sc1
    buffer_load_dwordx2 v[38:39], v7, s[36:39], s85 offen offset:2048 sc1
    buffer_load_dwordx2 v[40:41], v7, s[36:39], s86 offen offset:0 sc1
    buffer_load_dwordx2 v[42:43], v7, s[36:39], s86 offen offset:2048 sc1
    buffer_load_dwordx2 v[44:45], v7, s[36:39], s87 offen offset:0 sc1
    buffer_load_dwordx2 v[46:47], v7, s[36:39], s87 offen offset:2048 sc1
    s_waitcnt vmcnt(0)
    v_pk_add_f32 v[32:33], v[32:33], v[34:35]
    v_pk_add_f32 v[36:37], v[36:37], v[38:39]
    v_pk_add_f32 v[40:41], v[40:41], v[42:43]
    v_pk_add_f32 v[44:45], v[44:45], v[46:47]
    v_pk_add_f32 v[32:33], v[32:33], v[36:37]
    v_pk_add_f32 v[40:41], v[40:41], v[44:45]
    v_pk_add_f32 v[32:33], v[32:33], v[40:41]
    v_cmp_u_f32 vcc, v32, v33
    s_cbranch_vccz L_fast_264
    s_mov_b32 s78, 4194304
L_poll_265:
    buffer_load_dwordx2 v[32:33], v7, s[36:39], s84 offen offset:0 sc1
    buffer_load_dwordx2 v[34:35], v7, s[36:39], s84 offen offset:2048 sc1
    buffer_load_dwordx2 v[36:37], v7, s[36:39], s85 offen offset:0 sc1
    buffer_load_dwordx2 v[38:39], v7, s[36:39], s85 offen offset:2048 sc1
    buffer_load_dwordx2 v[40:41], v7, s[36:39], s86 offen offset:0 sc1
    buffer_load_dwordx2 v[42:43], v7, s[36:39], s86 offen offset:2048 sc1
    buffer_load_dwordx2 v[44:45], v7, s[36:39], s87 offen offset:0 sc1
    buffer_load_dwordx2 v[46:47], v7, s[36:39], s87 offen offset:2048 sc1
L_chk_267:
    s_waitcnt vmcnt(0)
    v_max3_u32 v12, v32, v33, v34
    v_max3_u32 v12, v12, v35, v36
    v_max3_u32 v12, v12, v37, v38
    v_max3_u32 v12, v12, v39, v40
    v_max3_u32 v12, v12, v41, v42
    v_max3_u32 v12, v12, v43, v44
    v_max3_u32 v12, v12, v45, v46
    v_max3_u32 v12, v12, v47, v47
    v_cmp_eq_u32 vcc, -1, v12
    s_cbranch_vccz L_got_266
    s_sub_u32 s78, s78, 1
    s_cbranch_scc0 L_poll_265
    s_branch L_exit
L_got_266:
    v_pk_add_f32 v[32:33], v[32:33], v[34:35]
    v_pk_add_f32 v[36:37], v[36:37], v[38:39]
    v_pk_add_f32 v[40:41], v[40:41], v[42:43]
    v_pk_add_f32 v[44:45], v[44:45], v[46:47]
    v_pk_add_f32 v[32:33], v[32:33], v[36:37]
    v_pk_add_f32 v[40:41], v[40:41], v[44:45]
    v_pk_add_f32 v[32:33], v[32:33], v[40:41]
L_fast_264:
    v_pk_add_f32 v[32:33], v[32:33], v[10:11]
    v_cvt_pk_bf16_f32 v15, v32, v33
L_havex1_263:
    s_add_u32 s84, s72, 155648
    s_add_u32 s85, s72, 159744
    s_add_u32 s86, s72, 163840
    s_add_u32 s87, s72, 167936
    s_waitcnt vmcnt(0)
    v_perm_b32 v14, v24, v16, s70
    v_perm_b32 v24, v24, v16, s71
    v_perm_b32 v16, v25, v17, s70
    v_perm_b32 v25, v25, v17, s71
    v_perm_b32 v17, v26, v18, s70
    v_perm_b32 v26, v26, v18, s71
    v_perm_b32 v18, v27, v19, s70
    v_perm_b32 v27, v27, v19, s71
    v_perm_b32 v19, v28, v20, s70
    v_perm_b32 v28, v28, v20, s71
    v_perm_b32 v20, v29, v21, s70
    v_perm_b32 v29, v29, v21, s71
    v_perm_b32 v21, v30, v22, s70
    v_perm_b32 v30, v30, v22, s71
    v_perm_b32 v22, v31, v23, s70
    v_perm_b32 v31, v31, v23, s71
    v_lshlrev_b32 v10, 16, v15
    v_and_b32 v11, 0xffff0000, v15
    buffer_load_dwordx2 v[32:33], v7, s[36:39], s84 offen offset:0 sc1
    buffer_load_dwordx2 v[34:35], v7, s[36:39], s84 offen offset:2048 sc1
    buffer_load_dwordx2 v[36:37], v7, s[36:39], s85 offen offset:0 sc1
    buffer_load_dwordx2 v[38:39], v7, s[36:39], s85 offen offset:2048 sc1
    buffer_load_dwordx2 v[40:41], v7, s[36:39], s86 offen offset:0 sc1
    buffer_load_dwordx2 v[42:43], v7, s[36:39], s86 offen offset:2048 sc1
    buffer_load_dwordx2 v[44:45], v7, s[36:39], s87 offen offset:0 sc1
    buffer_load_dwordx2 v[46:47], v7, s[36:39], s87 offen offset:2048 sc1
    s_waitcnt vmcnt(0)
    v_pk_add_f32 v[32:33], v[32:33], v[34:35]
    v_pk_add_f32 v[36:37], v[36:37], v[38:39]
    v_pk_add_f32 v[40:41], v[40:41], v[42:43]
    v_pk_add_f32 v[44:45], v[44:45], v[46:47]
    v_pk_add_f32 v[32:33], v[32:33], v[36:37]
    v_pk_add_f32 v[40:41], v[40:41], v[44:45]
    v_pk_add_f32 v[32:33], v[32:33], v[40:41]
    v_cmp_u_f32 vcc, v32, v33
    s_cbranch_vccz L_fast_268
    s_mov_b32 s78, 4194304
L_poll_269:
    buffer_load_dwordx2 v[32:33], v7, s[36:39], s84 offen offset:0 sc1
    buffer_load_dwordx2 v[34:35], v7, s[36:39], s84 offen offset:2048 sc1
    buffer_load_dwordx2 v[36:37], v7, s[36:39], s85 offen offset:0 sc1
    buffer_load_dwordx2 v[38:39], v7, s[36:39], s85 offen offset:2048 sc1
    buffer_load_dwordx2 v[40:41], v7, s[36:39], s86 offen offset:0 sc1
    buffer_load_dwordx2 v[42:43], v7, s[36:39], s86 offen offset:2048 sc1
    buffer_load_dwordx2 v[44:45], v7, s[36:39], s87 offen offset:0 sc1
    buffer_load_dwordx2 v[46:47], v7, s[36:39], s87 offen offset:2048 sc1
L_chk_271:
    s_waitcnt vmcnt(0)
    v_max3_u32 v12, v32, v33, v34
    v_max3_u32 v12, v12, v35, v36
    v_max3_u32 v12, v12, v37, v38
    v_max3_u32 v12, v12, v39, v40
    v_max3_u32 v12, v12, v41, v42
    v_max3_u32 v12, v12, v43, v44
    v_max3_u32 v12, v12, v45, v46
    v_max3_u32 v12, v12, v47, v47
    v_cmp_eq_u32 vcc, -1, v12
    s_cbranch_vccz L_got_270
    s_sub_u32 s78, s78, 1
    s_cbranch_scc0 L_poll_269
    s_branch L_exit
L_got_270:
    v_pk_add_f32 v[32:33], v[32:33], v[34:35]
    v_pk_add_f32 v[36:37], v[36:37], v[38:39]
    v_pk_add_f32 v[40:41], v[40:41], v[42:43]
    v_pk_add_f32 v[44:45], v[44:45], v[46:47]
    v_pk_add_f32 v[32:33], v[32:33], v[36:37]
    v_pk_add_f32 v[40:41], v[40:41], v[44:45]
    v_pk_add_f32 v[32:33], v[32:33], v[40:41]
L_fast_268:
    v_pk_add_f32 v[32:33], v[32:33], v[10:11]
    v_cvt_pk_bf16_f32 v15, v32, v33
    v_dot2_f32_bf16 v10, v15, s83, 0
    v_dot2_f32_bf16 v11, v15, v15, 0
    v_dot2_f32_bf16 v32, v14, v15, 0
    v_dot2_f32_bf16 v33, v24, v15, 0
    v_dot2_f32_bf16 v34, v16, v15, 0
    v_dot2_f32_bf16 v35, v25, v15, 0
    v_dot2_f32_bf16 v36, v17, v15, 0
    v_dot2_f32_bf16 v37, v26, v15, 0
    v_dot2_f32_bf16 v38, v18, v15, 0
    v_dot2_f32_bf16 v39, v27, v15, 0
    v_dot2_f32_bf16 v40, v19, v15, 0
    v_dot2_f32_bf16 v41, v28, v15, 0
    v_dot2_f32_bf16 v42, v20, v15, 0
    v_dot2_f32_bf16 v43, v29, v15, 0
    v_dot2_f32_bf16 v44, v21, v15, 0
    v_dot2_f32_bf16 v45, v30, v15, 0
    v_dot2_f32_bf16 v46, v22, v15, 0
    v_dot2_f32_bf16 v47, v31, v15, 0
    v_permlane32_swap_b32 v32, v40
    v_permlane32_swap_b32 v33, v41
    v_permlane32_swap_b32 v34, v42
    v_permlane32_swap_b32 v35, v43
    v_permlane32_swap_b32 v36, v44
    v_permlane32_swap_b32 v37, v45
    v_permlane32_swap_b32 v38, v46
    v_permlane32_swap_b32 v39, v47
    v_permlane32_swap_b32 v10, v11
    v_pk_add_f32 v[32:33], v[32:33], v[40:41]
    v_pk_add_f32 v[34:35], v[34:35], v[42:43]
    v_pk_add_f32 v[36:37], v[36:37], v[44:45]
    v_pk_add_f32 v[38:39], v[38:39], v[46:47]
    v_add_f32 v10, v10, v11
    v_permlane16_swap_b32 v32, v36
    v_permlane16_swap_b32 v33, v37
    v_permlane16_swap_b32 v34, v38
    v_permlane16_swap_b32 v35, v39
    v_mov_b32 v11, v10
    v_pk_add_f32 v[32:33], v[32:33], v[36:37]
    v_pk_add_f32 v[34:35], v[34:35], v[38:39]
    v_permlane16_swap_b32 v10, v11
    v_add_f32_dpp v32, v32, v32 row_ror:8 row_mask:0xf bank_mask:0xf
    v_add_f32_dpp v33, v33, v33 row_ror:8 row_mask:0xf bank_mask:0xf
    v_add_f32_dpp v34, v34, v34 row_ror:8 row_mask:0xf bank_mask:0xf
    v_add_f32_dpp v35, v35, v35 row_ror:8 row_mask:0xf bank_mask:0xf
    v_add_f32 v10, v10, v11
    v_add_f32_dpp v32, v32, v32 row_ror:4 row_mask:0xf bank_mask:0xf
    v_add_f32_dpp v33, v33, v33 row_ror:4 row_mask:0xf bank_mask:0xf
    v_add_f32_dpp v34, v34, v34 row_ror:4 row_mask:0xf bank_mask:0xf
    v_add_f32_dpp v35, v35, v35 row_ror:4 row_mask:0xf bank_mask:0xf
    v_add_f32_dpp v10, v10, v10 row_ror:8 row_mask:0xf bank_mask:0xf
    v_add_f32_dpp v32, v32, v32 row_ror:2 row_mask:0xf bank_mask:0xf
    v_add_f32_dpp v33, v33, v33 row_ror:2 row_mask:0xf bank_mask:0xf
    v_add_f32_dpp v34, v34, v34 row_ror:2 row_mask:0xf bank_mask:0xf
    v_add_f32_dpp v35, v35, v35 row_ror:2 row_mask:0xf bank_mask:0xf
    v_add_f32_dpp v10, v10, v10 row_ror:4 row_mask:0xf bank_mask:0xf
    v_add_f32_dpp v32, v32, v32 row_ror:1 row_mask:0xf bank_mask:0xf
    v_add_f32_dpp v33, v33, v33 row_ror:1 row_mask:0xf bank_mask:0xf
    v_add_f32_dpp v34, v34, v34 row_ror:1 row_mask:0xf bank_mask:0xf
    v_add_f32_dpp v35, v35, v35 row_ror:1 row_mask:0xf bank_mask:0xf
    v_add_f32_dpp v10, v10, v10 row_ror:2 row_mask:0xf bank_mask:0xf
    s_mov_b32 exec_lo, 0x10001
    s_mov_b32 exec_hi, 0x10001
    ds_write_b128 v4, v[32:35] offset:2688
    s_mov_b64 exec, -1
    v_add_f32_dpp v10, v10, v10 row_ror:1 row_mask:0xf bank_mask:0xf
    s_mov_b32 exec_lo, 0x1
    s_mov_b32 exec_hi, 0x1
    ds_write_b32 v5, v10 offset:2752
    s_mov_b64 exec, -1
    s_lshl_b32 s92, s64, 5
    s_add_u32 s92, s92, 188416
    v_lshrrev_b32 v8, 1, v6
    s_waitcnt lgkmcnt(0)
    s_barrier
    s_cmp_lg_u32 s3, 0
    s_cbranch_scc1 L_nopub_272
    ds_read_b64 v[36:37], v9 offset:2752
    ds_read_b64 v[38:39], v9 offset:2880
    ds_read_b64 v[40:41], v9 offset:3008
    ds_read_b64 v[42:43], v9 offset:3136
    ds_read_b32 v32, v6 offset:2688
    ds_read_b32 v33, v6 offset:2816
    ds_read_b32 v34, v6 offset:2944
    ds_read_b32 v35, v6 offset:3072
    ds_read_b32 v44, v6 offset:3264
    ds_read_b32 v45, v6 offset:3392
    ds_read_b32 v46, v6 offset:3520
    ds_read_b32 v47, v6 offset:3648
    s_waitcnt lgkmcnt(8)
    v_pk_add_f32 v[36:37], v[36:37], v[38:39]
    v_pk_add_f32 v[40:41], v[40:41], v[42:43]
    v_pk_add_f32 v[12:13], v[36:37], v[40:41]
    v_mul_f32 v12, 0x3b000000, v12
    v_mov_b32 v36, 0x3727c5ac
    v_fmac_f32 v36, 0x3b000000, v13
    v_fma_f32 v13, -v12, v12, v36
    v_max_f32 v13, 0x3727c5ac, v13
    v_rsq_f32 v13, v13
    s_waitcnt lgkmcnt(0)
    v_pk_add_f32 v[32:33], v[32:33], v[34:35]
    v_pk_add_f32 v[44:45], v[44:45], v[46:47]
    v_add_f32 v10, v32, v33
    v_add_f32 v44, v44, v45
    v_fma_f32 v10, -v12, v44, v10
    v_mul_f32 v10, v10, v13
    v_mul_f32 v10, 0x57800000, v10
    s_nop 1
    v_mov_b32_dpp v11, v10 quad_perm:[1,0,3,2] row_mask:0xf bank_mask:0xf
    v_cvt_pk_bf16_f32 v10, v10, v11
    v_min_u32 v10, -2, v10
    s_mov_b32 exec_lo, 0x5555
    s_mov_b32 exec_hi, 0x0
    s_cmp_eq_u32 s73, 0
    s_cbranch_scc1 L_stg_273
    buffer_store_dword v10, v8, s[36:39], s92 offen
    s_branch L_std_274
L_stg_273:
    buffer_store_dword v10, v8, s[36:39], s92 offen sc1
L_std_274:
    s_mov_b64 exec, -1
L_nopub_272:
    v_and_b32 v47, 48, v0
    v_and_b32 v45, 1, v0
    v_lshl_add_u32 v47, v45, 6, v47
    s_lshr_b32 s94, s64, 3
    s_lshl_b32 s94, s94, 8
    s_add_u32 s94, s94, 188416
    s_mov_b32 s78, 4194304
    buffer_load_dwordx4 v[16:19], v47, s[36:39], s94 offen offset:0 sc1
    buffer_load_dwordx4 v[20:23], v47, s[36:39], s94 offen offset:128 sc1
    v_and_b32 v32, 63, v0
    v_and_b32 v33, 48, v32
    v_and_b32 v34, 15, v32
    v_lshlrev_b32 v2, 5, v33
    v_lshl_add_u32 v2, v34, 4, v2
    v_lshrrev_b32 v35, 1, v34
    v_lshl_add_u32 v1, v35, 8, v47
    s_mul_i32 s93, s3, 39936
    s_add_u32 s93, s93, 4096
    v_lshl_add_u32 v3, v32, 4, s93
    v_and_b32 v35, 2, v34
    v_cmp_eq_u32 vcc, 2, v35
    v_mov_b32 v36, 0xffff
    v_mov_b32 v37, 0xffff0000
    v_cndmask_b32 v36, v36, v37, vcc
    v_and_b32 v35, 13, v34
    v_cmp_eq_u32 vcc, 0, v35
    s_nop 1
    v_cndmask_b32 v4, 0, v36, vcc
    v_cmp_eq_u32 vcc, 4, v35
    s_nop 1
    v_cndmask_b32 v5, 0, v36, vcc
    v_cmp_eq_u32 vcc, 8, v35
    s_nop 1
    v_cndmask_b32 v6, 0, v36, vcc
    v_cmp_eq_u32 vcc, 12, v35
    s_nop 1
    v_cndmask_b32 v7, 0, v36, vcc
    v_mov_b32 v8, 0
    v_mov_b32 v9, 0
    v_mov_b32 v10, 0
    v_mov_b32 v11, 0
    v_mov_b32 v12, 0
    v_mov_b32 v13, 0xff800000
    v_mov_b32 v14, 0xff800000
    s_lshl_b32 s0, s65, 8
    s_add_u32 s0, s0, 589824
    s_lshl_b32 s93, s64, 3
    s_lshl_b32 s92, s3, 1
    s_add_u32 s93, s93, s92
    s_add_u32 s93, s93, 589824
    s_and_b32 s92, s3, 1
    s_cmp_lt_u32 s92, s2
    s_cselect_b32 s1, s93, 0x7ffffff0
    s_mov_b32 s100, 1
    s_mov_b32 s84, 0x6040200
    s_mov_b32 s85, 0x7050301
    s_mov_b32 s86, 0x5010400
    s_mov_b32 s87, 0x7030602
    s_mov_b32 s88, 0x80808080
    s_mov_b32 s89, 0xf0f0f0f
    s_sub_u32 s69, s69, 402653184
    s_and_b32 s92, s62, 0xff00
    s_lshl_b32 s92, s92, 16
    s_add_u32 s83, s69, s92
    s_and_b32 s92, s63, 0xff00
    s_lshl_b32 s93, s92, 16
    s_add_u32 s71, s93, 0x3f800000
    s_branch L_chk_277
L_poll_275:
    buffer_load_dwordx4 v[16:19], v47, s[36:39], s94 offen offset:0 sc1
    buffer_load_dwordx4 v[20:23], v47, s[36:39], s94 offen offset:128 sc1
L_chk_277:
    s_waitcnt vmcnt(0)
    v_max3_u32 v45, v16, v17, v18
    v_max3_u32 v45, v45, v19, v20
    v_max3_u32 v45, v45, v21, v22
    v_max3_u32 v45, v45, v23, v23
    v_cmp_eq_u32 vcc, -1, v45
    s_cbranch_vccz L_got_276
    s_sub_u32 s78, s78, 1
    s_cbranch_scc0 L_poll_275
    s_branch L_exit
L_got_276:
    s_mov_b32 s72, 262144
    v_mfma_f32_16x16x32_bf16 v[24:27], v[48:51], v[16:19], 0
    v_mfma_f32_16x16x32_bf16 v[28:31], v[56:59], v[16:19], 0
    v_mfma_f32_16x16x32_bf16 v[24:27], v[52:55], v[20:23], v[24:27]
    v_mfma_f32_16x16x32_bf16 v[28:31], v[60:63], v[20:23], v[28:31]
    s_add_u32 s68, s67, 7864320
    s_xor_b32 s78, s68, s67
    s_and_b32 s78, s78, 0xff800000
    s_xor_b32 s68, s68, s78
    buffer_load_dwordx4 v[48:51], v1, s[28:31], s68 offen offset:0 nt
    buffer_load_dwordx4 v[52:55], v1, s[28:31], s68 offen offset:128 nt
    buffer_load_dwordx4 v[56:59], v1, s[28:31], s68 offen offset:2048 nt
    buffer_load_dwordx4 v[60:63], v1, s[28:31], s68 offen offset:2176 nt
    s_call_b64 s[76:77], L_score0
    s_nop 0
    v_mfma_f32_16x16x32_bf16 v[8:11], v[36:39], v[64:67], v[8:11]
    v_and_b32 v36, v34, v4
    v_and_b32 v37, v34, v5
    v_and_b32 v38, v34, v6
    v_and_b32 v39, v34, v7
    v_mfma_f32_16x16x32_bf16 v[8:11], v[40:43], v[68:71], v[8:11]
    v_and_b32 v40, v35, v4
    v_and_b32 v41, v35, v5
    v_and_b32 v42, v35, v6
    v_and_b32 v43, v35, v7
    v_mfma_f32_16x16x32_bf16 v[8:11], v[36:39], v[72:75], v[8:11]
    s_nop 0
    v_mfma_f32_16x16x32_bf16 v[8:11], v[40:43], v[76:79], v[8:11]
    buffer_load_dwordx4 v[64:67], v2, s[32:35], s68 offen offset:0 nt
    s_waitcnt vmcnt(4)
    buffer_load_dwordx4 v[68:71], v2, s[32:35], s68 offen offset:256 nt
    s_waitcnt vmcnt(4)
    buffer_load_dwordx4 v[72:75], v2, s[32:35], s68 offen offset:2048 nt
    s_waitcnt vmcnt(4)
    buffer_load_dwordx4 v[76:79], v2, s[32:35], s68 offen offset:2304 nt
    v_mfma_f32_16x16x32_bf16 v[24:27], v[80:83], v[16:19], 0
    v_mfma_f32_16x16x32_bf16 v[28:31], v[88:91], v[16:19], 0
    v_mfma_f32_16x16x32_bf16 v[24:27], v[84:87], v[20:23], v[24:27]
    v_mfma_f32_16x16x32_bf16 v[28:31], v[92:95], v[20:23], v[28:31]
    s_add_u32 s79, s67, 7733248
    s_xor_b32 s78, s79, s67
    s_and_b32 s78, s78, 0xff800000
    s_xor_b32 s79, s79, s78
    s_waitcnt vmcnt(4)
    buffer_load_dwordx4 v[80:83], v1, s[28:31], s79 offen offset:0 nt
    s_waitcnt vmcnt(4)
    buffer_load_dwordx4 v[84:87], v1, s[28:31], s79 offen offset:128 nt
    s_waitcnt vmcnt(4)
    buffer_load_dwordx4 v[88:91], v1, s[28:31], s79 offen offset:2048 nt
    s_waitcnt vmcnt(4)
    buffer_load_dwordx4 v[92:95], v1, s[28:31], s79 offen offset:2176 nt
    s_call_b64 s[76:77], L_score0
    s_nop 0
    v_mfma_f32_16x16x32_bf16 v[8:11], v[36:39], v[96:99], v[8:11]
    v_and_b32 v36, v34, v4
    v_and_b32 v37, v34, v5
    v_and_b32 v38, v34, v6
    v_and_b32 v39, v34, v7
    v_mfma_f32_16x16x32_bf16 v[8:11], v[40:43], v[100:103], v[8:11]
    v_and_b32 v40, v35, v4
    v_and_b32 v41, v35, v5
    v_and_b32 v42, v35, v6
    v_and_b32 v43, v35, v7
    v_mfma_f32_16x16x32_bf16 v[8:11], v[36:39], v[104:107], v[8:11]
    s_nop 0
    v_mfma_f32_16x16x32_bf16 v[8:11], v[40:43], v[108:111], v[8:11]
    s_waitcnt vmcnt(4)
    buffer_load_dwordx4 v[96:99], v2, s[32:35], s79 offen offset:0 nt
    s_waitcnt vmcnt(4)
    buffer_load_dwordx4 v[100:103], v2, s[32:35], s79 offen offset:256 nt
    s_waitcnt vmcnt(4)
    buffer_load_dwordx4 v[104:107], v2, s[32:35], s79 offen offset:2048 nt
    s_waitcnt vmcnt(4)
    buffer_load_dwordx4 v[108:111], v2, s[32:35], s79 offen offset:2304 nt
    v_mfma_f32_16x16x32_bf16 v[24:27], v[112:115], v[16:19], 0
    v_mfma_f32_16x16x32_bf16 v[28:31], v[120:123], v[16:19], 0
    v_mfma_f32_16x16x32_bf16 v[24:27], v[116:119], v[20:23], v[24:27]
    v_mfma_f32_16x16x32_bf16 v[28:31], v[124:127], v[20:23], v[28:31]
    s_add_u32 s68, s67, 7602176
    s_xor_b32 s78, s68, s67
    s_and_b32 s78, s78, 0xff800000
    s_xor_b32 s68, s68, s78
    s_waitcnt vmcnt(4)
    buffer_load_dwordx4 v[112:115], v1, s[28:31], s68 offen offset:0 nt
    s_waitcnt vmcnt(4)
    buffer_load_dwordx4 v[116:119], v1, s[28:31], s68 offen offset:128 nt
    s_waitcnt vmcnt(4)
    buffer_load_dwordx4 v[120:123], v1, s[28:31], s68 offen offset:2048 nt
    s_waitcnt vmcnt(4)
    buffer_load_dwordx4 v[124:127], v1, s[28:31], s68 offen offset:2176 nt
    s_call_b64 s[76:77], L_score0
    s_nop 0
    v_mfma_f32_16x16x32_bf16 v[8:11], v[36:39], v[128:131], v[8:11]
    v_and_b32 v36, v34, v4
    v_and_b32 v37, v34, v5
    v_and_b32 v38, v34, v6
    v_and_b32 v39, v34, v7
    v_mfma_f32_16x16x32_bf16 v[8:11], v[40:43], v[132:135], v[8:11]
    v_and_b32 v40, v35, v4
    v_and_b32 v41, v35, v5
    v_and_b32 v42, v35, v6
    v_and_b32 v43, v35, v7
    v_mfma_f32_16x16x32_bf16 v[8:11], v[36:39], v[136:139], v[8:11]
    s_nop 0
    v_mfma_f32_16x16x32_bf16 v[8:11], v[40:43], v[140:143], v[8:11]
    s_waitcnt vmcnt(4)
    buffer_load_dwordx4 v[128:131], v2, s[32:35], s68 offen offset:0 nt
    s_waitcnt vmcnt(4)
    buffer_load_dwordx4 v[132:135], v2, s[32:35], s68 offen offset:256 nt
    s_waitcnt vmcnt(4)
    buffer_load_dwordx4 v[136:139], v2, s[32:35], s68 offen offset:2048 nt
    s_waitcnt vmcnt(4)
    buffer_load_dwordx4 v[140:143], v2, s[32:35], s68 offen offset:2304 nt
    s_waitcnt vmcnt(20)
    v_mfma_f32_16x16x32_bf16 v[24:27], v[48:51], v[16:19], 0
    v_mfma_f32_16x16x32_bf16 v[28:31], v[56:59], v[16:19], 0
    v_mfma_f32_16x16x32_bf16 v[24:27], v[52:55], v[20:23], v[24:27]
    v_mfma_f32_16x16x32_bf16 v[28:31], v[60:63], v[20:23], v[28:31]
    s_call_b64 s[76:77], L_score0
    s_waitcnt vmcnt(16)
    v_mfma_f32_16x16x32_bf16 v[8:11], v[36:39], v[64:67], v[8:11]
    v_and_b32 v36, v34, v4
    v_and_b32 v37, v34, v5
    v_and_b32 v38, v34, v6
    v_and_b32 v39, v34, v7
    v_mfma_f32_16x16x32_bf16 v[8:11], v[40:43], v[68:71], v[8:11]
    v_and_b32 v40, v35, v4
    v_and_b32 v41, v35, v5
    v_and_b32 v42, v35, v6
    v_and_b32 v43, v35, v7
    v_mfma_f32_16x16x32_bf16 v[8:11], v[36:39], v[72:75], v[8:11]
    s_nop 0
    v_mfma_f32_16x16x32_bf16 v[8:11], v[40:43], v[76:79], v[8:11]
    s_add_u32 s79, s67, 7471104
    s_xor_b32 s78, s79, s67
    s_and_b32 s78, s78, 0xff800000
    s_xor_b32 s79, s79, s78
    s_waitcnt vmcnt(4)
    buffer_load_dwordx4 v[48:51], v1, s[28:31], s79 offen offset:0 nt
    s_waitcnt vmcnt(4)
    buffer_load_dwordx4 v[52:55], v1, s[28:31], s79 offen offset:128 nt
    s_waitcnt vmcnt(4)
    buffer_load_dwordx4 v[56:59], v1, s[28:31], s79 offen offset:2048 nt
    s_waitcnt vmcnt(4)
    buffer_load_dwordx4 v[60:63], v1, s[28:31], s79 offen offset:2176 nt
    s_waitcnt vmcnt(16)
    v_mfma_f32_16x16x32_bf16 v[24:27], v[80:83], v[16:19], 0
    v_mfma_f32_16x16x32_bf16 v[28:31], v[88:91], v[16:19], 0
    v_mfma_f32_16x16x32_bf16 v[24:27], v[84:87], v[20:23], v[24:27]
    v_mfma_f32_16x16x32_bf16 v[28:31], v[92:95], v[20:23], v[28:31]
    s_waitcnt vmcnt(4)
    buffer_load_dwordx4 v[64:67], v2, s[32:35], s79 offen offset:0 nt
    s_waitcnt vmcnt(4)
    buffer_load_dwordx4 v[68:71], v2, s[32:35], s79 offen offset:256 nt
    s_waitcnt vmcnt(4)
    buffer_load_dwordx4 v[72:75], v2, s[32:35], s79 offen offset:2048 nt
    s_waitcnt vmcnt(4)
    buffer_load_dwordx4 v[76:79], v2, s[32:35], s79 offen offset:2304 nt
    s_call_b64 s[76:77], L_score0
    s_waitcnt vmcnt(16)
    v_mfma_f32_16x16x32_bf16 v[8:11], v[36:39], v[96:99], v[8:11]
    v_and_b32 v36, v34, v4
    v_and_b32 v37, v34, v5
    v_and_b32 v38, v34, v6
    v_and_b32 v39, v34, v7
    v_mfma_f32_16x16x32_bf16 v[8:11], v[40:43], v[100:103], v[8:11]
    v_and_b32 v40, v35, v4
    v_and_b32 v41, v35, v5
    v_and_b32 v42, v35, v6
    v_and_b32 v43, v35, v7
    v_mfma_f32_16x16x32_bf16 v[8:11], v[36:39], v[104:107], v[8:11]
    s_nop 0
    v_mfma_f32_16x16x32_bf16 v[8:11], v[40:43], v[108:111], v[8:11]
    s_bitcmp1_b32 s64, 3
    s_cselect_b32 s78, 131072, 0
    s_add_u32 s68, s67, 0
    s_add_u32 s68, s68, s78
    s_xor_b32 s78, s68, s67
    s_and_b32 s78, s78, 0xff800000
    s_xor_b32 s68, s68, s78
    s_waitcnt vmcnt(4)
    buffer_load_dwordx4 v[80:83], v1, s[28:31], s68 offen offset:0 nt
    s_waitcnt vmcnt(4)
    buffer_load_dwordx4 v[84:87], v1, s[28:31], s68 offen offset:128 nt
    s_waitcnt vmcnt(4)
    buffer_load_dwordx4 v[88:91], v1, s[28:31], s68 offen offset:2048 nt
    s_waitcnt vmcnt(4)
    buffer_load_dwordx4 v[92:95], v1, s[28:31], s68 offen offset:2176 nt
    s_waitcnt vmcnt(16)
    v_mfma_f32_16x16x32_bf16 v[24:27], v[112:115], v[16:19], 0
    v_mfma_f32_16x16x32_bf16 v[28:31], v[120:123], v[16:19], 0
    v_mfma_f32_16x16x32_bf16 v[24:27], v[116:119], v[20:23], v[24:27]
    v_mfma_f32_16x16x32_bf16 v[28:31], v[124:127], v[20:23], v[28:31]
    s_waitcnt vmcnt(4)
    buffer_load_dwordx4 v[96:99], v2, s[32:35], s68 offen offset:0 nt
    s_waitcnt vmcnt(4)
    buffer_load_dwordx4 v[100:103], v2, s[32:35], s68 offen offset:256 nt
    s_waitcnt vmcnt(4)
    buffer_load_dwordx4 v[104:107], v2, s[32:35], s68 offen offset:2048 nt
    s_waitcnt vmcnt(4)
    buffer_load_dwordx4 v[108:111], v2, s[32:35], s68 offen offset:2304 nt
    s_call_b64 s[76:77], L_score0
    s_waitcnt vmcnt(16)
    v_mfma_f32_16x16x32_bf16 v[8:11], v[36:39], v[128:131], v[8:11]
    v_and_b32 v36, v34, v4
    v_and_b32 v37, v34, v5
    v_and_b32 v38, v34, v6
    v_and_b32 v39, v34, v7
    v_mfma_f32_16x16x32_bf16 v[8:11], v[40:43], v[132:135], v[8:11]
    v_and_b32 v40, v35, v4
    v_and_b32 v41, v35, v5
    v_and_b32 v42, v35, v6
    v_and_b32 v43, v35, v7
    v_mfma_f32_16x16x32_bf16 v[8:11], v[36:39], v[136:139], v[8:11]
    s_nop 0
    v_mfma_f32_16x16x32_bf16 v[8:11], v[40:43], v[140:143], v[8:11]
    s_bitcmp1_b32 s64, 3
    s_cselect_b32 s78, -131072, 0
    s_add_u32 s79, s67, 131072
    s_add_u32 s79, s79, s78
    s_xor_b32 s78, s79, s67
    s_and_b32 s78, s78, 0xff800000
    s_xor_b32 s79, s79, s78
    s_waitcnt vmcnt(4)
    buffer_load_dwordx4 v[112:115], v1, s[28:31], s79 offen offset:0 nt
    s_waitcnt vmcnt(4)
    buffer_load_dwordx4 v[116:119], v1, s[28:31], s79 offen offset:128 nt
    s_waitcnt vmcnt(14)
    v_mfma_f32_16x16x32_bf16 v[24:27], v[48:51], v[16:19], 0
    v_mfma_f32_16x16x32_bf16 v[28:31], v[56:59], v[16:19], 0
    v_mfma_f32_16x16x32_bf16 v[24:27], v[52:55], v[20:23], v[24:27]
    v_mfma_f32_16x16x32_bf16 v[28:31], v[60:63], v[20:23], v[28:31]
    s_waitcnt vmcnt(4)
    buffer_load_dwordx4 v[120:123], v1, s[28:31], s79 offen offset:2048 nt
    s_waitcnt vmcnt(4)
    buffer_load_dwordx4 v[124:127], v1, s[28:31], s79 offen offset:2176 nt
    s_call_b64 s[76:77], L_score0
    s_waitcnt vmcnt(12)
    v_mfma_f32_16x16x32_bf16 v[8:11], v[36:39], v[64:67], v[8:11]
    v_and_b32 v36, v34, v4
    v_and_b32 v37, v34, v5
    v_and_b32 v38, v34, v6
    v_and_b32 v39, v34, v7
    v_mfma_f32_16x16x32_bf16 v[8:11], v[40:43], v[68:71], v[8:11]
    v_and_b32 v40, v35, v4
    v_and_b32 v41, v35, v5
    v_and_b32 v42, v35, v6
    v_and_b32 v43, v35, v7
    v_mfma_f32_16x16x32_bf16 v[8:11], v[36:39], v[72:75], v[8:11]
    s_nop 0
    v_mfma_f32_16x16x32_bf16 v[8:11], v[40:43], v[76:79], v[8:11]
    s_waitcnt vmcnt(4)
    buffer_load_dwordx4 v[128:131], v2, s[32:35], s79 offen offset:0 nt
    s_bitcmp0_b32 s82, 0
    s_cselect_b32 s91, s83, s69
    s_cselect_b32 s95, s71, 1.0
    s_bitcmp0_b32 s82, 0
    s_cbranch_scc1 L_upk_282
    s_add_u32 s92, s67, 3407872
    s_xor_b32 s78, s92, s67
    s_and_b32 s78, s78, 0xff800000
    s_xor_b32 s92, s92, s78
    s_call_b64 s[76:77], L_reload0
    s_branch L_upe_283
L_upk_282:
    v_mov_b32 v40, v144
    v_mov_b32 v41, v145
    v_mov_b32 v42, v146
    v_mov_b32 v43, v147
    v_mov_b32 v44, v148
    v_mov_b32 v45, v149
    v_mov_b32 v46, v150
    v_mov_b32 v47, v151
    v_mov_b32 v32, v152
    v_mov_b32 v33, v153
    v_mov_b32 v34, v154
    v_mov_b32 v35, v155
    v_mov_b32 v36, v156
    s_call_b64 s[76:77], L_unpack32
L_upe_283:
    s_waitcnt vmcnt(4)
    buffer_load_dwordx4 v[132:135], v2, s[32:35], s79 offen offset:256 nt
    v_mfma_f32_16x16x32_bf16 v[24:27], v[32:35], v[16:19], 0
    v_mfma_f32_16x16x32_bf16 v[28:31], v[40:43], v[16:19], 0
    v_mfma_f32_16x16x32_bf16 v[24:27], v[36:39], v[20:23], v[24:27]
    v_mfma_f32_16x16x32_bf16 v[28:31], v[44:47], v[20:23], v[28:31]
    s_nop 6
    v_add_f32_dpp v32, v25, v24 quad_perm:[1,0,3,2] row_mask:0xf bank_mask:0xf
    v_add_f32_dpp v33, v27, v26 quad_perm:[1,0,3,2] row_mask:0xf bank_mask:0xf
    v_add_f32_dpp v34, v29, v28 quad_perm:[1,0,3,2] row_mask:0xf bank_mask:0xf
    v_add_f32_dpp v35, v31, v30 quad_perm:[1,0,3,2] row_mask:0xf bank_mask:0xf
    v_max3_f32 v36, v32, v33, v34
    v_max_f32 v36, v36, v35
    v_mul_f32 v36, s91, v36
    v_cmp_gt_f32 vcc, v36, v13
    s_waitcnt vmcnt(4)
    buffer_load_dwordx4 v[136:139], v2, s[32:35], s79 offen offset:2048 nt
    s_bitcmp0_b32 s82, 0
    s_cbranch_scc1 L_upk_284
    s_add_u32 s92, s67, 3407872
    s_xor_b32 s78, s92, s67
    s_and_b32 s78, s78, 0xff800000
    s_xor_b32 s92, s92, s78
    s_call_b64 s[76:77], L_reload1
    s_branch L_upe_285
L_upk_284:
    v_mov_b32 v152, v160
    v_mov_b32 v153, v161
    v_mov_b32 v154, v162
    v_mov_b32 v155, v163
    v_mov_b32 v156, v164
    v_mov_b32 v157, v165
    v_mov_b32 v158, v166
    v_mov_b32 v159, v167
    v_mov_b32 v144, v168
    v_mov_b32 v145, v169
    v_mov_b32 v146, v170
    v_mov_b32 v147, v171
    v_mov_b32 v148, v172
    s_call_b64 s[76:77], L_unpack144
L_upe_285:
    s_waitcnt vmcnt(4)
    buffer_load_dwordx4 v[140:143], v2, s[32:35], s79 offen offset:2304 nt
    s_call_b64 s[76:77], L_soft1
    v_mfma_f32_16x16x32_bf16 v[8:11], v[36:39], v[144:147], v[8:11]
    v_and_b32 v36, v34, v4
    v_and_b32 v37, v34, v5
    v_and_b32 v38, v34, v6
    v_and_b32 v39, v34, v7
    v_mfma_f32_16x16x32_bf16 v[8:11], v[40:43], v[148:151], v[8:11]
    v_and_b32 v40, v35, v4
    v_and_b32 v41, v35, v5
    v_and_b32 v42, v35, v6
    v_and_b32 v43, v35, v7
    v_mfma_f32_16x16x32_bf16 v[8:11], v[36:39], v[152:155], v[8:11]
    s_nop 0
    v_mfma_f32_16x16x32_bf16 v[8:11], v[40:43], v[156:159], v[8:11]
    s_bitcmp1_b32 s64, 3
    s_cselect_b32 s78, 131072, 0
    s_add_u32 s68, s67, 262144
    s_add_u32 s68, s68, s78
    s_xor_b32 s78, s68, s67
    s_and_b32 s78, s78, 0xff800000
    s_xor_b32 s68, s68, s78
    s_waitcnt vmcnt(4)
    buffer_load_dwordx4 v[48:51], v1, s[28:31], s68 offen offset:0 nt
    s_waitcnt vmcnt(4)
    buffer_load_dwordx4 v[52:55], v1, s[28:31], s68 offen offset:128 nt
    s_waitcnt vmcnt(14)
    v_mfma_f32_16x16x32_bf16 v[24:27], v[80:83], v[16:19], 0
    v_mfma_f32_16x16x32_bf16 v[28:31], v[88:91], v[16:19], 0
    v_mfma_f32_16x16x32_bf16 v[24:27], v[84:87], v[20:23], v[24:27]
    v_mfma_f32_16x16x32_bf16 v[28:31], v[92:95], v[20:23], v[28:31]
    s_waitcnt vmcnt(4)
    buffer_load_dwordx4 v[56:59], v1, s[28:31], s68 offen offset:2048 nt
    s_waitcnt vmcnt(4)
    buffer_load_dwordx4 v[60:63], v1, s[28:31], s68 offen offset:2176 nt
    s_call_b64 s[76:77], L_score0
    s_waitcnt vmcnt(12)
    v_mfma_f32_16x16x32_bf16 v[8:11], v[36:39], v[96:99], v[8:11]
    v_and_b32 v36, v34, v4
    v_and_b32 v37, v34, v5
    v_and_b32 v38, v34, v6
    v_and_b32 v39, v34, v7
    v_mfma_f32_16x16x32_bf16 v[8:11], v[40:43], v[100:103], v[8:11]
    v_and_b32 v40, v35, v4
    v_and_b32 v41, v35, v5
    v_and_b32 v42, v35, v6
    v_and_b32 v43, v35, v7
    v_mfma_f32_16x16x32_bf16 v[8:11], v[36:39], v[104:107], v[8:11]
    s_nop 0
    v_mfma_f32_16x16x32_bf16 v[8:11], v[40:43], v[108:111], v[8:11]
    s_waitcnt vmcnt(4)
    buffer_load_dwordx4 v[64:67], v2, s[32:35], s68 offen offset:0 nt
    s_bitcmp0_b32 s82, 1
    s_cselect_b32 s91, s83, s69
    s_cselect_b32 s95, s71, 1.0
    s_bitcmp0_b32 s82, 1
    s_cbranch_scc1 L_upk_288
    s_add_u32 s92, s67, 3670016
    s_xor_b32 s78, s92, s67
    s_and_b32 s78, s78, 0xff800000
    s_xor_b32 s92, s92, s78
    s_call_b64 s[76:77], L_reload0
    s_branch L_upe_289
L_upk_288:
    v_and_b32 v24, 63, v0
    v_mul_u32_u24 v24, 12, v24
    v_sub_u32 v24, v3, v24
    ds_read_b128 v[32:35], v3 offset:2048
    ds_read_b32 v36, v24 offset:3072
    ds_read_b128 v[40:43], v3 offset:0
    ds_read_b128 v[44:47], v3 offset:1024
    s_waitcnt lgkmcnt(0)
    s_call_b64 s[76:77], L_unpack32
L_upe_289:
    s_waitcnt vmcnt(4)
    buffer_load_dwordx4 v[68:71], v2, s[32:35], s68 offen offset:256 nt
    v_mfma_f32_16x16x32_bf16 v[24:27], v[32:35], v[16:19], 0
    v_mfma_f32_16x16x32_bf16 v[28:31], v[40:43], v[16:19], 0
    v_mfma_f32_16x16x32_bf16 v[24:27], v[36:39], v[20:23], v[24:27]
    v_mfma_f32_16x16x32_bf16 v[28:31], v[44:47], v[20:23], v[28:31]
    s_nop 6
    v_add_f32_dpp v32, v25, v24 quad_perm:[1,0,3,2] row_mask:0xf bank_mask:0xf
    v_add_f32_dpp v33, v27, v26 quad_perm:[1,0,3,2] row_mask:0xf bank_mask:0xf
    v_add_f32_dpp v34, v29, v28 quad_perm:[1,0,3,2] row_mask:0xf bank_mask:0xf
    v_add_f32_dpp v35, v31, v30 quad_perm:[1,0,3,2] row_mask:0xf bank_mask:0xf
    v_max3_f32 v36, v32, v33, v34
    v_max_f32 v36, v36, v35
    v_mul_f32 v36, s91, v36
    v_cmp_gt_f32 vcc, v36, v13
    s_waitcnt vmcnt(4)
    buffer_load_dwordx4 v[72:75], v2, s[32:35], s68 offen offset:2048 nt
    s_bitcmp0_b32 s82, 1
    s_cbranch_scc1 L_upk_290
    s_add_u32 s92, s67, 3670016
    s_xor_b32 s78, s92, s67
    s_and_b32 s78, s78, 0xff800000
    s_xor_b32 s92, s92, s78
    s_call_b64 s[76:77], L_reload1
    s_branch L_upe_291
L_upk_290:
    v_and_b32 v24, 63, v0
    v_mul_u32_u24 v24, 12, v24
    v_sub_u32 v24, v3, v24
    ds_read_b128 v[144:147], v3 offset:5376
    ds_read_b32 v148, v24 offset:6400
    ds_read_b128 v[152:155], v3 offset:3328
    ds_read_b128 v[156:159], v3 offset:4352
    s_waitcnt lgkmcnt(0)
    s_call_b64 s[76:77], L_unpack144
L_upe_291:
    s_waitcnt vmcnt(4)
    buffer_load_dwordx4 v[76:79], v2, s[32:35], s68 offen offset:2304 nt
    s_call_b64 s[76:77], L_soft1
    v_mfma_f32_16x16x32_bf16 v[8:11], v[36:39], v[144:147], v[8:11]
    v_and_b32 v36, v34, v4
    v_and_b32 v37, v34, v5
    v_and_b32 v38, v34, v6
    v_and_b32 v39, v34, v7
    v_mfma_f32_16x16x32_bf16 v[8:11], v[40:43], v[148:151], v[8:11]
    v_and_b32 v40, v35, v4
    v_and_b32 v41, v35, v5
    v_and_b32 v42, v35, v6
    v_and_b32 v43, v35, v7
    v_mfma_f32_16x16x32_bf16 v[8:11], v[36:39], v[152:155], v[8:11]
    s_nop 0
    v_mfma_f32_16x16x32_bf16 v[8:11], v[40:43], v[156:159], v[8:11]
    s_bitcmp1_b32 s64, 3
    s_cselect_b32 s78, -131072, 0
    s_add_u32 s79, s67, 393216
    s_add_u32 s79, s79, s78
    s_xor_b32 s78, s79, s67
    s_and_b32 s78, s78, 0xff800000
    s_xor_b32 s79, s79, s78
    s_waitcnt vmcnt(4)
    buffer_load_dwordx4 v[80:83], v1, s[28:31], s79 offen offset:0 nt
    s_waitcnt vmcnt(4)
    buffer_load_dwordx4 v[84:87], v1, s[28:31], s79 offen offset:128 nt
    s_waitcnt vmcnt(14)
    v_mfma_f32_16x16x32_bf16 v[24:27], v[112:115], v[16:19], 0
    v_mfma_f32_16x16x32_bf16 v[28:31], v[120:123], v[16:19], 0
    v_mfma_f32_16x16x32_bf16 v[24:27], v[116:119], v[20:23], v[24:27]
    v_mfma_f32_16x16x32_bf16 v[28:31], v[124:127], v[20:23], v[28:31]
    s_waitcnt vmcnt(4)
    buffer_load_dwordx4 v[88:91], v1, s[28:31], s79 offen offset:2048 nt
    s_waitcnt vmcnt(4)
    buffer_load_dwordx4 v[92:95], v1, s[28:31], s79 offen offset:2176 nt
    s_call_b64 s[76:77], L_score0
    s_waitcnt vmcnt(12)
    v_mfma_f32_16x16x32_bf16 v[8:11], v[36:39], v[128:131], v[8:11]
    v_and_b32 v36, v34, v4
    v_and_b32 v37, v34, v5
    v_and_b32 v38, v34, v6
    v_and_b32 v39, v34, v7
    v_mfma_f32_16x16x32_bf16 v[8:11], v[40:43], v[132:135], v[8:11]
    v_and_b32 v40, v35, v4
    v_and_b32 v41, v35, v5
    v_and_b32 v42, v35, v6
    v_and_b32 v43, v35, v7
    v_mfma_f32_16x16x32_bf16 v[8:11], v[36:39], v[136:139], v[8:11]
    s_nop 0
    v_mfma_f32_16x16x32_bf16 v[8:11], v[40:43], v[140:143], v[8:11]
    s_waitcnt vmcnt(4)
    buffer_load_dwordx4 v[96:99], v2, s[32:35], s79 offen offset:0 nt
    s_bitcmp0_b32 s82, 2
    s_cselect_b32 s91, s83, s69
    s_cselect_b32 s95, s71, 1.0
    s_bitcmp0_b32 s82, 2
    s_cbranch_scc1 L_upk_294
    s_add_u32 s92, s67, 3801088
    s_xor_b32 s78, s92, s67
    s_and_b32 s78, s78, 0xff800000
    s_xor_b32 s92, s92, s78
    s_call_b64 s[76:77], L_reload0
    s_branch L_upe_295
L_upk_294:
    v_and_b32 v24, 63, v0
    v_mul_u32_u24 v24, 12, v24
    v_sub_u32 v24, v3, v24
    ds_read_b128 v[32:35], v3 offset:8704
    ds_read_b32 v36, v24 offset:9728
    ds_read_b128 v[40:43], v3 offset:6656
    ds_read_b128 v[44:47], v3 offset:7680
    s_waitcnt lgkmcnt(0)
    s_call_b64 s[76:77], L_unpack32
L_upe_295:
    s_waitcnt vmcnt(4)
    buffer_load_dwordx4 v[100:103], v2, s[32:35], s79 offen offset:256 nt
    v_mfma_f32_16x16x32_bf16 v[24:27], v[32:35], v[16:19], 0
    v_mfma_f32_16x16x32_bf16 v[28:31], v[40:43], v[16:19], 0
    v_mfma_f32_16x16x32_bf16 v[24:27], v[36:39], v[20:23], v[24:27]
    v_mfma_f32_16x16x32_bf16 v[28:31], v[44:47], v[20:23], v[28:31]
    s_nop 6
    v_add_f32_dpp v32, v25, v24 quad_perm:[1,0,3,2] row_mask:0xf bank_mask:0xf
    v_add_f32_dpp v33, v27, v26 quad_perm:[1,0,3,2] row_mask:0xf bank_mask:0xf
    v_add_f32_dpp v34, v29, v28 quad_perm:[1,0,3,2] row_mask:0xf bank_mask:0xf
    v_add_f32_dpp v35, v31, v30 quad_perm:[1,0,3,2] row_mask:0xf bank_mask:0xf
    v_max3_f32 v36, v32, v33, v34
    v_max_f32 v36, v36, v35
    v_mul_f32 v36, s91, v36
    v_cmp_gt_f32 vcc, v36, v13
    s_waitcnt vmcnt(4)
    buffer_load_dwordx4 v[104:107], v2, s[32:35], s79 offen offset:2048 nt
    s_bitcmp0_b32 s82, 2
    s_cbranch_scc1 L_upk_296
    s_add_u32 s92, s67, 3801088
    s_xor_b32 s78, s92, s67
    s_and_b32 s78, s78, 0xff800000
    s_xor_b32 s92, s92, s78
    s_call_b64 s[76:77], L_reload1
    s_branch L_upe_297
L_upk_296:
    v_and_b32 v24, 63, v0
    v_mul_u32_u24 v24, 12, v24
    v_sub_u32 v24, v3, v24
    ds_read_b128 v[144:147], v3 offset:12032
    ds_read_b32 v148, v24 offset:13056
    ds_read_b128 v[152:155], v3 offset:9984
    ds_read_b128 v[156:159], v3 offset:11008
    s_waitcnt lgkmcnt(0)
    s_call_b64 s[76:77], L_unpack144
L_upe_297:
    s_waitcnt vmcnt(4)
    buffer_load_dwordx4 v[108:111], v2, s[32:35], s79 offen offset:2304 nt
    s_call_b64 s[76:77], L_soft1
    v_mfma_f32_16x16x32_bf16 v[8:11], v[36:39], v[144:147], v[8:11]
    v_and_b32 v36, v34, v4
    v_and_b32 v37, v34, v5
    v_and_b32 v38, v34, v6
    v_and_b32 v39, v34, v7
    v_mfma_f32_16x16x32_bf16 v[8:11], v[40:43], v[148:151], v[8:11]
    v_and_b32 v40, v35, v4
    v_and_b32 v41, v35, v5
    v_and_b32 v42, v35, v6
    v_and_b32 v43, v35, v7
    v_mfma_f32_16x16x32_bf16 v[8:11], v[36:39], v[152:155], v[8:11]
    s_nop 0
    v_mfma_f32_16x16x32_bf16 v[8:11], v[40:43], v[156:159], v[8:11]
    s_add_u32 s68, s67, 524288
    s_xor_b32 s78, s68, s67
    s_and_b32 s78, s78, 0xff800000
    s_xor_b32 s68, s68, s78
    s_waitcnt vmcnt(4)
    buffer_load_dwordx4 v[112:115], v1, s[28:31], s68 offen offset:0 nt
    s_waitcnt vmcnt(4)
    buffer_load_dwordx4 v[116:119], v1, s[28:31], s68 offen offset:128 nt
    s_waitcnt vmcnt(14)
    v_mfma_f32_16x16x32_bf16 v[24:27], v[48:51], v[16:19], 0
    v_mfma_f32_16x16x32_bf16 v[28:31], v[56:59], v[16:19], 0
    v_mfma_f32_16x16x32_bf16 v[24:27], v[52:55], v[20:23], v[24:27]
    v_mfma_f32_16x16x32_bf16 v[28:31], v[60:63], v[20:23], v[28:31]
    s_waitcnt vmcnt(4)
    buffer_load_dwordx4 v[120:123], v1, s[28:31], s68 offen offset:2048 nt
    s_waitcnt vmcnt(4)
    buffer_load_dwordx4 v[124:127], v1, s[28:31], s68 offen offset:2176 nt
    s_call_b64 s[76:77], L_score0
    s_waitcnt vmcnt(12)
    v_mfma_f32_16x16x32_bf16 v[8:11], v[36:39], v[64:67], v[8:11]
    v_and_b32 v36, v34, v4
    v_and_b32 v37, v34, v5
    v_and_b32 v38, v34, v6
    v_and_b32 v39, v34, v7
    v_mfma_f32_16x16x32_bf16 v[8:11], v[40:43], v[68:71], v[8:11]
    v_and_b32 v40, v35, v4
    v_and_b32 v41, v35, v5
    v_and_b32 v42, v35, v6
    v_and_b32 v43, v35, v7
    v_mfma_f32_16x16x32_bf16 v[8:11], v[36:39], v[72:75], v[8:11]
    s_nop 0
    v_mfma_f32_16x16x32_bf16 v[8:11], v[40:43], v[76:79], v[8:11]
    s_waitcnt vmcnt(4)
    buffer_load_dwordx4 v[128:131], v2, s[32:35], s68 offen offset:0 nt
    s_bitcmp0_b32 s82, 3
    s_cselect_b32 s91, s83, s69
    s_cselect_b32 s95, s71, 1.0
    s_bitcmp0_b32 s82, 3
    s_cbranch_scc1 L_upk_298
    s_add_u32 s92, s67, 4063232
    s_xor_b32 s78, s92, s67
    s_and_b32 s78, s78, 0xff800000
    s_xor_b32 s92, s92, s78
    s_call_b64 s[76:77], L_reload0
    s_branch L_upe_299
L_upk_298:
    v_and_b32 v24, 63, v0
    v_mul_u32_u24 v24, 12, v24
    v_sub_u32 v24, v3, v24
    ds_read_b128 v[32:35], v3 offset:15360
    ds_read_b32 v36, v24 offset:16384
    ds_read_b128 v[40:43], v3 offset:13312
    ds_read_b128 v[44:47], v3 offset:14336
    s_waitcnt lgkmcnt(0)
    s_call_b64 s[76:77], L_unpack32
L_upe_299:
    s_waitcnt vmcnt(4)
    buffer_load_dwordx4 v[132:135], v2, s[32:35], s68 offen offset:256 nt
    v_mfma_f32_16x16x32_bf16 v[24:27], v[32:35], v[16:19], 0
    v_mfma_f32_16x16x32_bf16 v[28:31], v[40:43], v[16:19], 0
    v_mfma_f32_16x16x32_bf16 v[24:27], v[36:39], v[20:23], v[24:27]
    v_mfma_f32_16x16x32_bf16 v[28:31], v[44:47], v[20:23], v[28:31]
    s_nop 6
    v_add_f32_dpp v32, v25, v24 quad_perm:[1,0,3,2] row_mask:0xf bank_mask:0xf
    v_add_f32_dpp v33, v27, v26 quad_perm:[1,0,3,2] row_mask:0xf bank_mask:0xf
    v_add_f32_dpp v34, v29, v28 quad_perm:[1,0,3,2] row_mask:0xf bank_mask:0xf
    v_add_f32_dpp v35, v31, v30 quad_perm:[1,0,3,2] row_mask:0xf bank_mask:0xf
    v_max3_f32 v36, v32, v33, v34
    v_max_f32 v36, v36, v35
    v_mul_f32 v36, s91, v36
    v_cmp_gt_f32 vcc, v36, v13
    s_waitcnt vmcnt(4)
    buffer_load_dwordx4 v[136:139], v2, s[32:35], s68 offen offset:2048 nt
    s_bitcmp0_b32 s82, 3
    s_cbranch_scc1 L_upk_300
    s_add_u32 s92, s67, 4063232
    s_xor_b32 s78, s92, s67
    s_and_b32 s78, s78, 0xff800000
    s_xor_b32 s92, s92, s78
    s_call_b64 s[76:77], L_reload1
    s_branch L_upe_301
L_upk_300:
    v_and_b32 v24, 63, v0
    v_mul_u32_u24 v24, 12, v24
    v_sub_u32 v24, v3, v24
    ds_read_b128 v[144:147], v3 offset:18688
    ds_read_b32 v148, v24 offset:19712
    ds_read_b128 v[152:155], v3 offset:16640
    ds_read_b128 v[156:159], v3 offset:17664
    s_waitcnt lgkmcnt(0)
    s_call_b64 s[76:77], L_unpack144
L_upe_301:
    s_waitcnt vmcnt(4)
    buffer_load_dwordx4 v[140:143], v2, s[32:35], s68 offen offset:2304 nt
    s_call_b64 s[76:77], L_soft1
    v_mfma_f32_16x16x32_bf16 v[8:11], v[36:39], v[144:147], v[8:11]
    v_and_b32 v36, v34, v4
    v_and_b32 v37, v34, v5
    v_and_b32 v38, v34, v6
    v_and_b32 v39, v34, v7
    v_mfma_f32_16x16x32_bf16 v[8:11], v[40:43], v[148:151], v[8:11]
    v_and_b32 v40, v35, v4
    v_and_b32 v41, v35, v5
    v_and_b32 v42, v35, v6
    v_and_b32 v43, v35, v7
    v_mfma_f32_16x16x32_bf16 v[8:11], v[36:39], v[152:155], v[8:11]
    s_nop 0
    v_mfma_f32_16x16x32_bf16 v[8:11], v[40:43], v[156:159], v[8:11]
    s_bitcmp1_b32 s64, 3
    s_cselect_b32 s78, -131072, 0
    s_add_u32 s79, s67, 786432
    s_add_u32 s79, s79, s78
    s_xor_b32 s78, s79, s67
    s_and_b32 s78, s78, 0xff800000
    s_xor_b32 s79, s79, s78
    s_waitcnt vmcnt(4)
    buffer_load_dwordx4 v[48:51], v1, s[28:31], s79 offen offset:0 nt
    s_waitcnt vmcnt(4)
    buffer_load_dwordx4 v[52:55], v1, s[28:31], s79 offen offset:128 nt
    s_waitcnt vmcnt(4)
    buffer_load_dwordx4 v[56:59], v1, s[28:31], s79 offen offset:2048 nt
    s_waitcnt vmcnt(4)
    buffer_load_dwordx4 v[60:63], v1, s[28:31], s79 offen offset:2176 nt
    s_waitcnt vmcnt(16)
    v_mfma_f32_16x16x32_bf16 v[24:27], v[80:83], v[16:19], 0
    v_mfma_f32_16x16x32_bf16 v[28:31], v[88:91], v[16:19], 0
    v_mfma_f32_16x16x32_bf16 v[24:27], v[84:87], v[20:23], v[24:27]
    v_mfma_f32_16x16x32_bf16 v[28:31], v[92:95], v[20:23], v[28:31]
    s_waitcnt vmcnt(4)
    buffer_load_dwordx4 v[64:67], v2, s[32:35], s79 offen offset:0 nt
    s_waitcnt vmcnt(4)
    buffer_load_dwordx4 v[68:71], v2, s[32:35], s79 offen offset:256 nt
    s_waitcnt vmcnt(4)
    buffer_load_dwordx4 v[72:75], v2, s[32:35], s79 offen offset:2048 nt
    s_waitcnt vmcnt(4)
    buffer_load_dwordx4 v[76:79], v2, s[32:35], s79 offen offset:2304 nt
    s_call_b64 s[76:77], L_score0
    s_waitcnt vmcnt(16)
    v_mfma_f32_16x16x32_bf16 v[8:11], v[36:39], v[96:99], v[8:11]
    v_and_b32 v36, v34, v4
    v_and_b32 v37, v34, v5
    v_and_b32 v38, v34, v6
    v_and_b32 v39, v34, v7
    v_mfma_f32_16x16x32_bf16 v[8:11], v[40:43], v[100:103], v[8:11]
    v_and_b32 v40, v35, v4
    v_and_b32 v41, v35, v5
    v_and_b32 v42, v35, v6
    v_and_b32 v43, v35, v7
    v_mfma_f32_16x16x32_bf16 v[8:11], v[36:39], v[104:107], v[8:11]
    s_nop 0
    v_mfma_f32_16x16x32_bf16 v[8:11], v[40:43], v[108:111], v[8:11]
    s_bitcmp1_b32 s64, 3
    s_cselect_b32 s78, 131072, 0
    s_add_u32 s68, s67, 655360
    s_add_u32 s68, s68, s78
    s_xor_b32 s78, s68, s67
    s_and_b32 s78, s78, 0xff800000
    s_xor_b32 s68, s68, s78
    s_waitcnt vmcnt(4)
    buffer_load_dwordx4 v[80:83], v1, s[28:31], s68 offen offset:0 nt
    s_waitcnt vmcnt(4)
    buffer_load_dwordx4 v[84:87], v1, s[28:31], s68 offen offset:128 nt
    s_waitcnt vmcnt(14)
    v_mfma_f32_16x16x32_bf16 v[24:27], v[112:115], v[16:19], 0
    v_mfma_f32_16x16x32_bf16 v[28:31], v[120:123], v[16:19], 0
    v_mfma_f32_16x16x32_bf16 v[24:27], v[116:119], v[20:23], v[24:27]
    v_mfma_f32_16x16x32_bf16 v[28:31], v[124:127], v[20:23], v[28:31]
    s_waitcnt vmcnt(4)
    buffer_load_dwordx4 v[88:91], v1, s[28:31], s68 offen offset:2048 nt
    s_waitcnt vmcnt(4)
    buffer_load_dwordx4 v[92:95], v1, s[28:31], s68 offen offset:2176 nt
    s_call_b64 s[76:77], L_score0
    s_waitcnt vmcnt(12)
    v_mfma_f32_16x16x32_bf16 v[8:11], v[36:39], v[128:131], v[8:11]
    v_and_b32 v36, v34, v4
    v_and_b32 v37, v34, v5
    v_and_b32 v38, v34, v6
    v_and_b32 v39, v34, v7
    v_mfma_f32_16x16x32_bf16 v[8:11], v[40:43], v[132:135], v[8:11]
    v_and_b32 v40, v35, v4
    v_and_b32 v41, v35, v5
    v_and_b32 v42, v35, v6
    v_and_b32 v43, v35, v7
    v_mfma_f32_16x16x32_bf16 v[8:11], v[36:39], v[136:139], v[8:11]
    s_nop 0
    v_mfma_f32_16x16x32_bf16 v[8:11], v[40:43], v[140:143], v[8:11]
    s_waitcnt vmcnt(4)
    buffer_load_dwordx4 v[96:99], v2, s[32:35], s68 offen offset:0 nt
    s_bitcmp0_b32 s82, 4
    s_cselect_b32 s91, s83, s69
    s_cselect_b32 s95, s71, 1.0
    s_bitcmp0_b32 s82, 4
    s_cbranch_scc1 L_upk_306
    s_add_u32 s92, s67, 4194304
    s_xor_b32 s78, s92, s67
    s_and_b32 s78, s78, 0xff800000
    s_xor_b32 s92, s92, s78
    s_call_b64 s[76:77], L_reload0
    s_branch L_upe_307
L_upk_306:
    v_and_b32 v24, 63, v0
    v_mul_u32_u24 v24, 12, v24
    v_sub_u32 v24, v3, v24
    ds_read_b128 v[32:35], v3 offset:22016
    ds_read_b32 v36, v24 offset:23040
    ds_read_b128 v[40:43], v3 offset:19968
    ds_read_b128 v[44:47], v3 offset:20992
    s_waitcnt lgkmcnt(0)
    s_call_b64 s[76:77], L_unpack32
L_upe_307:
    s_waitcnt vmcnt(4)
    buffer_load_dwordx4 v[100:103], v2, s[32:35], s68 offen offset:256 nt
    v_mfma_f32_16x16x32_bf16 v[24:27], v[32:35], v[16:19], 0
    v_mfma_f32_16x16x32_bf16 v[28:31], v[40:43], v[16:19], 0
    v_mfma_f32_16x16x32_bf16 v[24:27], v[36:39], v[20:23], v[24:27]
    v_mfma_f32_16x16x32_bf16 v[28:31], v[44:47], v[20:23], v[28:31]
    s_nop 6
    v_add_f32_dpp v32, v25, v24 quad_perm:[1,0,3,2] row_mask:0xf bank_mask:0xf
    v_add_f32_dpp v33, v27, v26 quad_perm:[1,0,3,2] row_mask:0xf bank_mask:0xf
    v_add_f32_dpp v34, v29, v28 quad_perm:[1,0,3,2] row_mask:0xf bank_mask:0xf
    v_add_f32_dpp v35, v31, v30 quad_perm:[1,0,3,2] row_mask:0xf bank_mask:0xf
    v_max3_f32 v36, v32, v33, v34
    v_max_f32 v36, v36, v35
    v_mul_f32 v36, s91, v36
    v_cmp_gt_f32 vcc, v36, v13
    s_waitcnt vmcnt(4)
    buffer_load_dwordx4 v[104:107], v2, s[32:35], s68 offen offset:2048 nt
    s_bitcmp0_b32 s82, 4
    s_cbranch_scc1 L_upk_308
    s_add_u32 s92, s67, 4194304
    s_xor_b32 s78, s92, s67
    s_and_b32 s78, s78, 0xff800000
    s_xor_b32 s92, s92, s78
    s_call_b64 s[76:77], L_reload1
    s_branch L_upe_309
L_upk_308:
    v_and_b32 v24, 63, v0
    v_mul_u32_u24 v24, 12, v24
    v_sub_u32 v24, v3, v24
    ds_read_b128 v[144:147], v3 offset:25344
    ds_read_b32 v148, v24 offset:26368
    ds_read_b128 v[152:155], v3 offset:23296
    ds_read_b128 v[156:159], v3 offset:24320
    s_waitcnt lgkmcnt(0)
    s_call_b64 s[76:77], L_unpack144
L_upe_309:
    s_waitcnt vmcnt(4)
    buffer_load_dwordx4 v[108:111], v2, s[32:35], s68 offen offset:2304 nt
    s_call_b64 s[76:77], L_soft1
    v_mfma_f32_16x16x32_bf16 v[8:11], v[36:39], v[144:147], v[8:11]
    v_and_b32 v36, v34, v4
    v_and_b32 v37, v34, v5
    v_and_b32 v38, v34, v6
    v_and_b32 v39, v34, v7
    v_mfma_f32_16x16x32_bf16 v[8:11], v[40:43], v[148:151], v[8:11]
    v_and_b32 v40, v35, v4
    v_and_b32 v41, v35, v5
    v_and_b32 v42, v35, v6
    v_and_b32 v43, v35, v7
    v_mfma_f32_16x16x32_bf16 v[8:11], v[36:39], v[152:155], v[8:11]
    s_nop 0
    v_mfma_f32_16x16x32_bf16 v[8:11], v[40:43], v[156:159], v[8:11]
    s_bitcmp1_b32 s64, 3
    s_cselect_b32 s78, -131072, 0
    s_add_u32 s79, s67, 1048576
    s_add_u32 s79, s79, s78
    s_xor_b32 s78, s79, s67
    s_and_b32 s78, s78, 0xff800000
    s_xor_b32 s79, s79, s78
    s_waitcnt vmcnt(4)
    buffer_load_dwordx4 v[112:115], v1, s[28:31], s79 offen offset:0 nt
    s_waitcnt vmcnt(4)
    buffer_load_dwordx4 v[116:119], v1, s[28:31], s79 offen offset:128 nt
    s_waitcnt vmcnt(14)
    v_mfma_f32_16x16x32_bf16 v[24:27], v[48:51], v[16:19], 0
    v_mfma_f32_16x16x32_bf16 v[28:31], v[56:59], v[16:19], 0
    v_mfma_f32_16x16x32_bf16 v[24:27], v[52:55], v[20:23], v[24:27]
    v_mfma_f32_16x16x32_bf16 v[28:31], v[60:63], v[20:23], v[28:31]
    s_waitcnt vmcnt(4)
    buffer_load_dwordx4 v[120:123], v1, s[28:31], s79 offen offset:2048 nt
    s_waitcnt vmcnt(4)
    buffer_load_dwordx4 v[124:127], v1, s[28:31], s79 offen offset:2176 nt
    s_call_b64 s[76:77], L_score0
    s_waitcnt vmcnt(12)
    v_mfma_f32_16x16x32_bf16 v[8:11], v[36:39], v[64:67], v[8:11]
    v_and_b32 v36, v34, v4
    v_and_b32 v37, v34, v5
    v_and_b32 v38, v34, v6
    v_and_b32 v39, v34, v7
    v_mfma_f32_16x16x32_bf16 v[8:11], v[40:43], v[68:71], v[8:11]
    v_and_b32 v40, v35, v4
    v_and_b32 v41, v35, v5
    v_and_b32 v42, v35, v6
    v_and_b32 v43, v35, v7
    v_mfma_f32_16x16x32_bf16 v[8:11], v[36:39], v[72:75], v[8:11]
    s_nop 0
    v_mfma_f32_16x16x32_bf16 v[8:11], v[40:43], v[76:79], v[8:11]
    s_waitcnt vmcnt(4)
    buffer_load_dwordx4 v[128:131], v2, s[32:35], s79 offen offset:0 nt
    s_bitcmp0_b32 s82, 5
    s_cselect_b32 s91, s83, s69
    s_cselect_b32 s95, s71, 1.0
    s_bitcmp0_b32 s82, 5
    s_cbranch_scc1 L_upk_312
    s_add_u32 s92, s67, 4456448
    s_xor_b32 s78, s92, s67
    s_and_b32 s78, s78, 0xff800000
    s_xor_b32 s92, s92, s78
    s_call_b64 s[76:77], L_reload0
    s_branch L_upe_313
L_upk_312:
    v_and_b32 v24, 63, v0
    v_mul_u32_u24 v24, 12, v24
    v_sub_u32 v24, v3, v24
    ds_read_b128 v[32:35], v3 offset:28672
    ds_read_b32 v36, v24 offset:29696
    ds_read_b128 v[40:43], v3 offset:26624
    ds_read_b128 v[44:47], v3 offset:27648
    s_waitcnt lgkmcnt(0)
    s_call_b64 s[76:77], L_unpack32
L_upe_313:
    s_waitcnt vmcnt(4)
    buffer_load_dwordx4 v[132:135], v2, s[32:35], s79 offen offset:256 nt
    v_mfma_f32_16x16x32_bf16 v[24:27], v[32:35], v[16:19], 0
    v_mfma_f32_16x16x32_bf16 v[28:31], v[40:43], v[16:19], 0
    v_mfma_f32_16x16x32_bf16 v[24:27], v[36:39], v[20:23], v[24:27]
    v_mfma_f32_16x16x32_bf16 v[28:31], v[44:47], v[20:23], v[28:31]
    s_nop 6
    v_add_f32_dpp v32, v25, v24 quad_perm:[1,0,3,2] row_mask:0xf bank_mask:0xf
    v_add_f32_dpp v33, v27, v26 quad_perm:[1,0,3,2] row_mask:0xf bank_mask:0xf
    v_add_f32_dpp v34, v29, v28 quad_perm:[1,0,3,2] row_mask:0xf bank_mask:0xf
    v_add_f32_dpp v35, v31, v30 quad_perm:[1,0,3,2] row_mask:0xf bank_mask:0xf
    v_max3_f32 v36, v32, v33, v34
    v_max_f32 v36, v36, v35
    v_mul_f32 v36, s91, v36
    v_cmp_gt_f32 vcc, v36, v13
    s_waitcnt vmcnt(4)
    buffer_load_dwordx4 v[136:139], v2, s[32:35], s79 offen offset:2048 nt
    s_bitcmp0_b32 s82, 5
    s_cbranch_scc1 L_upk_314
    s_add_u32 s92, s67, 4456448
    s_xor_b32 s78, s92, s67
    s_and_b32 s78, s78, 0xff800000
    s_xor_b32 s92, s92, s78
    s_call_b64 s[76:77], L_reload1
    s_branch L_upe_315
L_upk_314:
    v_and_b32 v24, 63, v0
    v_mul_u32_u24 v24, 12, v24
    v_sub_u32 v24, v3, v24
    ds_read_b128 v[144:147], v3 offset:32000
    ds_read_b32 v148, v24 offset:33024
    ds_read_b128 v[152:155], v3 offset:29952
    ds_read_b128 v[156:159], v3 offset:30976
    s_waitcnt lgkmcnt(0)
    s_call_b64 s[76:77], L_unpack144
L_upe_315:
    s_waitcnt vmcnt(4)
    buffer_load_dwordx4 v[140:143], v2, s[32:35], s79 offen offset:2304 nt
    s_call_b64 s[76:77], L_soft1
    v_mfma_f32_16x16x32_bf16 v[8:11], v[36:39], v[144:147], v[8:11]
    v_and_b32 v36, v34, v4
    v_and_b32 v37, v34, v5
    v_and_b32 v38, v34, v6
    v_and_b32 v39, v34, v7
    v_mfma_f32_16x16x32_bf16 v[8:11], v[40:43], v[148:151], v[8:11]
    v_and_b32 v40, v35, v4
    v_and_b32 v41, v35, v5
    v_and_b32 v42, v35, v6
    v_and_b32 v43, v35, v7
    v_mfma_f32_16x16x32_bf16 v[8:11], v[36:39], v[152:155], v[8:11]
    s_nop 0
    v_mfma_f32_16x16x32_bf16 v[8:11], v[40:43], v[156:159], v[8:11]
    s_bitcmp1_b32 s64, 3
    s_cselect_b32 s78, 131072, 0
    s_add_u32 s68, s67, 917504
    s_add_u32 s68, s68, s78
    s_xor_b32 s78, s68, s67
    s_and_b32 s78, s78, 0xff800000
    s_xor_b32 s68, s68, s78
    s_waitcnt vmcnt(4)
    buffer_load_dwordx4 v[48:51], v1, s[28:31], s68 offen offset:0 nt
    s_waitcnt vmcnt(4)
    buffer_load_dwordx4 v[52:55], v1, s[28:31], s68 offen offset:128 nt
    s_waitcnt vmcnt(14)
    v_mfma_f32_16x16x32_bf16 v[24:27], v[80:83], v[16:19], 0
    v_mfma_f32_16x16x32_bf16 v[28:31], v[88:91], v[16:19], 0
    v_mfma_f32_16x16x32_bf16 v[24:27], v[84:87], v[20:23], v[24:27]
    v_mfma_f32_16x16x32_bf16 v[28:31], v[92:95], v[20:23], v[28:31]
    s_waitcnt vmcnt(4)
    buffer_load_dwordx4 v[56:59], v1, s[28:31], s68 offen offset:2048 nt
    s_waitcnt vmcnt(4)
    buffer_load_dwordx4 v[60:63], v1, s[28:31], s68 offen offset:2176 nt
    s_call_b64 s[76:77], L_score0
    s_waitcnt vmcnt(12)
    v_mfma_f32_16x16x32_bf16 v[8:11], v[36:39], v[96:99], v[8:11]
    v_and_b32 v36, v34, v4
    v_and_b32 v37, v34, v5
    v_and_b32 v38, v34, v6
    v_and_b32 v39, v34, v7
    v_mfma_f32_16x16x32_bf16 v[8:11], v[40:43], v[100:103], v[8:11]
    v_and_b32 v40, v35, v4
    v_and_b32 v41, v35, v5
    v_and_b32 v42, v35, v6
    v_and_b32 v43, v35, v7
    v_mfma_f32_16x16x32_bf16 v[8:11], v[36:39], v[104:107], v[8:11]
    s_nop 0
    v_mfma_f32_16x16x32_bf16 v[8:11], v[40:43], v[108:111], v[8:11]
    s_waitcnt vmcnt(4)
    buffer_load_dwordx4 v[64:67], v2, s[32:35], s68 offen offset:0 nt
    s_bitcmp0_b32 s82, 6
    s_cselect_b32 s91, s83, s69
    s_cselect_b32 s95, s71, 1.0
    s_bitcmp0_b32 s82, 6
    s_cbranch_scc1 L_upk_318
    s_add_u32 s92, s67, 4718592
    s_xor_b32 s78, s92, s67
    s_and_b32 s78, s78, 0xff800000
    s_xor_b32 s92, s92, s78
    s_call_b64 s[76:77], L_reload0
    s_branch L_upe_319
L_upk_318:
    v_and_b32 v24, 63, v0
    v_mul_u32_u24 v24, 12, v24
    v_sub_u32 v24, v3, v24
    ds_read_b128 v[32:35], v3 offset:35328
    ds_read_b32 v36, v24 offset:36352
    ds_read_b128 v[40:43], v3 offset:33280
    ds_read_b128 v[44:47], v3 offset:34304
    s_waitcnt lgkmcnt(0)
    s_call_b64 s[76:77], L_unpack32
L_upe_319:
    s_waitcnt vmcnt(4)
    buffer_load_dwordx4 v[68:71], v2, s[32:35], s68 offen offset:256 nt
    v_mfma_f32_16x16x32_bf16 v[24:27], v[32:35], v[16:19], 0
    v_mfma_f32_16x16x32_bf16 v[28:31], v[40:43], v[16:19], 0
    v_mfma_f32_16x16x32_bf16 v[24:27], v[36:39], v[20:23], v[24:27]
    v_mfma_f32_16x16x32_bf16 v[28:31], v[44:47], v[20:23], v[28:31]
    s_nop 6
    v_add_f32_dpp v32, v25, v24 quad_perm:[1,0,3,2] row_mask:0xf bank_mask:0xf
    v_add_f32_dpp v33, v27, v26 quad_perm:[1,0,3,2] row_mask:0xf bank_mask:0xf
    v_add_f32_dpp v34, v29, v28 quad_perm:[1,0,3,2] row_mask:0xf bank_mask:0xf
    v_add_f32_dpp v35, v31, v30 quad_perm:[1,0,3,2] row_mask:0xf bank_mask:0xf
    v_max3_f32 v36, v32, v33, v34
    v_max_f32 v36, v36, v35
    v_mul_f32 v36, s91, v36
    v_cmp_gt_f32 vcc, v36, v13
    s_waitcnt vmcnt(4)
    buffer_load_dwordx4 v[72:75], v2, s[32:35], s68 offen offset:2048 nt
    s_bitcmp0_b32 s82, 6
    s_cbranch_scc1 L_upk_320
    s_add_u32 s92, s67, 4718592
    s_xor_b32 s78, s92, s67
    s_and_b32 s78, s78, 0xff800000
    s_xor_b32 s92, s92, s78
    s_call_b64 s[76:77], L_reload1
    s_branch L_upe_321
L_upk_320:
    v_and_b32 v24, 63, v0
    v_mul_u32_u24 v24, 12, v24
    v_sub_u32 v24, v3, v24
    ds_read_b128 v[144:147], v3 offset:38656
    ds_read_b32 v148, v24 offset:39680
    ds_read_b128 v[152:155], v3 offset:36608
    ds_read_b128 v[156:159], v3 offset:37632
    s_waitcnt lgkmcnt(0)
    s_call_b64 s[76:77], L_unpack144
L_upe_321:
    s_waitcnt vmcnt(4)
    buffer_load_dwordx4 v[76:79], v2, s[32:35], s68 offen offset:2304 nt
    s_call_b64 s[76:77], L_soft1
    v_mfma_f32_16x16x32_bf16 v[8:11], v[36:39], v[144:147], v[8:11]
    v_and_b32 v36, v34, v4
    v_and_b32 v37, v34, v5
    v_and_b32 v38, v34, v6
    v_and_b32 v39, v34, v7
    v_mfma_f32_16x16x32_bf16 v[8:11], v[40:43], v[148:151], v[8:11]
    v_and_b32 v40, v35, v4
    v_and_b32 v41, v35, v5
    v_and_b32 v42, v35, v6
    v_and_b32 v43, v35, v7
    v_mfma_f32_16x16x32_bf16 v[8:11], v[36:39], v[152:155], v[8:11]
    s_nop 0
    v_mfma_f32_16x16x32_bf16 v[8:11], v[40:43], v[156:159], v[8:11]
    s_bitcmp1_b32 s64, 3
    s_cselect_b32 s78, -131072, 0
    s_add_u32 s79, s67, 1310720
    s_add_u32 s79, s79, s78
    s_xor_b32 s78, s79, s67
    s_and_b32 s78, s78, 0xff800000
    s_xor_b32 s79, s79, s78
    s_waitcnt vmcnt(4)
    buffer_load_dwordx4 v[80:83], v1, s[28:31], s79 offen offset:0 nt
    s_waitcnt vmcnt(4)
    buffer_load_dwordx4 v[84:87], v1, s[28:31], s79 offen offset:128 nt
    s_waitcnt vmcnt(4)
    buffer_load_dwordx4 v[88:91], v1, s[28:31], s79 offen offset:2048 nt
    s_waitcnt vmcnt(4)
    buffer_load_dwordx4 v[92:95], v1, s[28:31], s79 offen offset:2176 nt
    s_waitcnt vmcnt(16)
    v_mfma_f32_16x16x32_bf16 v[24:27], v[112:115], v[16:19], 0
    v_mfma_f32_16x16x32_bf16 v[28:31], v[120:123], v[16:19], 0
    v_mfma_f32_16x16x32_bf16 v[24:27], v[116:119], v[20:23], v[24:27]
    v_mfma_f32_16x16x32_bf16 v[28:31], v[124:127], v[20:23], v[28:31]
    s_waitcnt vmcnt(4)
    buffer_load_dwordx4 v[96:99], v2, s[32:35], s79 offen offset:0 nt
    s_waitcnt vmcnt(4)
    buffer_load_dwordx4 v[100:103], v2, s[32:35], s79 offen offset:256 nt
    s_waitcnt vmcnt(4)
    buffer_load_dwordx4 v[104:107], v2, s[32:35], s79 offen offset:2048 nt
    s_waitcnt vmcnt(4)
    buffer_load_dwordx4 v[108:111], v2, s[32:35], s79 offen offset:2304 nt
    s_call_b64 s[76:77], L_score0
    s_waitcnt vmcnt(16)
    v_mfma_f32_16x16x32_bf16 v[8:11], v[36:39], v[128:131], v[8:11]
    v_and_b32 v36, v34, v4
    v_and_b32 v37, v34, v5
    v_and_b32 v38, v34, v6
    v_and_b32 v39, v34, v7
    v_mfma_f32_16x16x32_bf16 v[8:11], v[40:43], v[132:135], v[8:11]
    v_and_b32 v40, v35, v4
    v_and_b32 v41, v35, v5
    v_and_b32 v42, v35, v6
    v_and_b32 v43, v35, v7
    v_mfma_f32_16x16x32_bf16 v[8:11], v[36:39], v[136:139], v[8:11]
    s_nop 0
    v_mfma_f32_16x16x32_bf16 v[8:11], v[40:43], v[140:143], v[8:11]
    s_bitcmp1_b32 s64, 3
    s_cselect_b32 s78, 131072, 0
    s_add_u32 s68, s67, 1179648
    s_add_u32 s68, s68, s78
    s_xor_b32 s78, s68, s67
    s_and_b32 s78, s78, 0xff800000
    s_xor_b32 s68, s68, s78
    s_waitcnt vmcnt(4)
    buffer_load_dwordx4 v[112:115], v1, s[28:31], s68 offen offset:0 nt
    s_waitcnt vmcnt(4)
    buffer_load_dwordx4 v[116:119], v1, s[28:31], s68 offen offset:128 nt
    s_waitcnt vmcnt(14)
    v_mfma_f32_16x16x32_bf16 v[24:27], v[48:51], v[16:19], 0
    v_mfma_f32_16x16x32_bf16 v[28:31], v[56:59], v[16:19], 0
    v_mfma_f32_16x16x32_bf16 v[24:27], v[52:55], v[20:23], v[24:27]
    v_mfma_f32_16x16x32_bf16 v[28:31], v[60:63], v[20:23], v[28:31]
    s_waitcnt vmcnt(4)
    buffer_load_dwordx4 v[120:123], v1, s[28:31], s68 offen offset:2048 nt
    s_waitcnt vmcnt(4)
    buffer_load_dwordx4 v[124:127], v1, s[28:31], s68 offen offset:2176 nt
    s_call_b64 s[76:77], L_score0
    s_waitcnt vmcnt(12)
    v_mfma_f32_16x16x32_bf16 v[8:11], v[36:39], v[64:67], v[8:11]
    v_and_b32 v36, v34, v4
    v_and_b32 v37, v34, v5
    v_and_b32 v38, v34, v6
    v_and_b32 v39, v34, v7
    v_mfma_f32_16x16x32_bf16 v[8:11], v[40:43], v[68:71], v[8:11]
    v_and_b32 v40, v35, v4
    v_and_b32 v41, v35, v5
    v_and_b32 v42, v35, v6
    v_and_b32 v43, v35, v7
    v_mfma_f32_16x16x32_bf16 v[8:11], v[36:39], v[72:75], v[8:11]
    s_nop 0
    v_mfma_f32_16x16x32_bf16 v[8:11], v[40:43], v[76:79], v[8:11]
    s_waitcnt vmcnt(4)
    buffer_load_dwordx4 v[128:131], v2, s[32:35], s68 offen offset:0 nt
    s_bitcmp0_b32 s82, 7
    s_cselect_b32 s91, s83, s69
    s_cselect_b32 s95, s71, 1.0
    s_bitcmp0_b32 s82, 7
    s_cbranch_scc1 L_upk_326
    s_add_u32 s92, s67, 4849664
    s_xor_b32 s78, s92, s67
    s_and_b32 s78, s78, 0xff800000
    s_xor_b32 s92, s92, s78
    s_call_b64 s[76:77], L_reload0
    s_branch L_upe_327
L_upk_326:
    v_mov_b32 v40, v173
    v_mov_b32 v41, v174
    v_mov_b32 v42, v175
    v_mov_b32 v43, v176
    v_mov_b32 v44, v177
    v_mov_b32 v45, v178
    v_mov_b32 v46, v179
    v_mov_b32 v47, v180
    v_mov_b32 v32, v181
    v_mov_b32 v33, v182
    v_mov_b32 v34, v183
    v_mov_b32 v35, v184
    v_mov_b32 v36, v185
    s_call_b64 s[76:77], L_unpack32
L_upe_327:
    s_waitcnt vmcnt(4)
    buffer_load_dwordx4 v[132:135], v2, s[32:35], s68 offen offset:256 nt
    v_mfma_f32_16x16x32_bf16 v[24:27], v[32:35], v[16:19], 0
    v_mfma_f32_16x16x32_bf16 v[28:31], v[40:43], v[16:19], 0
    v_mfma_f32_16x16x32_bf16 v[24:27], v[36:39], v[20:23], v[24:27]
    v_mfma_f32_16x16x32_bf16 v[28:31], v[44:47], v[20:23], v[28:31]
    s_nop 6
    v_add_f32_dpp v32, v25, v24 quad_perm:[1,0,3,2] row_mask:0xf bank_mask:0xf
    v_add_f32_dpp v33, v27, v26 quad_perm:[1,0,3,2] row_mask:0xf bank_mask:0xf
    v_add_f32_dpp v34, v29, v28 quad_perm:[1,0,3,2] row_mask:0xf bank_mask:0xf
    v_add_f32_dpp v35, v31, v30 quad_perm:[1,0,3,2] row_mask:0xf bank_mask:0xf
    v_max3_f32 v36, v32, v33, v34
    v_max_f32 v36, v36, v35
    v_mul_f32 v36, s91, v36
    v_cmp_gt_f32 vcc, v36, v13
    s_waitcnt vmcnt(4)
    buffer_load_dwordx4 v[136:139], v2, s[32:35], s68 offen offset:2048 nt
    s_bitcmp0_b32 s82, 7
    s_cbranch_scc1 L_upk_328
    s_add_u32 s92, s67, 4849664
    s_xor_b32 s78, s92, s67
    s_and_b32 s78, s78, 0xff800000
    s_xor_b32 s92, s92, s78
    s_call_b64 s[76:77], L_reload1
    s_branch L_upe_329
L_upk_328:
    v_mov_b32 v152, v186
    v_mov_b32 v153, v187
    v_mov_b32 v154, v188
    v_mov_b32 v155, v189
    v_mov_b32 v156, v190
    v_mov_b32 v157, v191
    v_mov_b32 v158, v192
    v_mov_b32 v159, v193
    v_mov_b32 v144, v194
    v_mov_b32 v145, v195
    v_mov_b32 v146, v196
    v_mov_b32 v147, v197
    v_mov_b32 v148, v198
    s_call_b64 s[76:77], L_unpack144
L_upe_329:
    s_waitcnt vmcnt(4)
    buffer_load_dwordx4 v[140:143], v2, s[32:35], s68 offen offset:2304 nt
    s_call_b64 s[76:77], L_soft1
    v_mfma_f32_16x16x32_bf16 v[8:11], v[36:39], v[144:147], v[8:11]
    v_and_b32 v36, v34, v4
    v_and_b32 v37, v34, v5
    v_and_b32 v38, v34, v6
    v_and_b32 v39, v34, v7
    v_mfma_f32_16x16x32_bf16 v[8:11], v[40:43], v[148:151], v[8:11]
    v_and_b32 v40, v35, v4
    v_and_b32 v41, v35, v5
    v_and_b32 v42, v35, v6
    v_and_b32 v43, v35, v7
    v_mfma_f32_16x16x32_bf16 v[8:11], v[36:39], v[152:155], v[8:11]
    s_nop 0
    v_mfma_f32_16x16x32_bf16 v[8:11], v[40:43], v[156:159], v[8:11]
    s_add_u32 s79, s67, 1572864
    s_xor_b32 s78, s79, s67
    s_and_b32 s78, s78, 0xff800000
    s_xor_b32 s79, s79, s78
    s_waitcnt vmcnt(4)
    buffer_load_dwordx4 v[48:51], v1, s[28:31], s79 offen offset:0 nt
    s_waitcnt vmcnt(4)
    buffer_load_dwordx4 v[52:55], v1, s[28:31], s79 offen offset:128 nt
    s_waitcnt vmcnt(14)
    v_mfma_f32_16x16x32_bf16 v[24:27], v[80:83], v[16:19], 0
    v_mfma_f32_16x16x32_bf16 v[28:31], v[88:91], v[16:19], 0
    v_mfma_f32_16x16x32_bf16 v[24:27], v[84:87], v[20:23], v[24:27]
    v_mfma_f32_16x16x32_bf16 v[28:31], v[92:95], v[20:23], v[28:31]
    s_waitcnt vmcnt(4)
    buffer_load_dwordx4 v[56:59], v1, s[28:31], s79 offen offset:2048 nt
    s_waitcnt vmcnt(4)
    buffer_load_dwordx4 v[60:63], v1, s[28:31], s79 offen offset:2176 nt
    s_call_b64 s[76:77], L_score0
    s_waitcnt vmcnt(12)
    v_mfma_f32_16x16x32_bf16 v[8:11], v[36:39], v[96:99], v[8:11]
    v_and_b32 v36, v34, v4
    v_and_b32 v37, v34, v5
    v_and_b32 v38, v34, v6
    v_and_b32 v39, v34, v7
    v_mfma_f32_16x16x32_bf16 v[8:11], v[40:43], v[100:103], v[8:11]
    v_and_b32 v40, v35, v4
    v_and_b32 v41, v35, v5
    v_and_b32 v42, v35, v6
    v_and_b32 v43, v35, v7
    v_mfma_f32_16x16x32_bf16 v[8:11], v[36:39], v[104:107], v[8:11]
    s_nop 0
    v_mfma_f32_16x16x32_bf16 v[8:11], v[40:43], v[108:111], v[8:11]
    s_waitcnt vmcnt(4)
    buffer_load_dwordx4 v[64:67], v2, s[32:35], s79 offen offset:0 nt
    s_bitcmp0_b32 s82, 8
    s_cselect_b32 s91, s83, s69
    s_cselect_b32 s95, s71, 1.0
    s_bitcmp0_b32 s82, 8
    s_cbranch_scc1 L_upk_330
    s_add_u32 s92, s67, 5111808
    s_xor_b32 s78, s92, s67
    s_and_b32 s78, s78, 0xff800000
    s_xor_b32 s92, s92, s78
    s_call_b64 s[76:77], L_reload0
    s_branch L_upe_331
L_upk_330:
    v_mov_b32 v40, v199
    v_mov_b32 v41, v200
    v_mov_b32 v42, v201
    v_mov_b32 v43, v202
    v_mov_b32 v44, v203
    v_mov_b32 v45, v204
    v_mov_b32 v46, v205
    v_mov_b32 v47, v206
    v_mov_b32 v32, v207
    v_mov_b32 v33, v208
    v_mov_b32 v34, v209
    v_mov_b32 v35, v210
    v_mov_b32 v36, v211
    s_call_b64 s[76:77], L_unpack32
L_upe_331:
    s_waitcnt vmcnt(4)
    buffer_load_dwordx4 v[68:71], v2, s[32:35], s79 offen offset:256 nt
    v_mfma_f32_16x16x32_bf16 v[24:27], v[32:35], v[16:19], 0
    v_mfma_f32_16x16x32_bf16 v[28:31], v[40:43], v[16:19], 0
    v_mfma_f32_16x16x32_bf16 v[24:27], v[36:39], v[20:23], v[24:27]
    v_mfma_f32_16x16x32_bf16 v[28:31], v[44:47], v[20:23], v[28:31]
    s_nop 6
    v_add_f32_dpp v32, v25, v24 quad_perm:[1,0,3,2] row_mask:0xf bank_mask:0xf
    v_add_f32_dpp v33, v27, v26 quad_perm:[1,0,3,2] row_mask:0xf bank_mask:0xf
    v_add_f32_dpp v34, v29, v28 quad_perm:[1,0,3,2] row_mask:0xf bank_mask:0xf
    v_add_f32_dpp v35, v31, v30 quad_perm:[1,0,3,2] row_mask:0xf bank_mask:0xf
    v_max3_f32 v36, v32, v33, v34
    v_max_f32 v36, v36, v35
    v_mul_f32 v36, s91, v36
    v_cmp_gt_f32 vcc, v36, v13
    s_waitcnt vmcnt(4)
    buffer_load_dwordx4 v[72:75], v2, s[32:35], s79 offen offset:2048 nt
    s_bitcmp0_b32 s82, 8
    s_cbranch_scc1 L_upk_332
    s_add_u32 s92, s67, 5111808
    s_xor_b32 s78, s92, s67
    s_and_b32 s78, s78, 0xff800000
    s_xor_b32 s92, s92, s78
    s_call_b64 s[76:77], L_reload1
    s_branch L_upe_333
L_upk_332:
    v_mov_b32 v152, v212
    v_mov_b32 v153, v213
    v_mov_b32 v154, v214
    v_mov_b32 v155, v215
    v_mov_b32 v156, v216
    v_mov_b32 v157, v217
    v_mov_b32 v158, v218
    v_mov_b32 v159, v219
    v_mov_b32 v144, v220
    v_mov_b32 v145, v221
    v_mov_b32 v146, v222
    v_mov_b32 v147, v223
    v_accvgpr_read_b32 v148, a0
    s_call_b64 s[76:77], L_unpack144
L_upe_333:
    s_waitcnt vmcnt(4)
    buffer_load_dwordx4 v[76:79], v2, s[32:35], s79 offen offset:2304 nt
    s_call_b64 s[76:77], L_soft1
    v_mfma_f32_16x16x32_bf16 v[8:11], v[36:39], v[144:147], v[8:11]
    v_and_b32 v36, v34, v4
    v_and_b32 v37, v34, v5
    v_and_b32 v38, v34, v6
    v_and_b32 v39, v34, v7
    v_mfma_f32_16x16x32_bf16 v[8:11], v[40:43], v[148:151], v[8:11]
    v_and_b32 v40, v35, v4
    v_and_b32 v41, v35, v5
    v_and_b32 v42, v35, v6
    v_and_b32 v43, v35, v7
    v_mfma_f32_16x16x32_bf16 v[8:11], v[36:39], v[152:155], v[8:11]
    s_nop 0
    v_mfma_f32_16x16x32_bf16 v[8:11], v[40:43], v[156:159], v[8:11]
    s_bitcmp1_b32 s64, 3
    s_cselect_b32 s78, -262144, 0
    s_add_u32 s68, s67, 1703936
    s_add_u32 s68, s68, s78
    s_xor_b32 s78, s68, s67
    s_and_b32 s78, s78, 0xff800000
    s_xor_b32 s68, s68, s78
    s_waitcnt vmcnt(4)
    buffer_load_dwordx4 v[80:83], v1, s[28:31], s68 offen offset:0 nt
    s_waitcnt vmcnt(4)
    buffer_load_dwordx4 v[84:87], v1, s[28:31], s68 offen offset:128 nt
    s_waitcnt vmcnt(14)
    v_mfma_f32_16x16x32_bf16 v[24:27], v[112:115], v[16:19], 0
    v_mfma_f32_16x16x32_bf16 v[28:31], v[120:123], v[16:19], 0
    v_mfma_f32_16x16x32_bf16 v[24:27], v[116:119], v[20:23], v[24:27]
    v_mfma_f32_16x16x32_bf16 v[28:31], v[124:127], v[20:23], v[28:31]
    s_waitcnt vmcnt(4)
    buffer_load_dwordx4 v[88:91], v1, s[28:31], s68 offen offset:2048 nt
    s_waitcnt vmcnt(4)
    buffer_load_dwordx4 v[92:95], v1, s[28:31], s68 offen offset:2176 nt
    s_call_b64 s[76:77], L_score0
    s_waitcnt vmcnt(12)
    v_mfma_f32_16x16x32_bf16 v[8:11], v[36:39], v[128:131], v[8:11]
    v_and_b32 v36, v34, v4
    v_and_b32 v37, v34, v5
    v_and_b32 v38, v34, v6
    v_and_b32 v39, v34, v7
    v_mfma_f32_16x16x32_bf16 v[8:11], v[40:43], v[132:135], v[8:11]
    v_and_b32 v40, v35, v4
    v_and_b32 v41, v35, v5
    v_and_b32 v42, v35, v6
    v_and_b32 v43, v35, v7
    v_mfma_f32_16x16x32_bf16 v[8:11], v[36:39], v[136:139], v[8:11]
    s_nop 0
    v_mfma_f32_16x16x32_bf16 v[8:11], v[40:43], v[140:143], v[8:11]
    s_waitcnt vmcnt(4)
    buffer_load_dwordx4 v[96:99], v2, s[32:35], s68 offen offset:0 nt
    s_bitcmp0_b32 s82, 9
    s_cselect_b32 s91, s83, s69
    s_cselect_b32 s95, s71, 1.0
    s_bitcmp0_b32 s82, 9
    s_cbranch_scc1 L_upk_336
    s_add_u32 s92, s67, 5242880
    s_xor_b32 s78, s92, s67
    s_and_b32 s78, s78, 0xff800000
    s_xor_b32 s92, s92, s78
    s_call_b64 s[76:77], L_reload0
    s_branch L_upe_337
L_upk_336:
    v_accvgpr_read_b32 v40, a1
    v_accvgpr_read_b32 v41, a2
    v_accvgpr_read_b32 v42, a3
    v_accvgpr_read_b32 v43, a4
    v_accvgpr_read_b32 v44, a5
    v_accvgpr_read_b32 v45, a6
    v_accvgpr_read_b32 v46, a7
    v_accvgpr_read_b32 v47, a8
    v_accvgpr_read_b32 v32, a9
    v_accvgpr_read_b32 v33, a10
    v_accvgpr_read_b32 v34, a11
    v_accvgpr_read_b32 v35, a12
    v_accvgpr_read_b32 v36, a13
    s_call_b64 s[76:77], L_unpack32
L_upe_337:
    s_waitcnt vmcnt(4)
    buffer_load_dwordx4 v[100:103], v2, s[32:35], s68 offen offset:256 nt
    v_mfma_f32_16x16x32_bf16 v[24:27], v[32:35], v[16:19], 0
    v_mfma_f32_16x16x32_bf16 v[28:31], v[40:43], v[16:19], 0
    v_mfma_f32_16x16x32_bf16 v[24:27], v[36:39], v[20:23], v[24:27]
    v_mfma_f32_16x16x32_bf16 v[28:31], v[44:47], v[20:23], v[28:31]
    s_nop 6
    v_add_f32_dpp v32, v25, v24 quad_perm:[1,0,3,2] row_mask:0xf bank_mask:0xf
    v_add_f32_dpp v33, v27, v26 quad_perm:[1,0,3,2] row_mask:0xf bank_mask:0xf
    v_add_f32_dpp v34, v29, v28 quad_perm:[1,0,3,2] row_mask:0xf bank_mask:0xf
    v_add_f32_dpp v35, v31, v30 quad_perm:[1,0,3,2] row_mask:0xf bank_mask:0xf
    v_max3_f32 v36, v32, v33, v34
    v_max_f32 v36, v36, v35
    v_mul_f32 v36, s91, v36
    v_cmp_gt_f32 vcc, v36, v13
    s_waitcnt vmcnt(4)
    buffer_load_dwordx4 v[104:107], v2, s[32:35], s68 offen offset:2048 nt
    s_bitcmp0_b32 s82, 9
    s_cbranch_scc1 L_upk_338
    s_add_u32 s92, s67, 5242880
    s_xor_b32 s78, s92, s67
    s_and_b32 s78, s78, 0xff800000
    s_xor_b32 s92, s92, s78
    s_call_b64 s[76:77], L_reload1
    s_branch L_upe_339
L_upk_338:
    v_accvgpr_read_b32 v152, a14
    v_accvgpr_read_b32 v153, a15
    v_accvgpr_read_b32 v154, a16
    v_accvgpr_read_b32 v155, a17
    v_accvgpr_read_b32 v156, a18
    v_accvgpr_read_b32 v157, a19
    v_accvgpr_read_b32 v158, a20
    v_accvgpr_read_b32 v159, a21
    v_accvgpr_read_b32 v144, a22
    v_accvgpr_read_b32 v145, a23
    v_accvgpr_read_b32 v146, a24
    v_accvgpr_read_b32 v147, a25
    v_accvgpr_read_b32 v148, a26
    s_call_b64 s[76:77], L_unpack144
L_upe_339:
    s_waitcnt vmcnt(4)
    buffer_load_dwordx4 v[108:111], v2, s[32:35], s68 offen offset:2304 nt
    s_call_b64 s[76:77], L_soft1
    v_mfma_f32_16x16x32_bf16 v[8:11], v[36:39], v[144:147], v[8:11]
    v_and_b32 v36, v34, v4
    v_and_b32 v37, v34, v5
    v_and_b32 v38, v34, v6
    v_and_b32 v39, v34, v7
    v_mfma_f32_16x16x32_bf16 v[8:11], v[40:43], v[148:151], v[8:11]
    v_and_b32 v40, v35, v4
    v_and_b32 v41, v35, v5
    v_and_b32 v42, v35, v6
    v_and_b32 v43, v35, v7
    v_mfma_f32_16x16x32_bf16 v[8:11], v[36:39], v[152:155], v[8:11]
    s_nop 0
    v_mfma_f32_16x16x32_bf16 v[8:11], v[40:43], v[156:159], v[8:11]
    s_bitcmp1_b32 s64, 3
    s_cselect_b32 s78, 262144, 0
    s_add_u32 s79, s67, 1441792
    s_add_u32 s79, s79, s78
    s_xor_b32 s78, s79, s67
    s_and_b32 s78, s78, 0xff800000
    s_xor_b32 s79, s79, s78
    s_waitcnt vmcnt(4)
    buffer_load_dwordx4 v[112:115], v1, s[28:31], s79 offen offset:0 nt
    s_waitcnt vmcnt(4)
    buffer_load_dwordx4 v[116:119], v1, s[28:31], s79 offen offset:128 nt
    s_waitcnt vmcnt(4)
    buffer_load_dwordx4 v[120:123], v1, s[28:31], s79 offen offset:2048 nt
    s_waitcnt vmcnt(4)
    buffer_load_dwordx4 v[124:127], v1, s[28:31], s79 offen offset:2176 nt
    s_waitcnt vmcnt(16)
    v_mfma_f32_16x16x32_bf16 v[24:27], v[48:51], v[16:19], 0
    v_mfma_f32_16x16x32_bf16 v[28:31], v[56:59], v[16:19], 0
    v_mfma_f32_16x16x32_bf16 v[24:27], v[52:55], v[20:23], v[24:27]
    v_mfma_f32_16x16x32_bf16 v[28:31], v[60:63], v[20:23], v[28:31]
    s_waitcnt vmcnt(4)
    buffer_load_dwordx4 v[128:131], v2, s[32:35], s79 offen offset:0 nt
    s_waitcnt vmcnt(4)
    buffer_load_dwordx4 v[132:135], v2, s[32:35], s79 offen offset:256 nt
    s_waitcnt vmcnt(4)
    buffer_load_dwordx4 v[136:139], v2, s[32:35], s79 offen offset:2048 nt
    s_waitcnt vmcnt(4)
    buffer_load_dwordx4 v[140:143], v2, s[32:35], s79 offen offset:2304 nt
    s_call_b64 s[76:77], L_score0
    s_waitcnt vmcnt(16)
    v_mfma_f32_16x16x32_bf16 v[8:11], v[36:39], v[64:67], v[8:11]
    v_and_b32 v36, v34, v4
    v_and_b32 v37, v34, v5
    v_and_b32 v38, v34, v6
    v_and_b32 v39, v34, v7
    v_mfma_f32_16x16x32_bf16 v[8:11], v[40:43], v[68:71], v[8:11]
    v_and_b32 v40, v35, v4
    v_and_b32 v41, v35, v5
    v_and_b32 v42, v35, v6
    v_and_b32 v43, v35, v7
    v_mfma_f32_16x16x32_bf16 v[8:11], v[36:39], v[72:75], v[8:11]
    s_nop 0
    v_mfma_f32_16x16x32_bf16 v[8:11], v[40:43], v[76:79], v[8:11]
    s_bitcmp1_b32 s64, 3
    s_cselect_b32 s78, -131072, 0
    s_add_u32 s68, s67, 1966080
    s_add_u32 s68, s68, s78
    s_xor_b32 s78, s68, s67
    s_and_b32 s78, s78, 0xff800000
    s_xor_b32 s68, s68, s78
    s_waitcnt vmcnt(4)
    buffer_load_dwordx4 v[48:51], v1, s[28:31], s68 offen offset:0 nt
    s_waitcnt vmcnt(4)
    buffer_load_dwordx4 v[52:55], v1, s[28:31], s68 offen offset:128 nt
    s_waitcnt vmcnt(14)
    v_mfma_f32_16x16x32_bf16 v[24:27], v[80:83], v[16:19], 0
    v_mfma_f32_16x16x32_bf16 v[28:31], v[88:91], v[16:19], 0
    v_mfma_f32_16x16x32_bf16 v[24:27], v[84:87], v[20:23], v[24:27]
    v_mfma_f32_16x16x32_bf16 v[28:31], v[92:95], v[20:23], v[28:31]
    s_waitcnt vmcnt(4)
    buffer_load_dwordx4 v[56:59], v1, s[28:31], s68 offen offset:2048 nt
    s_waitcnt vmcnt(4)
    buffer_load_dwordx4 v[60:63], v1, s[28:31], s68 offen offset:2176 nt
    s_call_b64 s[76:77], L_score0
    s_waitcnt vmcnt(12)
    v_mfma_f32_16x16x32_bf16 v[8:11], v[36:39], v[96:99], v[8:11]
    v_and_b32 v36, v34, v4
    v_and_b32 v37, v34, v5
    v_and_b32 v38, v34, v6
    v_and_b32 v39, v34, v7
    v_mfma_f32_16x16x32_bf16 v[8:11], v[40:43], v[100:103], v[8:11]
    v_and_b32 v40, v35, v4
    v_and_b32 v41, v35, v5
    v_and_b32 v42, v35, v6
    v_and_b32 v43, v35, v7
    v_mfma_f32_16x16x32_bf16 v[8:11], v[36:39], v[104:107], v[8:11]
    s_nop 0
    v_mfma_f32_16x16x32_bf16 v[8:11], v[40:43], v[108:111], v[8:11]
    s_waitcnt vmcnt(4)
    buffer_load_dwordx4 v[64:67], v2, s[32:35], s68 offen offset:0 nt
    s_bitcmp0_b32 s82, 10
    s_cselect_b32 s91, s83, s69
    s_cselect_b32 s95, s71, 1.0
    s_bitcmp0_b32 s82, 10
    s_cbranch_scc1 L_upk_344
    s_add_u32 s92, s67, 5505024
    s_xor_b32 s78, s92, s67
    s_and_b32 s78, s78, 0xff800000
    s_xor_b32 s92, s92, s78
    s_call_b64 s[76:77], L_reload0
    s_branch L_upe_345
L_upk_344:
    v_accvgpr_read_b32 v40, a27
    v_accvgpr_read_b32 v41, a28
    v_accvgpr_read_b32 v42, a29
    v_accvgpr_read_b32 v43, a30
    v_accvgpr_read_b32 v44, a31
    v_accvgpr_read_b32 v45, a32
    v_accvgpr_read_b32 v46, a33
    v_accvgpr_read_b32 v47, a34
    v_accvgpr_read_b32 v32, a35
    v_accvgpr_read_b32 v33, a36
    v_accvgpr_read_b32 v34, a37
    v_accvgpr_read_b32 v35, a38
    v_accvgpr_read_b32 v36, a39
    s_call_b64 s[76:77], L_unpack32
L_upe_345:
    s_waitcnt vmcnt(4)
    buffer_load_dwordx4 v[68:71], v2, s[32:35], s68 offen offset:256 nt
    v_mfma_f32_16x16x32_bf16 v[24:27], v[32:35], v[16:19], 0
    v_mfma_f32_16x16x32_bf16 v[28:31], v[40:43], v[16:19], 0
    v_mfma_f32_16x16x32_bf16 v[24:27], v[36:39], v[20:23], v[24:27]
    v_mfma_f32_16x16x32_bf16 v[28:31], v[44:47], v[20:23], v[28:31]
    s_nop 6
    v_add_f32_dpp v32, v25, v24 quad_perm:[1,0,3,2] row_mask:0xf bank_mask:0xf
    v_add_f32_dpp v33, v27, v26 quad_perm:[1,0,3,2] row_mask:0xf bank_mask:0xf
    v_add_f32_dpp v34, v29, v28 quad_perm:[1,0,3,2] row_mask:0xf bank_mask:0xf
    v_add_f32_dpp v35, v31, v30 quad_perm:[1,0,3,2] row_mask:0xf bank_mask:0xf
    v_max3_f32 v36, v32, v33, v34
    v_max_f32 v36, v36, v35
    v_mul_f32 v36, s91, v36
    v_cmp_gt_f32 vcc, v36, v13
    s_waitcnt vmcnt(4)
    buffer_load_dwordx4 v[72:75], v2, s[32:35], s68 offen offset:2048 nt
    s_bitcmp0_b32 s82, 10
    s_cbranch_scc1 L_upk_346
    s_add_u32 s92, s67, 5505024
    s_xor_b32 s78, s92, s67
    s_and_b32 s78, s78, 0xff800000
    s_xor_b32 s92, s92, s78
    s_call_b64 s[76:77], L_reload1
    s_branch L_upe_347
L_upk_346:
    v_accvgpr_read_b32 v152, a40
    v_accvgpr_read_b32 v153, a41
    v_accvgpr_read_b32 v154, a42
    v_accvgpr_read_b32 v155, a43
    v_accvgpr_read_b32 v156, a44
    v_accvgpr_read_b32 v157, a45
    v_accvgpr_read_b32 v158, a46
    v_accvgpr_read_b32 v159, a47
    v_accvgpr_read_b32 v144, a48
    v_accvgpr_read_b32 v145, a49
    v_accvgpr_read_b32 v146, a50
    v_accvgpr_read_b32 v147, a51
    v_accvgpr_read_b32 v148, a52
    s_call_b64 s[76:77], L_unpack144
L_upe_347:
    s_waitcnt vmcnt(4)
    buffer_load_dwordx4 v[76:79], v2, s[32:35], s68 offen offset:2304 nt
    s_call_b64 s[76:77], L_soft1
    v_mfma_f32_16x16x32_bf16 v[8:11], v[36:39], v[144:147], v[8:11]
    v_and_b32 v36, v34, v4
    v_and_b32 v37, v34, v5
    v_and_b32 v38, v34, v6
    v_and_b32 v39, v34, v7
    v_mfma_f32_16x16x32_bf16 v[8:11], v[40:43], v[148:151], v[8:11]
    v_and_b32 v40, v35, v4
    v_and_b32 v41, v35, v5
    v_and_b32 v42, v35, v6
    v_and_b32 v43, v35, v7
    v_mfma_f32_16x16x32_bf16 v[8:11], v[36:39], v[152:155], v[8:11]
    s_nop 0
    v_mfma_f32_16x16x32_bf16 v[8:11], v[40:43], v[156:159], v[8:11]
    s_bitcmp1_b32 s64, 3
    s_cselect_b32 s78, 131072, 0
    s_add_u32 s79, s67, 1835008
    s_add_u32 s79, s79, s78
    s_xor_b32 s78, s79, s67
    s_and_b32 s78, s78, 0xff800000
    s_xor_b32 s79, s79, s78
    s_waitcnt vmcnt(4)
    buffer_load_dwordx4 v[80:83], v1, s[28:31], s79 offen offset:0 nt
    s_waitcnt vmcnt(4)
    buffer_load_dwordx4 v[84:87], v1, s[28:31], s79 offen offset:128 nt
    s_waitcnt vmcnt(14)
    v_mfma_f32_16x16x32_bf16 v[24:27], v[112:115], v[16:19], 0
    v_mfma_f32_16x16x32_bf16 v[28:31], v[120:123], v[16:19], 0
    v_mfma_f32_16x16x32_bf16 v[24:27], v[116:119], v[20:23], v[24:27]
    v_mfma_f32_16x16x32_bf16 v[28:31], v[124:127], v[20:23], v[28:31]
    s_waitcnt vmcnt(4)
    buffer_load_dwordx4 v[88:91], v1, s[28:31], s79 offen offset:2048 nt
    s_waitcnt vmcnt(4)
    buffer_load_dwordx4 v[92:95], v1, s[28:31], s79 offen offset:2176 nt
    s_call_b64 s[76:77], L_score0
    s_waitcnt vmcnt(12)
    v_mfma_f32_16x16x32_bf16 v[8:11], v[36:39], v[128:131], v[8:11]
    v_and_b32 v36, v34, v4
    v_and_b32 v37, v34, v5
    v_and_b32 v38, v34, v6
    v_and_b32 v39, v34, v7
    v_mfma_f32_16x16x32_bf16 v[8:11], v[40:43], v[132:135], v[8:11]
    v_and_b32 v40, v35, v4
    v_and_b32 v41, v35, v5
    v_and_b32 v42, v35, v6
    v_and_b32 v43, v35, v7
    v_mfma_f32_16x16x32_bf16 v[8:11], v[36:39], v[136:139], v[8:11]
    s_nop 0
    v_mfma_f32_16x16x32_bf16 v[8:11], v[40:43], v[140:143], v[8:11]
    s_waitcnt vmcnt(4)
    buffer_load_dwordx4 v[96:99], v2, s[32:35], s79 offen offset:0 nt
    s_bitcmp0_b32 s82, 11
    s_cselect_b32 s91, s83, s69
    s_cselect_b32 s95, s71, 1.0
    s_bitcmp0_b32 s82, 11
    s_cbranch_scc1 L_upk_350
    s_add_u32 s92, s67, 5636096
    s_xor_b32 s78, s92, s67
    s_and_b32 s78, s78, 0xff800000
    s_xor_b32 s92, s92, s78
    s_call_b64 s[76:77], L_reload0
    s_branch L_upe_351
L_upk_350:
    v_accvgpr_read_b32 v40, a53
    v_accvgpr_read_b32 v41, a54
    v_accvgpr_read_b32 v42, a55
    v_accvgpr_read_b32 v43, a56
    v_accvgpr_read_b32 v44, a57
    v_accvgpr_read_b32 v45, a58
    v_accvgpr_read_b32 v46, a59
    v_accvgpr_read_b32 v47, a60
    v_accvgpr_read_b32 v32, a61
    v_accvgpr_read_b32 v33, a62
    v_accvgpr_read_b32 v34, a63
    v_accvgpr_read_b32 v35, a64
    v_accvgpr_read_b32 v36, a65
    s_call_b64 s[76:77], L_unpack32
L_upe_351:
    s_waitcnt vmcnt(4)
    buffer_load_dwordx4 v[100:103], v2, s[32:35], s79 offen offset:256 nt
    v_mfma_f32_16x16x32_bf16 v[24:27], v[32:35], v[16:19], 0
    v_mfma_f32_16x16x32_bf16 v[28:31], v[40:43], v[16:19], 0
    v_mfma_f32_16x16x32_bf16 v[24:27], v[36:39], v[20:23], v[24:27]
    v_mfma_f32_16x16x32_bf16 v[28:31], v[44:47], v[20:23], v[28:31]
    s_nop 6
    v_add_f32_dpp v32, v25, v24 quad_perm:[1,0,3,2] row_mask:0xf bank_mask:0xf
    v_add_f32_dpp v33, v27, v26 quad_perm:[1,0,3,2] row_mask:0xf bank_mask:0xf
    v_add_f32_dpp v34, v29, v28 quad_perm:[1,0,3,2] row_mask:0xf bank_mask:0xf
    v_add_f32_dpp v35, v31, v30 quad_perm:[1,0,3,2] row_mask:0xf bank_mask:0xf
    v_max3_f32 v36, v32, v33, v34
    v_max_f32 v36, v36, v35
    v_mul_f32 v36, s91, v36
    v_cmp_gt_f32 vcc, v36, v13
    s_waitcnt vmcnt(4)
    buffer_load_dwordx4 v[104:107], v2, s[32:35], s79 offen offset:2048 nt
    s_bitcmp0_b32 s82, 11
    s_cbranch_scc1 L_upk_352
    s_add_u32 s92, s67, 5636096
    s_xor_b32 s78, s92, s67
    s_and_b32 s78, s78, 0xff800000
    s_xor_b32 s92, s92, s78
    s_call_b64 s[76:77], L_reload1
    s_branch L_upe_353
L_upk_352:
    v_accvgpr_read_b32 v152, a66
    v_accvgpr_read_b32 v153, a67
    v_accvgpr_read_b32 v154, a68
    v_accvgpr_read_b32 v155, a69
    v_accvgpr_read_b32 v156, a70
    v_accvgpr_read_b32 v157, a71
    v_accvgpr_read_b32 v158, a72
    v_accvgpr_read_b32 v159, a73
    v_accvgpr_read_b32 v144, a74
    v_accvgpr_read_b32 v145, a75
    v_accvgpr_read_b32 v146, a76
    v_accvgpr_read_b32 v147, a77
    v_accvgpr_read_b32 v148, a78
    s_call_b64 s[76:77], L_unpack144
L_upe_353:
    s_waitcnt vmcnt(4)
    buffer_load_dwordx4 v[108:111], v2, s[32:35], s79 offen offset:2304 nt
    s_call_b64 s[76:77], L_soft1
    v_mfma_f32_16x16x32_bf16 v[8:11], v[36:39], v[144:147], v[8:11]
    v_and_b32 v36, v34, v4
    v_and_b32 v37, v34, v5
    v_and_b32 v38, v34, v6
    v_and_b32 v39, v34, v7
    v_mfma_f32_16x16x32_bf16 v[8:11], v[40:43], v[148:151], v[8:11]
    v_and_b32 v40, v35, v4
    v_and_b32 v41, v35, v5
    v_and_b32 v42, v35, v6
    v_and_b32 v43, v35, v7
    v_mfma_f32_16x16x32_bf16 v[8:11], v[36:39], v[152:155], v[8:11]
    s_nop 0
    v_mfma_f32_16x16x32_bf16 v[8:11], v[40:43], v[156:159], v[8:11]
    s_add_u32 s68, s67, 2228224
    s_xor_b32 s78, s68, s67
    s_and_b32 s78, s78, 0xff800000
    s_xor_b32 s68, s68, s78
    s_waitcnt vmcnt(4)
    buffer_load_dwordx4 v[112:115], v1, s[28:31], s68 offen offset:0 nt
    s_waitcnt vmcnt(4)
    buffer_load_dwordx4 v[116:119], v1, s[28:31], s68 offen offset:128 nt
    s_waitcnt vmcnt(14)
    v_mfma_f32_16x16x32_bf16 v[24:27], v[48:51], v[16:19], 0
    v_mfma_f32_16x16x32_bf16 v[28:31], v[56:59], v[16:19], 0
    v_mfma_f32_16x16x32_bf16 v[24:27], v[52:55], v[20:23], v[24:27]
    v_mfma_f32_16x16x32_bf16 v[28:31], v[60:63], v[20:23], v[28:31]
    s_waitcnt vmcnt(4)
    buffer_load_dwordx4 v[120:123], v1, s[28:31], s68 offen offset:2048 nt
    s_waitcnt vmcnt(4)
    buffer_load_dwordx4 v[124:127], v1, s[28:31], s68 offen offset:2176 nt
    s_call_b64 s[76:77], L_score0
    s_waitcnt vmcnt(12)
    v_mfma_f32_16x16x32_bf16 v[8:11], v[36:39], v[64:67], v[8:11]
    v_and_b32 v36, v34, v4
    v_and_b32 v37, v34, v5
    v_and_b32 v38, v34, v6
    v_and_b32 v39, v34, v7
    v_mfma_f32_16x16x32_bf16 v[8:11], v[40:43], v[68:71], v[8:11]
    v_and_b32 v40, v35, v4
    v_and_b32 v41, v35, v5
    v_and_b32 v42, v35, v6
    v_and_b32 v43, v35, v7
    v_mfma_f32_16x16x32_bf16 v[8:11], v[36:39], v[72:75], v[8:11]
    s_nop 0
    v_mfma_f32_16x16x32_bf16 v[8:11], v[40:43], v[76:79], v[8:11]
    s_waitcnt vmcnt(4)
    buffer_load_dwordx4 v[128:131], v2, s[32:35], s68 offen offset:0 nt
    s_bitcmp0_b32 s82, 12
    s_cselect_b32 s91, s83, s69
    s_cselect_b32 s95, s71, 1.0
    s_bitcmp0_b32 s82, 12
    s_cbranch_scc1 L_upk_354
    s_add_u32 s92, s67, 5898240
    s_xor_b32 s78, s92, s67
    s_and_b32 s78, s78, 0xff800000
    s_xor_b32 s92, s92, s78
    s_call_b64 s[76:77], L_reload0
    s_branch L_upe_355
L_upk_354:
    v_accvgpr_read_b32 v40, a79
    v_accvgpr_read_b32 v41, a80
    v_accvgpr_read_b32 v42, a81
    v_accvgpr_read_b32 v43, a82
    v_accvgpr_read_b32 v44, a83
    v_accvgpr_read_b32 v45, a84
    v_accvgpr_read_b32 v46, a85
    v_accvgpr_read_b32 v47, a86
    v_accvgpr_read_b32 v32, a87
    v_accvgpr_read_b32 v33, a88
    v_accvgpr_read_b32 v34, a89
    v_accvgpr_read_b32 v35, a90
    v_accvgpr_read_b32 v36, a91
    s_call_b64 s[76:77], L_unpack32
L_upe_355:
    s_waitcnt vmcnt(4)
    buffer_load_dwordx4 v[132:135], v2, s[32:35], s68 offen offset:256 nt
    v_mfma_f32_16x16x32_bf16 v[24:27], v[32:35], v[16:19], 0
    v_mfma_f32_16x16x32_bf16 v[28:31], v[40:43], v[16:19], 0
    v_mfma_f32_16x16x32_bf16 v[24:27], v[36:39], v[20:23], v[24:27]
    v_mfma_f32_16x16x32_bf16 v[28:31], v[44:47], v[20:23], v[28:31]
    s_nop 6
    v_add_f32_dpp v32, v25, v24 quad_perm:[1,0,3,2] row_mask:0xf bank_mask:0xf
    v_add_f32_dpp v33, v27, v26 quad_perm:[1,0,3,2] row_mask:0xf bank_mask:0xf
    v_add_f32_dpp v34, v29, v28 quad_perm:[1,0,3,2] row_mask:0xf bank_mask:0xf
    v_add_f32_dpp v35, v31, v30 quad_perm:[1,0,3,2] row_mask:0xf bank_mask:0xf
    v_max3_f32 v36, v32, v33, v34
    v_max_f32 v36, v36, v35
    v_mul_f32 v36, s91, v36
    v_cmp_gt_f32 vcc, v36, v13
    s_waitcnt vmcnt(4)
    buffer_load_dwordx4 v[136:139], v2, s[32:35], s68 offen offset:2048 nt
    s_bitcmp0_b32 s82, 12
    s_cbranch_scc1 L_upk_356
    s_add_u32 s92, s67, 5898240
    s_xor_b32 s78, s92, s67
    s_and_b32 s78, s78, 0xff800000
    s_xor_b32 s92, s92, s78
    s_call_b64 s[76:77], L_reload1
    s_branch L_upe_357
L_upk_356:
    v_accvgpr_read_b32 v152, a92
    v_accvgpr_read_b32 v153, a93
    v_accvgpr_read_b32 v154, a94
    v_accvgpr_read_b32 v155, a95
    v_accvgpr_read_b32 v156, a96
    v_accvgpr_read_b32 v157, a97
    v_accvgpr_read_b32 v158, a98
    v_accvgpr_read_b32 v159, a99
    v_accvgpr_read_b32 v144, a100
    v_accvgpr_read_b32 v145, a101
    v_accvgpr_read_b32 v146, a102
    v_accvgpr_read_b32 v147, a103
    v_accvgpr_read_b32 v148, a104
    s_call_b64 s[76:77], L_unpack144
L_upe_357:
    s_waitcnt vmcnt(4)
    buffer_load_dwordx4 v[140:143], v2, s[32:35], s68 offen offset:2304 nt
    s_call_b64 s[76:77], L_soft1
    v_mfma_f32_16x16x32_bf16 v[8:11], v[36:39], v[144:147], v[8:11]
    v_and_b32 v36, v34, v4
    v_and_b32 v37, v34, v5
    v_and_b32 v38, v34, v6
    v_and_b32 v39, v34, v7
    v_mfma_f32_16x16x32_bf16 v[8:11], v[40:43], v[148:151], v[8:11]
    v_and_b32 v40, v35, v4
    v_and_b32 v41, v35, v5
    v_and_b32 v42, v35, v6
    v_and_b32 v43, v35, v7
    v_mfma_f32_16x16x32_bf16 v[8:11], v[36:39], v[152:155], v[8:11]
    s_nop 0
    v_mfma_f32_16x16x32_bf16 v[8:11], v[40:43], v[156:159], v[8:11]
    s_bitcmp1_b32 s64, 3
    s_cselect_b32 s78, -393216, 0
    s_add_u32 s79, s67, 2490368
    s_add_u32 s79, s79, s78
    s_xor_b32 s78, s79, s67
    s_and_b32 s78, s78, 0xff800000
    s_xor_b32 s79, s79, s78
    s_waitcnt vmcnt(4)
    buffer_load_dwordx4 v[48:51], v1, s[28:31], s79 offen offset:0 nt
    s_waitcnt vmcnt(4)
    buffer_load_dwordx4 v[52:55], v1, s[28:31], s79 offen offset:128 nt
    s_waitcnt vmcnt(14)
    v_mfma_f32_16x16x32_bf16 v[24:27], v[80:83], v[16:19], 0
    v_mfma_f32_16x16x32_bf16 v[28:31], v[88:91], v[16:19], 0
    v_mfma_f32_16x16x32_bf16 v[24:27], v[84:87], v[20:23], v[24:27]
    v_mfma_f32_16x16x32_bf16 v[28:31], v[92:95], v[20:23], v[28:31]
    s_waitcnt vmcnt(4)
    buffer_load_dwordx4 v[56:59], v1, s[28:31], s79 offen offset:2048 nt
    s_waitcnt vmcnt(4)
    buffer_load_dwordx4 v[60:63], v1, s[28:31], s79 offen offset:2176 nt
    s_call_b64 s[76:77], L_score0
    s_waitcnt vmcnt(12)
    v_mfma_f32_16x16x32_bf16 v[8:11], v[36:39], v[96:99], v[8:11]
    v_and_b32 v36, v34, v4
    v_and_b32 v37, v34, v5
    v_and_b32 v38, v34, v6
    v_and_b32 v39, v34, v7
    v_mfma_f32_16x16x32_bf16 v[8:11], v[40:43], v[100:103], v[8:11]
    v_and_b32 v40, v35, v4
    v_and_b32 v41, v35, v5
    v_and_b32 v42, v35, v6
    v_and_b32 v43, v35, v7
    v_mfma_f32_16x16x32_bf16 v[8:11], v[36:39], v[104:107], v[8:11]
    s_nop 0
    v_mfma_f32_16x16x32_bf16 v[8:11], v[40:43], v[108:111], v[8:11]
    s_waitcnt vmcnt(4)
    buffer_load_dwordx4 v[64:67], v2, s[32:35], s79 offen offset:0 nt
    s_bitcmp0_b32 s82, 13
    s_cselect_b32 s91, s83, s69
    s_cselect_b32 s95, s71, 1.0
    s_bitcmp0_b32 s82, 13
    s_cbranch_scc1 L_upk_360
    s_add_u32 s92, s67, 6029312
    s_xor_b32 s78, s92, s67
    s_and_b32 s78, s78, 0xff800000
    s_xor_b32 s92, s92, s78
    s_call_b64 s[76:77], L_reload0
    s_branch L_upe_361
L_upk_360:
    v_accvgpr_read_b32 v40, a105
    v_accvgpr_read_b32 v41, a106
    v_accvgpr_read_b32 v42, a107
    v_accvgpr_read_b32 v43, a108
    v_accvgpr_read_b32 v44, a109
    v_accvgpr_read_b32 v45, a110
    v_accvgpr_read_b32 v46, a111
    v_accvgpr_read_b32 v47, a112
    v_accvgpr_read_b32 v32, a113
    v_accvgpr_read_b32 v33, a114
    v_accvgpr_read_b32 v34, a115
    v_accvgpr_read_b32 v35, a116
    v_accvgpr_read_b32 v36, a117
    s_call_b64 s[76:77], L_unpack32
L_upe_361:
    s_waitcnt vmcnt(4)
    buffer_load_dwordx4 v[68:71], v2, s[32:35], s79 offen offset:256 nt
    v_mfma_f32_16x16x32_bf16 v[24:27], v[32:35], v[16:19], 0
    v_mfma_f32_16x16x32_bf16 v[28:31], v[40:43], v[16:19], 0
    v_mfma_f32_16x16x32_bf16 v[24:27], v[36:39], v[20:23], v[24:27]
    v_mfma_f32_16x16x32_bf16 v[28:31], v[44:47], v[20:23], v[28:31]
    s_nop 6
    v_add_f32_dpp v32, v25, v24 quad_perm:[1,0,3,2] row_mask:0xf bank_mask:0xf
    v_add_f32_dpp v33, v27, v26 quad_perm:[1,0,3,2] row_mask:0xf bank_mask:0xf
    v_add_f32_dpp v34, v29, v28 quad_perm:[1,0,3,2] row_mask:0xf bank_mask:0xf
    v_add_f32_dpp v35, v31, v30 quad_perm:[1,0,3,2] row_mask:0xf bank_mask:0xf
    v_max3_f32 v36, v32, v33, v34
    v_max_f32 v36, v36, v35
    v_mul_f32 v36, s91, v36
    v_cmp_gt_f32 vcc, v36, v13
    s_waitcnt vmcnt(4)
    buffer_load_dwordx4 v[72:75], v2, s[32:35], s79 offen offset:2048 nt
    s_bitcmp0_b32 s82, 13
    s_cbranch_scc1 L_upk_362
    s_add_u32 s92, s67, 6029312
    s_xor_b32 s78, s92, s67
    s_and_b32 s78, s78, 0xff800000
    s_xor_b32 s92, s92, s78
    s_call_b64 s[76:77], L_reload1
    s_branch L_upe_363
L_upk_362:
    v_accvgpr_read_b32 v152, a118
    v_accvgpr_read_b32 v153, a119
    v_accvgpr_read_b32 v154, a120
    v_accvgpr_read_b32 v155, a121
    v_accvgpr_read_b32 v156, a122
    v_accvgpr_read_b32 v157, a123
    v_accvgpr_read_b32 v158, a124
    v_accvgpr_read_b32 v159, a125
    v_accvgpr_read_b32 v144, a126
    v_accvgpr_read_b32 v145, a127
    v_accvgpr_read_b32 v146, a128
    v_accvgpr_read_b32 v147, a129
    v_accvgpr_read_b32 v148, a130
    s_call_b64 s[76:77], L_unpack144
L_upe_363:
    s_waitcnt vmcnt(4)
    buffer_load_dwordx4 v[76:79], v2, s[32:35], s79 offen offset:2304 nt
    s_call_b64 s[76:77], L_soft1
    v_mfma_f32_16x16x32_bf16 v[8:11], v[36:39], v[144:147], v[8:11]
    v_and_b32 v36, v34, v4
    v_and_b32 v37, v34, v5
    v_and_b32 v38, v34, v6
    v_and_b32 v39, v34, v7
    v_mfma_f32_16x16x32_bf16 v[8:11], v[40:43], v[148:151], v[8:11]
    v_and_b32 v40, v35, v4
    v_and_b32 v41, v35, v5
    v_and_b32 v42, v35, v6
    v_and_b32 v43, v35, v7
    v_mfma_f32_16x16x32_bf16 v[8:11], v[36:39], v[152:155], v[8:11]
    s_nop 0
    v_mfma_f32_16x16x32_bf16 v[8:11], v[40:43], v[156:159], v[8:11]
    s_bitcmp1_b32 s64, 3
    s_cselect_b32 s78, 393216, 0
    s_add_u32 s68, s67, 2097152
    s_add_u32 s68, s68, s78
    s_xor_b32 s78, s68, s67
    s_and_b32 s78, s78, 0xff800000
    s_xor_b32 s68, s68, s78
    s_waitcnt vmcnt(4)
    buffer_load_dwordx4 v[80:83], v1, s[28:31], s68 offen offset:0 nt
    s_waitcnt vmcnt(4)
    buffer_load_dwordx4 v[84:87], v1, s[28:31], s68 offen offset:128 nt
    s_waitcnt vmcnt(4)
    buffer_load_dwordx4 v[88:91], v1, s[28:31], s68 offen offset:2048 nt
    s_waitcnt vmcnt(4)
    buffer_load_dwordx4 v[92:95], v1, s[28:31], s68 offen offset:2176 nt
    s_waitcnt vmcnt(16)
    v_mfma_f32_16x16x32_bf16 v[24:27], v[112:115], v[16:19], 0
    v_mfma_f32_16x16x32_bf16 v[28:31], v[120:123], v[16:19], 0
    v_mfma_f32_16x16x32_bf16 v[24:27], v[116:119], v[20:23], v[24:27]
    v_mfma_f32_16x16x32_bf16 v[28:31], v[124:127], v[20:23], v[28:31]
    s_waitcnt vmcnt(4)
    buffer_load_dwordx4 v[96:99], v2, s[32:35], s68 offen offset:0 nt
    s_waitcnt vmcnt(4)
    buffer_load_dwordx4 v[100:103], v2, s[32:35], s68 offen offset:256 nt
    s_waitcnt vmcnt(4)
    buffer_load_dwordx4 v[104:107], v2, s[32:35], s68 offen offset:2048 nt
    s_waitcnt vmcnt(4)
    buffer_load_dwordx4 v[108:111], v2, s[32:35], s68 offen offset:2304 nt
    s_call_b64 s[76:77], L_score0
    s_waitcnt vmcnt(16)
    v_mfma_f32_16x16x32_bf16 v[8:11], v[36:39], v[128:131], v[8:11]
    v_and_b32 v36, v34, v4
    v_and_b32 v37, v34, v5
    v_and_b32 v38, v34, v6
    v_and_b32 v39, v34, v7
    v_mfma_f32_16x16x32_bf16 v[8:11], v[40:43], v[132:135], v[8:11]
    v_and_b32 v40, v35, v4
    v_and_b32 v41, v35, v5
    v_and_b32 v42, v35, v6
    v_and_b32 v43, v35, v7
    v_mfma_f32_16x16x32_bf16 v[8:11], v[36:39], v[136:139], v[8:11]
    s_nop 0
    v_mfma_f32_16x16x32_bf16 v[8:11], v[40:43], v[140:143], v[8:11]
    s_bitcmp1_b32 s64, 3
    s_cselect_b32 s78, -393216, 0
    s_add_u32 s79, s67, 2752512
    s_add_u32 s79, s79, s78
    s_xor_b32 s78, s79, s67
    s_and_b32 s78, s78, 0xff800000
    s_xor_b32 s79, s79, s78
    s_waitcnt vmcnt(4)
    buffer_load_dwordx4 v[112:115], v1, s[28:31], s79 offen offset:0 nt
    s_waitcnt vmcnt(4)
    buffer_load_dwordx4 v[116:119], v1, s[28:31], s79 offen offset:128 nt
    s_waitcnt vmcnt(14)
    v_mfma_f32_16x16x32_bf16 v[24:27], v[48:51], v[16:19], 0
    v_mfma_f32_16x16x32_bf16 v[28:31], v[56:59], v[16:19], 0
    v_mfma_f32_16x16x32_bf16 v[24:27], v[52:55], v[20:23], v[24:27]
    v_mfma_f32_16x16x32_bf16 v[28:31], v[60:63], v[20:23], v[28:31]
    s_waitcnt vmcnt(4)
    buffer_load_dwordx4 v[120:123], v1, s[28:31], s79 offen offset:2048 nt
    s_waitcnt vmcnt(4)
    buffer_load_dwordx4 v[124:127], v1, s[28:31], s79 offen offset:2176 nt
    s_call_b64 s[76:77], L_score0
    s_waitcnt vmcnt(12)
    v_mfma_f32_16x16x32_bf16 v[8:11], v[36:39], v[64:67], v[8:11]
    v_and_b32 v36, v34, v4
    v_and_b32 v37, v34, v5
    v_and_b32 v38, v34, v6
    v_and_b32 v39, v34, v7
    v_mfma_f32_16x16x32_bf16 v[8:11], v[40:43], v[68:71], v[8:11]
    v_and_b32 v40, v35, v4
    v_and_b32 v41, v35, v5
    v_and_b32 v42, v35, v6
    v_and_b32 v43, v35, v7
    v_mfma_f32_16x16x32_bf16 v[8:11], v[36:39], v[72:75], v[8:11]
    s_nop 0
    v_mfma_f32_16x16x32_bf16 v[8:11], v[40:43], v[76:79], v[8:11]
    s_waitcnt vmcnt(4)
    buffer_load_dwordx4 v[128:131], v2, s[32:35], s79 offen offset:0 nt
    s_bitcmp0_b32 s82, 14
    s_cselect_b32 s91, s83, s69
    s_cselect_b32 s95, s71, 1.0
    s_bitcmp0_b32 s82, 14
    s_cbranch_scc1 L_upk_368
    s_add_u32 s92, s67, 6291456
    s_xor_b32 s78, s92, s67
    s_and_b32 s78, s78, 0xff800000
    s_xor_b32 s92, s92, s78
    s_call_b64 s[76:77], L_reload0
    s_branch L_upe_369
L_upk_368:
    v_accvgpr_read_b32 v40, a131
    v_accvgpr_read_b32 v41, a132
    v_accvgpr_read_b32 v42, a133
    v_accvgpr_read_b32 v43, a134
    v_accvgpr_read_b32 v44, a135
    v_accvgpr_read_b32 v45, a136
    v_accvgpr_read_b32 v46, a137
    v_accvgpr_read_b32 v47, a138
    v_accvgpr_read_b32 v32, a139
    v_accvgpr_read_b32 v33, a140
    v_accvgpr_read_b32 v34, a141
    v_accvgpr_read_b32 v35, a142
    v_accvgpr_read_b32 v36, a143
    s_call_b64 s[76:77], L_unpack32
L_upe_369:
    s_waitcnt vmcnt(4)
    buffer_load_dwordx4 v[132:135], v2, s[32:35], s79 offen offset:256 nt
    v_mfma_f32_16x16x32_bf16 v[24:27], v[32:35], v[16:19], 0
    v_mfma_f32_16x16x32_bf16 v[28:31], v[40:43], v[16:19], 0
    v_mfma_f32_16x16x32_bf16 v[24:27], v[36:39], v[20:23], v[24:27]
    v_mfma_f32_16x16x32_bf16 v[28:31], v[44:47], v[20:23], v[28:31]
    s_nop 6
    v_add_f32_dpp v32, v25, v24 quad_perm:[1,0,3,2] row_mask:0xf bank_mask:0xf
    v_add_f32_dpp v33, v27, v26 quad_perm:[1,0,3,2] row_mask:0xf bank_mask:0xf
    v_add_f32_dpp v34, v29, v28 quad_perm:[1,0,3,2] row_mask:0xf bank_mask:0xf
    v_add_f32_dpp v35, v31, v30 quad_perm:[1,0,3,2] row_mask:0xf bank_mask:0xf
    v_max3_f32 v36, v32, v33, v34
    v_max_f32 v36, v36, v35
    v_mul_f32 v36, s91, v36
    v_cmp_gt_f32 vcc, v36, v13
    s_waitcnt vmcnt(4)
    buffer_load_dwordx4 v[136:139], v2, s[32:35], s79 offen offset:2048 nt
    s_bitcmp0_b32 s82, 14
    s_cbranch_scc1 L_upk_370
    s_add_u32 s92, s67, 6291456
    s_xor_b32 s78, s92, s67
    s_and_b32 s78, s78, 0xff800000
    s_xor_b32 s92, s92, s78
    s_call_b64 s[76:77], L_reload1
    s_branch L_upe_371
L_upk_370:
    v_accvgpr_read_b32 v152, a144
    v_accvgpr_read_b32 v153, a145
    v_accvgpr_read_b32 v154, a146
    v_accvgpr_read_b32 v155, a147
    v_accvgpr_read_b32 v156, a148
    v_accvgpr_read_b32 v157, a149
    v_accvgpr_read_b32 v158, a150
    v_accvgpr_read_b32 v159, a151
    v_accvgpr_read_b32 v144, a152
    v_accvgpr_read_b32 v145, a153
    v_accvgpr_read_b32 v146, a154
    v_accvgpr_read_b32 v147, a155
    v_accvgpr_read_b32 v148, a156
    s_call_b64 s[76:77], L_unpack144
L_upe_371:
    s_waitcnt vmcnt(4)
    buffer_load_dwordx4 v[140:143], v2, s[32:35], s79 offen offset:2304 nt
    s_call_b64 s[76:77], L_soft1
    v_mfma_f32_16x16x32_bf16 v[8:11], v[36:39], v[144:147], v[8:11]
    v_and_b32 v36, v34, v4
    v_and_b32 v37, v34, v5
    v_and_b32 v38, v34, v6
    v_and_b32 v39, v34, v7
    v_mfma_f32_16x16x32_bf16 v[8:11], v[40:43], v[148:151], v[8:11]
    v_and_b32 v40, v35, v4
    v_and_b32 v41, v35, v5
    v_and_b32 v42, v35, v6
    v_and_b32 v43, v35, v7
    v_mfma_f32_16x16x32_bf16 v[8:11], v[36:39], v[152:155], v[8:11]
    s_nop 0
    v_mfma_f32_16x16x32_bf16 v[8:11], v[40:43], v[156:159], v[8:11]
    s_bitcmp1_b32 s64, 3
    s_cselect_b32 s78, 393216, 0
    s_add_u32 s68, s67, 2359296
    s_add_u32 s68, s68, s78
    s_xor_b32 s78, s68, s67
    s_and_b32 s78, s78, 0xff800000
    s_xor_b32 s68, s68, s78
    s_waitcnt vmcnt(4)
    buffer_load_dwordx4 v[48:51], v1, s[28:31], s68 offen offset:0 nt
    s_waitcnt vmcnt(4)
    buffer_load_dwordx4 v[52:55], v1, s[28:31], s68 offen offset:128 nt
    s_waitcnt vmcnt(14)
    v_mfma_f32_16x16x32_bf16 v[24:27], v[80:83], v[16:19], 0
    v_mfma_f32_16x16x32_bf16 v[28:31], v[88:91], v[16:19], 0
    v_mfma_f32_16x16x32_bf16 v[24:27], v[84:87], v[20:23], v[24:27]
    v_mfma_f32_16x16x32_bf16 v[28:31], v[92:95], v[20:23], v[28:31]
    s_waitcnt vmcnt(4)
    buffer_load_dwordx4 v[56:59], v1, s[28:31], s68 offen offset:2048 nt
    s_waitcnt vmcnt(4)
    buffer_load_dwordx4 v[60:63], v1, s[28:31], s68 offen offset:2176 nt
    s_call_b64 s[76:77], L_score0
    s_waitcnt vmcnt(12)
    v_mfma_f32_16x16x32_bf16 v[8:11], v[36:39], v[96:99], v[8:11]
    v_and_b32 v36, v34, v4
    v_and_b32 v37, v34, v5
    v_and_b32 v38, v34, v6
    v_and_b32 v39, v34, v7
    v_mfma_f32_16x16x32_bf16 v[8:11], v[40:43], v[100:103], v[8:11]
    v_and_b32 v40, v35, v4
    v_and_b32 v41, v35, v5
    v_and_b32 v42, v35, v6
    v_and_b32 v43, v35, v7
    v_mfma_f32_16x16x32_bf16 v[8:11], v[36:39], v[104:107], v[8:11]
    s_nop 0
    v_mfma_f32_16x16x32_bf16 v[8:11], v[40:43], v[108:111], v[8:11]
    s_waitcnt vmcnt(4)
    buffer_load_dwordx4 v[64:67], v2, s[32:35], s68 offen offset:0 nt
    s_bitcmp0_b32 s82, 15
    s_cselect_b32 s91, s83, s69
    s_cselect_b32 s95, s71, 1.0
    s_bitcmp0_b32 s82, 15
    s_cbranch_scc1 L_upk_374
    s_add_u32 s92, s67, 6553600
    s_xor_b32 s78, s92, s67
    s_and_b32 s78, s78, 0xff800000
    s_xor_b32 s92, s92, s78
    s_call_b64 s[76:77], L_reload0
    s_branch L_upe_375
L_upk_374:
    v_accvgpr_read_b32 v40, a157
    v_accvgpr_read_b32 v41, a158
    v_accvgpr_read_b32 v42, a159
    v_accvgpr_read_b32 v43, a160
    v_accvgpr_read_b32 v44, a161
    v_accvgpr_read_b32 v45, a162
    v_accvgpr_read_b32 v46, a163
    v_accvgpr_read_b32 v47, a164
    v_accvgpr_read_b32 v32, a165
    v_accvgpr_read_b32 v33, a166
    v_accvgpr_read_b32 v34, a167
    v_accvgpr_read_b32 v35, a168
    v_accvgpr_read_b32 v36, a169
    s_call_b64 s[76:77], L_unpack32
L_upe_375:
    s_waitcnt vmcnt(4)
    buffer_load_dwordx4 v[68:71], v2, s[32:35], s68 offen offset:256 nt
    v_mfma_f32_16x16x32_bf16 v[24:27], v[32:35], v[16:19], 0
    v_mfma_f32_16x16x32_bf16 v[28:31], v[40:43], v[16:19], 0
    v_mfma_f32_16x16x32_bf16 v[24:27], v[36:39], v[20:23], v[24:27]
    v_mfma_f32_16x16x32_bf16 v[28:31], v[44:47], v[20:23], v[28:31]
    s_nop 6
    v_add_f32_dpp v32, v25, v24 quad_perm:[1,0,3,2] row_mask:0xf bank_mask:0xf
    v_add_f32_dpp v33, v27, v26 quad_perm:[1,0,3,2] row_mask:0xf bank_mask:0xf
    v_add_f32_dpp v34, v29, v28 quad_perm:[1,0,3,2] row_mask:0xf bank_mask:0xf
    v_add_f32_dpp v35, v31, v30 quad_perm:[1,0,3,2] row_mask:0xf bank_mask:0xf
    v_max3_f32 v36, v32, v33, v34
    v_max_f32 v36, v36, v35
    v_mul_f32 v36, s91, v36
    v_cmp_gt_f32 vcc, v36, v13
    s_waitcnt vmcnt(4)
    buffer_load_dwordx4 v[72:75], v2, s[32:35], s68 offen offset:2048 nt
    s_bitcmp0_b32 s82, 15
    s_cbranch_scc1 L_upk_376
    s_add_u32 s92, s67, 6553600
    s_xor_b32 s78, s92, s67
    s_and_b32 s78, s78, 0xff800000
    s_xor_b32 s92, s92, s78
    s_call_b64 s[76:77], L_reload1
    s_branch L_upe_377
L_upk_376:
    v_accvgpr_read_b32 v152, a170
    v_accvgpr_read_b32 v153, a171
    v_accvgpr_read_b32 v154, a172
    v_accvgpr_read_b32 v155, a173
    v_accvgpr_read_b32 v156, a174
    v_accvgpr_read_b32 v157, a175
    v_accvgpr_read_b32 v158, a176
    v_accvgpr_read_b32 v159, a177
    v_accvgpr_read_b32 v144, a178
    v_accvgpr_read_b32 v145, a179
    v_accvgpr_read_b32 v146, a180
    v_accvgpr_read_b32 v147, a181
    v_accvgpr_read_b32 v148, a182
    s_call_b64 s[76:77], L_unpack144
L_upe_377:
    s_waitcnt vmcnt(4)
    buffer_load_dwordx4 v[76:79], v2, s[32:35], s68 offen offset:2304 nt
    s_call_b64 s[76:77], L_soft1
    v_mfma_f32_16x16x32_bf16 v[8:11], v[36:39], v[144:147], v[8:11]
    v_and_b32 v36, v34, v4
    v_and_b32 v37, v34, v5
    v_and_b32 v38, v34, v6
    v_and_b32 v39, v34, v7
    v_mfma_f32_16x16x32_bf16 v[8:11], v[40:43], v[148:151], v[8:11]
    v_and_b32 v40, v35, v4
    v_and_b32 v41, v35, v5
    v_and_b32 v42, v35, v6
    v_and_b32 v43, v35, v7
    v_mfma_f32_16x16x32_bf16 v[8:11], v[36:39], v[152:155], v[8:11]
    s_nop 0
    v_mfma_f32_16x16x32_bf16 v[8:11], v[40:43], v[156:159], v[8:11]
    s_add_u32 s79, s67, 3014656
    s_xor_b32 s78, s79, s67
    s_and_b32 s78, s78, 0xff800000
    s_xor_b32 s79, s79, s78
    s_waitcnt vmcnt(4)
    buffer_load_dwordx4 v[80:83], v1, s[28:31], s79 offen offset:0 nt
    s_waitcnt vmcnt(4)
    buffer_load_dwordx4 v[84:87], v1, s[28:31], s79 offen offset:128 nt
    s_waitcnt vmcnt(14)
    v_mfma_f32_16x16x32_bf16 v[24:27], v[112:115], v[16:19], 0
    v_mfma_f32_16x16x32_bf16 v[28:31], v[120:123], v[16:19], 0
    v_mfma_f32_16x16x32_bf16 v[24:27], v[116:119], v[20:23], v[24:27]
    v_mfma_f32_16x16x32_bf16 v[28:31], v[124:127], v[20:23], v[28:31]
    s_waitcnt vmcnt(4)
    buffer_load_dwordx4 v[88:91], v1, s[28:31], s79 offen offset:2048 nt
    s_waitcnt vmcnt(4)
    buffer_load_dwordx4 v[92:95], v1, s[28:31], s79 offen offset:2176 nt
    s_call_b64 s[76:77], L_score0
    s_waitcnt vmcnt(12)
    v_mfma_f32_16x16x32_bf16 v[8:11], v[36:39], v[128:131], v[8:11]
    v_and_b32 v36, v34, v4
    v_and_b32 v37, v34, v5
    v_and_b32 v38, v34, v6
    v_and_b32 v39, v34, v7
    v_mfma_f32_16x16x32_bf16 v[8:11], v[40:43], v[132:135], v[8:11]
    v_and_b32 v40, v35, v4
    v_and_b32 v41, v35, v5
    v_and_b32 v42, v35, v6
    v_and_b32 v43, v35, v7
    v_mfma_f32_16x16x32_bf16 v[8:11], v[36:39], v[136:139], v[8:11]
    s_nop 0
    v_mfma_f32_16x16x32_bf16 v[8:11], v[40:43], v[140:143], v[8:11]
    s_waitcnt vmcnt(4)
    buffer_load_dwordx4 v[96:99], v2, s[32:35], s79 offen offset:0 nt
    s_bitcmp0_b32 s82, 16
    s_cselect_b32 s91, s83, s69
    s_cselect_b32 s95, s71, 1.0
    s_bitcmp0_b32 s82, 16
    s_cbranch_scc1 L_upk_378
    s_add_u32 s92, s67, 6684672
    s_xor_b32 s78, s92, s67
    s_and_b32 s78, s78, 0xff800000
    s_xor_b32 s92, s92, s78
    s_call_b64 s[76:77], L_reload0
    s_branch L_upe_379
L_upk_378:
    v_accvgpr_read_b32 v40, a183
    v_accvgpr_read_b32 v41, a184
    v_accvgpr_read_b32 v42, a185
    v_accvgpr_read_b32 v43, a186
    v_accvgpr_read_b32 v44, a187
    v_accvgpr_read_b32 v45, a188
    v_accvgpr_read_b32 v46, a189
    v_accvgpr_read_b32 v47, a190
    v_accvgpr_read_b32 v32, a191
    v_accvgpr_read_b32 v33, a192
    v_accvgpr_read_b32 v34, a193
    v_accvgpr_read_b32 v35, a194
    v_accvgpr_read_b32 v36, a195
    s_call_b64 s[76:77], L_unpack32
L_upe_379:
    s_waitcnt vmcnt(4)
    buffer_load_dwordx4 v[100:103], v2, s[32:35], s79 offen offset:256 nt
    v_mfma_f32_16x16x32_bf16 v[24:27], v[32:35], v[16:19], 0
    v_mfma_f32_16x16x32_bf16 v[28:31], v[40:43], v[16:19], 0
    v_mfma_f32_16x16x32_bf16 v[24:27], v[36:39], v[20:23], v[24:27]
    v_mfma_f32_16x16x32_bf16 v[28:31], v[44:47], v[20:23], v[28:31]
    s_nop 6
    v_add_f32_dpp v32, v25, v24 quad_perm:[1,0,3,2] row_mask:0xf bank_mask:0xf
    v_add_f32_dpp v33, v27, v26 quad_perm:[1,0,3,2] row_mask:0xf bank_mask:0xf
    v_add_f32_dpp v34, v29, v28 quad_perm:[1,0,3,2] row_mask:0xf bank_mask:0xf
    v_add_f32_dpp v35, v31, v30 quad_perm:[1,0,3,2] row_mask:0xf bank_mask:0xf
    v_max3_f32 v36, v32, v33, v34
    v_max_f32 v36, v36, v35
    v_mul_f32 v36, s91, v36
    v_cmp_gt_f32 vcc, v36, v13
    s_waitcnt vmcnt(4)
    buffer_load_dwordx4 v[104:107], v2, s[32:35], s79 offen offset:2048 nt
    s_bitcmp0_b32 s82, 16
    s_cbranch_scc1 L_upk_380
    s_add_u32 s92, s67, 6684672
    s_xor_b32 s78, s92, s67
    s_and_b32 s78, s78, 0xff800000
    s_xor_b32 s92, s92, s78
    s_call_b64 s[76:77], L_reload1
    s_branch L_upe_381
L_upk_380:
    v_accvgpr_read_b32 v152, a196
    v_accvgpr_read_b32 v153, a197
    v_accvgpr_read_b32 v154, a198
    v_accvgpr_read_b32 v155, a199
    v_accvgpr_read_b32 v156, a200
    v_accvgpr_read_b32 v157, a201
    v_accvgpr_read_b32 v158, a202
    v_accvgpr_read_b32 v159, a203
    v_accvgpr_read_b32 v144, a204
    v_accvgpr_read_b32 v145, a205
    v_accvgpr_read_b32 v146, a206
    v_accvgpr_read_b32 v147, a207
    v_accvgpr_read_b32 v148, a208
    s_call_b64 s[76:77], L_unpack144
L_upe_381:
    s_waitcnt vmcnt(4)
    buffer_load_dwordx4 v[108:111], v2, s[32:35], s79 offen offset:2304 nt
    s_call_b64 s[76:77], L_soft1
    v_mfma_f32_16x16x32_bf16 v[8:11], v[36:39], v[144:147], v[8:11]
    v_and_b32 v36, v34, v4
    v_and_b32 v37, v34, v5
    v_and_b32 v38, v34, v6
    v_and_b32 v39, v34, v7
    v_mfma_f32_16x16x32_bf16 v[8:11], v[40:43], v[148:151], v[8:11]
    v_and_b32 v40, v35, v4
    v_and_b32 v41, v35, v5
    v_and_b32 v42, v35, v6
    v_and_b32 v43, v35, v7
    v_mfma_f32_16x16x32_bf16 v[8:11], v[36:39], v[152:155], v[8:11]
    s_nop 0
    v_mfma_f32_16x16x32_bf16 v[8:11], v[40:43], v[156:159], v[8:11]
    s_bitcmp1_b32 s64, 3
    s_cselect_b32 s78, -524288, 0
    s_add_u32 s68, s67, 3145728
    s_add_u32 s68, s68, s78
    s_xor_b32 s78, s68, s67
    s_and_b32 s78, s78, 0xff800000
    s_xor_b32 s68, s68, s78
    s_waitcnt vmcnt(4)
    buffer_load_dwordx4 v[112:115], v1, s[28:31], s68 offen offset:0 nt
    s_waitcnt vmcnt(4)
    buffer_load_dwordx4 v[116:119], v1, s[28:31], s68 offen offset:128 nt
    s_waitcnt vmcnt(4)
    buffer_load_dwordx4 v[120:123], v1, s[28:31], s68 offen offset:2048 nt
    s_waitcnt vmcnt(4)
    buffer_load_dwordx4 v[124:127], v1, s[28:31], s68 offen offset:2176 nt
    s_waitcnt vmcnt(16)
    v_mfma_f32_16x16x32_bf16 v[24:27], v[48:51], v[16:19], 0
    v_mfma_f32_16x16x32_bf16 v[28:31], v[56:59], v[16:19], 0
    v_mfma_f32_16x16x32_bf16 v[24:27], v[52:55], v[20:23], v[24:27]
    v_mfma_f32_16x16x32_bf16 v[28:31], v[60:63], v[20:23], v[28:31]
    s_waitcnt vmcnt(4)
    buffer_load_dwordx4 v[128:131], v2, s[32:35], s68 offen offset:0 nt
    s_waitcnt vmcnt(4)
    buffer_load_dwordx4 v[132:135], v2, s[32:35], s68 offen offset:256 nt
    s_waitcnt vmcnt(4)
    buffer_load_dwordx4 v[136:139], v2, s[32:35], s68 offen offset:2048 nt
    s_waitcnt vmcnt(4)
    buffer_load_dwordx4 v[140:143], v2, s[32:35], s68 offen offset:2304 nt
    s_call_b64 s[76:77], L_score0
    s_waitcnt vmcnt(16)
    v_mfma_f32_16x16x32_bf16 v[8:11], v[36:39], v[64:67], v[8:11]
    v_and_b32 v36, v34, v4
    v_and_b32 v37, v34, v5
    v_and_b32 v38, v34, v6
    v_and_b32 v39, v34, v7
    v_mfma_f32_16x16x32_bf16 v[8:11], v[40:43], v[68:71], v[8:11]
    v_and_b32 v40, v35, v4
    v_and_b32 v41, v35, v5
    v_and_b32 v42, v35, v6
    v_and_b32 v43, v35, v7
    v_mfma_f32_16x16x32_bf16 v[8:11], v[36:39], v[72:75], v[8:11]
    s_nop 0
    v_mfma_f32_16x16x32_bf16 v[8:11], v[40:43], v[76:79], v[8:11]
    s_bitcmp1_b32 s64, 3
    s_cselect_b32 s78, 524288, 0
    s_add_u32 s79, s67, 2621440
    s_add_u32 s79, s79, s78
    s_xor_b32 s78, s79, s67
    s_and_b32 s78, s78, 0xff800000
    s_xor_b32 s79, s79, s78
    s_waitcnt vmcnt(4)
    buffer_load_dwordx4 v[48:51], v1, s[28:31], s79 offen offset:0 nt
    s_waitcnt vmcnt(4)
    buffer_load_dwordx4 v[52:55], v1, s[28:31], s79 offen offset:128 nt
    s_waitcnt vmcnt(14)
    v_mfma_f32_16x16x32_bf16 v[24:27], v[80:83], v[16:19], 0
    v_mfma_f32_16x16x32_bf16 v[28:31], v[88:91], v[16:19], 0
    v_mfma_f32_16x16x32_bf16 v[24:27], v[84:87], v[20:23], v[24:27]
    v_mfma_f32_16x16x32_bf16 v[28:31], v[92:95], v[20:23], v[28:31]
    s_waitcnt vmcnt(4)
    buffer_load_dwordx4 v[56:59], v1, s[28:31], s79 offen offset:2048 nt
    s_waitcnt vmcnt(4)
    buffer_load_dwordx4 v[60:63], v1, s[28:31], s79 offen offset:2176 nt
    s_call_b64 s[76:77], L_score0
    s_waitcnt vmcnt(12)
    v_mfma_f32_16x16x32_bf16 v[8:11], v[36:39], v[96:99], v[8:11]
    v_and_b32 v36, v34, v4
    v_and_b32 v37, v34, v5
    v_and_b32 v38, v34, v6
    v_and_b32 v39, v34, v7
    v_mfma_f32_16x16x32_bf16 v[8:11], v[40:43], v[100:103], v[8:11]
    v_and_b32 v40, v35, v4
    v_and_b32 v41, v35, v5
    v_and_b32 v42, v35, v6
    v_and_b32 v43, v35, v7
    v_mfma_f32_16x16x32_bf16 v[8:11], v[36:39], v[104:107], v[8:11]
    s_nop 0
    v_mfma_f32_16x16x32_bf16 v[8:11], v[40:43], v[108:111], v[8:11]
    s_waitcnt vmcnt(4)
    buffer_load_dwordx4 v[64:67], v2, s[32:35], s79 offen offset:0 nt
    s_bitcmp0_b32 s82, 17
    s_cselect_b32 s91, s83, s69
    s_cselect_b32 s95, s71, 1.0
    s_bitcmp0_b32 s82, 17
    s_cbranch_scc1 L_upk_386
    s_add_u32 s92, s67, 6946816
    s_xor_b32 s78, s92, s67
    s_and_b32 s78, s78, 0xff800000
    s_xor_b32 s92, s92, s78
    s_call_b64 s[76:77], L_reload0
    s_branch L_upe_387
L_upk_386:
    v_accvgpr_read_b32 v40, a209
    v_accvgpr_read_b32 v41, a210
    v_accvgpr_read_b32 v42, a211
    v_accvgpr_read_b32 v43, a212
    v_accvgpr_read_b32 v44, a213
    v_accvgpr_read_b32 v45, a214
    v_accvgpr_read_b32 v46, a215
    v_accvgpr_read_b32 v47, a216
    v_accvgpr_read_b32 v32, a217
    v_accvgpr_read_b32 v33, a218
    v_accvgpr_read_b32 v34, a219
    v_accvgpr_read_b32 v35, a220
    v_accvgpr_read_b32 v36, a221
    s_call_b64 s[76:77], L_unpack32
L_upe_387:
    s_waitcnt vmcnt(4)
    buffer_load_dwordx4 v[68:71], v2, s[32:35], s79 offen offset:256 nt
    v_mfma_f32_16x16x32_bf16 v[24:27], v[32:35], v[16:19], 0
    v_mfma_f32_16x16x32_bf16 v[28:31], v[40:43], v[16:19], 0
    v_mfma_f32_16x16x32_bf16 v[24:27], v[36:39], v[20:23], v[24:27]
    v_mfma_f32_16x16x32_bf16 v[28:31], v[44:47], v[20:23], v[28:31]
    s_nop 6
    v_add_f32_dpp v32, v25, v24 quad_perm:[1,0,3,2] row_mask:0xf bank_mask:0xf
    v_add_f32_dpp v33, v27, v26 quad_perm:[1,0,3,2] row_mask:0xf bank_mask:0xf
    v_add_f32_dpp v34, v29, v28 quad_perm:[1,0,3,2] row_mask:0xf bank_mask:0xf
    v_add_f32_dpp v35, v31, v30 quad_perm:[1,0,3,2] row_mask:0xf bank_mask:0xf
    v_max3_f32 v36, v32, v33, v34
    v_max_f32 v36, v36, v35
    v_mul_f32 v36, s91, v36
    v_cmp_gt_f32 vcc, v36, v13
    s_waitcnt vmcnt(4)
    buffer_load_dwordx4 v[72:75], v2, s[32:35], s79 offen offset:2048 nt
    s_bitcmp0_b32 s82, 17
    s_cbranch_scc1 L_upk_388
    s_add_u32 s92, s67, 6946816
    s_xor_b32 s78, s92, s67
    s_and_b32 s78, s78, 0xff800000
    s_xor_b32 s92, s92, s78
    s_call_b64 s[76:77], L_reload1
    s_branch L_upe_389
L_upk_388:
    v_mov_b32 v152, v224
    v_mov_b32 v153, v225
    v_mov_b32 v154, v226
    v_mov_b32 v155, v227
    v_mov_b32 v156, v228
    v_mov_b32 v157, v229
    v_mov_b32 v158, v230
    v_mov_b32 v159, v231
    v_mov_b32 v144, v232
    v_mov_b32 v145, v233
    v_mov_b32 v146, v234
    v_mov_b32 v147, v235
    v_mov_b32 v148, v236
    s_call_b64 s[76:77], L_unpack144
L_upe_389:
    s_waitcnt vmcnt(4)
    buffer_load_dwordx4 v[76:79], v2, s[32:35], s79 offen offset:2304 nt
    s_call_b64 s[76:77], L_soft1
    v_mfma_f32_16x16x32_bf16 v[8:11], v[36:39], v[144:147], v[8:11]
    v_and_b32 v36, v34, v4
    v_and_b32 v37, v34, v5
    v_and_b32 v38, v34, v6
    v_and_b32 v39, v34, v7
    v_mfma_f32_16x16x32_bf16 v[8:11], v[40:43], v[148:151], v[8:11]
    v_and_b32 v40, v35, v4
    v_and_b32 v41, v35, v5
    v_and_b32 v42, v35, v6
    v_and_b32 v43, v35, v7
    v_mfma_f32_16x16x32_bf16 v[8:11], v[36:39], v[152:155], v[8:11]
    s_nop 0
    v_mfma_f32_16x16x32_bf16 v[8:11], v[40:43], v[156:159], v[8:11]
    s_bitcmp1_b32 s64, 3
    s_cselect_b32 s78, -655360, 0
    s_add_u32 s68, s67, 3538944
    s_add_u32 s68, s68, s78
    s_xor_b32 s78, s68, s67
    s_and_b32 s78, s78, 0xff800000
    s_xor_b32 s68, s68, s78
    s_waitcnt vmcnt(4)
    buffer_load_dwordx4 v[80:83], v1, s[28:31], s68 offen offset:0 nt
    s_waitcnt vmcnt(4)
    buffer_load_dwordx4 v[84:87], v1, s[28:31], s68 offen offset:128 nt
    s_waitcnt vmcnt(14)
    v_mfma_f32_16x16x32_bf16 v[24:27], v[112:115], v[16:19], 0
    v_mfma_f32_16x16x32_bf16 v[28:31], v[120:123], v[16:19], 0
    v_mfma_f32_16x16x32_bf16 v[24:27], v[116:119], v[20:23], v[24:27]
    v_mfma_f32_16x16x32_bf16 v[28:31], v[124:127], v[20:23], v[28:31]
    s_waitcnt vmcnt(4)
    buffer_load_dwordx4 v[88:91], v1, s[28:31], s68 offen offset:2048 nt
    s_waitcnt vmcnt(4)
    buffer_load_dwordx4 v[92:95], v1, s[28:31], s68 offen offset:2176 nt
    s_call_b64 s[76:77], L_score0
    s_waitcnt vmcnt(12)
    v_mfma_f32_16x16x32_bf16 v[8:11], v[36:39], v[128:131], v[8:11]
    v_and_b32 v36, v34, v4
    v_and_b32 v37, v34, v5
    v_and_b32 v38, v34, v6
    v_and_b32 v39, v34, v7
    v_mfma_f32_16x16x32_bf16 v[8:11], v[40:43], v[132:135], v[8:11]
    v_and_b32 v40, v35, v4
    v_and_b32 v41, v35, v5
    v_and_b32 v42, v35, v6
    v_and_b32 v43, v35, v7
    v_mfma_f32_16x16x32_bf16 v[8:11], v[36:39], v[136:139], v[8:11]
    s_nop 0
    v_mfma_f32_16x16x32_bf16 v[8:11], v[40:43], v[140:143], v[8:11]
    s_waitcnt vmcnt(4)
    buffer_load_dwordx4 v[96:99], v2, s[32:35], s68 offen offset:0 nt
    s_bitcmp0_b32 s82, 18
    s_cselect_b32 s91, s83, s69
    s_cselect_b32 s95, s71, 1.0
    s_bitcmp0_b32 s82, 18
    s_cbranch_scc1 L_upk_392
    s_add_u32 s92, s67, 7077888
    s_xor_b32 s78, s92, s67
    s_and_b32 s78, s78, 0xff800000
    s_xor_b32 s92, s92, s78
    s_call_b64 s[76:77], L_reload0
    s_branch L_upe_393
L_upk_392:
    v_accvgpr_read_b32 v40, a222
    v_accvgpr_read_b32 v41, a223
    v_accvgpr_read_b32 v42, a224
    v_accvgpr_read_b32 v43, a225
    v_accvgpr_read_b32 v44, a226
    v_accvgpr_read_b32 v45, a227
    v_accvgpr_read_b32 v46, a228
    v_accvgpr_read_b32 v47, a229
    v_accvgpr_read_b32 v32, a230
    v_accvgpr_read_b32 v33, a231
    v_accvgpr_read_b32 v34, a232
    v_accvgpr_read_b32 v35, a233
    v_accvgpr_read_b32 v36, a234
    s_call_b64 s[76:77], L_unpack32
L_upe_393:
    s_waitcnt vmcnt(4)
    buffer_load_dwordx4 v[100:103], v2, s[32:35], s68 offen offset:256 nt
    v_mfma_f32_16x16x32_bf16 v[24:27], v[32:35], v[16:19], 0
    v_mfma_f32_16x16x32_bf16 v[28:31], v[40:43], v[16:19], 0
    v_mfma_f32_16x16x32_bf16 v[24:27], v[36:39], v[20:23], v[24:27]
    v_mfma_f32_16x16x32_bf16 v[28:31], v[44:47], v[20:23], v[28:31]
    s_nop 6
    v_add_f32_dpp v32, v25, v24 quad_perm:[1,0,3,2] row_mask:0xf bank_mask:0xf
    v_add_f32_dpp v33, v27, v26 quad_perm:[1,0,3,2] row_mask:0xf bank_mask:0xf
    v_add_f32_dpp v34, v29, v28 quad_perm:[1,0,3,2] row_mask:0xf bank_mask:0xf
    v_add_f32_dpp v35, v31, v30 quad_perm:[1,0,3,2] row_mask:0xf bank_mask:0xf
    v_max3_f32 v36, v32, v33, v34
    v_max_f32 v36, v36, v35
    v_mul_f32 v36, s91, v36
    v_cmp_gt_f32 vcc, v36, v13
    s_waitcnt vmcnt(4)
    buffer_load_dwordx4 v[104:107], v2, s[32:35], s68 offen offset:2048 nt
    s_bitcmp0_b32 s82, 18
    s_cbranch_scc1 L_upk_394
    s_add_u32 s92, s67, 7077888
    s_xor_b32 s78, s92, s67
    s_and_b32 s78, s78, 0xff800000
    s_xor_b32 s92, s92, s78
    s_call_b64 s[76:77], L_reload1
    s_branch L_upe_395
L_upk_394:
    v_mov_b32 v152, v237
    v_mov_b32 v153, v238
    v_mov_b32 v154, v239
    v_mov_b32 v155, v240
    v_mov_b32 v156, v241
    v_mov_b32 v157, v242
    v_mov_b32 v158, v243
    v_mov_b32 v159, v244
    v_mov_b32 v144, v245
    v_mov_b32 v145, v246
    v_mov_b32 v146, v247
    v_mov_b32 v147, v248
    v_mov_b32 v148, v249
    s_call_b64 s[76:77], L_unpack144
L_upe_395:
    s_waitcnt vmcnt(4)
    buffer_load_dwordx4 v[108:111], v2, s[32:35], s68 offen offset:2304 nt
    s_call_b64 s[76:77], L_soft1
    v_mfma_f32_16x16x32_bf16 v[8:11], v[36:39], v[144:147], v[8:11]
    v_and_b32 v36, v34, v4
    v_and_b32 v37, v34, v5
    v_and_b32 v38, v34, v6
    v_and_b32 v39, v34, v7
    v_mfma_f32_16x16x32_bf16 v[8:11], v[40:43], v[148:151], v[8:11]
    v_and_b32 v40, v35, v4
    v_and_b32 v41, v35, v5
    v_and_b32 v42, v35, v6
    v_and_b32 v43, v35, v7
    v_mfma_f32_16x16x32_bf16 v[8:11], v[36:39], v[152:155], v[8:11]
    s_nop 0
    v_mfma_f32_16x16x32_bf16 v[8:11], v[40:43], v[156:159], v[8:11]
    s_bitcmp1_b32 s64, 3
    s_cselect_b32 s78, 655360, 0
    s_add_u32 s79, s67, 2883584
    s_add_u32 s79, s79, s78
    s_xor_b32 s78, s79, s67
    s_and_b32 s78, s78, 0xff800000
    s_xor_b32 s79, s79, s78
    s_waitcnt vmcnt(4)
    buffer_load_dwordx4 v[112:115], v1, s[28:31], s79 offen offset:0 nt
    s_waitcnt vmcnt(4)
    buffer_load_dwordx4 v[116:119], v1, s[28:31], s79 offen offset:128 nt
    s_waitcnt vmcnt(14)
    v_mfma_f32_16x16x32_bf16 v[24:27], v[48:51], v[16:19], 0
    v_mfma_f32_16x16x32_bf16 v[28:31], v[56:59], v[16:19], 0
    v_mfma_f32_16x16x32_bf16 v[24:27], v[52:55], v[20:23], v[24:27]
    v_mfma_f32_16x16x32_bf16 v[28:31], v[60:63], v[20:23], v[28:31]
    s_waitcnt vmcnt(4)
    buffer_load_dwordx4 v[120:123], v1, s[28:31], s79 offen offset:2048 nt
    s_waitcnt vmcnt(4)
    buffer_load_dwordx4 v[124:127], v1, s[28:31], s79 offen offset:2176 nt
    s_call_b64 s[76:77], L_score0
    s_waitcnt vmcnt(12)
    v_mfma_f32_16x16x32_bf16 v[8:11], v[36:39], v[64:67], v[8:11]
    v_and_b32 v36, v34, v4
    v_and_b32 v37, v34, v5
    v_and_b32 v38, v34, v6
    v_and_b32 v39, v34, v7
    v_mfma_f32_16x16x32_bf16 v[8:11], v[40:43], v[68:71], v[8:11]
    v_and_b32 v40, v35, v4
    v_and_b32 v41, v35, v5
    v_and_b32 v42, v35, v6
    v_and_b32 v43, v35, v7
    v_mfma_f32_16x16x32_bf16 v[8:11], v[36:39], v[72:75], v[8:11]
    s_nop 0
    v_mfma_f32_16x16x32_bf16 v[8:11], v[40:43], v[76:79], v[8:11]
    v_mov_b32 v45, 748
    v_and_b32 v44, 63, v0
    v_lshlrev_b32 v44, 2, v44
    s_mov_b64 exec, 1
    buffer_store_dword v45, v44, s[36:39], s1 offen
    s_mov_b64 exec, -1
    buffer_load_dword v14, v44, s[36:39], s0 offen sc1
    s_cmp_eq_u32 s100, 0
    s_cbranch_scc1 L_bv_399
    s_cmp_eq_u32 s100, 2
    s_cbranch_scc1 L_bv_401
    s_waitcnt vmcnt(6)
    buffer_load_dwordx4 v[128:131], v2, s[32:35], s79 offen offset:0 nt
    s_branch L_be_398
L_bv_399:
    s_waitcnt vmcnt(5)
    buffer_load_dwordx4 v[128:131], v2, s[32:35], s79 offen offset:0 nt
    s_branch L_be_398
L_bv_401:
    s_waitcnt vmcnt(9)
    buffer_load_dwordx4 v[128:131], v2, s[32:35], s79 offen offset:0 nt
L_be_398:
    s_bitcmp0_b32 s82, 19
    s_cselect_b32 s91, s83, s69
    s_cselect_b32 s95, s71, 1.0
    s_bitcmp0_b32 s82, 19
    s_cbranch_scc1 L_upk_402
    s_add_u32 s92, s67, 7340032
    s_xor_b32 s78, s92, s67
    s_and_b32 s78, s78, 0xff800000
    s_xor_b32 s92, s92, s78
    s_call_b64 s[76:77], L_reload0
    s_branch L_upe_403
L_upk_402:
    v_accvgpr_read_b32 v40, a235
    v_accvgpr_read_b32 v41, a236
    v_accvgpr_read_b32 v42, a237
    v_accvgpr_read_b32 v43, a238
    v_accvgpr_read_b32 v44, a239
    v_accvgpr_read_b32 v45, a240
    v_accvgpr_read_b32 v46, a241
    v_accvgpr_read_b32 v47, a242
    v_accvgpr_read_b32 v32, a243
    v_accvgpr_read_b32 v33, a244
    v_accvgpr_read_b32 v34, a245
    v_accvgpr_read_b32 v35, a246
    v_accvgpr_read_b32 v36, a247
    s_call_b64 s[76:77], L_unpack32
L_upe_403:
    s_cmp_eq_u32 s100, 0
    s_cbranch_scc1 L_bv_405
    s_cmp_eq_u32 s100, 2
    s_cbranch_scc1 L_bv_407
    s_waitcnt vmcnt(6)
    buffer_load_dwordx4 v[132:135], v2, s[32:35], s79 offen offset:256 nt
    s_branch L_be_404
L_bv_405:
    s_waitcnt vmcnt(5)
    buffer_load_dwordx4 v[132:135], v2, s[32:35], s79 offen offset:256 nt
    s_branch L_be_404
L_bv_407:
    s_waitcnt vmcnt(9)
    buffer_load_dwordx4 v[132:135], v2, s[32:35], s79 offen offset:256 nt
L_be_404:
    v_mfma_f32_16x16x32_bf16 v[24:27], v[32:35], v[16:19], 0
    v_mfma_f32_16x16x32_bf16 v[28:31], v[40:43], v[16:19], 0
    v_mfma_f32_16x16x32_bf16 v[24:27], v[36:39], v[20:23], v[24:27]
    v_mfma_f32_16x16x32_bf16 v[28:31], v[44:47], v[20:23], v[28:31]
    s_nop 6
    v_add_f32_dpp v32, v25, v24 quad_perm:[1,0,3,2] row_mask:0xf bank_mask:0xf
    v_add_f32_dpp v33, v27, v26 quad_perm:[1,0,3,2] row_mask:0xf bank_mask:0xf
    v_add_f32_dpp v34, v29, v28 quad_perm:[1,0,3,2] row_mask:0xf bank_mask:0xf
    v_add_f32_dpp v35, v31, v30 quad_perm:[1,0,3,2] row_mask:0xf bank_mask:0xf
    v_max3_f32 v36, v32, v33, v34
    v_max_f32 v36, v36, v35
    v_mul_f32 v36, s91, v36
    v_cmp_gt_f32 vcc, v36, v13
    s_cmp_eq_u32 s100, 0
    s_cbranch_scc1 L_bv_409
    s_cmp_eq_u32 s100, 2
    s_cbranch_scc1 L_bv_411
    s_waitcnt vmcnt(6)
    buffer_load_dwordx4 v[136:139], v2, s[32:35], s79 offen offset:2048 nt
    s_branch L_be_408
L_bv_409:
    s_waitcnt vmcnt(5)
    buffer_load_dwordx4 v[136:139], v2, s[32:35], s79 offen offset:2048 nt
    s_branch L_be_408
L_bv_411:
    s_waitcnt vmcnt(9)
    buffer_load_dwordx4 v[136:139], v2, s[32:35], s79 offen offset:2048 nt
L_be_408:
    s_bitcmp0_b32 s82, 19
    s_cbranch_scc1 L_upk_412
    s_add_u32 s92, s67, 7340032
    s_xor_b32 s78, s92, s67
    s_and_b32 s78, s78, 0xff800000
    s_xor_b32 s92, s92, s78
    s_call_b64 s[76:77], L_reload1
    s_branch L_upe_413
L_upk_412:
    v_mov_b32 v152, v250
    v_mov_b32 v153, v251
    v_mov_b32 v154, v252
    v_mov_b32 v155, v253
    v_mov_b32 v156, v254
    v_mov_b32 v157, v255
    v_accvgpr_read_b32 v158, a248
    v_accvgpr_read_b32 v159, a249
    v_accvgpr_read_b32 v144, a250
    v_accvgpr_read_b32 v145, a251
    v_accvgpr_read_b32 v146, a252
    v_accvgpr_read_b32 v147, a253
    v_accvgpr_read_b32 v148, a254
    s_call_b64 s[76:77], L_unpack144
L_upe_413:
    s_cmp_eq_u32 s100, 0
    s_cbranch_scc1 L_bv_415
    s_cmp_eq_u32 s100, 2
    s_cbranch_scc1 L_bv_417
    s_waitcnt vmcnt(6)
    buffer_load_dwordx4 v[140:143], v2, s[32:35], s79 offen offset:2304 nt
    s_branch L_be_414
L_bv_415:
    s_waitcnt vmcnt(5)
    buffer_load_dwordx4 v[140:143], v2, s[32:35], s79 offen offset:2304 nt
    s_branch L_be_414
L_bv_417:
    s_waitcnt vmcnt(9)
    buffer_load_dwordx4 v[140:143], v2, s[32:35], s79 offen offset:2304 nt
L_be_414:
    s_call_b64 s[76:77], L_soft1
    v_mfma_f32_16x16x32_bf16 v[8:11], v[36:39], v[144:147], v[8:11]
    v_and_b32 v36, v34, v4
    v_and_b32 v37, v34, v5
    v_and_b32 v38, v34, v6
    v_and_b32 v39, v34, v7
    v_mfma_f32_16x16x32_bf16 v[8:11], v[40:43], v[148:151], v[8:11]
    v_and_b32 v40, v35, v4
    v_and_b32 v41, v35, v5
    v_and_b32 v42, v35, v6
    v_and_b32 v43, v35, v7
    v_mfma_f32_16x16x32_bf16 v[8:11], v[36:39], v[152:155], v[8:11]
    s_nop 0
    v_mfma_f32_16x16x32_bf16 v[8:11], v[40:43], v[156:159], v[8:11]
    s_mov_b32 s70, 0x05040100
    s_mov_b32 s71, 0x07060302
    s_mov_b32 s83, 0x3f803f80
    s_bitcmp1_b32 s64, 3
    s_cselect_b32 s78, -1048576, 0
    s_add_u32 s68, s67, 4325376
    s_add_u32 s68, s68, s78
    s_xor_b32 s78, s68, s67
    s_and_b32 s78, s78, 0xff800000
    s_xor_b32 s68, s68, s78
    s_cmp_eq_u32 s100, 0
    s_cbranch_scc1 L_bv_421
    s_cmp_eq_u32 s100, 2
    s_cbranch_scc1 L_bv_423
    s_waitcnt vmcnt(6)
    buffer_load_dwordx4 v[48:51], v1, s[28:31], s68 offen offset:0 nt
    s_waitcnt vmcnt(4)
    buffer_load_dwordx4 v[52:55], v1, s[28:31], s68 offen offset:128 nt
    s_waitcnt vmcnt(4)
    buffer_load_dwordx4 v[56:59], v1, s[28:31], s68 offen offset:2048 nt
    s_waitcnt vmcnt(4)
    buffer_load_dwordx4 v[60:63], v1, s[28:31], s68 offen offset:2176 nt
    s_branch L_be_420
L_bv_421:
    s_waitcnt vmcnt(3)
    buffer_load_dwordx4 v[48:51], v1, s[28:31], s68 offen offset:0 nt
    s_waitcnt vmcnt(3)
    buffer_load_dwordx4 v[52:55], v1, s[28:31], s68 offen offset:128 nt
    s_waitcnt vmcnt(3)
    buffer_load_dwordx4 v[56:59], v1, s[28:31], s68 offen offset:2048 nt
    s_waitcnt vmcnt(3)
    buffer_load_dwordx4 v[60:63], v1, s[28:31], s68 offen offset:2176 nt
    s_branch L_be_420
L_bv_423:
    s_waitcnt vmcnt(9)
    buffer_load_dwordx4 v[48:51], v1, s[28:31], s68 offen offset:0 nt
    s_waitcnt vmcnt(9)
    buffer_load_dwordx4 v[52:55], v1, s[28:31], s68 offen offset:128 nt
    s_waitcnt vmcnt(9)
    buffer_load_dwordx4 v[56:59], v1, s[28:31], s68 offen offset:2048 nt
    s_waitcnt vmcnt(9)
    buffer_load_dwordx4 v[60:63], v1, s[28:31], s68 offen offset:2176 nt
L_be_420:
    s_waitcnt vmcnt(18)
    v_mfma_f32_16x16x32_bf16 v[24:27], v[80:83], v[16:19], 0
    v_mfma_f32_16x16x32_bf16 v[28:31], v[88:91], v[16:19], 0
    v_mfma_f32_16x16x32_bf16 v[24:27], v[84:87], v[20:23], v[24:27]
    v_mfma_f32_16x16x32_bf16 v[28:31], v[92:95], v[20:23], v[28:31]
    s_cmp_eq_u32 s100, 0
    s_cbranch_scc1 L_bv_425
    s_cmp_eq_u32 s100, 2
    s_cbranch_scc1 L_bv_427
    s_waitcnt vmcnt(4)
    buffer_load_dwordx4 v[64:67], v2, s[32:35], s68 offen offset:0 nt
    s_waitcnt vmcnt(4)
    buffer_load_dwordx4 v[68:71], v2, s[32:35], s68 offen offset:256 nt
    s_waitcnt vmcnt(4)
    buffer_load_dwordx4 v[72:75], v2, s[32:35], s68 offen offset:2048 nt
    s_waitcnt vmcnt(4)
    buffer_load_dwordx4 v[76:79], v2, s[32:35], s68 offen offset:2304 nt
    s_branch L_be_424
L_bv_425:
    s_waitcnt vmcnt(3)
    buffer_load_dwordx4 v[64:67], v2, s[32:35], s68 offen offset:0 nt
    s_waitcnt vmcnt(3)
    buffer_load_dwordx4 v[68:71], v2, s[32:35], s68 offen offset:256 nt
    s_waitcnt vmcnt(3)
    buffer_load_dwordx4 v[72:75], v2, s[32:35], s68 offen offset:2048 nt
    s_waitcnt vmcnt(3)
    buffer_load_dwordx4 v[76:79], v2, s[32:35], s68 offen offset:2304 nt
    s_branch L_be_424
L_bv_427:
    s_waitcnt vmcnt(7)
    buffer_load_dwordx4 v[64:67], v2, s[32:35], s68 offen offset:0 nt
    s_waitcnt vmcnt(7)
    buffer_load_dwordx4 v[68:71], v2, s[32:35], s68 offen offset:256 nt
    s_waitcnt vmcnt(7)
    buffer_load_dwordx4 v[72:75], v2, s[32:35], s68 offen offset:2048 nt
    s_waitcnt vmcnt(7)
    buffer_load_dwordx4 v[76:79], v2, s[32:35], s68 offen offset:2304 nt
L_be_424:
    s_call_b64 s[76:77], L_score0
    s_waitcnt vmcnt(18)
    v_mfma_f32_16x16x32_bf16 v[8:11], v[36:39], v[96:99], v[8:11]
    v_and_b32 v36, v34, v4
    v_and_b32 v37, v34, v5
    v_and_b32 v38, v34, v6
    v_and_b32 v39, v34, v7
    v_mfma_f32_16x16x32_bf16 v[8:11], v[40:43], v[100:103], v[8:11]
    v_and_b32 v40, v35, v4
    v_and_b32 v41, v35, v5
    v_and_b32 v42, v35, v6
    v_and_b32 v43, v35, v7
    v_mfma_f32_16x16x32_bf16 v[8:11], v[36:39], v[104:107], v[8:11]
    s_nop 0
    v_mfma_f32_16x16x32_bf16 v[8:11], v[40:43], v[108:111], v[8:11]
    s_waitcnt vmcnt(12)
    s_movk_i32 s101, 744
    v_mov_b32 v47, v14
    s_call_b64 s[76:77], L_pace2
    v_mov_b32 v45, 760
    v_and_b32 v44, 63, v0
    v_lshlrev_b32 v44, 2, v44
    s_mov_b64 exec, 1
    buffer_store_dword v45, v44, s[36:39], s1 offen
    s_mov_b64 exec, -1
    buffer_load_dword v14, v44, s[36:39], s0 offen sc1
    s_bitcmp1_b32 s64, 3
    s_cselect_b32 s78, 1048576, 0
    s_add_u32 s79, s67, 3276800
    s_add_u32 s79, s79, s78
    s_xor_b32 s78, s79, s67
    s_and_b32 s78, s78, 0xff800000
    s_xor_b32 s79, s79, s78
    s_cmp_eq_u32 s100, 0
    s_cbranch_scc1 L_bv_431
    s_cmp_eq_u32 s100, 2
    s_cbranch_scc1 L_bv_433
    s_waitcnt vmcnt(6)
    buffer_load_dwordx4 v[80:83], v1, s[28:31], s79 offen offset:0 nt
    s_waitcnt vmcnt(6)
    buffer_load_dwordx4 v[84:87], v1, s[28:31], s79 offen offset:128 nt
    s_waitcnt vmcnt(6)
    buffer_load_dwordx4 v[88:91], v1, s[28:31], s79 offen offset:2048 nt
    s_waitcnt vmcnt(6)
    buffer_load_dwordx4 v[92:95], v1, s[28:31], s79 offen offset:2176 nt
    s_branch L_be_430
L_bv_431:
    s_waitcnt vmcnt(5)
    buffer_load_dwordx4 v[80:83], v1, s[28:31], s79 offen offset:0 nt
    s_waitcnt vmcnt(5)
    buffer_load_dwordx4 v[84:87], v1, s[28:31], s79 offen offset:128 nt
    s_waitcnt vmcnt(5)
    buffer_load_dwordx4 v[88:91], v1, s[28:31], s79 offen offset:2048 nt
    s_waitcnt vmcnt(5)
    buffer_load_dwordx4 v[92:95], v1, s[28:31], s79 offen offset:2176 nt
    s_branch L_be_430
L_bv_433:
    s_waitcnt vmcnt(9)
    buffer_load_dwordx4 v[80:83], v1, s[28:31], s79 offen offset:0 nt
    s_waitcnt vmcnt(9)
    buffer_load_dwordx4 v[84:87], v1, s[28:31], s79 offen offset:128 nt
    s_waitcnt vmcnt(9)
    buffer_load_dwordx4 v[88:91], v1, s[28:31], s79 offen offset:2048 nt
    s_waitcnt vmcnt(9)
    buffer_load_dwordx4 v[92:95], v1, s[28:31], s79 offen offset:2176 nt
L_be_430:
    s_waitcnt vmcnt(20)
    v_mfma_f32_16x16x32_bf16 v[24:27], v[112:115], v[16:19], 0
    v_mfma_f32_16x16x32_bf16 v[28:31], v[120:123], v[16:19], 0
    v_mfma_f32_16x16x32_bf16 v[24:27], v[116:119], v[20:23], v[24:27]
    v_mfma_f32_16x16x32_bf16 v[28:31], v[124:127], v[20:23], v[28:31]
    s_cmp_eq_u32 s100, 0
    s_cbranch_scc1 L_bv_435
    s_cmp_eq_u32 s100, 2
    s_cbranch_scc1 L_bv_437
    s_waitcnt vmcnt(6)
    buffer_load_dwordx4 v[96:99], v2, s[32:35], s79 offen offset:0 nt
    s_waitcnt vmcnt(4)
    buffer_load_dwordx4 v[100:103], v2, s[32:35], s79 offen offset:256 nt
    s_waitcnt vmcnt(4)
    buffer_load_dwordx4 v[104:107], v2, s[32:35], s79 offen offset:2048 nt
    s_waitcnt vmcnt(4)
    buffer_load_dwordx4 v[108:111], v2, s[32:35], s79 offen offset:2304 nt
    s_branch L_be_434
L_bv_435:
    s_waitcnt vmcnt(3)
    buffer_load_dwordx4 v[96:99], v2, s[32:35], s79 offen offset:0 nt
    s_waitcnt vmcnt(3)
    buffer_load_dwordx4 v[100:103], v2, s[32:35], s79 offen offset:256 nt
    s_waitcnt vmcnt(3)
    buffer_load_dwordx4 v[104:107], v2, s[32:35], s79 offen offset:2048 nt
    s_waitcnt vmcnt(3)
    buffer_load_dwordx4 v[108:111], v2, s[32:35], s79 offen offset:2304 nt
    s_branch L_be_434
L_bv_437:
    s_waitcnt vmcnt(9)
    buffer_load_dwordx4 v[96:99], v2, s[32:35], s79 offen offset:0 nt
    s_waitcnt vmcnt(9)
    buffer_load_dwordx4 v[100:103], v2, s[32:35], s79 offen offset:256 nt
    s_waitcnt vmcnt(9)
    buffer_load_dwordx4 v[104:107], v2, s[32:35], s79 offen offset:2048 nt
    s_waitcnt vmcnt(9)
    buffer_load_dwordx4 v[108:111], v2, s[32:35], s79 offen offset:2304 nt
L_be_434:
    s_call_b64 s[76:77], L_score0
    s_waitcnt vmcnt(18)
    v_mfma_f32_16x16x32_bf16 v[8:11], v[36:39], v[128:131], v[8:11]
    v_and_b32 v36, v34, v4
    v_and_b32 v37, v34, v5
    v_and_b32 v38, v34, v6
    v_and_b32 v39, v34, v7
    v_mfma_f32_16x16x32_bf16 v[8:11], v[40:43], v[132:135], v[8:11]
    v_and_b32 v40, v35, v4
    v_and_b32 v41, v35, v5
    v_and_b32 v42, v35, v6
    v_and_b32 v43, v35, v7
    v_mfma_f32_16x16x32_bf16 v[8:11], v[36:39], v[136:139], v[8:11]
    s_nop 0
    v_mfma_f32_16x16x32_bf16 v[8:11], v[40:43], v[140:143], v[8:11]
    s_waitcnt vmcnt(8)
    s_movk_i32 s101, 756
    v_mov_b32 v47, v14
    s_call_b64 s[76:77], L_pace2
    v_mov_b32 v45, 768
    v_and_b32 v44, 63, v0
    v_lshlrev_b32 v44, 2, v44
    s_mov_b64 exec, 1
    buffer_store_dword v45, v44, s[36:39], s1 offen
    s_mov_b64 exec, -1
    buffer_load_dword v14, v44, s[36:39], s0 offen sc1
    s_add_u32 s68, s67, 4980736
    s_xor_b32 s78, s68, s67
    s_and_b32 s78, s78, 0xff800000
    s_xor_b32 s68, s68, s78
    s_cmp_eq_u32 s100, 0
    s_cbranch_scc1 L_bv_439
    s_cmp_eq_u32 s100, 2
    s_cbranch_scc1 L_bv_441
    s_waitcnt vmcnt(6)
    buffer_load_dwordx4 v[112:115], v1, s[28:31], s68 offen offset:0 nt
    s_waitcnt vmcnt(6)
    buffer_load_dwordx4 v[116:119], v1, s[28:31], s68 offen offset:128 nt
    s_waitcnt vmcnt(6)
    buffer_load_dwordx4 v[120:123], v1, s[28:31], s68 offen offset:2048 nt
    s_waitcnt vmcnt(6)
    buffer_load_dwordx4 v[124:127], v1, s[28:31], s68 offen offset:2176 nt
    s_branch L_be_438
L_bv_439:
    s_waitcnt vmcnt(5)
    buffer_load_dwordx4 v[112:115], v1, s[28:31], s68 offen offset:0 nt
    s_waitcnt vmcnt(5)
    buffer_load_dwordx4 v[116:119], v1, s[28:31], s68 offen offset:128 nt
    s_waitcnt vmcnt(5)
    buffer_load_dwordx4 v[120:123], v1, s[28:31], s68 offen offset:2048 nt
    s_waitcnt vmcnt(5)
    buffer_load_dwordx4 v[124:127], v1, s[28:31], s68 offen offset:2176 nt
    s_branch L_be_438
L_bv_441:
    s_waitcnt vmcnt(9)
    buffer_load_dwordx4 v[112:115], v1, s[28:31], s68 offen offset:0 nt
    s_waitcnt vmcnt(9)
    buffer_load_dwordx4 v[116:119], v1, s[28:31], s68 offen offset:128 nt
    s_waitcnt vmcnt(9)
    buffer_load_dwordx4 v[120:123], v1, s[28:31], s68 offen offset:2048 nt
    s_waitcnt vmcnt(9)
    buffer_load_dwordx4 v[124:127], v1, s[28:31], s68 offen offset:2176 nt
L_be_438:
    s_waitcnt vmcnt(20)
    v_mfma_f32_16x16x32_bf16 v[24:27], v[48:51], v[16:19], 0
    v_mfma_f32_16x16x32_bf16 v[28:31], v[56:59], v[16:19], 0
    v_mfma_f32_16x16x32_bf16 v[24:27], v[52:55], v[20:23], v[24:27]
    v_mfma_f32_16x16x32_bf16 v[28:31], v[60:63], v[20:23], v[28:31]
    s_cmp_eq_u32 s100, 0
    s_cbranch_scc1 L_bv_443
    s_cmp_eq_u32 s100, 2
    s_cbranch_scc1 L_bv_445
    s_waitcnt vmcnt(6)
    buffer_load_dwordx4 v[128:131], v2, s[32:35], s68 offen offset:0 nt
    s_waitcnt vmcnt(4)
    buffer_load_dwordx4 v[132:135], v2, s[32:35], s68 offen offset:256 nt
    s_waitcnt vmcnt(4)
    buffer_load_dwordx4 v[136:139], v2, s[32:35], s68 offen offset:2048 nt
    s_waitcnt vmcnt(4)
    buffer_load_dwordx4 v[140:143], v2, s[32:35], s68 offen offset:2304 nt
    s_branch L_be_442
L_bv_443:
    s_waitcnt vmcnt(3)
    buffer_load_dwordx4 v[128:131], v2, s[32:35], s68 offen offset:0 nt
    s_waitcnt vmcnt(3)
    buffer_load_dwordx4 v[132:135], v2, s[32:35], s68 offen offset:256 nt
    s_waitcnt vmcnt(3)
    buffer_load_dwordx4 v[136:139], v2, s[32:35], s68 offen offset:2048 nt
    s_waitcnt vmcnt(3)
    buffer_load_dwordx4 v[140:143], v2, s[32:35], s68 offen offset:2304 nt
    s_branch L_be_442
L_bv_445:
    s_waitcnt vmcnt(9)
    buffer_load_dwordx4 v[128:131], v2, s[32:35], s68 offen offset:0 nt
    s_waitcnt vmcnt(9)
    buffer_load_dwordx4 v[132:135], v2, s[32:35], s68 offen offset:256 nt
    s_waitcnt vmcnt(9)
    buffer_load_dwordx4 v[136:139], v2, s[32:35], s68 offen offset:2048 nt
    s_waitcnt vmcnt(9)
    buffer_load_dwordx4 v[140:143], v2, s[32:35], s68 offen offset:2304 nt
L_be_442:
    s_call_b64 s[76:77], L_score0
    s_waitcnt vmcnt(20)
    v_mfma_f32_16x16x32_bf16 v[8:11], v[36:39], v[64:67], v[8:11]
    v_and_b32 v36, v34, v4
    v_and_b32 v37, v34, v5
    v_and_b32 v38, v34, v6
    v_and_b32 v39, v34, v7
    v_mfma_f32_16x16x32_bf16 v[8:11], v[40:43], v[68:71], v[8:11]
    v_and_b32 v40, v35, v4
    v_and_b32 v41, v35, v5
    v_and_b32 v42, v35, v6
    v_and_b32 v43, v35, v7
    v_mfma_f32_16x16x32_bf16 v[8:11], v[36:39], v[72:75], v[8:11]
    s_nop 0
    v_mfma_f32_16x16x32_bf16 v[8:11], v[40:43], v[76:79], v[8:11]
    s_waitcnt vmcnt(8)
    s_movk_i32 s101, 764
    v_mov_b32 v47, v14
    s_call_b64 s[76:77], L_pace2
    v_mov_b32 v45, 776
    v_and_b32 v44, 63, v0
    v_lshlrev_b32 v44, 2, v44
    s_mov_b64 exec, 1
    buffer_store_dword v45, v44, s[36:39], s1 offen
    s_mov_b64 exec, -1
    buffer_load_dword v14, v44, s[36:39], s0 offen sc1
    s_bitcmp1_b32 s64, 3
    s_cselect_b32 s78, -1835008, 0
    s_add_u32 s79, s67, 5767168
    s_add_u32 s79, s79, s78
    s_xor_b32 s78, s79, s67
    s_and_b32 s78, s78, 0xff800000
    s_xor_b32 s79, s79, s78
    s_cmp_eq_u32 s100, 0
    s_cbranch_scc1 L_bv_449
    s_cmp_eq_u32 s100, 2
    s_cbranch_scc1 L_bv_451
    s_waitcnt vmcnt(6)
    buffer_load_dwordx4 v[48:51], v1, s[28:31], s79 offen offset:0 nt
    s_waitcnt vmcnt(6)
    buffer_load_dwordx4 v[52:55], v1, s[28:31], s79 offen offset:128 nt
    s_waitcnt vmcnt(6)
    buffer_load_dwordx4 v[56:59], v1, s[28:31], s79 offen offset:2048 nt
    s_waitcnt vmcnt(6)
    buffer_load_dwordx4 v[60:63], v1, s[28:31], s79 offen offset:2176 nt
    s_branch L_be_448
L_bv_449:
    s_waitcnt vmcnt(5)
    buffer_load_dwordx4 v[48:51], v1, s[28:31], s79 offen offset:0 nt
    s_waitcnt vmcnt(5)
    buffer_load_dwordx4 v[52:55], v1, s[28:31], s79 offen offset:128 nt
    s_waitcnt vmcnt(5)
    buffer_load_dwordx4 v[56:59], v1, s[28:31], s79 offen offset:2048 nt
    s_waitcnt vmcnt(5)
    buffer_load_dwordx4 v[60:63], v1, s[28:31], s79 offen offset:2176 nt
    s_branch L_be_448
L_bv_451:
    s_waitcnt vmcnt(9)
    buffer_load_dwordx4 v[48:51], v1, s[28:31], s79 offen offset:0 nt
    s_waitcnt vmcnt(9)
    buffer_load_dwordx4 v[52:55], v1, s[28:31], s79 offen offset:128 nt
    s_waitcnt vmcnt(9)
    buffer_load_dwordx4 v[56:59], v1, s[28:31], s79 offen offset:2048 nt
    s_waitcnt vmcnt(9)
    buffer_load_dwordx4 v[60:63], v1, s[28:31], s79 offen offset:2176 nt
L_be_448:
    s_waitcnt vmcnt(20)
    v_mfma_f32_16x16x32_bf16 v[24:27], v[80:83], v[16:19], 0
    v_mfma_f32_16x16x32_bf16 v[28:31], v[88:91], v[16:19], 0
    v_mfma_f32_16x16x32_bf16 v[24:27], v[84:87], v[20:23], v[24:27]
    v_mfma_f32_16x16x32_bf16 v[28:31], v[92:95], v[20:23], v[28:31]
    s_cmp_eq_u32 s100, 0
    s_cbranch_scc1 L_bv_453
    s_cmp_eq_u32 s100, 2
    s_cbranch_scc1 L_bv_455
    s_waitcnt vmcnt(6)
    buffer_load_dwordx4 v[64:67], v2, s[32:35], s79 offen offset:0 nt
    s_waitcnt vmcnt(4)
    buffer_load_dwordx4 v[68:71], v2, s[32:35], s79 offen offset:256 nt
    s_waitcnt vmcnt(4)
    buffer_load_dwordx4 v[72:75], v2, s[32:35], s79 offen offset:2048 nt
    s_waitcnt vmcnt(4)
    buffer_load_dwordx4 v[76:79], v2, s[32:35], s79 offen offset:2304 nt
    s_branch L_be_452
L_bv_453:
    s_waitcnt vmcnt(3)
    buffer_load_dwordx4 v[64:67], v2, s[32:35], s79 offen offset:0 nt
    s_waitcnt vmcnt(3)
    buffer_load_dwordx4 v[68:71], v2, s[32:35], s79 offen offset:256 nt
    s_waitcnt vmcnt(3)
    buffer_load_dwordx4 v[72:75], v2, s[32:35], s79 offen offset:2048 nt
    s_waitcnt vmcnt(3)
    buffer_load_dwordx4 v[76:79], v2, s[32:35], s79 offen offset:2304 nt
    s_branch L_be_452
L_bv_455:
    s_waitcnt vmcnt(9)
    buffer_load_dwordx4 v[64:67], v2, s[32:35], s79 offen offset:0 nt
    s_waitcnt vmcnt(9)
    buffer_load_dwordx4 v[68:71], v2, s[32:35], s79 offen offset:256 nt
    s_waitcnt vmcnt(9)
    buffer_load_dwordx4 v[72:75], v2, s[32:35], s79 offen offset:2048 nt
    s_waitcnt vmcnt(9)
    buffer_load_dwordx4 v[76:79], v2, s[32:35], s79 offen offset:2304 nt
L_be_452:
    s_call_b64 s[76:77], L_score0
    s_waitcnt vmcnt(20)
    v_mfma_f32_16x16x32_bf16 v[8:11], v[36:39], v[96:99], v[8:11]
    v_and_b32 v36, v34, v4
    v_and_b32 v37, v34, v5
    v_and_b32 v38, v34, v6
    v_and_b32 v39, v34, v7
    v_mfma_f32_16x16x32_bf16 v[8:11], v[40:43], v[100:103], v[8:11]
    v_and_b32 v40, v35, v4
    v_and_b32 v41, v35, v5
    v_and_b32 v42, v35, v6
    v_and_b32 v43, v35, v7
    v_mfma_f32_16x16x32_bf16 v[8:11], v[36:39], v[104:107], v[8:11]
    s_nop 0
    v_mfma_f32_16x16x32_bf16 v[8:11], v[40:43], v[108:111], v[8:11]
    s_waitcnt vmcnt(8)
    s_movk_i32 s101, 772
    v_mov_b32 v47, v14
    s_call_b64 s[76:77], L_pace2
    v_mov_b32 v45, 784
    v_and_b32 v44, 63, v0
    v_lshlrev_b32 v44, 2, v44
    s_mov_b64 exec, 1
    buffer_store_dword v45, v44, s[36:39], s1 offen
    s_mov_b64 exec, -1
    buffer_load_dword v14, v44, s[36:39], s0 offen sc1
    s_bitcmp1_b32 s64, 3
    s_cselect_b32 s78, 1835008, 0
    s_add_u32 s68, s67, 3932160
    s_add_u32 s68, s68, s78
    s_xor_b32 s78, s68, s67
    s_and_b32 s78, s78, 0xff800000
    s_xor_b32 s68, s68, s78
    s_cmp_eq_u32 s100, 0
    s_cbranch_scc1 L_bv_459
    s_cmp_eq_u32 s100, 2
    s_cbranch_scc1 L_bv_461
    s_waitcnt vmcnt(6)
    buffer_load_dwordx4 v[80:83], v1, s[28:31], s68 offen offset:0 nt
    s_waitcnt vmcnt(6)
    buffer_load_dwordx4 v[84:87], v1, s[28:31], s68 offen offset:128 nt
    s_waitcnt vmcnt(6)
    buffer_load_dwordx4 v[88:91], v1, s[28:31], s68 offen offset:2048 nt
    s_waitcnt vmcnt(6)
    buffer_load_dwordx4 v[92:95], v1, s[28:31], s68 offen offset:2176 nt
    s_branch L_be_458
L_bv_459:
    s_waitcnt vmcnt(5)
    buffer_load_dwordx4 v[80:83], v1, s[28:31], s68 offen offset:0 nt
    s_waitcnt vmcnt(5)
    buffer_load_dwordx4 v[84:87], v1, s[28:31], s68 offen offset:128 nt
    s_waitcnt vmcnt(5)
    buffer_load_dwordx4 v[88:91], v1, s[28:31], s68 offen offset:2048 nt
    s_waitcnt vmcnt(5)
    buffer_load_dwordx4 v[92:95], v1, s[28:31], s68 offen offset:2176 nt
    s_branch L_be_458
L_bv_461:
    s_waitcnt vmcnt(9)
    buffer_load_dwordx4 v[80:83], v1, s[28:31], s68 offen offset:0 nt
    s_waitcnt vmcnt(9)
    buffer_load_dwordx4 v[84:87], v1, s[28:31], s68 offen offset:128 nt
    s_waitcnt vmcnt(9)
    buffer_load_dwordx4 v[88:91], v1, s[28:31], s68 offen offset:2048 nt
    s_waitcnt vmcnt(9)
    buffer_load_dwordx4 v[92:95], v1, s[28:31], s68 offen offset:2176 nt
L_be_458:
    s_waitcnt vmcnt(20)
    v_mfma_f32_16x16x32_bf16 v[24:27], v[112:115], v[16:19], 0
    v_mfma_f32_16x16x32_bf16 v[28:31], v[120:123], v[16:19], 0
    v_mfma_f32_16x16x32_bf16 v[24:27], v[116:119], v[20:23], v[24:27]
    v_mfma_f32_16x16x32_bf16 v[28:31], v[124:127], v[20:23], v[28:31]
    s_cmp_eq_u32 s100, 0
    s_cbranch_scc1 L_bv_463
    s_cmp_eq_u32 s100, 2
    s_cbranch_scc1 L_bv_465
    s_waitcnt vmcnt(6)
    buffer_load_dwordx4 v[96:99], v2, s[32:35], s68 offen offset:0 nt
    s_waitcnt vmcnt(4)
    buffer_load_dwordx4 v[100:103], v2, s[32:35], s68 offen offset:256 nt
    s_waitcnt vmcnt(4)
    buffer_load_dwordx4 v[104:107], v2, s[32:35], s68 offen offset:2048 nt
    s_waitcnt vmcnt(4)
    buffer_load_dwordx4 v[108:111], v2, s[32:35], s68 offen offset:2304 nt
    s_branch L_be_462
L_bv_463:
    s_waitcnt vmcnt(3)
    buffer_load_dwordx4 v[96:99], v2, s[32:35], s68 offen offset:0 nt
    s_waitcnt vmcnt(3)
    buffer_load_dwordx4 v[100:103], v2, s[32:35], s68 offen offset:256 nt
    s_waitcnt vmcnt(3)
    buffer_load_dwordx4 v[104:107], v2, s[32:35], s68 offen offset:2048 nt
    s_waitcnt vmcnt(3)
    buffer_load_dwordx4 v[108:111], v2, s[32:35], s68 offen offset:2304 nt
    s_branch L_be_462
L_bv_465:
    s_waitcnt vmcnt(9)
    buffer_load_dwordx4 v[96:99], v2, s[32:35], s68 offen offset:0 nt
    s_waitcnt vmcnt(9)
    buffer_load_dwordx4 v[100:103], v2, s[32:35], s68 offen offset:256 nt
    s_waitcnt vmcnt(9)
    buffer_load_dwordx4 v[104:107], v2, s[32:35], s68 offen offset:2048 nt
    s_waitcnt vmcnt(9)
    buffer_load_dwordx4 v[108:111], v2, s[32:35], s68 offen offset:2304 nt
L_be_462:
    s_call_b64 s[76:77], L_score0
    s_waitcnt vmcnt(20)
    v_mfma_f32_16x16x32_bf16 v[8:11], v[36:39], v[128:131], v[8:11]
    v_and_b32 v36, v34, v4
    v_and_b32 v37, v34, v5
    v_and_b32 v38, v34, v6
    v_and_b32 v39, v34, v7
    v_mfma_f32_16x16x32_bf16 v[8:11], v[40:43], v[132:135], v[8:11]
    v_and_b32 v40, v35, v4
    v_and_b32 v41, v35, v5
    v_and_b32 v42, v35, v6
    v_and_b32 v43, v35, v7
    v_mfma_f32_16x16x32_bf16 v[8:11], v[36:39], v[136:139], v[8:11]
    s_nop 0
    v_mfma_f32_16x16x32_bf16 v[8:11], v[40:43], v[140:143], v[8:11]
    s_waitcnt vmcnt(8)
    s_movk_i32 s101, 780
    v_mov_b32 v47, v14
    s_call_b64 s[76:77], L_pace2
    v_mov_b32 v45, 792
    v_and_b32 v44, 63, v0
    v_lshlrev_b32 v44, 2, v44
    s_mov_b64 exec, 1
    buffer_store_dword v45, v44, s[36:39], s1 offen
    s_mov_b64 exec, -1
    buffer_load_dword v14, v44, s[36:39], s0 offen sc1
    s_bitcmp1_b32 s64, 3
    s_cselect_b32 s78, -1835008, 0
    s_add_u32 s79, s67, 6422528
    s_add_u32 s79, s79, s78
    s_xor_b32 s78, s79, s67
    s_and_b32 s78, s78, 0xff800000
    s_xor_b32 s79, s79, s78
    s_cmp_eq_u32 s100, 0
    s_cbranch_scc1 L_bv_469
    s_cmp_eq_u32 s100, 2
    s_cbranch_scc1 L_bv_471
    s_waitcnt vmcnt(6)
    buffer_load_dwordx4 v[112:115], v1, s[28:31], s79 offen offset:0 nt
    s_waitcnt vmcnt(6)
    buffer_load_dwordx4 v[116:119], v1, s[28:31], s79 offen offset:128 nt
    s_waitcnt vmcnt(6)
    buffer_load_dwordx4 v[120:123], v1, s[28:31], s79 offen offset:2048 nt
    s_waitcnt vmcnt(6)
    buffer_load_dwordx4 v[124:127], v1, s[28:31], s79 offen offset:2176 nt
    s_branch L_be_468
L_bv_469:
    s_waitcnt vmcnt(5)
    buffer_load_dwordx4 v[112:115], v1, s[28:31], s79 offen offset:0 nt
    s_waitcnt vmcnt(5)
    buffer_load_dwordx4 v[116:119], v1, s[28:31], s79 offen offset:128 nt
    s_waitcnt vmcnt(5)
    buffer_load_dwordx4 v[120:123], v1, s[28:31], s79 offen offset:2048 nt
    s_waitcnt vmcnt(5)
    buffer_load_dwordx4 v[124:127], v1, s[28:31], s79 offen offset:2176 nt
    s_branch L_be_468
L_bv_471:
    s_waitcnt vmcnt(9)
    buffer_load_dwordx4 v[112:115], v1, s[28:31], s79 offen offset:0 nt
    s_waitcnt vmcnt(9)
    buffer_load_dwordx4 v[116:119], v1, s[28:31], s79 offen offset:128 nt
    s_waitcnt vmcnt(9)
    buffer_load_dwordx4 v[120:123], v1, s[28:31], s79 offen offset:2048 nt
    s_waitcnt vmcnt(9)
    buffer_load_dwordx4 v[124:127], v1, s[28:31], s79 offen offset:2176 nt
L_be_468:
    s_waitcnt vmcnt(20)
    v_mfma_f32_16x16x32_bf16 v[24:27], v[48:51], v[16:19], 0
    v_mfma_f32_16x16x32_bf16 v[28:31], v[56:59], v[16:19], 0
    v_mfma_f32_16x16x32_bf16 v[24:27], v[52:55], v[20:23], v[24:27]
    v_mfma_f32_16x16x32_bf16 v[28:31], v[60:63], v[20:23], v[28:31]
    s_cmp_eq_u32 s100, 0
    s_cbranch_scc1 L_bv_473
    s_cmp_eq_u32 s100, 2
    s_cbranch_scc1 L_bv_475
    s_waitcnt vmcnt(6)
    buffer_load_dwordx4 v[128:131], v2, s[32:35], s79 offen offset:0 nt
    s_waitcnt vmcnt(4)
    buffer_load_dwordx4 v[132:135], v2, s[32:35], s79 offen offset:256 nt
    s_waitcnt vmcnt(4)
    buffer_load_dwordx4 v[136:139], v2, s[32:35], s79 offen offset:2048 nt
    s_waitcnt vmcnt(4)
    buffer_load_dwordx4 v[140:143], v2, s[32:35], s79 offen offset:2304 nt
    s_branch L_be_472
L_bv_473:
    s_waitcnt vmcnt(3)
    buffer_load_dwordx4 v[128:131], v2, s[32:35], s79 offen offset:0 nt
    s_waitcnt vmcnt(3)
    buffer_load_dwordx4 v[132:135], v2, s[32:35], s79 offen offset:256 nt
    s_waitcnt vmcnt(3)
    buffer_load_dwordx4 v[136:139], v2, s[32:35], s79 offen offset:2048 nt
    s_waitcnt vmcnt(3)
    buffer_load_dwordx4 v[140:143], v2, s[32:35], s79 offen offset:2304 nt
    s_branch L_be_472
L_bv_475:
    s_waitcnt vmcnt(9)
    buffer_load_dwordx4 v[128:131], v2, s[32:35], s79 offen offset:0 nt
    s_waitcnt vmcnt(9)
    buffer_load_dwordx4 v[132:135], v2, s[32:35], s79 offen offset:256 nt
    s_waitcnt vmcnt(9)
    buffer_load_dwordx4 v[136:139], v2, s[32:35], s79 offen offset:2048 nt
    s_waitcnt vmcnt(9)
    buffer_load_dwordx4 v[140:143], v2, s[32:35], s79 offen offset:2304 nt
L_be_472:
    s_call_b64 s[76:77], L_score0
    s_waitcnt vmcnt(20)
    v_mfma_f32_16x16x32_bf16 v[8:11], v[36:39], v[64:67], v[8:11]
    v_and_b32 v36, v34, v4
    v_and_b32 v37, v34, v5
    v_and_b32 v38, v34, v6
    v_and_b32 v39, v34, v7
    v_mfma_f32_16x16x32_bf16 v[8:11], v[40:43], v[68:71], v[8:11]
    v_and_b32 v40, v35, v4
    v_and_b32 v41, v35, v5
    v_and_b32 v42, v35, v6
    v_and_b32 v43, v35, v7
    v_mfma_f32_16x16x32_bf16 v[8:11], v[36:39], v[72:75], v[8:11]
    s_nop 0
    v_mfma_f32_16x16x32_bf16 v[8:11], v[40:43], v[76:79], v[8:11]
    s_waitcnt vmcnt(8)
    s_movk_i32 s101, 788
    v_mov_b32 v47, v14
    s_call_b64 s[76:77], L_pace2
    v_mov_b32 v45, 800
    v_and_b32 v44, 63, v0
    v_lshlrev_b32 v44, 2, v44
    s_mov_b64 exec, 1
    buffer_store_dword v45, v44, s[36:39], s1 offen
    s_mov_b64 exec, -1
    buffer_load_dword v14, v44, s[36:39], s0 offen sc1
    s_bitcmp1_b32 s64, 3
    s_cselect_b32 s78, 1835008, 0
    s_add_u32 s68, s67, 4587520
    s_add_u32 s68, s68, s78
    s_xor_b32 s78, s68, s67
    s_and_b32 s78, s78, 0xff800000
    s_xor_b32 s68, s68, s78
    s_cmp_eq_u32 s100, 0
    s_cbranch_scc1 L_bv_479
    s_cmp_eq_u32 s100, 2
    s_cbranch_scc1 L_bv_481
    s_waitcnt vmcnt(6)
    buffer_load_dwordx4 v[48:51], v1, s[28:31], s68 offen offset:0 nt
    s_waitcnt vmcnt(6)
    buffer_load_dwordx4 v[52:55], v1, s[28:31], s68 offen offset:128 nt
    s_waitcnt vmcnt(6)
    buffer_load_dwordx4 v[56:59], v1, s[28:31], s68 offen offset:2048 nt
    s_waitcnt vmcnt(6)
    buffer_load_dwordx4 v[60:63], v1, s[28:31], s68 offen offset:2176 nt
    s_branch L_be_478
L_bv_479:
    s_waitcnt vmcnt(5)
    buffer_load_dwordx4 v[48:51], v1, s[28:31], s68 offen offset:0 nt
    s_waitcnt vmcnt(5)
    buffer_load_dwordx4 v[52:55], v1, s[28:31], s68 offen offset:128 nt
    s_waitcnt vmcnt(5)
    buffer_load_dwordx4 v[56:59], v1, s[28:31], s68 offen offset:2048 nt
    s_waitcnt vmcnt(5)
    buffer_load_dwordx4 v[60:63], v1, s[28:31], s68 offen offset:2176 nt
    s_branch L_be_478
L_bv_481:
    s_waitcnt vmcnt(9)
    buffer_load_dwordx4 v[48:51], v1, s[28:31], s68 offen offset:0 nt
    s_waitcnt vmcnt(9)
    buffer_load_dwordx4 v[52:55], v1, s[28:31], s68 offen offset:128 nt
    s_waitcnt vmcnt(9)
    buffer_load_dwordx4 v[56:59], v1, s[28:31], s68 offen offset:2048 nt
    s_waitcnt vmcnt(9)
    buffer_load_dwordx4 v[60:63], v1, s[28:31], s68 offen offset:2176 nt
L_be_478:
    s_waitcnt vmcnt(20)
    v_mfma_f32_16x16x32_bf16 v[24:27], v[80:83], v[16:19], 0
    v_mfma_f32_16x16x32_bf16 v[28:31], v[88:91], v[16:19], 0
    v_mfma_f32_16x16x32_bf16 v[24:27], v[84:87], v[20:23], v[24:27]
    v_mfma_f32_16x16x32_bf16 v[28:31], v[92:95], v[20:23], v[28:31]
    s_cmp_eq_u32 s100, 0
    s_cbranch_scc1 L_bv_483
    s_cmp_eq_u32 s100, 2
    s_cbranch_scc1 L_bv_485
    s_waitcnt vmcnt(6)
    buffer_load_dwordx4 v[64:67], v2, s[32:35], s68 offen offset:0 nt
    s_waitcnt vmcnt(4)
    buffer_load_dwordx4 v[68:71], v2, s[32:35], s68 offen offset:256 nt
    s_waitcnt vmcnt(4)
    buffer_load_dwordx4 v[72:75], v2, s[32:35], s68 offen offset:2048 nt
    s_waitcnt vmcnt(4)
    buffer_load_dwordx4 v[76:79], v2, s[32:35], s68 offen offset:2304 nt
    s_branch L_be_482
L_bv_483:
    s_waitcnt vmcnt(3)
    buffer_load_dwordx4 v[64:67], v2, s[32:35], s68 offen offset:0 nt
    s_waitcnt vmcnt(3)
    buffer_load_dwordx4 v[68:71], v2, s[32:35], s68 offen offset:256 nt
    s_waitcnt vmcnt(3)
    buffer_load_dwordx4 v[72:75], v2, s[32:35], s68 offen offset:2048 nt
    s_waitcnt vmcnt(3)
    buffer_load_dwordx4 v[76:79], v2, s[32:35], s68 offen offset:2304 nt
    s_branch L_be_482
L_bv_485:
    s_waitcnt vmcnt(9)
    buffer_load_dwordx4 v[64:67], v2, s[32:35], s68 offen offset:0 nt
    s_waitcnt vmcnt(9)
    buffer_load_dwordx4 v[68:71], v2, s[32:35], s68 offen offset:256 nt
    s_waitcnt vmcnt(9)
    buffer_load_dwordx4 v[72:75], v2, s[32:35], s68 offen offset:2048 nt
    s_waitcnt vmcnt(9)
    buffer_load_dwordx4 v[76:79], v2, s[32:35], s68 offen offset:2304 nt
L_be_482:
    s_call_b64 s[76:77], L_score0
    s_waitcnt vmcnt(20)
    v_mfma_f32_16x16x32_bf16 v[8:11], v[36:39], v[96:99], v[8:11]
    v_and_b32 v36, v34, v4
    v_and_b32 v37, v34, v5
    v_and_b32 v38, v34, v6
    v_and_b32 v39, v34, v7
    v_mfma_f32_16x16x32_bf16 v[8:11], v[40:43], v[100:103], v[8:11]
    v_and_b32 v40, v35, v4
    v_and_b32 v41, v35, v5
    v_and_b32 v42, v35, v6
    v_and_b32 v43, v35, v7
    v_mfma_f32_16x16x32_bf16 v[8:11], v[36:39], v[104:107], v[8:11]
    s_nop 0
    v_mfma_f32_16x16x32_bf16 v[8:11], v[40:43], v[108:111], v[8:11]
    s_waitcnt vmcnt(8)
    s_movk_i32 s101, 796
    v_mov_b32 v47, v14
    s_call_b64 s[76:77], L_pace2
    v_mov_b32 v45, 808
    v_and_b32 v44, 63, v0
    v_lshlrev_b32 v44, 2, v44
    s_mov_b64 exec, 1
    buffer_store_dword v45, v44, s[36:39], s1 offen
    s_mov_b64 exec, -1
    buffer_load_dword v14, v44, s[36:39], s0 offen sc1
    s_bitcmp1_b32 s64, 3
    s_cselect_b32 s78, -1835008, 0
    s_add_u32 s79, s67, 7208960
    s_add_u32 s79, s79, s78
    s_xor_b32 s78, s79, s67
    s_and_b32 s78, s78, 0xff800000
    s_xor_b32 s79, s79, s78
    s_cmp_eq_u32 s100, 0
    s_cbranch_scc1 L_bv_489
    s_cmp_eq_u32 s100, 2
    s_cbranch_scc1 L_bv_491
    s_waitcnt vmcnt(6)
    buffer_load_dwordx4 v[80:83], v1, s[28:31], s79 offen offset:0 nt
    s_waitcnt vmcnt(6)
    buffer_load_dwordx4 v[84:87], v1, s[28:31], s79 offen offset:128 nt
    s_waitcnt vmcnt(6)
    buffer_load_dwordx4 v[88:91], v1, s[28:31], s79 offen offset:2048 nt
    s_waitcnt vmcnt(6)
    buffer_load_dwordx4 v[92:95], v1, s[28:31], s79 offen offset:2176 nt
    s_branch L_be_488
L_bv_489:
    s_waitcnt vmcnt(5)
    buffer_load_dwordx4 v[80:83], v1, s[28:31], s79 offen offset:0 nt
    s_waitcnt vmcnt(5)
    buffer_load_dwordx4 v[84:87], v1, s[28:31], s79 offen offset:128 nt
    s_waitcnt vmcnt(5)
    buffer_load_dwordx4 v[88:91], v1, s[28:31], s79 offen offset:2048 nt
    s_waitcnt vmcnt(5)
    buffer_load_dwordx4 v[92:95], v1, s[28:31], s79 offen offset:2176 nt
    s_branch L_be_488
L_bv_491:
    s_waitcnt vmcnt(9)
    buffer_load_dwordx4 v[80:83], v1, s[28:31], s79 offen offset:0 nt
    s_waitcnt vmcnt(9)
    buffer_load_dwordx4 v[84:87], v1, s[28:31], s79 offen offset:128 nt
    s_waitcnt vmcnt(9)
    buffer_load_dwordx4 v[88:91], v1, s[28:31], s79 offen offset:2048 nt
    s_waitcnt vmcnt(9)
    buffer_load_dwordx4 v[92:95], v1, s[28:31], s79 offen offset:2176 nt
L_be_488:
    s_waitcnt vmcnt(20)
    v_mfma_f32_16x16x32_bf16 v[24:27], v[112:115], v[16:19], 0
    v_mfma_f32_16x16x32_bf16 v[28:31], v[120:123], v[16:19], 0
    v_mfma_f32_16x16x32_bf16 v[24:27], v[116:119], v[20:23], v[24:27]
    v_mfma_f32_16x16x32_bf16 v[28:31], v[124:127], v[20:23], v[28:31]
    s_cmp_eq_u32 s100, 0
    s_cbranch_scc1 L_bv_493
    s_cmp_eq_u32 s100, 2
    s_cbranch_scc1 L_bv_495
    s_waitcnt vmcnt(6)
    buffer_load_dwordx4 v[96:99], v2, s[32:35], s79 offen offset:0 nt
    s_waitcnt vmcnt(4)
    buffer_load_dwordx4 v[100:103], v2, s[32:35], s79 offen offset:256 nt
    s_waitcnt vmcnt(4)
    buffer_load_dwordx4 v[104:107], v2, s[32:35], s79 offen offset:2048 nt
    s_waitcnt vmcnt(4)
    buffer_load_dwordx4 v[108:111], v2, s[32:35], s79 offen offset:2304 nt
    s_branch L_be_492
L_bv_493:
    s_waitcnt vmcnt(3)
    buffer_load_dwordx4 v[96:99], v2, s[32:35], s79 offen offset:0 nt
    s_waitcnt vmcnt(3)
    buffer_load_dwordx4 v[100:103], v2, s[32:35], s79 offen offset:256 nt
    s_waitcnt vmcnt(3)
    buffer_load_dwordx4 v[104:107], v2, s[32:35], s79 offen offset:2048 nt
    s_waitcnt vmcnt(3)
    buffer_load_dwordx4 v[108:111], v2, s[32:35], s79 offen offset:2304 nt
    s_branch L_be_492
L_bv_495:
    s_waitcnt vmcnt(9)
    buffer_load_dwordx4 v[96:99], v2, s[32:35], s79 offen offset:0 nt
    s_waitcnt vmcnt(9)
    buffer_load_dwordx4 v[100:103], v2, s[32:35], s79 offen offset:256 nt
    s_waitcnt vmcnt(9)
    buffer_load_dwordx4 v[104:107], v2, s[32:35], s79 offen offset:2048 nt
    s_waitcnt vmcnt(9)
    buffer_load_dwordx4 v[108:111], v2, s[32:35], s79 offen offset:2304 nt
L_be_492:
    s_call_b64 s[76:77], L_score0
    s_waitcnt vmcnt(20)
    v_mfma_f32_16x16x32_bf16 v[8:11], v[36:39], v[128:131], v[8:11]
    v_and_b32 v36, v34, v4
    v_and_b32 v37, v34, v5
    v_and_b32 v38, v34, v6
    v_and_b32 v39, v34, v7
    v_mfma_f32_16x16x32_bf16 v[8:11], v[40:43], v[132:135], v[8:11]
    v_and_b32 v40, v35, v4
    v_and_b32 v41, v35, v5
    v_and_b32 v42, v35, v6
    v_and_b32 v43, v35, v7
    v_mfma_f32_16x16x32_bf16 v[8:11], v[36:39], v[136:139], v[8:11]
    s_nop 0
    v_mfma_f32_16x16x32_bf16 v[8:11], v[40:43], v[140:143], v[8:11]
    s_waitcnt vmcnt(8)
    s_movk_i32 s101, 804
    v_mov_b32 v47, v14
    s_call_b64 s[76:77], L_pace2
    v_mov_b32 v45, 816
    v_and_b32 v44, 63, v0
    v_lshlrev_b32 v44, 2, v44
    s_mov_b64 exec, 1
    buffer_store_dword v45, v44, s[36:39], s1 offen
    s_mov_b64 exec, -1
    buffer_load_dword v14, v44, s[36:39], s0 offen sc1
    s_bitcmp1_b32 s64, 3
    s_cselect_b32 s78, 1835008, 0
    s_add_u32 s68, s67, 5373952
    s_add_u32 s68, s68, s78
    s_xor_b32 s78, s68, s67
    s_and_b32 s78, s78, 0xff800000
    s_xor_b32 s68, s68, s78
    s_cmp_eq_u32 s100, 0
    s_cbranch_scc1 L_bv_499
    s_cmp_eq_u32 s100, 2
    s_cbranch_scc1 L_bv_501
    s_waitcnt vmcnt(6)
    buffer_load_dwordx4 v[112:115], v1, s[28:31], s68 offen offset:0 nt
    s_waitcnt vmcnt(6)
    buffer_load_dwordx4 v[116:119], v1, s[28:31], s68 offen offset:128 nt
    s_waitcnt vmcnt(6)
    buffer_load_dwordx4 v[120:123], v1, s[28:31], s68 offen offset:2048 nt
    s_waitcnt vmcnt(6)
    buffer_load_dwordx4 v[124:127], v1, s[28:31], s68 offen offset:2176 nt
    s_branch L_be_498
L_bv_499:
    s_waitcnt vmcnt(5)
    buffer_load_dwordx4 v[112:115], v1, s[28:31], s68 offen offset:0 nt
    s_waitcnt vmcnt(5)
    buffer_load_dwordx4 v[116:119], v1, s[28:31], s68 offen offset:128 nt
    s_waitcnt vmcnt(5)
    buffer_load_dwordx4 v[120:123], v1, s[28:31], s68 offen offset:2048 nt
    s_waitcnt vmcnt(5)
    buffer_load_dwordx4 v[124:127], v1, s[28:31], s68 offen offset:2176 nt
    s_branch L_be_498
L_bv_501:
    s_waitcnt vmcnt(9)
    buffer_load_dwordx4 v[112:115], v1, s[28:31], s68 offen offset:0 nt
    s_waitcnt vmcnt(9)
    buffer_load_dwordx4 v[116:119], v1, s[28:31], s68 offen offset:128 nt
    s_waitcnt vmcnt(9)
    buffer_load_dwordx4 v[120:123], v1, s[28:31], s68 offen offset:2048 nt
    s_waitcnt vmcnt(9)
    buffer_load_dwordx4 v[124:127], v1, s[28:31], s68 offen offset:2176 nt
L_be_498:
    s_waitcnt vmcnt(20)
    v_mfma_f32_16x16x32_bf16 v[24:27], v[48:51], v[16:19], 0
    v_mfma_f32_16x16x32_bf16 v[28:31], v[56:59], v[16:19], 0
    v_mfma_f32_16x16x32_bf16 v[24:27], v[52:55], v[20:23], v[24:27]
    v_mfma_f32_16x16x32_bf16 v[28:31], v[60:63], v[20:23], v[28:31]
    s_cmp_eq_u32 s100, 0
    s_cbranch_scc1 L_bv_503
    s_cmp_eq_u32 s100, 2
    s_cbranch_scc1 L_bv_505
    s_waitcnt vmcnt(6)
    buffer_load_dwordx4 v[128:131], v2, s[32:35], s68 offen offset:0 nt
    s_waitcnt vmcnt(4)
    buffer_load_dwordx4 v[132:135], v2, s[32:35], s68 offen offset:256 nt
    s_waitcnt vmcnt(4)
    buffer_load_dwordx4 v[136:139], v2, s[32:35], s68 offen offset:2048 nt
    s_waitcnt vmcnt(4)
    buffer_load_dwordx4 v[140:143], v2, s[32:35], s68 offen offset:2304 nt
    s_branch L_be_502
L_bv_503:
    s_waitcnt vmcnt(3)
    buffer_load_dwordx4 v[128:131], v2, s[32:35], s68 offen offset:0 nt
    s_waitcnt vmcnt(3)
    buffer_load_dwordx4 v[132:135], v2, s[32:35], s68 offen offset:256 nt
    s_waitcnt vmcnt(3)
    buffer_load_dwordx4 v[136:139], v2, s[32:35], s68 offen offset:2048 nt
    s_waitcnt vmcnt(3)
    buffer_load_dwordx4 v[140:143], v2, s[32:35], s68 offen offset:2304 nt
    s_branch L_be_502
L_bv_505:
    s_waitcnt vmcnt(9)
    buffer_load_dwordx4 v[128:131], v2, s[32:35], s68 offen offset:0 nt
    s_waitcnt vmcnt(9)
    buffer_load_dwordx4 v[132:135], v2, s[32:35], s68 offen offset:256 nt
    s_waitcnt vmcnt(9)
    buffer_load_dwordx4 v[136:139], v2, s[32:35], s68 offen offset:2048 nt
    s_waitcnt vmcnt(9)
    buffer_load_dwordx4 v[140:143], v2, s[32:35], s68 offen offset:2304 nt
L_be_502:
    s_call_b64 s[76:77], L_score0
    s_waitcnt vmcnt(20)
    v_mfma_f32_16x16x32_bf16 v[8:11], v[36:39], v[64:67], v[8:11]
    v_and_b32 v36, v34, v4
    v_and_b32 v37, v34, v5
    v_and_b32 v38, v34, v6
    v_and_b32 v39, v34, v7
    v_mfma_f32_16x16x32_bf16 v[8:11], v[40:43], v[68:71], v[8:11]
    v_and_b32 v40, v35, v4
    v_and_b32 v41, v35, v5
    v_and_b32 v42, v35, v6
    v_and_b32 v43, v35, v7
    v_mfma_f32_16x16x32_bf16 v[8:11], v[36:39], v[72:75], v[8:11]
    s_nop 0
    v_mfma_f32_16x16x32_bf16 v[8:11], v[40:43], v[76:79], v[8:11]
    s_add_u32 s79, s67, 6160384
    s_xor_b32 s78, s79, s67
    s_and_b32 s78, s78, 0xff800000
    s_xor_b32 s79, s79, s78
    s_waitcnt vmcnt(13)
    buffer_load_dwordx4 v[48:51], v1, s[28:31], s79 offen offset:0 nt
    s_waitcnt vmcnt(13)
    buffer_load_dwordx4 v[52:55], v1, s[28:31], s79 offen offset:128 nt
    s_waitcnt vmcnt(13)
    buffer_load_dwordx4 v[56:59], v1, s[28:31], s79 offen offset:2048 nt
    s_waitcnt vmcnt(13)
    buffer_load_dwordx4 v[60:63], v1, s[28:31], s79 offen offset:2176 nt
    s_waitcnt vmcnt(18)
    v_mfma_f32_16x16x32_bf16 v[24:27], v[80:83], v[16:19], 0
    v_mfma_f32_16x16x32_bf16 v[28:31], v[88:91], v[16:19], 0
    v_mfma_f32_16x16x32_bf16 v[24:27], v[84:87], v[20:23], v[24:27]
    v_mfma_f32_16x16x32_bf16 v[28:31], v[92:95], v[20:23], v[28:31]
    s_waitcnt vmcnt(11)
    buffer_load_dwordx4 v[64:67], v2, s[32:35], s79 offen offset:0 nt
    s_waitcnt vmcnt(11)
    buffer_load_dwordx4 v[68:71], v2, s[32:35], s79 offen offset:256 nt
    s_waitcnt vmcnt(11)
    buffer_load_dwordx4 v[72:75], v2, s[32:35], s79 offen offset:2048 nt
    s_waitcnt vmcnt(11)
    buffer_load_dwordx4 v[76:79], v2, s[32:35], s79 offen offset:2304 nt
    s_call_b64 s[76:77], L_score0
    s_waitcnt vmcnt(18)
    v_mfma_f32_16x16x32_bf16 v[8:11], v[36:39], v[96:99], v[8:11]
    v_and_b32 v36, v34, v4
    v_and_b32 v37, v34, v5
    v_and_b32 v38, v34, v6
    v_and_b32 v39, v34, v7
    v_mfma_f32_16x16x32_bf16 v[8:11], v[40:43], v[100:103], v[8:11]
    v_and_b32 v40, v35, v4
    v_and_b32 v41, v35, v5
    v_and_b32 v42, v35, v6
    v_and_b32 v43, v35, v7
    v_mfma_f32_16x16x32_bf16 v[8:11], v[36:39], v[104:107], v[8:11]
    s_nop 0
    v_mfma_f32_16x16x32_bf16 v[8:11], v[40:43], v[108:111], v[8:11]
    s_add_u32 s68, s67, 6815744
    s_xor_b32 s78, s68, s67
    s_and_b32 s78, s78, 0xff800000
    s_xor_b32 s68, s68, s78
    s_waitcnt vmcnt(11)
    buffer_load_dwordx4 v[80:83], v1, s[28:31], s68 offen offset:0 nt
    s_waitcnt vmcnt(11)
    buffer_load_dwordx4 v[84:87], v1, s[28:31], s68 offen offset:128 nt
    s_waitcnt vmcnt(11)
    buffer_load_dwordx4 v[88:91], v1, s[28:31], s68 offen offset:2048 nt
    s_waitcnt vmcnt(11)
    buffer_load_dwordx4 v[92:95], v1, s[28:31], s68 offen offset:2176 nt
    s_waitcnt vmcnt(16)
    v_mfma_f32_16x16x32_bf16 v[24:27], v[112:115], v[16:19], 0
    v_mfma_f32_16x16x32_bf16 v[28:31], v[120:123], v[16:19], 0
    v_mfma_f32_16x16x32_bf16 v[24:27], v[116:119], v[20:23], v[24:27]
    v_mfma_f32_16x16x32_bf16 v[28:31], v[124:127], v[20:23], v[28:31]
    s_waitcnt vmcnt(11)
    buffer_load_dwordx4 v[96:99], v2, s[32:35], s68 offen offset:0 nt
    s_waitcnt vmcnt(11)
    buffer_load_dwordx4 v[100:103], v2, s[32:35], s68 offen offset:256 nt
    s_waitcnt vmcnt(11)
    buffer_load_dwordx4 v[104:107], v2, s[32:35], s68 offen offset:2048 nt
    s_waitcnt vmcnt(11)
    buffer_load_dwordx4 v[108:111], v2, s[32:35], s68 offen offset:2304 nt
    v_and_b32 v44, 63, v0
    s_cmp_ge_u32 s3, 2
    s_cbranch_scc1 L_w2_506
    s_getpc_b64 s[94:95]
L_here_509:
    s_sub_u32 s94, s94, L_here_509-L_mid
    s_subb_u32 s95, s95, 0
    v_lshlrev_b32 v44, 7, v44
    global_load_dword v2, v44, s[94:95]
    s_branch L_we_508
L_w2_506:
    v_lshrrev_b32 v45, 2, v44
    v_mul_u32_u24 v45, 2752, v45
    v_and_b32 v46, 3, v44
    v_mul_u32_u24 v46, 112, v46
    v_add_u32 v45, v45, v46
    s_mul_i32 s92, s66, 44032
    s_lshl_b32 s93, s74, 5
    s_add_u32 s92, s92, s93
    s_cmp_eq_u32 s3, 3
    s_cbranch_scc1 L_w3_507
    buffer_load_dword v2, v45, s[48:51], s92 offen
    s_branch L_we_508
L_w3_507:
    buffer_load_dword v2, v45, s[52:55], s92 offen
L_we_508:
    s_call_b64 s[76:77], L_score0
    s_waitcnt vmcnt(17)
    v_mfma_f32_16x16x32_bf16 v[8:11], v[36:39], v[128:131], v[8:11]
    v_and_b32 v36, v34, v4
    v_and_b32 v37, v34, v5
    v_and_b32 v38, v34, v6
    v_and_b32 v39, v34, v7
    v_mfma_f32_16x16x32_bf16 v[8:11], v[40:43], v[132:135], v[8:11]
    v_and_b32 v40, v35, v4
    v_and_b32 v41, v35, v5
    v_and_b32 v42, v35, v6
    v_and_b32 v43, v35, v7
    v_mfma_f32_16x16x32_bf16 v[8:11], v[36:39], v[136:139], v[8:11]
    s_nop 0
    v_mfma_f32_16x16x32_bf16 v[8:11], v[40:43], v[140:143], v[8:11]
    s_waitcnt vmcnt(13)
    v_mfma_f32_16x16x32_bf16 v[24:27], v[48:51], v[16:19], 0
    v_mfma_f32_16x16x32_bf16 v[28:31], v[56:59], v[16:19], 0
    v_mfma_f32_16x16x32_bf16 v[24:27], v[52:55], v[20:23], v[24:27]
    v_mfma_f32_16x16x32_bf16 v[28:31], v[60:63], v[20:23], v[28:31]
    s_call_b64 s[76:77], L_score0
    s_waitcnt vmcnt(9)
    v_mfma_f32_16x16x32_bf16 v[8:11], v[36:39], v[64:67], v[8:11]
    v_and_b32 v36, v34, v4
    v_and_b32 v37, v34, v5
    v_and_b32 v38, v34, v6
    v_and_b32 v39, v34, v7
    v_mfma_f32_16x16x32_bf16 v[8:11], v[40:43], v[68:71], v[8:11]
    v_and_b32 v40, v35, v4
    v_and_b32 v41, v35, v5
    v_and_b32 v42, v35, v6
    v_and_b32 v43, v35, v7
    v_mfma_f32_16x16x32_bf16 v[8:11], v[36:39], v[72:75], v[8:11]
    s_nop 0
    v_mfma_f32_16x16x32_bf16 v[8:11], v[40:43], v[76:79], v[8:11]
    s_waitcnt vmcnt(5)
    v_mfma_f32_16x16x32_bf16 v[24:27], v[80:83], v[16:19], 0
    v_mfma_f32_16x16x32_bf16 v[28:31], v[88:91], v[16:19], 0
    v_mfma_f32_16x16x32_bf16 v[24:27], v[84:87], v[20:23], v[24:27]
    v_mfma_f32_16x16x32_bf16 v[28:31], v[92:95], v[20:23], v[28:31]
    s_nop 6
    v_add_f32_dpp v32, v25, v24 quad_perm:[1,0,3,2] row_mask:0xf bank_mask:0xf
    v_add_f32_dpp v33, v27, v26 quad_perm:[1,0,3,2] row_mask:0xf bank_mask:0xf
    v_add_f32_dpp v34, v29, v28 quad_perm:[1,0,3,2] row_mask:0xf bank_mask:0xf
    v_add_f32_dpp v35, v31, v30 quad_perm:[1,0,3,2] row_mask:0xf bank_mask:0xf
    v_max3_f32 v36, v32, v33, v34
    v_max_f32 v36, v36, v35
    v_mul_f32 v36, s69, v36
    v_cmp_gt_f32 vcc, v36, v13
    v_lshlrev_b32 v40, 11, v0
    s_lshl_b32 s92, s65, 19
    s_lshl_b32 s93, s66, 5
    s_add_u32 s92, s92, s93
    buffer_load_dwordx4 v[16:19], v40, s[44:47], s92 offen offset:0
    buffer_load_dwordx4 v[20:23], v40, s[44:47], s92 offen offset:16
    buffer_load_dwordx4 v[24:27], v40, s[44:47], s92 offen offset:1024
    buffer_load_dwordx4 v[28:31], v40, s[44:47], s92 offen offset:1040
    v_and_b32 v44, 15, v0
    v_lshlrev_b32 v44, 5, v44
    v_and_b32 v45, 48, v0
    v_lshrrev_b32 v45, 1, v45
    v_add_u32 v44, v44, v45
    v_lshrrev_b32 v45, 6, v0
    v_lshl_add_u32 v44, v45, 9, v44
    v_lshlrev_b32 v45, 3, v45
    v_add_u32 v45, 2048, v45
    s_call_b64 s[76:77], L_soft0
    s_waitcnt vmcnt(5)
    v_mfma_f32_16x16x32_bf16 v[8:11], v[36:39], v[96:99], v[8:11]
    v_and_b32 v36, v34, v4
    v_and_b32 v37, v34, v5
    v_and_b32 v38, v34, v6
    v_and_b32 v39, v34, v7
    v_mfma_f32_16x16x32_bf16 v[8:11], v[40:43], v[100:103], v[8:11]
    v_and_b32 v40, v35, v4
    v_and_b32 v41, v35, v5
    v_and_b32 v42, v35, v6
    v_and_b32 v43, v35, v7
    v_mfma_f32_16x16x32_bf16 v[8:11], v[36:39], v[104:107], v[8:11]
    s_nop 0
    v_mfma_f32_16x16x32_bf16 v[8:11], v[40:43], v[108:111], v[8:11]
    s_branch L_mid
L_rescale:
    v_mov_b32_dpp v36, v36 quad_perm:[0,0,2,2] row_mask:0xf bank_mask:0xf
    v_mov_b32 v37, v36
    s_nop 1
    v_permlane32_swap_b32 v36, v37
    v_max_f32 v36, v36, v37
    v_mov_b32 v37, v36
    s_nop 1
    v_permlane16_swap_b32 v36, v37
    v_max_f32 v36, v36, v37
    v_max_f32 v14, v36, v14
    v_mul_f32 v38, s69, v14
    v_sub_f32 v37, v13, v38
    v_exp_f32 v37, v37
    v_mov_b32 v13, v38
    v_mul_f32 v8, v8, v37
    v_mul_f32 v10, v10, v37
    v_mul_f32 v12, v12, v37
    s_setpc_b64 s[76:77]
L_pace1:
    v_mov_b32 v34, s101
    v_cmp_le_i32 vcc, 1, v47
    s_nop 1
    v_cndmask_b32 v33, v34, v47, vcc
    s_nop 1
    v_add_u32_dpp v33, v33, v33 row_ror:8 row_mask:0xf bank_mask:0xf
    s_nop 1
    v_add_u32_dpp v33, v33, v33 row_ror:4 row_mask:0xf bank_mask:0xf
    s_nop 1
    v_add_u32_dpp v33, v33, v33 row_ror:2 row_mask:0xf bank_mask:0xf
    s_nop 1
    v_add_u32_dpp v33, v33, v33 row_ror:1 row_mask:0xf bank_mask:0xf
    s_nop 0
    v_readlane_b32 s92, v33, 0
    v_readlane_b32 s93, v33, 16
    v_readlane_b32 s94, v33, 32
    v_readlane_b32 s95, v33, 48
    s_lshl_b32 s101, s101, 6
    s_add_u32 s92, s92, s93
    s_add_u32 s94, s94, s95
    s_add_u32 s92, s92, s94
    s_sub_i32 s92, s92, s101
    s_mul_i32 s92, s92, s2
    s_cmp_gt_i32 s92, 192
    s_cselect_b32 s100, 2, 1
    s_cmp_lt_i32 s92, -192
    s_cselect_b32 s100, 0, s100
    s_setpc_b64 s[76:77]
L_pace2:
    v_mov_b32 v34, s101
    v_cmp_le_i32 vcc, 512, v47
    s_nop 1
    v_cndmask_b32 v33, v34, v47, vcc
    s_nop 1
    v_add_u32_dpp v33, v33, v33 row_ror:8 row_mask:0xf bank_mask:0xf
    s_nop 1
    v_add_u32_dpp v33, v33, v33 row_ror:4 row_mask:0xf bank_mask:0xf
    s_nop 1
    v_add_u32_dpp v33, v33, v33 row_ror:2 row_mask:0xf bank_mask:0xf
    s_nop 1
    v_add_u32_dpp v33, v33, v33 row_ror:1 row_mask:0xf bank_mask:0xf
    s_nop 0
    v_readlane_b32 s92, v33, 0
    v_readlane_b32 s93, v33, 16
    v_readlane_b32 s94, v33, 32
    v_readlane_b32 s95, v33, 48
    s_lshl_b32 s101, s101, 6
    s_add_u32 s92, s92, s93
    s_add_u32 s94, s94, s95
    s_add_u32 s92, s92, s94
    s_sub_i32 s92, s92, s101
    s_mul_i32 s92, s92, s2
    s_cmp_gt_i32 s92, 192
    s_cselect_b32 s100, 2, 1
    s_cmp_lt_i32 s92, -192
    s_cselect_b32 s100, 0, s100
    s_setpc_b64 s[76:77]
L_tagspin:
    s_mov_b32 s78, 4194304
    v_mov_b32 v33, 0
L_tagspin_top:
    s_sleep 16
    global_load_dword v32, v33, s[62:63] sc1
    s_waitcnt vmcnt(0)
    v_readfirstlane_b32 s97, v32
    s_nop 1
    s_cmp_lg_u32 s97, 0
    s_cbranch_scc1 L_tagspin_done
    s_sub_u32 s78, s78, 1
    s_cbranch_scc0 L_tagspin_top
    s_branch L_exit
L_tagspin_done:
    s_setpc_b64 s[76:77]
L_flagspin:
    s_mov_b32 s78, 4194304
    s_lshr_b32 s93, s65, 1
    s_add_u32 s93, s93, s3
    s_and_b32 s93, s93, 3
    s_mul_i32 s93, s93, 8192
    s_add_u32 s93, s93, 524288
    v_and_b32 v34, 63, v0
    v_mul_u32_u24 v34, 128, v34
L_flagspin_top:
    s_sleep 16
    buffer_load_dword v33, v34, s[36:39], s93 offen sc1
    s_waitcnt vmcnt(0)
    v_xor_b32 v32, s97, v33
    v_and_b32 v32, 0x1ff, v32
    v_cmp_ne_u32 vcc, 0, v32
    s_cbranch_vccz L_flagspin_done
    s_sub_u32 s78, s78, 1
    s_cbranch_scc0 L_flagspin_top
    s_branch L_exit
L_flagspin_done:
    s_setpc_b64 s[76:77]
L_pack48_0:
    v_perm_b32 v34, v49, v48, s85
    v_and_b32 v48, s86, v48
    v_and_b32 v49, s86, v49
    v_and_b32 v32, s88, v34
    v_pk_sub_u16 v34, v48, s90
    v_pk_sub_u16 v35, v49, s90
    v_pk_sub_u16 v48, v48, s91 clamp
    v_pk_sub_u16 v49, v49, s91 clamp
    v_pk_min_u16 v33, v34, v35
    v_perm_b32 v24, v49, v48, s85
    v_perm_b32 v48, v49, v48, s84
    v_perm_b32 v34, v51, v50, s85
    v_and_b32 v50, s86, v50
    v_and_b32 v51, s86, v51
    v_lshrrev_b32 v32, 1, v32
    v_and_or_b32 v32, v34, s88, v32
    v_pk_sub_u16 v34, v50, s90
    v_pk_sub_u16 v35, v51, s90
    v_pk_sub_u16 v50, v50, s91 clamp
    v_pk_sub_u16 v51, v51, s91 clamp
    v_pk_min_u16 v33, v33, v34
    v_pk_min_u16 v33, v33, v35
    v_perm_b32 v25, v51, v50, s85
    v_perm_b32 v49, v51, v50, s84
    v_perm_b32 v34, v53, v52, s85
    v_and_b32 v52, s86, v52
    v_and_b32 v53, s86, v53
    v_lshrrev_b32 v32, 1, v32
    v_and_or_b32 v32, v34, s88, v32
    v_pk_sub_u16 v34, v52, s90
    v_pk_sub_u16 v35, v53, s90
    v_pk_sub_u16 v52, v52, s91 clamp
    v_pk_sub_u16 v53, v53, s91 clamp
    v_pk_min_u16 v33, v33, v34
    v_pk_min_u16 v33, v33, v35
    v_perm_b32 v26, v53, v52, s85
    v_perm_b32 v50, v53, v52, s84
    v_perm_b32 v34, v55, v54, s85
    v_and_b32 v54, s86, v54
    v_and_b32 v55, s86, v55
    v_lshrrev_b32 v32, 1, v32
    v_and_or_b32 v32, v34, s88, v32
    v_pk_sub_u16 v34, v54, s90
    v_pk_sub_u16 v35, v55, s90
    v_pk_sub_u16 v54, v54, s91 clamp
    v_pk_sub_u16 v55, v55, s91 clamp
    v_pk_min_u16 v33, v33, v34
    v_pk_min_u16 v33, v33, v35
    v_perm_b32 v27, v55, v54, s85
    v_perm_b32 v51, v55, v54, s84
    s_setpc_b64 s[76:77]
L_pack48_1:
    v_perm_b32 v34, v57, v56, s85
    v_and_b32 v56, s86, v56
    v_and_b32 v57, s86, v57
    v_lshrrev_b32 v32, 1, v32
    v_and_or_b32 v32, v34, s88, v32
    v_pk_sub_u16 v34, v56, s90
    v_pk_sub_u16 v35, v57, s90
    v_pk_sub_u16 v56, v56, s91 clamp
    v_pk_sub_u16 v57, v57, s91 clamp
    v_pk_min_u16 v33, v33, v34
    v_pk_min_u16 v33, v33, v35
    v_perm_b32 v28, v57, v56, s85
    v_perm_b32 v52, v57, v56, s84
    v_perm_b32 v34, v59, v58, s85
    v_and_b32 v58, s86, v58
    v_and_b32 v59, s86, v59
    v_lshrrev_b32 v32, 1, v32
    v_and_or_b32 v32, v34, s88, v32
    v_pk_sub_u16 v34, v58, s90
    v_pk_sub_u16 v35, v59, s90
    v_pk_sub_u16 v58, v58, s91 clamp
    v_pk_sub_u16 v59, v59, s91 clamp
    v_pk_min_u16 v33, v33, v34
    v_pk_min_u16 v33, v33, v35
    v_perm_b32 v29, v59, v58, s85
    v_perm_b32 v53, v59, v58, s84
    v_perm_b32 v34, v61, v60, s85
    v_and_b32 v60, s86, v60
    v_and_b32 v61, s86, v61
    v_lshrrev_b32 v32, 1, v32
    v_and_or_b32 v32, v34, s88, v32
    v_pk_sub_u16 v34, v60, s90
    v_pk_sub_u16 v35, v61, s90
    v_pk_sub_u16 v60, v60, s91 clamp
    v_pk_sub_u16 v61, v61, s91 clamp
    v_pk_min_u16 v33, v33, v34
    v_pk_min_u16 v33, v33, v35
    v_perm_b32 v30, v61, v60, s85
    v_perm_b32 v54, v61, v60, s84
    v_perm_b32 v34, v63, v62, s85
    v_and_b32 v62, s86, v62
    v_and_b32 v63, s86, v63
    v_lshrrev_b32 v32, 1, v32
    v_and_or_b32 v32, v34, s88, v32
    v_pk_sub_u16 v34, v62, s90
    v_pk_sub_u16 v35, v63, s90
    v_pk_sub_u16 v62, v62, s91 clamp
    v_pk_sub_u16 v63, v63, s91 clamp
    v_pk_min_u16 v33, v33, v34
    v_pk_min_u16 v33, v33, v35
    v_perm_b32 v31, v63, v62, s85
    v_perm_b32 v55, v63, v62, s84
    v_lshl_or_b32 v56, v25, 4, v24
    v_lshl_or_b32 v57, v27, 4, v26
    v_lshl_or_b32 v58, v29, 4, v28
    v_lshl_or_b32 v59, v31, 4, v30
    v_or3_b32 v36, v24, v25, v26
    v_or3_b32 v37, v27, v28, v29
    v_or3_b32 v36, v36, v30, v31
    s_add_u32 s92, s91, 0x007f007f
    v_pk_sub_u16 v33, s92, v33 clamp
    v_or_b32 v36, v36, v37
    v_and_b32 v36, 0x70707070, v36
    v_or_b32 v36, v36, v33
    v_cmp_ne_u32 vcc, 0, v36
    s_setpc_b64 s[76:77]
L_pack64_0:
    v_perm_b32 v34, v65, v64, s85
    v_and_b32 v64, s86, v64
    v_and_b32 v65, s86, v65
    v_and_b32 v32, s88, v34
    v_pk_sub_u16 v34, v64, s90
    v_pk_sub_u16 v35, v65, s90
    v_pk_sub_u16 v64, v64, s91 clamp
    v_pk_sub_u16 v65, v65, s91 clamp
    v_pk_min_u16 v33, v34, v35
    v_perm_b32 v24, v65, v64, s85
    v_perm_b32 v64, v65, v64, s84
    v_perm_b32 v34, v67, v66, s85
    v_and_b32 v66, s86, v66
    v_and_b32 v67, s86, v67
    v_lshrrev_b32 v32, 1, v32
    v_and_or_b32 v32, v34, s88, v32
    v_pk_sub_u16 v34, v66, s90
    v_pk_sub_u16 v35, v67, s90
    v_pk_sub_u16 v66, v66, s91 clamp
    v_pk_sub_u16 v67, v67, s91 clamp
    v_pk_min_u16 v33, v33, v34
    v_pk_min_u16 v33, v33, v35
    v_perm_b32 v25, v67, v66, s85
    v_perm_b32 v65, v67, v66, s84
    v_perm_b32 v34, v69, v68, s85
    v_and_b32 v68, s86, v68
    v_and_b32 v69, s86, v69
    v_lshrrev_b32 v32, 1, v32
    v_and_or_b32 v32, v34, s88, v32
    v_pk_sub_u16 v34, v68, s90
    v_pk_sub_u16 v35, v69, s90
    v_pk_sub_u16 v68, v68, s91 clamp
    v_pk_sub_u16 v69, v69, s91 clamp
    v_pk_min_u16 v33, v33, v34
    v_pk_min_u16 v33, v33, v35
    v_perm_b32 v26, v69, v68, s85
    v_perm_b32 v66, v69, v68, s84
    v_perm_b32 v34, v71, v70, s85
    v_and_b32 v70, s86, v70
    v_and_b32 v71, s86, v71
    v_lshrrev_b32 v32, 1, v32
    v_and_or_b32 v32, v34, s88, v32
    v_pk_sub_u16 v34, v70, s90
    v_pk_sub_u16 v35, v71, s90
    v_pk_sub_u16 v70, v70, s91 clamp
    v_pk_sub_u16 v71, v71, s91 clamp
    v_pk_min_u16 v33, v33, v34
    v_pk_min_u16 v33, v33, v35
    v_perm_b32 v27, v71, v70, s85
    v_perm_b32 v67, v71, v70, s84
    s_setpc_b64 s[76:77]
L_pack64_1:
    v_perm_b32 v34, v73, v72, s85
    v_and_b32 v72, s86, v72
    v_and_b32 v73, s86, v73
    v_lshrrev_b32 v32, 1, v32
    v_and_or_b32 v32, v34, s88, v32
    v_pk_sub_u16 v34, v72, s90
    v_pk_sub_u16 v35, v73, s90
    v_pk_sub_u16 v72, v72, s91 clamp
    v_pk_sub_u16 v73, v73, s91 clamp
    v_pk_min_u16 v33, v33, v34
    v_pk_min_u16 v33, v33, v35
    v_perm_b32 v28, v73, v72, s85
    v_perm_b32 v68, v73, v72, s84
    v_perm_b32 v34, v75, v74, s85
    v_and_b32 v74, s86, v74
    v_and_b32 v75, s86, v75
    v_lshrrev_b32 v32, 1, v32
    v_and_or_b32 v32, v34, s88, v32
    v_pk_sub_u16 v34, v74, s90
    v_pk_sub_u16 v35, v75, s90
    v_pk_sub_u16 v74, v74, s91 clamp
    v_pk_sub_u16 v75, v75, s91 clamp
    v_pk_min_u16 v33, v33, v34
    v_pk_min_u16 v33, v33, v35
    v_perm_b32 v29, v75, v74, s85
    v_perm_b32 v69, v75, v74, s84
    v_perm_b32 v34, v77, v76, s85
    v_and_b32 v76, s86, v76
    v_and_b32 v77, s86, v77
    v_lshrrev_b32 v32, 1, v32
    v_and_or_b32 v32, v34, s88, v32
    v_pk_sub_u16 v34, v76, s90
    v_pk_sub_u16 v35, v77, s90
    v_pk_sub_u16 v76, v76, s91 clamp
    v_pk_sub_u16 v77, v77, s91 clamp
    v_pk_min_u16 v33, v33, v34
    v_pk_min_u16 v33, v33, v35
    v_perm_b32 v30, v77, v76, s85
    v_perm_b32 v70, v77, v76, s84
    v_perm_b32 v34, v79, v78, s85
    v_and_b32 v78, s86, v78
    v_and_b32 v79, s86, v79
    v_lshrrev_b32 v32, 1, v32
    v_and_or_b32 v32, v34, s88, v32
    v_pk_sub_u16 v34, v78, s90
    v_pk_sub_u16 v35, v79, s90
    v_pk_sub_u16 v78, v78, s91 clamp
    v_pk_sub_u16 v79, v79, s91 clamp
    v_pk_min_u16 v33, v33, v34
    v_pk_min_u16 v33, v33, v35
    v_perm_b32 v31, v79, v78, s85
    v_perm_b32 v71, v79, v78, s84
    v_lshl_or_b32 v72, v25, 4, v24
    v_lshl_or_b32 v73, v27, 4, v26
    v_lshl_or_b32 v74, v29, 4, v28
    v_lshl_or_b32 v75, v31, 4, v30
    v_or3_b32 v36, v24, v25, v26
    v_or3_b32 v37, v27, v28, v29
    v_or3_b32 v36, v36, v30, v31
    s_add_u32 s92, s91, 0x007f007f
    v_pk_sub_u16 v33, s92, v33 clamp
    v_or_b32 v36, v36, v37
    v_and_b32 v36, 0x70707070, v36
    v_or_b32 v36, v36, v33
    v_cmp_ne_u32 vcc, 0, v36
    s_setpc_b64 s[76:77]
L_pack80_0:
    v_perm_b32 v34, v81, v80, s85
    v_and_b32 v80, s86, v80
    v_and_b32 v81, s86, v81
    v_and_b32 v32, s88, v34
    v_pk_sub_u16 v34, v80, s90
    v_pk_sub_u16 v35, v81, s90
    v_pk_sub_u16 v80, v80, s91 clamp
    v_pk_sub_u16 v81, v81, s91 clamp
    v_pk_min_u16 v33, v34, v35
    v_perm_b32 v24, v81, v80, s85
    v_perm_b32 v80, v81, v80, s84
    v_perm_b32 v34, v83, v82, s85
    v_and_b32 v82, s86, v82
    v_and_b32 v83, s86, v83
    v_lshrrev_b32 v32, 1, v32
    v_and_or_b32 v32, v34, s88, v32
    v_pk_sub_u16 v34, v82, s90
    v_pk_sub_u16 v35, v83, s90
    v_pk_sub_u16 v82, v82, s91 clamp
    v_pk_sub_u16 v83, v83, s91 clamp
    v_pk_min_u16 v33, v33, v34
    v_pk_min_u16 v33, v33, v35
    v_perm_b32 v25, v83, v82, s85
    v_perm_b32 v81, v83, v82, s84
    v_perm_b32 v34, v85, v84, s85
    v_and_b32 v84, s86, v84
    v_and_b32 v85, s86, v85
    v_lshrrev_b32 v32, 1, v32
    v_and_or_b32 v32, v34, s88, v32
    v_pk_sub_u16 v34, v84, s90
    v_pk_sub_u16 v35, v85, s90
    v_pk_sub_u16 v84, v84, s91 clamp
    v_pk_sub_u16 v85, v85, s91 clamp
    v_pk_min_u16 v33, v33, v34
    v_pk_min_u16 v33, v33, v35
    v_perm_b32 v26, v85, v84, s85
    v_perm_b32 v82, v85, v84, s84
    v_perm_b32 v34, v87, v86, s85
    v_and_b32 v86, s86, v86
    v_and_b32 v87, s86, v87
    v_lshrrev_b32 v32, 1, v32
    v_and_or_b32 v32, v34, s88, v32
    v_pk_sub_u16 v34, v86, s90
    v_pk_sub_u16 v35, v87, s90
    v_pk_sub_u16 v86, v86, s91 clamp
    v_pk_sub_u16 v87, v87, s91 clamp
    v_pk_min_u16 v33, v33, v34
    v_pk_min_u16 v33, v33, v35
    v_perm_b32 v27, v87, v86, s85
    v_perm_b32 v83, v87, v86, s84
    s_setpc_b64 s[76:77]
L_pack80_1:
    v_perm_b32 v34, v89, v88, s85
    v_and_b32 v88, s86, v88
    v_and_b32 v89, s86, v89
    v_lshrrev_b32 v32, 1, v32
    v_and_or_b32 v32, v34, s88, v32
    v_pk_sub_u16 v34, v88, s90
    v_pk_sub_u16 v35, v89, s90
    v_pk_sub_u16 v88, v88, s91 clamp
    v_pk_sub_u16 v89, v89, s91 clamp
    v_pk_min_u16 v33, v33, v34
    v_pk_min_u16 v33, v33, v35
    v_perm_b32 v28, v89, v88, s85
    v_perm_b32 v84, v89, v88, s84
    v_perm_b32 v34, v91, v90, s85
    v_and_b32 v90, s86, v90
    v_and_b32 v91, s86, v91
    v_lshrrev_b32 v32, 1, v32
    v_and_or_b32 v32, v34, s88, v32
    v_pk_sub_u16 v34, v90, s90
    v_pk_sub_u16 v35, v91, s90
    v_pk_sub_u16 v90, v90, s91 clamp
    v_pk_sub_u16 v91, v91, s91 clamp
    v_pk_min_u16 v33, v33, v34
    v_pk_min_u16 v33, v33, v35
    v_perm_b32 v29, v91, v90, s85
    v_perm_b32 v85, v91, v90, s84
    v_perm_b32 v34, v93, v92, s85
    v_and_b32 v92, s86, v92
    v_and_b32 v93, s86, v93
    v_lshrrev_b32 v32, 1, v32
    v_and_or_b32 v32, v34, s88, v32
    v_pk_sub_u16 v34, v92, s90
    v_pk_sub_u16 v35, v93, s90
    v_pk_sub_u16 v92, v92, s91 clamp
    v_pk_sub_u16 v93, v93, s91 clamp
    v_pk_min_u16 v33, v33, v34
    v_pk_min_u16 v33, v33, v35
    v_perm_b32 v30, v93, v92, s85
    v_perm_b32 v86, v93, v92, s84
    v_perm_b32 v34, v95, v94, s85
    v_and_b32 v94, s86, v94
    v_and_b32 v95, s86, v95
    v_lshrrev_b32 v32, 1, v32
    v_and_or_b32 v32, v34, s88, v32
    v_pk_sub_u16 v34, v94, s90
    v_pk_sub_u16 v35, v95, s90
    v_pk_sub_u16 v94, v94, s91 clamp
    v_pk_sub_u16 v95, v95, s91 clamp
    v_pk_min_u16 v33, v33, v34
    v_pk_min_u16 v33, v33, v35
    v_perm_b32 v31, v95, v94, s85
    v_perm_b32 v87, v95, v94, s84
    v_lshl_or_b32 v88, v25, 4, v24
    v_lshl_or_b32 v89, v27, 4, v26
    v_lshl_or_b32 v90, v29, 4, v28
    v_lshl_or_b32 v91, v31, 4, v30
    v_or3_b32 v36, v24, v25, v26
    v_or3_b32 v37, v27, v28, v29
    v_or3_b32 v36, v36, v30, v31
    s_add_u32 s92, s91, 0x007f007f
    v_pk_sub_u16 v33, s92, v33 clamp
    v_or_b32 v36, v36, v37
    v_and_b32 v36, 0x70707070, v36
    v_or_b32 v36, v36, v33
    v_cmp_ne_u32 vcc, 0, v36
    s_setpc_b64 s[76:77]
L_pack96_0:
    v_perm_b32 v34, v97, v96, s85
    v_and_b32 v96, s86, v96
    v_and_b32 v97, s86, v97
    v_and_b32 v32, s88, v34
    v_pk_sub_u16 v34, v96, s90
    v_pk_sub_u16 v35, v97, s90
    v_pk_sub_u16 v96, v96, s91 clamp
    v_pk_sub_u16 v97, v97, s91 clamp
    v_pk_min_u16 v33, v34, v35
    v_perm_b32 v24, v97, v96, s85
    v_perm_b32 v96, v97, v96, s84
    v_perm_b32 v34, v99, v98, s85
    v_and_b32 v98, s86, v98
    v_and_b32 v99, s86, v99
    v_lshrrev_b32 v32, 1, v32
    v_and_or_b32 v32, v34, s88, v32
    v_pk_sub_u16 v34, v98, s90
    v_pk_sub_u16 v35, v99, s90
    v_pk_sub_u16 v98, v98, s91 clamp
    v_pk_sub_u16 v99, v99, s91 clamp
    v_pk_min_u16 v33, v33, v34
    v_pk_min_u16 v33, v33, v35
    v_perm_b32 v25, v99, v98, s85
    v_perm_b32 v97, v99, v98, s84
    v_perm_b32 v34, v101, v100, s85
    v_and_b32 v100, s86, v100
    v_and_b32 v101, s86, v101
    v_lshrrev_b32 v32, 1, v32
    v_and_or_b32 v32, v34, s88, v32
    v_pk_sub_u16 v34, v100, s90
    v_pk_sub_u16 v35, v101, s90
    v_pk_sub_u16 v100, v100, s91 clamp
    v_pk_sub_u16 v101, v101, s91 clamp
    v_pk_min_u16 v33, v33, v34
    v_pk_min_u16 v33, v33, v35
    v_perm_b32 v26, v101, v100, s85
    v_perm_b32 v98, v101, v100, s84
    v_perm_b32 v34, v103, v102, s85
    v_and_b32 v102, s86, v102
    v_and_b32 v103, s86, v103
    v_lshrrev_b32 v32, 1, v32
    v_and_or_b32 v32, v34, s88, v32
    v_pk_sub_u16 v34, v102, s90
    v_pk_sub_u16 v35, v103, s90
    v_pk_sub_u16 v102, v102, s91 clamp
    v_pk_sub_u16 v103, v103, s91 clamp
    v_pk_min_u16 v33, v33, v34
    v_pk_min_u16 v33, v33, v35
    v_perm_b32 v27, v103, v102, s85
    v_perm_b32 v99, v103, v102, s84
    s_setpc_b64 s[76:77]
L_pack96_1:
    v_perm_b32 v34, v105, v104, s85
    v_and_b32 v104, s86, v104
    v_and_b32 v105, s86, v105
    v_lshrrev_b32 v32, 1, v32
    v_and_or_b32 v32, v34, s88, v32
    v_pk_sub_u16 v34, v104, s90
    v_pk_sub_u16 v35, v105, s90
    v_pk_sub_u16 v104, v104, s91 clamp
    v_pk_sub_u16 v105, v105, s91 clamp
    v_pk_min_u16 v33, v33, v34
    v_pk_min_u16 v33, v33, v35
    v_perm_b32 v28, v105, v104, s85
    v_perm_b32 v100, v105, v104, s84
    v_perm_b32 v34, v107, v106, s85
    v_and_b32 v106, s86, v106
    v_and_b32 v107, s86, v107
    v_lshrrev_b32 v32, 1, v32
    v_and_or_b32 v32, v34, s88, v32
    v_pk_sub_u16 v34, v106, s90
    v_pk_sub_u16 v35, v107, s90
    v_pk_sub_u16 v106, v106, s91 clamp
    v_pk_sub_u16 v107, v107, s91 clamp
    v_pk_min_u16 v33, v33, v34
    v_pk_min_u16 v33, v33, v35
    v_perm_b32 v29, v107, v106, s85
    v_perm_b32 v101, v107, v106, s84
    v_perm_b32 v34, v109, v108, s85
    v_and_b32 v108, s86, v108
    v_and_b32 v109, s86, v109
    v_lshrrev_b32 v32, 1, v32
    v_and_or_b32 v32, v34, s88, v32
    v_pk_sub_u16 v34, v108, s90
    v_pk_sub_u16 v35, v109, s90
    v_pk_sub_u16 v108, v108, s91 clamp
    v_pk_sub_u16 v109, v109, s91 clamp
    v_pk_min_u16 v33, v33, v34
    v_pk_min_u16 v33, v33, v35
    v_perm_b32 v30, v109, v108, s85
    v_perm_b32 v102, v109, v108, s84
    v_perm_b32 v34, v111, v110, s85
    v_and_b32 v110, s86, v110
    v_and_b32 v111, s86, v111
    v_lshrrev_b32 v32, 1, v32
    v_and_or_b32 v32, v34, s88, v32
    v_pk_sub_u16 v34, v110, s90
    v_pk_sub_u16 v35, v111, s90
    v_pk_sub_u16 v110, v110, s91 clamp
    v_pk_sub_u16 v111, v111, s91 clamp
    v_pk_min_u16 v33, v33, v34
    v_pk_min_u16 v33, v33, v35
    v_perm_b32 v31, v111, v110, s85
    v_perm_b32 v103, v111, v110, s84
    v_lshl_or_b32 v104, v25, 4, v24
    v_lshl_or_b32 v105, v27, 4, v26
    v_lshl_or_b32 v106, v29, 4, v28
    v_lshl_or_b32 v107, v31, 4, v30
    v_or3_b32 v36, v24, v25, v26
    v_or3_b32 v37, v27, v28, v29
    v_or3_b32 v36, v36, v30, v31
    s_add_u32 s92, s91, 0x007f007f
    v_pk_sub_u16 v33, s92, v33 clamp
    v_or_b32 v36, v36, v37
    v_and_b32 v36, 0x70707070, v36
    v_or_b32 v36, v36, v33
    v_cmp_ne_u32 vcc, 0, v36
    s_setpc_b64 s[76:77]
L_pack112_0:
    v_perm_b32 v34, v113, v112, s85
    v_and_b32 v112, s86, v112
    v_and_b32 v113, s86, v113
    v_and_b32 v32, s88, v34
    v_pk_sub_u16 v34, v112, s90
    v_pk_sub_u16 v35, v113, s90
    v_pk_sub_u16 v112, v112, s91 clamp
    v_pk_sub_u16 v113, v113, s91 clamp
    v_pk_min_u16 v33, v34, v35
    v_perm_b32 v24, v113, v112, s85
    v_perm_b32 v112, v113, v112, s84
    v_perm_b32 v34, v115, v114, s85
    v_and_b32 v114, s86, v114
    v_and_b32 v115, s86, v115
    v_lshrrev_b32 v32, 1, v32
    v_and_or_b32 v32, v34, s88, v32
    v_pk_sub_u16 v34, v114, s90
    v_pk_sub_u16 v35, v115, s90
    v_pk_sub_u16 v114, v114, s91 clamp
    v_pk_sub_u16 v115, v115, s91 clamp
    v_pk_min_u16 v33, v33, v34
    v_pk_min_u16 v33, v33, v35
    v_perm_b32 v25, v115, v114, s85
    v_perm_b32 v113, v115, v114, s84
    v_perm_b32 v34, v117, v116, s85
    v_and_b32 v116, s86, v116
    v_and_b32 v117, s86, v117
    v_lshrrev_b32 v32, 1, v32
    v_and_or_b32 v32, v34, s88, v32
    v_pk_sub_u16 v34, v116, s90
    v_pk_sub_u16 v35, v117, s90
    v_pk_sub_u16 v116, v116, s91 clamp
    v_pk_sub_u16 v117, v117, s91 clamp
    v_pk_min_u16 v33, v33, v34
    v_pk_min_u16 v33, v33, v35
    v_perm_b32 v26, v117, v116, s85
    v_perm_b32 v114, v117, v116, s84
    v_perm_b32 v34, v119, v118, s85
    v_and_b32 v118, s86, v118
    v_and_b32 v119, s86, v119
    v_lshrrev_b32 v32, 1, v32
    v_and_or_b32 v32, v34, s88, v32
    v_pk_sub_u16 v34, v118, s90
    v_pk_sub_u16 v35, v119, s90
    v_pk_sub_u16 v118, v118, s91 clamp
    v_pk_sub_u16 v119, v119, s91 clamp
    v_pk_min_u16 v33, v33, v34
    v_pk_min_u16 v33, v33, v35
    v_perm_b32 v27, v119, v118, s85
    v_perm_b32 v115, v119, v118, s84
    s_setpc_b64 s[76:77]
L_pack112_1:
    v_perm_b32 v34, v121, v120, s85
    v_and_b32 v120, s86, v120
    v_and_b32 v121, s86, v121
    v_lshrrev_b32 v32, 1, v32
    v_and_or_b32 v32, v34, s88, v32
    v_pk_sub_u16 v34, v120, s90
    v_pk_sub_u16 v35, v121, s90
    v_pk_sub_u16 v120, v120, s91 clamp
    v_pk_sub_u16 v121, v121, s91 clamp
    v_pk_min_u16 v33, v33, v34
    v_pk_min_u16 v33, v33, v35
    v_perm_b32 v28, v121, v120, s85
    v_perm_b32 v116, v121, v120, s84
    v_perm_b32 v34, v123, v122, s85
    v_and_b32 v122, s86, v122
    v_and_b32 v123, s86, v123
    v_lshrrev_b32 v32, 1, v32
    v_and_or_b32 v32, v34, s88, v32
    v_pk_sub_u16 v34, v122, s90
    v_pk_sub_u16 v35, v123, s90
    v_pk_sub_u16 v122, v122, s91 clamp
    v_pk_sub_u16 v123, v123, s91 clamp
    v_pk_min_u16 v33, v33, v34
    v_pk_min_u16 v33, v33, v35
    v_perm_b32 v29, v123, v122, s85
    v_perm_b32 v117, v123, v122, s84
    v_perm_b32 v34, v125, v124, s85
    v_and_b32 v124, s86, v124
    v_and_b32 v125, s86, v125
    v_lshrrev_b32 v32, 1, v32
    v_and_or_b32 v32, v34, s88, v32
    v_pk_sub_u16 v34, v124, s90
    v_pk_sub_u16 v35, v125, s90
    v_pk_sub_u16 v124, v124, s91 clamp
    v_pk_sub_u16 v125, v125, s91 clamp
    v_pk_min_u16 v33, v33, v34
    v_pk_min_u16 v33, v33, v35
    v_perm_b32 v30, v125, v124, s85
    v_perm_b32 v118, v125, v124, s84
    v_perm_b32 v34, v127, v126, s85
    v_and_b32 v126, s86, v126
    v_and_b32 v127, s86, v127
    v_lshrrev_b32 v32, 1, v32
    v_and_or_b32 v32, v34, s88, v32
    v_pk_sub_u16 v34, v126, s90
    v_pk_sub_u16 v35, v127, s90
    v_pk_sub_u16 v126, v126, s91 clamp
    v_pk_sub_u16 v127, v127, s91 clamp
    v_pk_min_u16 v33, v33, v34
    v_pk_min_u16 v33, v33, v35
    v_perm_b32 v31, v127, v126, s85
    v_perm_b32 v119, v127, v126, s84
    v_lshl_or_b32 v120, v25, 4, v24
    v_lshl_or_b32 v121, v27, 4, v26
    v_lshl_or_b32 v122, v29, 4, v28
    v_lshl_or_b32 v123, v31, 4, v30
    v_or3_b32 v36, v24, v25, v26
    v_or3_b32 v37, v27, v28, v29
    v_or3_b32 v36, v36, v30, v31
    s_add_u32 s92, s91, 0x007f007f
    v_pk_sub_u16 v33, s92, v33 clamp
    v_or_b32 v36, v36, v37
    v_and_b32 v36, 0x70707070, v36
    v_or_b32 v36, v36, v33
    v_cmp_ne_u32 vcc, 0, v36
    s_setpc_b64 s[76:77]
L_pack128_0:
    v_perm_b32 v34, v129, v128, s85
    v_and_b32 v128, s86, v128
    v_and_b32 v129, s86, v129
    v_and_b32 v32, s88, v34
    v_pk_sub_u16 v34, v128, s90
    v_pk_sub_u16 v35, v129, s90
    v_pk_sub_u16 v128, v128, s91 clamp
    v_pk_sub_u16 v129, v129, s91 clamp
    v_pk_min_u16 v33, v34, v35
    v_perm_b32 v24, v129, v128, s85
    v_perm_b32 v128, v129, v128, s84
    v_perm_b32 v34, v131, v130, s85
    v_and_b32 v130, s86, v130
    v_and_b32 v131, s86, v131
    v_lshrrev_b32 v32, 1, v32
    v_and_or_b32 v32, v34, s88, v32
    v_pk_sub_u16 v34, v130, s90
    v_pk_sub_u16 v35, v131, s90
    v_pk_sub_u16 v130, v130, s91 clamp
    v_pk_sub_u16 v131, v131, s91 clamp
    v_pk_min_u16 v33, v33, v34
    v_pk_min_u16 v33, v33, v35
    v_perm_b32 v25, v131, v130, s85
    v_perm_b32 v129, v131, v130, s84
    v_perm_b32 v34, v133, v132, s85
    v_and_b32 v132, s86, v132
    v_and_b32 v133, s86, v133
    v_lshrrev_b32 v32, 1, v32
    v_and_or_b32 v32, v34, s88, v32
    v_pk_sub_u16 v34, v132, s90
    v_pk_sub_u16 v35, v133, s90
    v_pk_sub_u16 v132, v132, s91 clamp
    v_pk_sub_u16 v133, v133, s91 clamp
    v_pk_min_u16 v33, v33, v34
    v_pk_min_u16 v33, v33, v35
    v_perm_b32 v26, v133, v132, s85
    v_perm_b32 v130, v133, v132, s84
    v_perm_b32 v34, v135, v134, s85
    v_and_b32 v134, s86, v134
    v_and_b32 v135, s86, v135
    v_lshrrev_b32 v32, 1, v32
    v_and_or_b32 v32, v34, s88, v32
    v_pk_sub_u16 v34, v134, s90
    v_pk_sub_u16 v35, v135, s90
    v_pk_sub_u16 v134, v134, s91 clamp
    v_pk_sub_u16 v135, v135, s91 clamp
    v_pk_min_u16 v33, v33, v34
    v_pk_min_u16 v33, v33, v35
    v_perm_b32 v27, v135, v134, s85
    v_perm_b32 v131, v135, v134, s84
    s_setpc_b64 s[76:77]
L_pack128_1:
    v_perm_b32 v34, v137, v136, s85
    v_and_b32 v136, s86, v136
    v_and_b32 v137, s86, v137
    v_lshrrev_b32 v32, 1, v32
    v_and_or_b32 v32, v34, s88, v32
    v_pk_sub_u16 v34, v136, s90
    v_pk_sub_u16 v35, v137, s90
    v_pk_sub_u16 v136, v136, s91 clamp
    v_pk_sub_u16 v137, v137, s91 clamp
    v_pk_min_u16 v33, v33, v34
    v_pk_min_u16 v33, v33, v35
    v_perm_b32 v28, v137, v136, s85
    v_perm_b32 v132, v137, v136, s84
    v_perm_b32 v34, v139, v138, s85
    v_and_b32 v138, s86, v138
    v_and_b32 v139, s86, v139
    v_lshrrev_b32 v32, 1, v32
    v_and_or_b32 v32, v34, s88, v32
    v_pk_sub_u16 v34, v138, s90
    v_pk_sub_u16 v35, v139, s90
    v_pk_sub_u16 v138, v138, s91 clamp
    v_pk_sub_u16 v139, v139, s91 clamp
    v_pk_min_u16 v33, v33, v34
    v_pk_min_u16 v33, v33, v35
    v_perm_b32 v29, v139, v138, s85
    v_perm_b32 v133, v139, v138, s84
    v_perm_b32 v34, v141, v140, s85
    v_and_b32 v140, s86, v140
    v_and_b32 v141, s86, v141
    v_lshrrev_b32 v32, 1, v32
    v_and_or_b32 v32, v34, s88, v32
    v_pk_sub_u16 v34, v140, s90
    v_pk_sub_u16 v35, v141, s90
    v_pk_sub_u16 v140, v140, s91 clamp
    v_pk_sub_u16 v141, v141, s91 clamp
    v_pk_min_u16 v33, v33, v34
    v_pk_min_u16 v33, v33, v35
    v_perm_b32 v30, v141, v140, s85
    v_perm_b32 v134, v141, v140, s84
    v_perm_b32 v34, v143, v142, s85
    v_and_b32 v142, s86, v142
    v_and_b32 v143, s86, v143
    v_lshrrev_b32 v32, 1, v32
    v_and_or_b32 v32, v34, s88, v32
    v_pk_sub_u16 v34, v142, s90
    v_pk_sub_u16 v35, v143, s90
    v_pk_sub_u16 v142, v142, s91 clamp
    v_pk_sub_u16 v143, v143, s91 clamp
    v_pk_min_u16 v33, v33, v34
    v_pk_min_u16 v33, v33, v35
    v_perm_b32 v31, v143, v142, s85
    v_perm_b32 v135, v143, v142, s84
    v_lshl_or_b32 v136, v25, 4, v24
    v_lshl_or_b32 v137, v27, 4, v26
    v_lshl_or_b32 v138, v29, 4, v28
    v_lshl_or_b32 v139, v31, 4, v30
    v_or3_b32 v36, v24, v25, v26
    v_or3_b32 v37, v27, v28, v29
    v_or3_b32 v36, v36, v30, v31
    s_add_u32 s92, s91, 0x007f007f
    v_pk_sub_u16 v33, s92, v33 clamp
    v_or_b32 v36, v36, v37
    v_and_b32 v36, 0x70707070, v36
    v_or_b32 v36, v36, v33
    v_cmp_ne_u32 vcc, 0, v36
    s_setpc_b64 s[76:77]
L_unpack32:
    v_lshrrev_b32 v25, 4, v32
    v_and_b32 v24, s89, v32
    v_and_b32 v25, s89, v25
    v_lshrrev_b32 v27, 4, v33
    v_and_b32 v26, s89, v33
    v_and_b32 v27, s89, v27
    v_lshrrev_b32 v29, 4, v34
    v_and_b32 v28, s89, v34
    v_and_b32 v29, s89, v29
    v_lshrrev_b32 v31, 4, v35
    v_and_b32 v30, s89, v35
    v_and_b32 v31, s89, v31
    v_and_or_b32 v31, v36, s88, v31
    v_lshlrev_b32 v36, 1, v36
    v_and_or_b32 v30, v36, s88, v30
    v_lshlrev_b32 v36, 1, v36
    v_and_or_b32 v29, v36, s88, v29
    v_lshlrev_b32 v36, 1, v36
    v_and_or_b32 v28, v36, s88, v28
    v_lshlrev_b32 v36, 1, v36
    v_and_or_b32 v27, v36, s88, v27
    v_lshlrev_b32 v36, 1, v36
    v_and_or_b32 v26, v36, s88, v26
    v_lshlrev_b32 v36, 1, v36
    v_and_or_b32 v25, v36, s88, v25
    v_lshlrev_b32 v36, 1, v36
    v_and_or_b32 v24, v36, s88, v24
    v_perm_b32 v32, v24, v40, s86
    v_perm_b32 v33, v24, v40, s87
    v_perm_b32 v34, v25, v41, s86
    v_perm_b32 v35, v25, v41, s87
    v_perm_b32 v36, v26, v42, s86
    v_perm_b32 v37, v26, v42, s87
    v_perm_b32 v38, v27, v43, s86
    v_perm_b32 v39, v27, v43, s87
    v_perm_b32 v40, v28, v44, s86
    v_perm_b32 v41, v28, v44, s87
    v_perm_b32 v42, v29, v45, s86
    v_perm_b32 v43, v29, v45, s87
    v_perm_b32 v44, v30, v46, s86
    v_perm_b32 v45, v30, v46, s87
    v_perm_b32 v46, v31, v47, s86
    v_perm_b32 v47, v31, v47, s87
    s_setpc_b64 s[76:77]
L_unpack144:
    v_lshrrev_b32 v25, 4, v144
    v_and_b32 v24, s89, v144
    v_and_b32 v25, s89, v25
    v_lshrrev_b32 v27, 4, v145
    v_and_b32 v26, s89, v145
    v_and_b32 v27, s89, v27
    v_lshrrev_b32 v29, 4, v146
    v_and_b32 v28, s89, v146
    v_and_b32 v29, s89, v29
    v_lshrrev_b32 v31, 4, v147
    v_and_b32 v30, s89, v147
    v_and_b32 v31, s89, v31
    v_and_or_b32 v31, v148, s88, v31
    v_lshlrev_b32 v148, 1, v148
    v_and_or_b32 v30, v148, s88, v30
    v_lshlrev_b32 v148, 1, v148
    v_and_or_b32 v29, v148, s88, v29
    v_lshlrev_b32 v148, 1, v148
    v_and_or_b32 v28, v148, s88, v28
    v_lshlrev_b32 v148, 1, v148
    v_and_or_b32 v27, v148, s88, v27
    v_lshlrev_b32 v148, 1, v148
    v_and_or_b32 v26, v148, s88, v26
    v_lshlrev_b32 v148, 1, v148
    v_and_or_b32 v25, v148, s88, v25
    v_lshlrev_b32 v148, 1, v148
    v_and_or_b32 v24, v148, s88, v24
    v_perm_b32 v144, v24, v152, s86
    v_perm_b32 v145, v24, v152, s87
    v_perm_b32 v146, v25, v153, s86
    v_perm_b32 v147, v25, v153, s87
    v_perm_b32 v148, v26, v154, s86
    v_perm_b32 v149, v26, v154, s87
    v_perm_b32 v150, v27, v155, s86
    v_perm_b32 v151, v27, v155, s87
    v_perm_b32 v152, v28, v156, s86
    v_perm_b32 v153, v28, v156, s87
    v_perm_b32 v154, v29, v157, s86
    v_perm_b32 v155, v29, v157, s87
    v_perm_b32 v156, v30, v158, s86
    v_perm_b32 v157, v30, v158, s87
    v_perm_b32 v158, v31, v159, s86
    v_perm_b32 v159, v31, v159, s87
    s_setpc_b64 s[76:77]
L_score0:
    s_nop 5
    v_add_f32_dpp v32, v25, v24 quad_perm:[1,0,3,2] row_mask:0xf bank_mask:0xf
    v_add_f32_dpp v33, v27, v26 quad_perm:[1,0,3,2] row_mask:0xf bank_mask:0xf
    v_add_f32_dpp v34, v29, v28 quad_perm:[1,0,3,2] row_mask:0xf bank_mask:0xf
    v_add_f32_dpp v35, v31, v30 quad_perm:[1,0,3,2] row_mask:0xf bank_mask:0xf
    v_max3_f32 v36, v32, v33, v34
    v_max_f32 v36, v36, v35
    v_mul_f32 v36, s69, v36
    v_cmp_gt_f32 vcc, v36, v13
L_soft0:
    s_nop 1
    s_and_b64 vcc, vcc, s[98:99]
    s_cbranch_scc0 L_nr_510
    v_mov_b32_dpp v36, v36 quad_perm:[0,0,2,2] row_mask:0xf bank_mask:0xf
    v_mov_b32 v37, v36
    s_nop 1
    v_permlane32_swap_b32 v36, v37
    v_max_f32 v36, v36, v37
    v_mov_b32 v37, v36
    s_nop 1
    v_permlane16_swap_b32 v36, v37
    v_max_f32 v36, v36, v37
    v_max_f32 v36, v36, v13
    v_sub_f32 v37, v13, v36
    v_exp_f32 v37, v37
    v_mov_b32 v13, v36
    v_mul_f32 v8, v8, v37
    v_mul_f32 v10, v10, v37
    v_mul_f32 v12, v12, v37
L_nr_510:
L_exp0:
    v_fma_f32 v32, v32, s69, -v13
    v_fma_f32 v33, v33, s69, -v13
    v_fma_f32 v34, v34, s69, -v13
    v_fma_f32 v35, v35, s69, -v13
    v_exp_f32 v32, v32
    v_exp_f32 v33, v33
    v_exp_f32 v34, v34
    v_exp_f32 v35, v35
    v_add_f32 v36, v32, v33
    v_add_f32 v40, v34, v35
    v_cvt_pk_bf16_f32 v32, v32, v32
    v_cvt_pk_bf16_f32 v33, v33, v33
    v_cvt_pk_bf16_f32 v34, v34, v34
    v_cvt_pk_bf16_f32 v35, v35, v35
    v_add_f32 v36, v36, v40
    v_add_f32 v12, v12, v36
    v_and_b32 v36, v32, v4
    v_and_b32 v37, v32, v5
    v_and_b32 v38, v32, v6
    v_and_b32 v39, v32, v7
    v_and_b32 v40, v33, v4
    v_and_b32 v41, v33, v5
    v_and_b32 v42, v33, v6
    v_and_b32 v43, v33, v7
    s_setpc_b64 s[76:77]
L_soft1:
    s_and_b64 vcc, vcc, s[98:99]
    s_cbranch_scc0 L_nr_511
    v_mov_b32_dpp v36, v36 quad_perm:[0,0,2,2] row_mask:0xf bank_mask:0xf
    v_mov_b32 v37, v36
    s_nop 1
    v_permlane32_swap_b32 v36, v37
    v_max_f32 v36, v36, v37
    v_mov_b32 v37, v36
    s_nop 1
    v_permlane16_swap_b32 v36, v37
    v_max_f32 v36, v36, v37
    v_max_f32 v36, v36, v13
    v_sub_f32 v37, v13, v36
    v_exp_f32 v37, v37
    v_mov_b32 v13, v36
    v_mul_f32 v8, v8, v37
    v_mul_f32 v10, v10, v37
    v_mul_f32 v12, v12, v37
L_nr_511:
L_exp1:
    v_fma_f32 v32, v32, s91, -v13
    v_fma_f32 v33, v33, s91, -v13
    v_fma_f32 v34, v34, s91, -v13
    v_fma_f32 v35, v35, s91, -v13
    v_exp_f32 v32, v32
    v_exp_f32 v33, v33
    v_exp_f32 v34, v34
    v_exp_f32 v35, v35
    v_add_f32 v36, v32, v33
    v_add_f32 v40, v34, v35
    v_mul_f32 v32, s95, v32
    v_mul_f32 v33, s95, v33
    v_mul_f32 v34, s95, v34
    v_mul_f32 v35, s95, v35
    v_cvt_pk_bf16_f32 v32, v32, v32
    v_cvt_pk_bf16_f32 v33, v33, v33
    v_cvt_pk_bf16_f32 v34, v34, v34
    v_cvt_pk_bf16_f32 v35, v35, v35
    v_add_f32 v36, v36, v40
    v_add_f32 v12, v12, v36
    v_and_b32 v36, v32, v4
    v_and_b32 v37, v32, v5
    v_and_b32 v38, v32, v6
    v_and_b32 v39, v32, v7
    v_and_b32 v40, v33, v4
    v_and_b32 v41, v33, v5
    v_and_b32 v42, v33, v6
    v_and_b32 v43, v33, v7
    s_setpc_b64 s[76:77]
L_reload0:
    buffer_load_dwordx4 v[32:35], v1, s[28:31], s92 offen offset:0 nt
    buffer_load_dwordx4 v[36:39], v1, s[28:31], s92 offen offset:128 nt
    buffer_load_dwordx4 v[40:43], v1, s[28:31], s92 offen offset:2048 nt
    buffer_load_dwordx4 v[44:47], v1, s[28:31], s92 offen offset:2176 nt
    s_waitcnt vmcnt(0)
    s_setpc_b64 s[76:77]
L_reload1:
    buffer_load_dwordx4 v[144:147], v2, s[32:35], s92 offen offset:0 nt
    buffer_load_dwordx4 v[148:151], v2, s[32:35], s92 offen offset:256 nt
    buffer_load_dwordx4 v[152:155], v2, s[32:35], s92 offen offset:2048 nt
    buffer_load_dwordx4 v[156:159], v2, s[32:35], s92 offen offset:2304 nt
    s_waitcnt vmcnt(0)
    s_setpc_b64 s[76:77]
.section .rodata,"a"
.p2align 6
.amdhsa_kernel interleave_layers__gqa_block_cached__glu_gated_bilinear__decode_kernel
  .amdhsa_next_free_vgpr 512
  .amdhsa_next_free_sgpr 102
  .amdhsa_accum_offset 256
  .amdhsa_group_segment_fixed_size 0
  .amdhsa_kernarg_size 96
  .amdhsa_user_sgpr_count 2
  .amdhsa_user_sgpr_kernarg_segment_ptr 1
  .amdhsa_system_sgpr_workgroup_id_x 1
  .amdhsa_float_denorm_mode_32 3
.end_amdhsa_kernel
```
